```python
import torch

def _softmax(x, axis=-1):
    return torch.softmax(x, dim=axis)

def _gelu(x):
    return torch.nn.functional.gelu(x, approximate='tanh')

def _silu(x):
    return torch.nn.functional.silu(x)

def _sigmoid(x):
    return torch.sigmoid(x)

def _layernorm(x, axis=-1, eps=1e-05):
    m = x.mean(dim=axis, keepdim=True)
    v = x.var(dim=axis, keepdim=True, unbiased=False)
    return (x - m) / torch.sqrt(v + eps)

def _scatter_add(tgt, idx, src, axis=0):
    return tgt.clone().index_add_(axis, idx, src)

def _segment_sum(src, seg, n):
    out = torch.zeros((n,) + src.shape[1:], dtype=src.dtype)
    return out.index_add_(0, seg, src)

def _pad(x, pw):
    flat = tuple((v for pair in reversed(pw) for v in pair))
    return torch.nn.functional.pad(x, flat)
kernel_name = 'recurrent_scan__memory_aug_recurrent_mem_tr__glu_gated_reglu__prompt'

def setup_inputs():

    _w = lambda a: (lambda t: t.to(torch.bfloat16) if t.is_floating_point() else t)(torch.as_tensor(a))

    def _A_setup():
        B, S, Dm = (1, 2048, 512)
        H, Dh = (32, 128)
        M, seg = (8, 32)
        seg = min(seg, S)
        S = S // seg * seg
        return {'x': _w((lambda *s: torch.randn(*s, dtype=torch.bfloat16) * 0.1)(B, S, Dm)), 'mem0': _w((lambda *s: torch.randn(*s, dtype=torch.bfloat16) * 1.6)(B, M, Dm)), 'Wq': _w((lambda *s: torch.randn(*s, dtype=torch.bfloat16) * 0.8)(Dm, H, Dh) * Dm ** (-0.5)), 'Wk': _w((lambda *s: torch.randn(*s, dtype=torch.bfloat16) * 0.8)(Dm, H, Dh) * Dm ** (-0.5)), 'Wv': _w((lambda *s: torch.randn(*s, dtype=torch.bfloat16) * 1.6)(Dm, H, Dh) * Dm ** (-0.5)), 'Wo': _w((lambda *s: torch.randn(*s, dtype=torch.bfloat16) * 1.6)(H, Dh, Dm) * (H * Dh) ** (-0.5)), 'seg_len': seg}
    _A_in = _A_setup()

    def _B_setup():
        B, S, D, F = (1, 2048, 512, 1376)
        return {'x': _w((lambda *s: torch.randn(*s, dtype=torch.bfloat16) * 0.1)(B, S, D)), 'W_gate': _w((lambda *s: torch.randn(*s, dtype=torch.bfloat16) * 0.4)(D, F) * (2.0 / D) ** 0.5), 'W_up': _w((lambda *s: torch.randn(*s, dtype=torch.bfloat16) * 0.4)(D, F) * (2.0 / D) ** 0.5), 'W_down': _w((lambda *s: torch.randn(*s, dtype=torch.bfloat16) * 0.4)(F, D) * (1.0 / F) ** 0.5)}
    _B_in = _B_setup()
    return {'A_x': _A_in['x'], 'A_mem0': _A_in['mem0'], 'A_Wq': _A_in['Wq'], 'A_Wk': _A_in['Wk'], 'A_Wv': _A_in['Wv'], 'A_Wo': _A_in['Wo'], 'A_seg_len': _A_in['seg_len'], 'B_x': _B_in['x'], 'B_W_gate': _B_in['W_gate'], 'B_W_up': _B_in['W_up'], 'B_W_down': _B_in['W_down']}

def reference(A_x, A_mem0, A_Wq, A_Wk, A_Wv, A_Wo, A_seg_len, B_x, B_W_gate, B_W_up, B_W_down):

    def _A_ref(x, mem0, Wq, Wk, Wv, Wo, seg_len):
        B, S, Dm = x.shape
        H, Dh = (Wq.shape[1], Wq.shape[2])
        M = mem0.shape[1]
        scale = Dh ** (-0.5)
        n_seg = S // seg_len
        L = M + seg_len
        idx = torch.arange(L)
        mask = (idx[:, None] < M) | (idx[:, None] >= idx[None, :])
        mem = mem0
        outs = []
        for s in range(n_seg):
            xs = x[:, s * seg_len:(s + 1) * seg_len, :].clone()
            h = torch.concatenate([mem, xs], axis=1)
            q = torch.einsum('btd,dhe->bhte', h, Wq)
            k = torch.einsum('btd,dhe->bhte', h, Wk)
            v = torch.einsum('btd,dhe->bhte', h, Wv)
            scores = torch.einsum('bhqe,bhke->bhqk', q, k) * scale
            scores = torch.where(mask[None, None], scores, -1000000000.0)
            p = _softmax(scores, axis=-1)
            o = torch.einsum('bhqk,bhke->bhqe', p, v)
            o = torch.einsum('bhte,hed->btd', o, Wo)
            mem = o[:, :M, :].clone()
            outs.append(o[:, M:, :])
        return torch.concatenate(outs, axis=1)

    def _B_ref(x, W_gate, W_up, W_down):
        gate = torch.einsum('bsd,df->bsf', x, W_gate)
        up = torch.einsum('bsd,df->bsf', x, W_up)
        gate = gate * (lambda x, dt: x.to(dt))(gate > 0, gate.dtype)
        h = gate * up
        return torch.einsum('bsf,fd->bsd', h, W_down)
    x = A_x
    xn = _layernorm(x, axis=-1)
    s = _A_ref(xn, A_mem0, A_Wq, A_Wk, A_Wv, A_Wo, A_seg_len)
    g = _silu(_B_ref(xn, B_W_gate, B_W_up, B_W_down))
    return x + s * g
```

```asm
; @launch grid=(256,1,1) block=(256,1,1) lds=163840
.amdgcn_target "amdgcn-amd-amdhsa--gfx950"
.text
.globl recurrent_scan__memory_aug_recurrent_mem_tr__glu_gated_reglu__prompt_kernel
.p2align 8
.type recurrent_scan__memory_aug_recurrent_mem_tr__glu_gated_reglu__prompt_kernel,@function
recurrent_scan__memory_aug_recurrent_mem_tr__glu_gated_reglu__prompt_kernel:
    s_load_dwordx2 s[4:5], s[0:1], 104
    s_load_dwordx2 s[16:17], s[0:1], 96
    s_load_dwordx2 s[84:85], s[0:1], 40
    s_load_dwordx2 s[80:81], s[0:1], 32
    s_load_dwordx2 s[76:77], s[0:1], 16
    s_load_dwordx2 s[88:89], s[0:1], 24
    s_memrealtime s[38:39]
    s_cmp_ge_u32 s2, 256
    s_cbranch_scc1 L_END
    v_lshrrev_b32 v1, 6, v0
    s_nop 0
    v_readfirstlane_b32 s21, v1
    s_mov_b32 s6, 268435456
    s_mov_b32 s7, 0x20000
    s_getreg_b32 s3, hwreg(HW_REG_XCC_ID, 0, 4)
    s_sub_u32 s3, s3, s2
    s_and_b32 s3, s3, 7
    s_mov_b32 s99, s2
    s_mov_b32 s18, 256
    s_mov_b32 s19, 0x20000
    v_mov_b32 v22, 0
    s_waitcnt lgkmcnt(0)
    s_or_b32 s32, s2, s21
    s_cmp_lg_u32 s32, 0
    s_cbranch_scc1 TG_1
    s_and_b32 s39, s39, 0x00ffffff
    s_lshl_b32 s32, s3, 24
    s_or_b32 s39, s39, s32
    s_or_b32 s39, s39, 0x08000000
    v_mov_b32 v20, s38
    v_mov_b32 v21, s39
    buffer_store_dwordx2 v[20:21], v22, s[16:19], 0 offen sc1
TG_1:
L_ROLE:
    s_add_u32 s32, s99, s3
    s_and_b32 s32, s32, 7
    s_lshl_b32 s32, s32, 2
    s_lshr_b32 s32, 0x64530172, s32
    s_and_b32 s32, s32, 7
    s_and_b32 s2, s99, 0xf8
    s_or_b32 s2, s2, s32
    s_lshr_b32 s20, s2, 3
    s_cmp_eq_u32 s32, 0
    s_cbranch_scc1 L_CHAIN
    s_sub_u32 s32, s32, 1
    s_lshl_b32 s32, s32, 5
    s_add_u32 s20, s20, s32
    v_and_b32 v250, 63, v0
    v_lshlrev_b32 v251, 4, v250
    v_mov_b32 v252, 0
    v_min_u32 v253, 1, v250
    v_lshlrev_b32 v253, 31, v253
    s_cmp_ge_u32 s20, 192
    s_cbranch_scc1 WFF_3
    s_cmp_lt_u32 s20, 32
    s_cbranch_scc1 WFF_3
    s_cmp_ge_u32 s20, 128
    s_cbranch_scc1 WQ_2
    s_sub_u32 s23, s20, 32
    s_mul_i32 s22, s23, 171
    s_lshr_b32 s22, s22, 9
    s_mul_i32 s44, s22, 3
    s_sub_u32 s23, s23, s44
    s_mov_b32 s10, 0x400000
    s_mov_b32 s11, 0x20000
    s_cmp_lt_u32 s21, 2
    s_cselect_b32 s8, s88, s80
    s_cselect_b32 s9, s89, s81
    s_and_b32 s44, s21, 1
    s_lshl_b32 s41, s44, 7
    s_lshl_b32 s42, s22, 8
    s_add_u32 s41, s41, s42
    s_lshl_b32 s27, s22, 12
    s_add_u32 s27, s27, 94502912
    s_mov_b32 s25, s23
    s_mul_i32 s40, s21, 24576
    s_add_u32 s40, s40, 65536
    v_lshrrev_b32 v1, 3, v250
    v_lshrrev_b32 v2, 2, v250
    v_and_b32 v2, 4, v2
    v_xor_b32 v2, v2, v250
    v_and_b32 v2, 7, v2
    v_lshlrev_b32 v2, 4, v2
    v_lshl_add_u32 v3, v1, 13, v2
    s_add_u32 m0, s40, 0
    s_add_u32 s35, s41, 0
    buffer_load_dwordx4 v3, s[8:11], s35 offen  lds
    s_add_u32 m0, s40, 1024
    s_add_u32 s35, s41, 65536
    buffer_load_dwordx4 v3, s[8:11], s35 offen  lds
    s_add_u32 m0, s40, 2048
    s_add_u32 s35, s41, 131072
    buffer_load_dwordx4 v3, s[8:11], s35 offen  lds
    s_add_u32 m0, s40, 3072
    s_add_u32 s35, s41, 196608
    buffer_load_dwordx4 v3, s[8:11], s35 offen  lds
    s_add_u32 m0, s40, 4096
    s_add_u32 s35, s41, 262144
    buffer_load_dwordx4 v3, s[8:11], s35 offen  lds
    s_add_u32 m0, s40, 5120
    s_add_u32 s35, s41, 327680
    buffer_load_dwordx4 v3, s[8:11], s35 offen  lds
    s_add_u32 m0, s40, 6144
    s_add_u32 s35, s41, 393216
    buffer_load_dwordx4 v3, s[8:11], s35 offen  lds
    s_add_u32 m0, s40, 7168
    s_add_u32 s35, s41, 458752
    buffer_load_dwordx4 v3, s[8:11], s35 offen  lds
    s_add_u32 m0, s40, 8192
    s_add_u32 s35, s41, 524288
    buffer_load_dwordx4 v3, s[8:11], s35 offen  lds
    s_add_u32 m0, s40, 9216
    s_add_u32 s35, s41, 589824
    buffer_load_dwordx4 v3, s[8:11], s35 offen  lds
    s_add_u32 m0, s40, 10240
    s_add_u32 s35, s41, 655360
    buffer_load_dwordx4 v3, s[8:11], s35 offen  lds
    s_add_u32 m0, s40, 11264
    s_add_u32 s35, s41, 720896
    buffer_load_dwordx4 v3, s[8:11], s35 offen  lds
    s_add_u32 m0, s40, 12288
    s_add_u32 s35, s41, 786432
    buffer_load_dwordx4 v3, s[8:11], s35 offen  lds
    s_add_u32 m0, s40, 13312
    s_add_u32 s35, s41, 851968
    buffer_load_dwordx4 v3, s[8:11], s35 offen  lds
    s_add_u32 m0, s40, 14336
    s_add_u32 s35, s41, 917504
    buffer_load_dwordx4 v3, s[8:11], s35 offen  lds
    s_add_u32 m0, s40, 15360
    s_add_u32 s35, s41, 983040
    buffer_load_dwordx4 v3, s[8:11], s35 offen  lds
    s_add_u32 m0, s40, 16384
    s_add_u32 s35, s41, 1048576
    buffer_load_dwordx4 v3, s[8:11], s35 offen  lds
    s_add_u32 m0, s40, 17408
    s_add_u32 s35, s41, 1114112
    buffer_load_dwordx4 v3, s[8:11], s35 offen  lds
    s_add_u32 m0, s40, 18432
    s_add_u32 s35, s41, 1179648
    buffer_load_dwordx4 v3, s[8:11], s35 offen  lds
    s_add_u32 m0, s40, 19456
    s_add_u32 s35, s41, 1245184
    buffer_load_dwordx4 v3, s[8:11], s35 offen  lds
    s_add_u32 m0, s40, 20480
    s_add_u32 s35, s41, 1310720
    buffer_load_dwordx4 v3, s[8:11], s35 offen  lds
    s_add_u32 m0, s40, 21504
    s_add_u32 s35, s41, 1376256
    buffer_load_dwordx4 v3, s[8:11], s35 offen  lds
    s_add_u32 m0, s40, 22528
    s_add_u32 s35, s41, 1441792
    buffer_load_dwordx4 v3, s[8:11], s35 offen  lds
    s_add_u32 m0, s40, 23552
    s_add_u32 s35, s41, 1507328
    buffer_load_dwordx4 v3, s[8:11], s35 offen  lds
    v_lshrrev_b32 v4, 4, v250
    v_bfe_u32 v5, v250, 2, 2
    v_lshl_add_u32 v4, v4, 3, v5
    v_lshlrev_b32 v4, 7, v4
    v_lshrrev_b32 v5, 1, v5
    v_lshl_add_u32 v4, v5, 6, v4
    v_and_b32 v5, 3, v250
    v_lshl_add_u32 v4, v5, 4, v4
    v_add_u32 v4, s40, v4
    v_xor_b32 v5, 64, v4
    s_mov_b32 s64, 0
    s_lshl_b32 s43, s25, 2
    s_add_u32 s43, s43, s21
    s_lshl_b32 s43, s43, 7
    s_add_u32 s43, s43, 94404608
    s_waitcnt vmcnt(20)
    ds_read_b64_tr_b16 a[0:1], v4 offset:0
    ds_read_b64_tr_b16 a[2:3], v4 offset:512
    ds_read_b64_tr_b16 a[64:65], v4 offset:8
    ds_read_b64_tr_b16 a[66:67], v4 offset:520
    ds_read_b64_tr_b16 a[128:129], v5 offset:0
    ds_read_b64_tr_b16 a[130:131], v5 offset:512
    ds_read_b64_tr_b16 a[192:193], v5 offset:8
    ds_read_b64_tr_b16 a[194:195], v5 offset:520
    s_waitcnt lgkmcnt(0)
    s_add_u32 m0, s40, 0
    s_add_u32 s35, s41, 1572864
    buffer_load_dwordx4 v3, s[8:11], s35 offen  lds
    s_add_u32 m0, s40, 1024
    s_add_u32 s35, s41, 1638400
    buffer_load_dwordx4 v3, s[8:11], s35 offen  lds
    s_add_u32 m0, s40, 2048
    s_add_u32 s35, s41, 1703936
    buffer_load_dwordx4 v3, s[8:11], s35 offen  lds
    s_add_u32 m0, s40, 3072
    s_add_u32 s35, s41, 1769472
    buffer_load_dwordx4 v3, s[8:11], s35 offen  lds
    s_waitcnt vmcnt(20)
    ds_read_b64_tr_b16 a[4:5], v4 offset:4096
    ds_read_b64_tr_b16 a[6:7], v4 offset:4608
    ds_read_b64_tr_b16 a[68:69], v4 offset:4104
    ds_read_b64_tr_b16 a[70:71], v4 offset:4616
    ds_read_b64_tr_b16 a[132:133], v5 offset:4096
    ds_read_b64_tr_b16 a[134:135], v5 offset:4608
    ds_read_b64_tr_b16 a[196:197], v5 offset:4104
    ds_read_b64_tr_b16 a[198:199], v5 offset:4616
    s_waitcnt lgkmcnt(0)
    s_add_u32 m0, s40, 4096
    s_add_u32 s35, s41, 1835008
    buffer_load_dwordx4 v3, s[8:11], s35 offen  lds
    s_add_u32 m0, s40, 5120
    s_add_u32 s35, s41, 1900544
    buffer_load_dwordx4 v3, s[8:11], s35 offen  lds
    s_add_u32 m0, s40, 6144
    s_add_u32 s35, s41, 1966080
    buffer_load_dwordx4 v3, s[8:11], s35 offen  lds
    s_add_u32 m0, s40, 7168
    s_add_u32 s35, s41, 2031616
    buffer_load_dwordx4 v3, s[8:11], s35 offen  lds
    s_waitcnt vmcnt(20)
    ds_read_b64_tr_b16 a[8:9], v4 offset:8192
    ds_read_b64_tr_b16 a[10:11], v4 offset:8704
    ds_read_b64_tr_b16 a[72:73], v4 offset:8200
    ds_read_b64_tr_b16 a[74:75], v4 offset:8712
    ds_read_b64_tr_b16 a[136:137], v5 offset:8192
    ds_read_b64_tr_b16 a[138:139], v5 offset:8704
    ds_read_b64_tr_b16 a[200:201], v5 offset:8200
    ds_read_b64_tr_b16 a[202:203], v5 offset:8712
    s_waitcnt lgkmcnt(0)
    s_add_u32 m0, s40, 8192
    s_add_u32 s35, s41, 2097152
    buffer_load_dwordx4 v3, s[8:11], s35 offen  lds
    s_add_u32 m0, s40, 9216
    s_add_u32 s35, s41, 2162688
    buffer_load_dwordx4 v3, s[8:11], s35 offen  lds
    s_add_u32 m0, s40, 10240
    s_add_u32 s35, s41, 2228224
    buffer_load_dwordx4 v3, s[8:11], s35 offen  lds
    s_add_u32 m0, s40, 11264
    s_add_u32 s35, s41, 2293760
    buffer_load_dwordx4 v3, s[8:11], s35 offen  lds
    s_waitcnt vmcnt(20)
    ds_read_b64_tr_b16 a[12:13], v4 offset:12288
    ds_read_b64_tr_b16 a[14:15], v4 offset:12800
    ds_read_b64_tr_b16 a[76:77], v4 offset:12296
    ds_read_b64_tr_b16 a[78:79], v4 offset:12808
    ds_read_b64_tr_b16 a[140:141], v5 offset:12288
    ds_read_b64_tr_b16 a[142:143], v5 offset:12800
    ds_read_b64_tr_b16 a[204:205], v5 offset:12296
    ds_read_b64_tr_b16 a[206:207], v5 offset:12808
    s_waitcnt lgkmcnt(0)
    s_add_u32 m0, s40, 12288
    s_add_u32 s35, s41, 2359296
    buffer_load_dwordx4 v3, s[8:11], s35 offen  lds
    s_add_u32 m0, s40, 13312
    s_add_u32 s35, s41, 2424832
    buffer_load_dwordx4 v3, s[8:11], s35 offen  lds
    s_add_u32 m0, s40, 14336
    s_add_u32 s35, s41, 2490368
    buffer_load_dwordx4 v3, s[8:11], s35 offen  lds
    s_add_u32 m0, s40, 15360
    s_add_u32 s35, s41, 2555904
    buffer_load_dwordx4 v3, s[8:11], s35 offen  lds
    s_waitcnt vmcnt(20)
    ds_read_b64_tr_b16 a[16:17], v4 offset:16384
    ds_read_b64_tr_b16 a[18:19], v4 offset:16896
    ds_read_b64_tr_b16 a[80:81], v4 offset:16392
    ds_read_b64_tr_b16 a[82:83], v4 offset:16904
    ds_read_b64_tr_b16 a[144:145], v5 offset:16384
    ds_read_b64_tr_b16 a[146:147], v5 offset:16896
    ds_read_b64_tr_b16 a[208:209], v5 offset:16392
    ds_read_b64_tr_b16 a[210:211], v5 offset:16904
    s_waitcnt lgkmcnt(0)
    s_add_u32 m0, s40, 16384
    s_add_u32 s35, s41, 2621440
    buffer_load_dwordx4 v3, s[8:11], s35 offen  lds
    s_add_u32 m0, s40, 17408
    s_add_u32 s35, s41, 2686976
    buffer_load_dwordx4 v3, s[8:11], s35 offen  lds
    s_add_u32 m0, s40, 18432
    s_add_u32 s35, s41, 2752512
    buffer_load_dwordx4 v3, s[8:11], s35 offen  lds
    s_add_u32 m0, s40, 19456
    s_add_u32 s35, s41, 2818048
    buffer_load_dwordx4 v3, s[8:11], s35 offen  lds
    s_waitcnt vmcnt(20)
    ds_read_b64_tr_b16 a[20:21], v4 offset:20480
    ds_read_b64_tr_b16 a[22:23], v4 offset:20992
    ds_read_b64_tr_b16 a[84:85], v4 offset:20488
    ds_read_b64_tr_b16 a[86:87], v4 offset:21000
    ds_read_b64_tr_b16 a[148:149], v5 offset:20480
    ds_read_b64_tr_b16 a[150:151], v5 offset:20992
    ds_read_b64_tr_b16 a[212:213], v5 offset:20488
    ds_read_b64_tr_b16 a[214:215], v5 offset:21000
    s_waitcnt lgkmcnt(0)
    buffer_load_dwordx2 v[254:255], v252, s[16:19], 0 offen sc1
    buffer_load_dwordx2 v[10:11], v252, s[4:7], s43 offen sc1
    s_add_u32 m0, s40, 20480
    s_add_u32 s35, s41, 2883584
    buffer_load_dwordx4 v3, s[8:11], s35 offen  lds
    s_add_u32 m0, s40, 21504
    s_add_u32 s35, s41, 2949120
    buffer_load_dwordx4 v3, s[8:11], s35 offen  lds
    s_add_u32 m0, s40, 22528
    s_add_u32 s35, s41, 3014656
    buffer_load_dwordx4 v3, s[8:11], s35 offen  lds
    s_add_u32 m0, s40, 23552
    s_add_u32 s35, s41, 3080192
    buffer_load_dwordx4 v3, s[8:11], s35 offen  lds
    s_waitcnt vmcnt(22)
    ds_read_b64_tr_b16 a[24:25], v4 offset:0
    ds_read_b64_tr_b16 a[26:27], v4 offset:512
    ds_read_b64_tr_b16 a[88:89], v4 offset:8
    ds_read_b64_tr_b16 a[90:91], v4 offset:520
    ds_read_b64_tr_b16 a[152:153], v5 offset:0
    ds_read_b64_tr_b16 a[154:155], v5 offset:512
    ds_read_b64_tr_b16 a[216:217], v5 offset:8
    ds_read_b64_tr_b16 a[218:219], v5 offset:520
    s_waitcnt lgkmcnt(0)
    s_add_u32 m0, s40, 0
    s_add_u32 s35, s41, 3145728
    buffer_load_dwordx4 v3, s[8:11], s35 offen  lds
    s_add_u32 m0, s40, 1024
    s_add_u32 s35, s41, 3211264
    buffer_load_dwordx4 v3, s[8:11], s35 offen  lds
    s_add_u32 m0, s40, 2048
    s_add_u32 s35, s41, 3276800
    buffer_load_dwordx4 v3, s[8:11], s35 offen  lds
    s_add_u32 m0, s40, 3072
    s_add_u32 s35, s41, 3342336
    buffer_load_dwordx4 v3, s[8:11], s35 offen  lds
    s_waitcnt vmcnt(22)
    ds_read_b64_tr_b16 a[28:29], v4 offset:4096
    ds_read_b64_tr_b16 a[30:31], v4 offset:4608
    ds_read_b64_tr_b16 a[92:93], v4 offset:4104
    ds_read_b64_tr_b16 a[94:95], v4 offset:4616
    ds_read_b64_tr_b16 a[156:157], v5 offset:4096
    ds_read_b64_tr_b16 a[158:159], v5 offset:4608
    ds_read_b64_tr_b16 a[220:221], v5 offset:4104
    ds_read_b64_tr_b16 a[222:223], v5 offset:4616
    s_waitcnt lgkmcnt(0)
    s_add_u32 m0, s40, 4096
    s_add_u32 s35, s41, 3407872
    buffer_load_dwordx4 v3, s[8:11], s35 offen  lds
    s_add_u32 m0, s40, 5120
    s_add_u32 s35, s41, 3473408
    buffer_load_dwordx4 v3, s[8:11], s35 offen  lds
    s_add_u32 m0, s40, 6144
    s_add_u32 s35, s41, 3538944
    buffer_load_dwordx4 v3, s[8:11], s35 offen  lds
    s_add_u32 m0, s40, 7168
    s_add_u32 s35, s41, 3604480
    buffer_load_dwordx4 v3, s[8:11], s35 offen  lds
    s_waitcnt vmcnt(22)
    ds_read_b64_tr_b16 a[32:33], v4 offset:8192
    ds_read_b64_tr_b16 a[34:35], v4 offset:8704
    ds_read_b64_tr_b16 a[96:97], v4 offset:8200
    ds_read_b64_tr_b16 a[98:99], v4 offset:8712
    ds_read_b64_tr_b16 a[160:161], v5 offset:8192
    ds_read_b64_tr_b16 a[162:163], v5 offset:8704
    ds_read_b64_tr_b16 a[224:225], v5 offset:8200
    ds_read_b64_tr_b16 a[226:227], v5 offset:8712
    s_waitcnt lgkmcnt(0)
    s_add_u32 m0, s40, 8192
    s_add_u32 s35, s41, 3670016
    buffer_load_dwordx4 v3, s[8:11], s35 offen  lds
    s_add_u32 m0, s40, 9216
    s_add_u32 s35, s41, 3735552
    buffer_load_dwordx4 v3, s[8:11], s35 offen  lds
    s_add_u32 m0, s40, 10240
    s_add_u32 s35, s41, 3801088
    buffer_load_dwordx4 v3, s[8:11], s35 offen  lds
    s_add_u32 m0, s40, 11264
    s_add_u32 s35, s41, 3866624
    buffer_load_dwordx4 v3, s[8:11], s35 offen  lds
    s_waitcnt vmcnt(22)
    ds_read_b64_tr_b16 a[36:37], v4 offset:12288
    ds_read_b64_tr_b16 a[38:39], v4 offset:12800
    ds_read_b64_tr_b16 a[100:101], v4 offset:12296
    ds_read_b64_tr_b16 a[102:103], v4 offset:12808
    ds_read_b64_tr_b16 a[164:165], v5 offset:12288
    ds_read_b64_tr_b16 a[166:167], v5 offset:12800
    ds_read_b64_tr_b16 a[228:229], v5 offset:12296
    ds_read_b64_tr_b16 a[230:231], v5 offset:12808
    s_waitcnt lgkmcnt(0)
    s_add_u32 m0, s40, 12288
    s_add_u32 s35, s41, 3932160
    buffer_load_dwordx4 v3, s[8:11], s35 offen  lds
    s_add_u32 m0, s40, 13312
    s_add_u32 s35, s41, 3997696
    buffer_load_dwordx4 v3, s[8:11], s35 offen  lds
    s_add_u32 m0, s40, 14336
    s_add_u32 s35, s41, 4063232
    buffer_load_dwordx4 v3, s[8:11], s35 offen  lds
    s_add_u32 m0, s40, 15360
    s_add_u32 s35, s41, 4128768
    buffer_load_dwordx4 v3, s[8:11], s35 offen  lds
    s_waitcnt vmcnt(22)
    ds_read_b64_tr_b16 a[40:41], v4 offset:16384
    ds_read_b64_tr_b16 a[42:43], v4 offset:16896
    ds_read_b64_tr_b16 a[104:105], v4 offset:16392
    ds_read_b64_tr_b16 a[106:107], v4 offset:16904
    ds_read_b64_tr_b16 a[168:169], v5 offset:16384
    ds_read_b64_tr_b16 a[170:171], v5 offset:16896
    ds_read_b64_tr_b16 a[232:233], v5 offset:16392
    ds_read_b64_tr_b16 a[234:235], v5 offset:16904
    s_waitcnt lgkmcnt(0)
    s_waitcnt vmcnt(16)
    ds_read_b64_tr_b16 a[44:45], v4 offset:20480
    ds_read_b64_tr_b16 a[46:47], v4 offset:20992
    ds_read_b64_tr_b16 a[108:109], v4 offset:20488
    ds_read_b64_tr_b16 a[110:111], v4 offset:21000
    ds_read_b64_tr_b16 a[172:173], v5 offset:20480
    ds_read_b64_tr_b16 a[174:175], v5 offset:20992
    ds_read_b64_tr_b16 a[236:237], v5 offset:20488
    ds_read_b64_tr_b16 a[238:239], v5 offset:21000
    s_waitcnt lgkmcnt(0)
    v_cmp_ne_u64 vcc, v[254:255], v[10:11]
    s_cbranch_vccnz EC_4
    v_cmp_eq_u32 vcc, 0, v255
    s_cbranch_vccnz EC_4
    s_lshl_b32 s44, s21, 14
    s_lshl_b32 s45, s25, 16
    s_add_u32 s45, s45, s44
    s_add_u32 m0, s44, 0
    s_add_u32 s35, s45, 0
    buffer_load_dwordx4 v251, s[4:7], s35 offen sc1 lds
    s_add_u32 m0, s44, 1024
    s_add_u32 s35, s45, 1024
    buffer_load_dwordx4 v251, s[4:7], s35 offen sc1 lds
    s_add_u32 m0, s44, 2048
    s_add_u32 s35, s45, 2048
    buffer_load_dwordx4 v251, s[4:7], s35 offen sc1 lds
    s_add_u32 m0, s44, 3072
    s_add_u32 s35, s45, 3072
    buffer_load_dwordx4 v251, s[4:7], s35 offen sc1 lds
    s_add_u32 m0, s44, 4096
    s_add_u32 s35, s45, 4096
    buffer_load_dwordx4 v251, s[4:7], s35 offen sc1 lds
    s_add_u32 m0, s44, 5120
    s_add_u32 s35, s45, 5120
    buffer_load_dwordx4 v251, s[4:7], s35 offen sc1 lds
    s_add_u32 m0, s44, 6144
    s_add_u32 s35, s45, 6144
    buffer_load_dwordx4 v251, s[4:7], s35 offen sc1 lds
    s_add_u32 m0, s44, 7168
    s_add_u32 s35, s45, 7168
    buffer_load_dwordx4 v251, s[4:7], s35 offen sc1 lds
    s_add_u32 m0, s44, 8192
    s_add_u32 s35, s45, 8192
    buffer_load_dwordx4 v251, s[4:7], s35 offen sc1 lds
    s_add_u32 m0, s44, 9216
    s_add_u32 s35, s45, 9216
    buffer_load_dwordx4 v251, s[4:7], s35 offen sc1 lds
    s_add_u32 m0, s44, 10240
    s_add_u32 s35, s45, 10240
    buffer_load_dwordx4 v251, s[4:7], s35 offen sc1 lds
    s_add_u32 m0, s44, 11264
    s_add_u32 s35, s45, 11264
    buffer_load_dwordx4 v251, s[4:7], s35 offen sc1 lds
    s_add_u32 m0, s44, 12288
    s_add_u32 s35, s45, 12288
    buffer_load_dwordx4 v251, s[4:7], s35 offen sc1 lds
    s_add_u32 m0, s44, 13312
    s_add_u32 s35, s45, 13312
    buffer_load_dwordx4 v251, s[4:7], s35 offen sc1 lds
    s_add_u32 m0, s44, 14336
    s_add_u32 s35, s45, 14336
    buffer_load_dwordx4 v251, s[4:7], s35 offen sc1 lds
    s_add_u32 m0, s44, 15360
    s_add_u32 s35, s45, 15360
    buffer_load_dwordx4 v251, s[4:7], s35 offen sc1 lds
    s_mov_b32 s64, 1
EC_4:
    s_waitcnt vmcnt(12)
    ds_read_b64_tr_b16 a[48:49], v4 offset:0
    ds_read_b64_tr_b16 a[50:51], v4 offset:512
    ds_read_b64_tr_b16 a[112:113], v4 offset:8
    ds_read_b64_tr_b16 a[114:115], v4 offset:520
    ds_read_b64_tr_b16 a[176:177], v5 offset:0
    ds_read_b64_tr_b16 a[178:179], v5 offset:512
    ds_read_b64_tr_b16 a[240:241], v5 offset:8
    ds_read_b64_tr_b16 a[242:243], v5 offset:520
    s_waitcnt lgkmcnt(0)
    s_waitcnt vmcnt(8)
    ds_read_b64_tr_b16 a[52:53], v4 offset:4096
    ds_read_b64_tr_b16 a[54:55], v4 offset:4608
    ds_read_b64_tr_b16 a[116:117], v4 offset:4104
    ds_read_b64_tr_b16 a[118:119], v4 offset:4616
    ds_read_b64_tr_b16 a[180:181], v5 offset:4096
    ds_read_b64_tr_b16 a[182:183], v5 offset:4608
    ds_read_b64_tr_b16 a[244:245], v5 offset:4104
    ds_read_b64_tr_b16 a[246:247], v5 offset:4616
    s_waitcnt lgkmcnt(0)
    s_waitcnt vmcnt(4)
    ds_read_b64_tr_b16 a[56:57], v4 offset:8192
    ds_read_b64_tr_b16 a[58:59], v4 offset:8704
    ds_read_b64_tr_b16 a[120:121], v4 offset:8200
    ds_read_b64_tr_b16 a[122:123], v4 offset:8712
    ds_read_b64_tr_b16 a[184:185], v5 offset:8192
    ds_read_b64_tr_b16 a[186:187], v5 offset:8704
    ds_read_b64_tr_b16 a[248:249], v5 offset:8200
    ds_read_b64_tr_b16 a[250:251], v5 offset:8712
    s_waitcnt lgkmcnt(0)
    s_waitcnt vmcnt(0)
    ds_read_b64_tr_b16 a[60:61], v4 offset:12288
    ds_read_b64_tr_b16 a[62:63], v4 offset:12800
    ds_read_b64_tr_b16 a[124:125], v4 offset:12296
    ds_read_b64_tr_b16 a[126:127], v4 offset:12808
    ds_read_b64_tr_b16 a[188:189], v5 offset:12288
    ds_read_b64_tr_b16 a[190:191], v5 offset:12800
    ds_read_b64_tr_b16 a[252:253], v5 offset:12296
    ds_read_b64_tr_b16 a[254:255], v5 offset:12808
    s_waitcnt lgkmcnt(0)
    v_readfirstlane_b32 s38, v254
    v_readfirstlane_b32 s39, v255
    s_mov_b32 s30, 0x400000
    s_nop 1
    s_cmp_lg_u32 s39, 0
    s_cbranch_scc1 HT_5
    s_mov_b32 s30, 1000000
TP_6:
    buffer_load_dwordx2 v[254:255], v252, s[16:19], 0 offen sc1
    s_sub_u32 s30, s30, 1
    s_cbranch_scc1 L_FAIL
    s_waitcnt vmcnt(0)
    v_readfirstlane_b32 s38, v254
    v_readfirstlane_b32 s39, v255
    s_nop 3
    s_cmp_eq_u32 s39, 0
    s_cbranch_scc1 TP_6
    s_mov_b32 s30, 0x400000
HT_5:
    s_bfe_u32 s32, s39, 0x30018
    s_cmp_lg_u32 s32, s3
    s_cbranch_scc1 L_RESTART
    s_mov_b32 s24, 3
    s_and_b32 s42, s21, 1
    s_lshl_b32 s26, s22, 13
    s_lshl_b32 s40, s42, 11
    s_add_u32 s40, s40, 2097152
    s_lshl_b32 s41, s42, 12
    s_add_u32 s41, s41, 18874368
    s_cmp_lt_u32 s21, 2
    s_cselect_b32 s40, s40, s41
    s_add_u32 s26, s26, s40
    v_lshlrev_b32 v9, 7, v250
    s_lshl_b32 s40, s25, 2
    s_add_u32 s40, s40, s21
    s_lshl_b32 s40, s40, 7
    s_add_u32 s40, s40, 94404608
    s_cmp_lg_u32 s64, 0
    s_cbranch_scc1 GS_7
WF_8:
    buffer_load_dwordx2 v[10:11], v252, s[4:7], s40 offen offset:0 sc1
    s_waitcnt vmcnt(0)
    v_cmp_ne_u64 vcc, s[38:39], v[10:11]
    s_cbranch_vccz WK_9
    s_sub_u32 s30, s30, 1
    s_cbranch_scc1 L_FAIL
    s_sleep 8
    s_branch WF_8
WK_9:
    s_lshl_b32 s44, s21, 14
    s_lshl_b32 s45, s25, 16
    s_add_u32 s45, s45, s44
    s_add_u32 m0, s44, 0
    s_add_u32 s35, s45, 0
    buffer_load_dwordx4 v251, s[4:7], s35 offen sc1 lds
    s_add_u32 m0, s44, 1024
    s_add_u32 s35, s45, 1024
    buffer_load_dwordx4 v251, s[4:7], s35 offen sc1 lds
    s_add_u32 m0, s44, 2048
    s_add_u32 s35, s45, 2048
    buffer_load_dwordx4 v251, s[4:7], s35 offen sc1 lds
    s_add_u32 m0, s44, 3072
    s_add_u32 s35, s45, 3072
    buffer_load_dwordx4 v251, s[4:7], s35 offen sc1 lds
    s_add_u32 m0, s44, 4096
    s_add_u32 s35, s45, 4096
    buffer_load_dwordx4 v251, s[4:7], s35 offen sc1 lds
    s_add_u32 m0, s44, 5120
    s_add_u32 s35, s45, 5120
    buffer_load_dwordx4 v251, s[4:7], s35 offen sc1 lds
    s_add_u32 m0, s44, 6144
    s_add_u32 s35, s45, 6144
    buffer_load_dwordx4 v251, s[4:7], s35 offen sc1 lds
    s_add_u32 m0, s44, 7168
    s_add_u32 s35, s45, 7168
    buffer_load_dwordx4 v251, s[4:7], s35 offen sc1 lds
    s_add_u32 m0, s44, 8192
    s_add_u32 s35, s45, 8192
    buffer_load_dwordx4 v251, s[4:7], s35 offen sc1 lds
    s_add_u32 m0, s44, 9216
    s_add_u32 s35, s45, 9216
    buffer_load_dwordx4 v251, s[4:7], s35 offen sc1 lds
    s_add_u32 m0, s44, 10240
    s_add_u32 s35, s45, 10240
    buffer_load_dwordx4 v251, s[4:7], s35 offen sc1 lds
    s_add_u32 m0, s44, 11264
    s_add_u32 s35, s45, 11264
    buffer_load_dwordx4 v251, s[4:7], s35 offen sc1 lds
    s_add_u32 m0, s44, 12288
    s_add_u32 s35, s45, 12288
    buffer_load_dwordx4 v251, s[4:7], s35 offen sc1 lds
    s_add_u32 m0, s44, 13312
    s_add_u32 s35, s45, 13312
    buffer_load_dwordx4 v251, s[4:7], s35 offen sc1 lds
    s_add_u32 m0, s44, 14336
    s_add_u32 s35, s45, 14336
    buffer_load_dwordx4 v251, s[4:7], s35 offen sc1 lds
    s_add_u32 m0, s44, 15360
    s_add_u32 s35, s45, 15360
    buffer_load_dwordx4 v251, s[4:7], s35 offen sc1 lds
    s_mov_b32 s64, 1
GS_7:
    s_mov_b32 s28, -1
    s_mov_b32 s43, -1
    v_mov_b32 v128, v251
    v_add_u32 v129, 0x10000, v251
    v_mov_b32 v130, 0x80000000
    s_mov_b32 s60, 0
    s_mov_b32 s61, 0
    s_mov_b32 s62, 0
    s_mov_b32 s63, 0
    s_lshl_b32 s40, s21, 13
    s_add_u32 s40, s40, 94404608
    s_cmp_ge_u32 s21, 2
    s_cbranch_scc1 GS_10
WF_11:
    buffer_load_dwordx2 v[10:11], v9, s[4:7], s40 offen offset:0 sc1
    s_waitcnt vmcnt(0)
    v_cmp_ne_u64 vcc, s[38:39], v[10:11]
    s_cbranch_vccz WK_12
    s_sub_u32 s30, s30, 1
    s_cbranch_scc1 L_FAIL
    s_sleep 8
    s_branch WF_11
WK_12:
GS_10:
    s_cmp_lt_u32 s21, 2
    s_cbranch_scc1 WT_15
GL_17:
    s_waitcnt vmcnt(0)
    s_barrier
    s_add_u32 s40, s25, s24
    s_min_u32 s41, s40, 31
    s_lshl_b32 s45, s41, 16
    s_add_u32 s45, s45, s44
    ds_read_b128 v[64:67], v128 offset:0
    ds_read_b128 v[68:71], v128 offset:16384
    ds_read_b128 v[72:75], v128 offset:32768
    ds_read_b128 v[76:79], v128 offset:49152
    s_cmp_lt_i32 s43, 0
    s_cbranch_scc1 GF_19
    buffer_store_dwordx2 v[254:255], v253, s[4:7], s43 offen sc1
GF_19:
    s_mov_b32 s43, s28
    s_waitcnt lgkmcnt(0)
    v_mfma_f32_16x16x32_bf16 v[0:3], v[64:67], a[0:3], 0
    ds_read_b128 v[80:83], v128 offset:1024
    v_mfma_f32_16x16x32_bf16 v[4:7], v[68:71], a[0:3], 0
    ds_read_b128 v[84:87], v128 offset:17408
    v_mfma_f32_16x16x32_bf16 v[8:11], v[72:75], a[0:3], 0
    ds_read_b128 v[88:91], v128 offset:33792
    v_mfma_f32_16x16x32_bf16 v[12:15], v[76:79], a[0:3], 0
    ds_read_b128 v[92:95], v128 offset:50176
    v_mfma_f32_16x16x32_bf16 v[16:19], v[64:67], a[64:67], 0
    v_mfma_f32_16x16x32_bf16 v[20:23], v[68:71], a[64:67], 0
    s_add_u32 m0, s44, 65536
    s_add_u32 s35, s45, 0
    buffer_load_dwordx4 v251, s[4:7], s35 offen sc1 lds
    v_mfma_f32_16x16x32_bf16 v[24:27], v[72:75], a[64:67], 0
    v_mfma_f32_16x16x32_bf16 v[28:31], v[76:79], a[64:67], 0
    v_mfma_f32_16x16x32_bf16 v[32:35], v[64:67], a[128:131], 0
    v_mfma_f32_16x16x32_bf16 v[36:39], v[68:71], a[128:131], 0
    buffer_store_dwordx4 v[96:99], v130, s[4:7], s60 offen offset:0 sc1
    v_mfma_f32_16x16x32_bf16 v[40:43], v[72:75], a[128:131], 0
    v_mfma_f32_16x16x32_bf16 v[44:47], v[76:79], a[128:131], 0
    v_mfma_f32_16x16x32_bf16 v[48:51], v[64:67], a[192:195], 0
    v_mfma_f32_16x16x32_bf16 v[52:55], v[68:71], a[192:195], 0
    s_add_u32 m0, s44, 66560
    s_add_u32 s35, s45, 1024
    buffer_load_dwordx4 v251, s[4:7], s35 offen sc1 lds
    v_mfma_f32_16x16x32_bf16 v[56:59], v[72:75], a[192:195], 0
    v_mfma_f32_16x16x32_bf16 v[60:63], v[76:79], a[192:195], 0
    s_waitcnt lgkmcnt(0)
    v_mfma_f32_16x16x32_bf16 v[0:3], v[80:83], a[4:7], v[0:3]
    ds_read_b128 v[64:67], v128 offset:2048
    v_mfma_f32_16x16x32_bf16 v[4:7], v[84:87], a[4:7], v[4:7]
    ds_read_b128 v[68:71], v128 offset:18432
    v_mfma_f32_16x16x32_bf16 v[8:11], v[88:91], a[4:7], v[8:11]
    ds_read_b128 v[72:75], v128 offset:34816
    v_mfma_f32_16x16x32_bf16 v[12:15], v[92:95], a[4:7], v[12:15]
    ds_read_b128 v[76:79], v128 offset:51200
    v_mfma_f32_16x16x32_bf16 v[16:19], v[80:83], a[68:71], v[16:19]
    v_mfma_f32_16x16x32_bf16 v[20:23], v[84:87], a[68:71], v[20:23]
    s_add_u32 m0, s44, 67584
    s_add_u32 s35, s45, 2048
    buffer_load_dwordx4 v251, s[4:7], s35 offen sc1 lds
    v_mfma_f32_16x16x32_bf16 v[24:27], v[88:91], a[68:71], v[24:27]
    v_mfma_f32_16x16x32_bf16 v[28:31], v[92:95], a[68:71], v[28:31]
    v_mfma_f32_16x16x32_bf16 v[32:35], v[80:83], a[132:135], v[32:35]
    v_mfma_f32_16x16x32_bf16 v[36:39], v[84:87], a[132:135], v[36:39]
    buffer_store_dwordx4 v[100:103], v130, s[4:7], s60 offen offset:1024 sc1
    v_mfma_f32_16x16x32_bf16 v[40:43], v[88:91], a[132:135], v[40:43]
    v_mfma_f32_16x16x32_bf16 v[44:47], v[92:95], a[132:135], v[44:47]
    v_mfma_f32_16x16x32_bf16 v[48:51], v[80:83], a[196:199], v[48:51]
    v_mfma_f32_16x16x32_bf16 v[52:55], v[84:87], a[196:199], v[52:55]
    s_add_u32 m0, s44, 68608
    s_add_u32 s35, s45, 3072
    buffer_load_dwordx4 v251, s[4:7], s35 offen sc1 lds
    v_mfma_f32_16x16x32_bf16 v[56:59], v[88:91], a[196:199], v[56:59]
    v_mfma_f32_16x16x32_bf16 v[60:63], v[92:95], a[196:199], v[60:63]
    s_waitcnt lgkmcnt(0)
    v_mfma_f32_16x16x32_bf16 v[0:3], v[64:67], a[8:11], v[0:3]
    ds_read_b128 v[80:83], v128 offset:3072
    v_mfma_f32_16x16x32_bf16 v[4:7], v[68:71], a[8:11], v[4:7]
    ds_read_b128 v[84:87], v128 offset:19456
    v_mfma_f32_16x16x32_bf16 v[8:11], v[72:75], a[8:11], v[8:11]
    ds_read_b128 v[88:91], v128 offset:35840
    v_mfma_f32_16x16x32_bf16 v[12:15], v[76:79], a[8:11], v[12:15]
    ds_read_b128 v[92:95], v128 offset:52224
    v_mfma_f32_16x16x32_bf16 v[16:19], v[64:67], a[72:75], v[16:19]
    v_mfma_f32_16x16x32_bf16 v[20:23], v[68:71], a[72:75], v[20:23]
    s_add_u32 m0, s44, 69632
    s_add_u32 s35, s45, 4096
    buffer_load_dwordx4 v251, s[4:7], s35 offen sc1 lds
    v_mfma_f32_16x16x32_bf16 v[24:27], v[72:75], a[72:75], v[24:27]
    v_mfma_f32_16x16x32_bf16 v[28:31], v[76:79], a[72:75], v[28:31]
    v_mfma_f32_16x16x32_bf16 v[32:35], v[64:67], a[136:139], v[32:35]
    v_mfma_f32_16x16x32_bf16 v[36:39], v[68:71], a[136:139], v[36:39]
    buffer_store_dwordx4 v[104:107], v130, s[4:7], s60 offen offset:2048 sc1
    v_mfma_f32_16x16x32_bf16 v[40:43], v[72:75], a[136:139], v[40:43]
    v_mfma_f32_16x16x32_bf16 v[44:47], v[76:79], a[136:139], v[44:47]
    v_mfma_f32_16x16x32_bf16 v[48:51], v[64:67], a[200:203], v[48:51]
    v_mfma_f32_16x16x32_bf16 v[52:55], v[68:71], a[200:203], v[52:55]
    s_add_u32 m0, s44, 70656
    s_add_u32 s35, s45, 5120
    buffer_load_dwordx4 v251, s[4:7], s35 offen sc1 lds
    v_mfma_f32_16x16x32_bf16 v[56:59], v[72:75], a[200:203], v[56:59]
    v_mfma_f32_16x16x32_bf16 v[60:63], v[76:79], a[200:203], v[60:63]
    s_waitcnt lgkmcnt(0)
    v_mfma_f32_16x16x32_bf16 v[0:3], v[80:83], a[12:15], v[0:3]
    ds_read_b128 v[64:67], v128 offset:4096
    v_mfma_f32_16x16x32_bf16 v[4:7], v[84:87], a[12:15], v[4:7]
    ds_read_b128 v[68:71], v128 offset:20480
    v_mfma_f32_16x16x32_bf16 v[8:11], v[88:91], a[12:15], v[8:11]
    ds_read_b128 v[72:75], v128 offset:36864
    v_mfma_f32_16x16x32_bf16 v[12:15], v[92:95], a[12:15], v[12:15]
    ds_read_b128 v[76:79], v128 offset:53248
    v_mfma_f32_16x16x32_bf16 v[16:19], v[80:83], a[76:79], v[16:19]
    v_mfma_f32_16x16x32_bf16 v[20:23], v[84:87], a[76:79], v[20:23]
    s_add_u32 m0, s44, 71680
    s_add_u32 s35, s45, 6144
    buffer_load_dwordx4 v251, s[4:7], s35 offen sc1 lds
    v_mfma_f32_16x16x32_bf16 v[24:27], v[88:91], a[76:79], v[24:27]
    v_mfma_f32_16x16x32_bf16 v[28:31], v[92:95], a[76:79], v[28:31]
    v_mfma_f32_16x16x32_bf16 v[32:35], v[80:83], a[140:143], v[32:35]
    v_mfma_f32_16x16x32_bf16 v[36:39], v[84:87], a[140:143], v[36:39]
    buffer_store_dwordx4 v[108:111], v130, s[4:7], s60 offen offset:3072 sc1
    v_mfma_f32_16x16x32_bf16 v[40:43], v[88:91], a[140:143], v[40:43]
    v_mfma_f32_16x16x32_bf16 v[44:47], v[92:95], a[140:143], v[44:47]
    v_mfma_f32_16x16x32_bf16 v[48:51], v[80:83], a[204:207], v[48:51]
    v_mfma_f32_16x16x32_bf16 v[52:55], v[84:87], a[204:207], v[52:55]
    s_add_u32 m0, s44, 72704
    s_add_u32 s35, s45, 7168
    buffer_load_dwordx4 v251, s[4:7], s35 offen sc1 lds
    v_mfma_f32_16x16x32_bf16 v[56:59], v[88:91], a[204:207], v[56:59]
    v_mfma_f32_16x16x32_bf16 v[60:63], v[92:95], a[204:207], v[60:63]
    s_waitcnt lgkmcnt(0)
    v_mfma_f32_16x16x32_bf16 v[0:3], v[64:67], a[16:19], v[0:3]
    ds_read_b128 v[80:83], v128 offset:5120
    v_mfma_f32_16x16x32_bf16 v[4:7], v[68:71], a[16:19], v[4:7]
    ds_read_b128 v[84:87], v128 offset:21504
    v_mfma_f32_16x16x32_bf16 v[8:11], v[72:75], a[16:19], v[8:11]
    ds_read_b128 v[88:91], v128 offset:37888
    v_mfma_f32_16x16x32_bf16 v[12:15], v[76:79], a[16:19], v[12:15]
    ds_read_b128 v[92:95], v128 offset:54272
    v_mfma_f32_16x16x32_bf16 v[16:19], v[64:67], a[80:83], v[16:19]
    v_mfma_f32_16x16x32_bf16 v[20:23], v[68:71], a[80:83], v[20:23]
    s_add_u32 m0, s44, 73728
    s_add_u32 s35, s45, 8192
    buffer_load_dwordx4 v251, s[4:7], s35 offen sc1 lds
    v_mfma_f32_16x16x32_bf16 v[24:27], v[72:75], a[80:83], v[24:27]
    v_mfma_f32_16x16x32_bf16 v[28:31], v[76:79], a[80:83], v[28:31]
    v_mfma_f32_16x16x32_bf16 v[32:35], v[64:67], a[144:147], v[32:35]
    v_mfma_f32_16x16x32_bf16 v[36:39], v[68:71], a[144:147], v[36:39]
    buffer_store_dwordx4 v[112:115], v130, s[4:7], s61 offen offset:0 sc1
    v_mfma_f32_16x16x32_bf16 v[40:43], v[72:75], a[144:147], v[40:43]
    v_mfma_f32_16x16x32_bf16 v[44:47], v[76:79], a[144:147], v[44:47]
    v_mfma_f32_16x16x32_bf16 v[48:51], v[64:67], a[208:211], v[48:51]
    v_mfma_f32_16x16x32_bf16 v[52:55], v[68:71], a[208:211], v[52:55]
    s_add_u32 m0, s44, 74752
    s_add_u32 s35, s45, 9216
    buffer_load_dwordx4 v251, s[4:7], s35 offen sc1 lds
    v_mfma_f32_16x16x32_bf16 v[56:59], v[72:75], a[208:211], v[56:59]
    v_mfma_f32_16x16x32_bf16 v[60:63], v[76:79], a[208:211], v[60:63]
    s_waitcnt lgkmcnt(0)
    v_mfma_f32_16x16x32_bf16 v[0:3], v[80:83], a[20:23], v[0:3]
    ds_read_b128 v[64:67], v128 offset:6144
    v_mfma_f32_16x16x32_bf16 v[4:7], v[84:87], a[20:23], v[4:7]
    ds_read_b128 v[68:71], v128 offset:22528
    v_mfma_f32_16x16x32_bf16 v[8:11], v[88:91], a[20:23], v[8:11]
    ds_read_b128 v[72:75], v128 offset:38912
    v_mfma_f32_16x16x32_bf16 v[12:15], v[92:95], a[20:23], v[12:15]
    ds_read_b128 v[76:79], v128 offset:55296
    v_mfma_f32_16x16x32_bf16 v[16:19], v[80:83], a[84:87], v[16:19]
    v_mfma_f32_16x16x32_bf16 v[20:23], v[84:87], a[84:87], v[20:23]
    s_add_u32 m0, s44, 75776
    s_add_u32 s35, s45, 10240
    buffer_load_dwordx4 v251, s[4:7], s35 offen sc1 lds
    v_mfma_f32_16x16x32_bf16 v[24:27], v[88:91], a[84:87], v[24:27]
    v_mfma_f32_16x16x32_bf16 v[28:31], v[92:95], a[84:87], v[28:31]
    v_mfma_f32_16x16x32_bf16 v[32:35], v[80:83], a[148:151], v[32:35]
    v_mfma_f32_16x16x32_bf16 v[36:39], v[84:87], a[148:151], v[36:39]
    buffer_store_dwordx4 v[116:119], v130, s[4:7], s61 offen offset:1024 sc1
    v_mfma_f32_16x16x32_bf16 v[40:43], v[88:91], a[148:151], v[40:43]
    v_mfma_f32_16x16x32_bf16 v[44:47], v[92:95], a[148:151], v[44:47]
    v_mfma_f32_16x16x32_bf16 v[48:51], v[80:83], a[212:215], v[48:51]
    v_mfma_f32_16x16x32_bf16 v[52:55], v[84:87], a[212:215], v[52:55]
    s_add_u32 m0, s44, 76800
    s_add_u32 s35, s45, 11264
    buffer_load_dwordx4 v251, s[4:7], s35 offen sc1 lds
    v_mfma_f32_16x16x32_bf16 v[56:59], v[88:91], a[212:215], v[56:59]
    v_mfma_f32_16x16x32_bf16 v[60:63], v[92:95], a[212:215], v[60:63]
    s_waitcnt lgkmcnt(0)
    v_mfma_f32_16x16x32_bf16 v[0:3], v[64:67], a[24:27], v[0:3]
    ds_read_b128 v[80:83], v128 offset:7168
    v_mfma_f32_16x16x32_bf16 v[4:7], v[68:71], a[24:27], v[4:7]
    ds_read_b128 v[84:87], v128 offset:23552
    v_mfma_f32_16x16x32_bf16 v[8:11], v[72:75], a[24:27], v[8:11]
    ds_read_b128 v[88:91], v128 offset:39936
    v_mfma_f32_16x16x32_bf16 v[12:15], v[76:79], a[24:27], v[12:15]
    ds_read_b128 v[92:95], v128 offset:56320
    v_mfma_f32_16x16x32_bf16 v[16:19], v[64:67], a[88:91], v[16:19]
    v_mfma_f32_16x16x32_bf16 v[20:23], v[68:71], a[88:91], v[20:23]
    s_add_u32 m0, s44, 77824
    s_add_u32 s35, s45, 12288
    buffer_load_dwordx4 v251, s[4:7], s35 offen sc1 lds
    v_mfma_f32_16x16x32_bf16 v[24:27], v[72:75], a[88:91], v[24:27]
    v_mfma_f32_16x16x32_bf16 v[28:31], v[76:79], a[88:91], v[28:31]
    v_mfma_f32_16x16x32_bf16 v[32:35], v[64:67], a[152:155], v[32:35]
    v_mfma_f32_16x16x32_bf16 v[36:39], v[68:71], a[152:155], v[36:39]
    buffer_store_dwordx4 v[120:123], v130, s[4:7], s61 offen offset:2048 sc1
    v_mfma_f32_16x16x32_bf16 v[40:43], v[72:75], a[152:155], v[40:43]
    v_mfma_f32_16x16x32_bf16 v[44:47], v[76:79], a[152:155], v[44:47]
    v_mfma_f32_16x16x32_bf16 v[48:51], v[64:67], a[216:219], v[48:51]
    v_mfma_f32_16x16x32_bf16 v[52:55], v[68:71], a[216:219], v[52:55]
    v_mfma_f32_16x16x32_bf16 v[56:59], v[72:75], a[216:219], v[56:59]
    v_mfma_f32_16x16x32_bf16 v[60:63], v[76:79], a[216:219], v[60:63]
    s_waitcnt lgkmcnt(0)
    v_mfma_f32_16x16x32_bf16 v[0:3], v[80:83], a[28:31], v[0:3]
    ds_read_b128 v[64:67], v128 offset:8192
    v_mfma_f32_16x16x32_bf16 v[4:7], v[84:87], a[28:31], v[4:7]
    ds_read_b128 v[68:71], v128 offset:24576
    v_mfma_f32_16x16x32_bf16 v[8:11], v[88:91], a[28:31], v[8:11]
    ds_read_b128 v[72:75], v128 offset:40960
    v_mfma_f32_16x16x32_bf16 v[12:15], v[92:95], a[28:31], v[12:15]
    ds_read_b128 v[76:79], v128 offset:57344
    v_mfma_f32_16x16x32_bf16 v[16:19], v[80:83], a[92:95], v[16:19]
    v_mfma_f32_16x16x32_bf16 v[20:23], v[84:87], a[92:95], v[20:23]
    s_add_u32 m0, s44, 78848
    s_add_u32 s35, s45, 13312
    buffer_load_dwordx4 v251, s[4:7], s35 offen sc1 lds
    v_mfma_f32_16x16x32_bf16 v[24:27], v[88:91], a[92:95], v[24:27]
    v_mfma_f32_16x16x32_bf16 v[28:31], v[92:95], a[92:95], v[28:31]
    v_mfma_f32_16x16x32_bf16 v[32:35], v[80:83], a[156:159], v[32:35]
    v_mfma_f32_16x16x32_bf16 v[36:39], v[84:87], a[156:159], v[36:39]
    buffer_store_dwordx4 v[124:127], v130, s[4:7], s61 offen offset:3072 sc1
    v_mfma_f32_16x16x32_bf16 v[40:43], v[88:91], a[156:159], v[40:43]
    v_mfma_f32_16x16x32_bf16 v[44:47], v[92:95], a[156:159], v[44:47]
    v_mfma_f32_16x16x32_bf16 v[48:51], v[80:83], a[220:223], v[48:51]
    v_mfma_f32_16x16x32_bf16 v[52:55], v[84:87], a[220:223], v[52:55]
    v_mfma_f32_16x16x32_bf16 v[56:59], v[88:91], a[220:223], v[56:59]
    v_mfma_f32_16x16x32_bf16 v[60:63], v[92:95], a[220:223], v[60:63]
    s_waitcnt lgkmcnt(0)
    v_mfma_f32_16x16x32_bf16 v[0:3], v[64:67], a[32:35], v[0:3]
    ds_read_b128 v[80:83], v128 offset:9216
    v_mfma_f32_16x16x32_bf16 v[4:7], v[68:71], a[32:35], v[4:7]
    ds_read_b128 v[84:87], v128 offset:25600
    v_mfma_f32_16x16x32_bf16 v[8:11], v[72:75], a[32:35], v[8:11]
    ds_read_b128 v[88:91], v128 offset:41984
    v_mfma_f32_16x16x32_bf16 v[12:15], v[76:79], a[32:35], v[12:15]
    ds_read_b128 v[92:95], v128 offset:58368
    v_mfma_f32_16x16x32_bf16 v[16:19], v[64:67], a[96:99], v[16:19]
    v_mfma_f32_16x16x32_bf16 v[20:23], v[68:71], a[96:99], v[20:23]
    s_add_u32 m0, s44, 79872
    s_add_u32 s35, s45, 14336
    buffer_load_dwordx4 v251, s[4:7], s35 offen sc1 lds
    v_mfma_f32_16x16x32_bf16 v[24:27], v[72:75], a[96:99], v[24:27]
    v_mfma_f32_16x16x32_bf16 v[28:31], v[76:79], a[96:99], v[28:31]
    v_mfma_f32_16x16x32_bf16 v[32:35], v[64:67], a[160:163], v[32:35]
    v_mfma_f32_16x16x32_bf16 v[36:39], v[68:71], a[160:163], v[36:39]
    v_mfma_f32_16x16x32_bf16 v[40:43], v[72:75], a[160:163], v[40:43]
    v_mfma_f32_16x16x32_bf16 v[44:47], v[76:79], a[160:163], v[44:47]
    v_mfma_f32_16x16x32_bf16 v[48:51], v[64:67], a[224:227], v[48:51]
    v_mfma_f32_16x16x32_bf16 v[52:55], v[68:71], a[224:227], v[52:55]
    v_mfma_f32_16x16x32_bf16 v[56:59], v[72:75], a[224:227], v[56:59]
    v_mfma_f32_16x16x32_bf16 v[60:63], v[76:79], a[224:227], v[60:63]
    s_waitcnt lgkmcnt(0)
    v_mfma_f32_16x16x32_bf16 v[0:3], v[80:83], a[36:39], v[0:3]
    ds_read_b128 v[64:67], v128 offset:10240
    v_mfma_f32_16x16x32_bf16 v[4:7], v[84:87], a[36:39], v[4:7]
    ds_read_b128 v[68:71], v128 offset:26624
    v_mfma_f32_16x16x32_bf16 v[8:11], v[88:91], a[36:39], v[8:11]
    ds_read_b128 v[72:75], v128 offset:43008
    v_mfma_f32_16x16x32_bf16 v[12:15], v[92:95], a[36:39], v[12:15]
    ds_read_b128 v[76:79], v128 offset:59392
    v_mfma_f32_16x16x32_bf16 v[16:19], v[80:83], a[100:103], v[16:19]
    v_mfma_f32_16x16x32_bf16 v[20:23], v[84:87], a[100:103], v[20:23]
    s_add_u32 m0, s44, 80896
    s_add_u32 s35, s45, 15360
    buffer_load_dwordx4 v251, s[4:7], s35 offen sc1 lds
    v_mfma_f32_16x16x32_bf16 v[24:27], v[88:91], a[100:103], v[24:27]
    v_mfma_f32_16x16x32_bf16 v[28:31], v[92:95], a[100:103], v[28:31]
    v_mfma_f32_16x16x32_bf16 v[32:35], v[80:83], a[164:167], v[32:35]
    v_mfma_f32_16x16x32_bf16 v[36:39], v[84:87], a[164:167], v[36:39]
    v_mfma_f32_16x16x32_bf16 v[40:43], v[88:91], a[164:167], v[40:43]
    v_mfma_f32_16x16x32_bf16 v[44:47], v[92:95], a[164:167], v[44:47]
    v_mfma_f32_16x16x32_bf16 v[48:51], v[80:83], a[228:231], v[48:51]
    v_mfma_f32_16x16x32_bf16 v[52:55], v[84:87], a[228:231], v[52:55]
    v_mfma_f32_16x16x32_bf16 v[56:59], v[88:91], a[228:231], v[56:59]
    v_mfma_f32_16x16x32_bf16 v[60:63], v[92:95], a[228:231], v[60:63]
    s_waitcnt lgkmcnt(0)
    v_mfma_f32_16x16x32_bf16 v[0:3], v[64:67], a[40:43], v[0:3]
    ds_read_b128 v[80:83], v128 offset:11264
    v_mfma_f32_16x16x32_bf16 v[4:7], v[68:71], a[40:43], v[4:7]
    ds_read_b128 v[84:87], v128 offset:27648
    v_mfma_f32_16x16x32_bf16 v[8:11], v[72:75], a[40:43], v[8:11]
    ds_read_b128 v[88:91], v128 offset:44032
    v_mfma_f32_16x16x32_bf16 v[12:15], v[76:79], a[40:43], v[12:15]
    ds_read_b128 v[92:95], v128 offset:60416
    v_mfma_f32_16x16x32_bf16 v[16:19], v[64:67], a[104:107], v[16:19]
    v_mfma_f32_16x16x32_bf16 v[20:23], v[68:71], a[104:107], v[20:23]
    v_mfma_f32_16x16x32_bf16 v[24:27], v[72:75], a[104:107], v[24:27]
    v_mfma_f32_16x16x32_bf16 v[28:31], v[76:79], a[104:107], v[28:31]
    v_mfma_f32_16x16x32_bf16 v[32:35], v[64:67], a[168:171], v[32:35]
    v_mfma_f32_16x16x32_bf16 v[36:39], v[68:71], a[168:171], v[36:39]
    v_mfma_f32_16x16x32_bf16 v[40:43], v[72:75], a[168:171], v[40:43]
    v_mfma_f32_16x16x32_bf16 v[44:47], v[76:79], a[168:171], v[44:47]
    v_mfma_f32_16x16x32_bf16 v[48:51], v[64:67], a[232:235], v[48:51]
    v_mfma_f32_16x16x32_bf16 v[52:55], v[68:71], a[232:235], v[52:55]
    v_mfma_f32_16x16x32_bf16 v[56:59], v[72:75], a[232:235], v[56:59]
    v_mfma_f32_16x16x32_bf16 v[60:63], v[76:79], a[232:235], v[60:63]
    s_waitcnt lgkmcnt(0)
    v_mfma_f32_16x16x32_bf16 v[0:3], v[80:83], a[44:47], v[0:3]
    ds_read_b128 v[64:67], v128 offset:12288
    v_mfma_f32_16x16x32_bf16 v[4:7], v[84:87], a[44:47], v[4:7]
    ds_read_b128 v[68:71], v128 offset:28672
    v_mfma_f32_16x16x32_bf16 v[8:11], v[88:91], a[44:47], v[8:11]
    ds_read_b128 v[72:75], v128 offset:45056
    v_mfma_f32_16x16x32_bf16 v[12:15], v[92:95], a[44:47], v[12:15]
    ds_read_b128 v[76:79], v128 offset:61440
    v_mfma_f32_16x16x32_bf16 v[16:19], v[80:83], a[108:111], v[16:19]
    v_mfma_f32_16x16x32_bf16 v[20:23], v[84:87], a[108:111], v[20:23]
    v_mfma_f32_16x16x32_bf16 v[24:27], v[88:91], a[108:111], v[24:27]
    v_mfma_f32_16x16x32_bf16 v[28:31], v[92:95], a[108:111], v[28:31]
    v_mfma_f32_16x16x32_bf16 v[32:35], v[80:83], a[172:175], v[32:35]
    v_mfma_f32_16x16x32_bf16 v[36:39], v[84:87], a[172:175], v[36:39]
    v_mfma_f32_16x16x32_bf16 v[40:43], v[88:91], a[172:175], v[40:43]
    v_mfma_f32_16x16x32_bf16 v[44:47], v[92:95], a[172:175], v[44:47]
    v_mfma_f32_16x16x32_bf16 v[48:51], v[80:83], a[236:239], v[48:51]
    v_mfma_f32_16x16x32_bf16 v[52:55], v[84:87], a[236:239], v[52:55]
    v_mfma_f32_16x16x32_bf16 v[56:59], v[88:91], a[236:239], v[56:59]
    v_mfma_f32_16x16x32_bf16 v[60:63], v[92:95], a[236:239], v[60:63]
    s_waitcnt lgkmcnt(0)
    v_mfma_f32_16x16x32_bf16 v[0:3], v[64:67], a[48:51], v[0:3]
    ds_read_b128 v[80:83], v128 offset:13312
    v_mfma_f32_16x16x32_bf16 v[4:7], v[68:71], a[48:51], v[4:7]
    ds_read_b128 v[84:87], v128 offset:29696
    v_mfma_f32_16x16x32_bf16 v[8:11], v[72:75], a[48:51], v[8:11]
    ds_read_b128 v[88:91], v128 offset:46080
    v_mfma_f32_16x16x32_bf16 v[12:15], v[76:79], a[48:51], v[12:15]
    ds_read_b128 v[92:95], v128 offset:62464
    v_mfma_f32_16x16x32_bf16 v[16:19], v[64:67], a[112:115], v[16:19]
    v_mfma_f32_16x16x32_bf16 v[20:23], v[68:71], a[112:115], v[20:23]
    v_mfma_f32_16x16x32_bf16 v[24:27], v[72:75], a[112:115], v[24:27]
    v_mfma_f32_16x16x32_bf16 v[28:31], v[76:79], a[112:115], v[28:31]
    v_mfma_f32_16x16x32_bf16 v[32:35], v[64:67], a[176:179], v[32:35]
    v_mfma_f32_16x16x32_bf16 v[36:39], v[68:71], a[176:179], v[36:39]
    v_mfma_f32_16x16x32_bf16 v[40:43], v[72:75], a[176:179], v[40:43]
    v_mfma_f32_16x16x32_bf16 v[44:47], v[76:79], a[176:179], v[44:47]
    v_mfma_f32_16x16x32_bf16 v[48:51], v[64:67], a[240:243], v[48:51]
    v_mfma_f32_16x16x32_bf16 v[52:55], v[68:71], a[240:243], v[52:55]
    v_mfma_f32_16x16x32_bf16 v[56:59], v[72:75], a[240:243], v[56:59]
    v_mfma_f32_16x16x32_bf16 v[60:63], v[76:79], a[240:243], v[60:63]
    s_waitcnt lgkmcnt(0)
    v_mfma_f32_16x16x32_bf16 v[0:3], v[80:83], a[52:55], v[0:3]
    ds_read_b128 v[64:67], v128 offset:14336
    v_mfma_f32_16x16x32_bf16 v[4:7], v[84:87], a[52:55], v[4:7]
    ds_read_b128 v[68:71], v128 offset:30720
    v_mfma_f32_16x16x32_bf16 v[8:11], v[88:91], a[52:55], v[8:11]
    ds_read_b128 v[72:75], v128 offset:47104
    v_mfma_f32_16x16x32_bf16 v[12:15], v[92:95], a[52:55], v[12:15]
    ds_read_b128 v[76:79], v128 offset:63488
    v_mfma_f32_16x16x32_bf16 v[16:19], v[80:83], a[116:119], v[16:19]
    v_mfma_f32_16x16x32_bf16 v[20:23], v[84:87], a[116:119], v[20:23]
    v_mfma_f32_16x16x32_bf16 v[24:27], v[88:91], a[116:119], v[24:27]
    v_mfma_f32_16x16x32_bf16 v[28:31], v[92:95], a[116:119], v[28:31]
    v_mfma_f32_16x16x32_bf16 v[32:35], v[80:83], a[180:183], v[32:35]
    v_mfma_f32_16x16x32_bf16 v[36:39], v[84:87], a[180:183], v[36:39]
    v_mfma_f32_16x16x32_bf16 v[40:43], v[88:91], a[180:183], v[40:43]
    v_mfma_f32_16x16x32_bf16 v[44:47], v[92:95], a[180:183], v[44:47]
    v_mfma_f32_16x16x32_bf16 v[48:51], v[80:83], a[244:247], v[48:51]
    v_mfma_f32_16x16x32_bf16 v[52:55], v[84:87], a[244:247], v[52:55]
    v_mfma_f32_16x16x32_bf16 v[56:59], v[88:91], a[244:247], v[56:59]
    v_mfma_f32_16x16x32_bf16 v[60:63], v[92:95], a[244:247], v[60:63]
    s_waitcnt lgkmcnt(0)
    v_mfma_f32_16x16x32_bf16 v[0:3], v[64:67], a[56:59], v[0:3]
    ds_read_b128 v[80:83], v128 offset:15360
    v_mfma_f32_16x16x32_bf16 v[4:7], v[68:71], a[56:59], v[4:7]
    ds_read_b128 v[84:87], v128 offset:31744
    v_mfma_f32_16x16x32_bf16 v[8:11], v[72:75], a[56:59], v[8:11]
    ds_read_b128 v[88:91], v128 offset:48128
    v_mfma_f32_16x16x32_bf16 v[12:15], v[76:79], a[56:59], v[12:15]
    ds_read_b128 v[92:95], v128 offset:64512
    v_mfma_f32_16x16x32_bf16 v[16:19], v[64:67], a[120:123], v[16:19]
    v_mfma_f32_16x16x32_bf16 v[20:23], v[68:71], a[120:123], v[20:23]
    v_mfma_f32_16x16x32_bf16 v[24:27], v[72:75], a[120:123], v[24:27]
    v_mfma_f32_16x16x32_bf16 v[28:31], v[76:79], a[120:123], v[28:31]
    v_mfma_f32_16x16x32_bf16 v[32:35], v[64:67], a[184:187], v[32:35]
    v_mfma_f32_16x16x32_bf16 v[36:39], v[68:71], a[184:187], v[36:39]
    v_mfma_f32_16x16x32_bf16 v[40:43], v[72:75], a[184:187], v[40:43]
    v_mfma_f32_16x16x32_bf16 v[44:47], v[76:79], a[184:187], v[44:47]
    v_mfma_f32_16x16x32_bf16 v[48:51], v[64:67], a[248:251], v[48:51]
    v_mfma_f32_16x16x32_bf16 v[52:55], v[68:71], a[248:251], v[52:55]
    v_mfma_f32_16x16x32_bf16 v[56:59], v[72:75], a[248:251], v[56:59]
    v_mfma_f32_16x16x32_bf16 v[60:63], v[76:79], a[248:251], v[60:63]
    s_waitcnt lgkmcnt(0)
    v_mfma_f32_16x16x32_bf16 v[0:3], v[80:83], a[60:63], v[0:3]
    v_mfma_f32_16x16x32_bf16 v[4:7], v[84:87], a[60:63], v[4:7]
    v_mfma_f32_16x16x32_bf16 v[8:11], v[88:91], a[60:63], v[8:11]
    v_mfma_f32_16x16x32_bf16 v[12:15], v[92:95], a[60:63], v[12:15]
    v_mfma_f32_16x16x32_bf16 v[16:19], v[80:83], a[124:127], v[16:19]
    v_mfma_f32_16x16x32_bf16 v[20:23], v[84:87], a[124:127], v[20:23]
    v_mfma_f32_16x16x32_bf16 v[24:27], v[88:91], a[124:127], v[24:27]
    v_mfma_f32_16x16x32_bf16 v[28:31], v[92:95], a[124:127], v[28:31]
    v_mfma_f32_16x16x32_bf16 v[32:35], v[80:83], a[188:191], v[32:35]
    v_mfma_f32_16x16x32_bf16 v[36:39], v[84:87], a[188:191], v[36:39]
    v_mfma_f32_16x16x32_bf16 v[40:43], v[88:91], a[188:191], v[40:43]
    v_mfma_f32_16x16x32_bf16 v[44:47], v[92:95], a[188:191], v[44:47]
    v_mfma_f32_16x16x32_bf16 v[48:51], v[80:83], a[252:255], v[48:51]
    v_mfma_f32_16x16x32_bf16 v[52:55], v[84:87], a[252:255], v[52:55]
    v_mfma_f32_16x16x32_bf16 v[56:59], v[88:91], a[252:255], v[56:59]
    v_mfma_f32_16x16x32_bf16 v[60:63], v[92:95], a[252:255], v[60:63]
    s_nop 7
    s_lshl_b32 s41, s25, 19
    s_add_u32 s41, s41, s26
    v_mov_b32 v130, v251
    s_add_u32 s60, s41, 0
    v_cvt_pk_bf16_f32 v96, v0, v1
    v_cvt_pk_bf16_f32 v97, v2, v3
    v_cvt_pk_bf16_f32 v98, v4, v5
    v_cvt_pk_bf16_f32 v99, v6, v7
    v_cvt_pk_bf16_f32 v100, v16, v17
    v_cvt_pk_bf16_f32 v101, v18, v19
    v_cvt_pk_bf16_f32 v102, v20, v21
    v_cvt_pk_bf16_f32 v103, v22, v23
    v_cvt_pk_bf16_f32 v104, v32, v33
    v_cvt_pk_bf16_f32 v105, v34, v35
    v_cvt_pk_bf16_f32 v106, v36, v37
    v_cvt_pk_bf16_f32 v107, v38, v39
    v_cvt_pk_bf16_f32 v108, v48, v49
    v_cvt_pk_bf16_f32 v109, v50, v51
    v_cvt_pk_bf16_f32 v110, v52, v53
    v_cvt_pk_bf16_f32 v111, v54, v55
    s_add_u32 s61, s41, 262144
    v_cvt_pk_bf16_f32 v112, v8, v9
    v_cvt_pk_bf16_f32 v113, v10, v11
    v_cvt_pk_bf16_f32 v114, v12, v13
    v_cvt_pk_bf16_f32 v115, v14, v15
    v_cvt_pk_bf16_f32 v116, v24, v25
    v_cvt_pk_bf16_f32 v117, v26, v27
    v_cvt_pk_bf16_f32 v118, v28, v29
    v_cvt_pk_bf16_f32 v119, v30, v31
    v_cvt_pk_bf16_f32 v120, v40, v41
    v_cvt_pk_bf16_f32 v121, v42, v43
    v_cvt_pk_bf16_f32 v122, v44, v45
    v_cvt_pk_bf16_f32 v123, v46, v47
    v_cvt_pk_bf16_f32 v124, v56, v57
    v_cvt_pk_bf16_f32 v125, v58, v59
    v_cvt_pk_bf16_f32 v126, v60, v61
    v_cvt_pk_bf16_f32 v127, v62, v63
    s_cmp_ge_i32 s28, 0
    s_cbranch_scc1 G1_20
    buffer_store_dwordx4 v[96:99], v130, s[4:7], s60 offen offset:0 sc1
    buffer_store_dwordx4 v[100:103], v130, s[4:7], s60 offen offset:1024 sc1
    buffer_store_dwordx4 v[104:107], v130, s[4:7], s60 offen offset:2048 sc1
    buffer_store_dwordx4 v[108:111], v130, s[4:7], s60 offen offset:3072 sc1
    buffer_store_dwordx4 v[112:115], v130, s[4:7], s61 offen offset:0 sc1
    buffer_store_dwordx4 v[116:119], v130, s[4:7], s61 offen offset:1024 sc1
    buffer_store_dwordx4 v[120:123], v130, s[4:7], s61 offen offset:2048 sc1
    buffer_store_dwordx4 v[124:127], v130, s[4:7], s61 offen offset:3072 sc1
    s_lshl_b32 s43, s25, 7
    s_add_u32 s43, s43, s27
    v_mov_b32 v130, 0x80000000
G1_20:
    s_lshl_b32 s42, s25, 7
    s_add_u32 s28, s42, s27
    s_mov_b32 s25, s40
    s_cmp_ge_u32 s25, 32
    s_cbranch_scc1 GE_18
    s_waitcnt vmcnt(0)
    s_barrier
    s_add_u32 s40, s25, s24
    s_min_u32 s41, s40, 31
    s_lshl_b32 s45, s41, 16
    s_add_u32 s45, s45, s44
    ds_read_b128 v[64:67], v129 offset:0
    ds_read_b128 v[68:71], v129 offset:16384
    ds_read_b128 v[72:75], v129 offset:32768
    ds_read_b128 v[76:79], v129 offset:49152
    s_cmp_lt_i32 s43, 0
    s_cbranch_scc1 GF_21
    buffer_store_dwordx2 v[254:255], v253, s[4:7], s43 offen sc1
GF_21:
    s_mov_b32 s43, s28
    s_waitcnt lgkmcnt(0)
    v_mfma_f32_16x16x32_bf16 v[0:3], v[64:67], a[0:3], 0
    ds_read_b128 v[80:83], v129 offset:1024
    v_mfma_f32_16x16x32_bf16 v[4:7], v[68:71], a[0:3], 0
    ds_read_b128 v[84:87], v129 offset:17408
    v_mfma_f32_16x16x32_bf16 v[8:11], v[72:75], a[0:3], 0
    ds_read_b128 v[88:91], v129 offset:33792
    v_mfma_f32_16x16x32_bf16 v[12:15], v[76:79], a[0:3], 0
    ds_read_b128 v[92:95], v129 offset:50176
    v_mfma_f32_16x16x32_bf16 v[16:19], v[64:67], a[64:67], 0
    v_mfma_f32_16x16x32_bf16 v[20:23], v[68:71], a[64:67], 0
    s_add_u32 m0, s44, 0
    s_add_u32 s35, s45, 0
    buffer_load_dwordx4 v251, s[4:7], s35 offen sc1 lds
    v_mfma_f32_16x16x32_bf16 v[24:27], v[72:75], a[64:67], 0
    v_mfma_f32_16x16x32_bf16 v[28:31], v[76:79], a[64:67], 0
    v_mfma_f32_16x16x32_bf16 v[32:35], v[64:67], a[128:131], 0
    v_mfma_f32_16x16x32_bf16 v[36:39], v[68:71], a[128:131], 0
    buffer_store_dwordx4 v[96:99], v130, s[4:7], s60 offen offset:0 sc1
    v_mfma_f32_16x16x32_bf16 v[40:43], v[72:75], a[128:131], 0
    v_mfma_f32_16x16x32_bf16 v[44:47], v[76:79], a[128:131], 0
    v_mfma_f32_16x16x32_bf16 v[48:51], v[64:67], a[192:195], 0
    v_mfma_f32_16x16x32_bf16 v[52:55], v[68:71], a[192:195], 0
    s_add_u32 m0, s44, 1024
    s_add_u32 s35, s45, 1024
    buffer_load_dwordx4 v251, s[4:7], s35 offen sc1 lds
    v_mfma_f32_16x16x32_bf16 v[56:59], v[72:75], a[192:195], 0
    v_mfma_f32_16x16x32_bf16 v[60:63], v[76:79], a[192:195], 0
    s_waitcnt lgkmcnt(0)
    v_mfma_f32_16x16x32_bf16 v[0:3], v[80:83], a[4:7], v[0:3]
    ds_read_b128 v[64:67], v129 offset:2048
    v_mfma_f32_16x16x32_bf16 v[4:7], v[84:87], a[4:7], v[4:7]
    ds_read_b128 v[68:71], v129 offset:18432
    v_mfma_f32_16x16x32_bf16 v[8:11], v[88:91], a[4:7], v[8:11]
    ds_read_b128 v[72:75], v129 offset:34816
    v_mfma_f32_16x16x32_bf16 v[12:15], v[92:95], a[4:7], v[12:15]
    ds_read_b128 v[76:79], v129 offset:51200
    v_mfma_f32_16x16x32_bf16 v[16:19], v[80:83], a[68:71], v[16:19]
    v_mfma_f32_16x16x32_bf16 v[20:23], v[84:87], a[68:71], v[20:23]
    s_add_u32 m0, s44, 2048
    s_add_u32 s35, s45, 2048
    buffer_load_dwordx4 v251, s[4:7], s35 offen sc1 lds
    v_mfma_f32_16x16x32_bf16 v[24:27], v[88:91], a[68:71], v[24:27]
    v_mfma_f32_16x16x32_bf16 v[28:31], v[92:95], a[68:71], v[28:31]
    v_mfma_f32_16x16x32_bf16 v[32:35], v[80:83], a[132:135], v[32:35]
    v_mfma_f32_16x16x32_bf16 v[36:39], v[84:87], a[132:135], v[36:39]
    buffer_store_dwordx4 v[100:103], v130, s[4:7], s60 offen offset:1024 sc1
    v_mfma_f32_16x16x32_bf16 v[40:43], v[88:91], a[132:135], v[40:43]
    v_mfma_f32_16x16x32_bf16 v[44:47], v[92:95], a[132:135], v[44:47]
    v_mfma_f32_16x16x32_bf16 v[48:51], v[80:83], a[196:199], v[48:51]
    v_mfma_f32_16x16x32_bf16 v[52:55], v[84:87], a[196:199], v[52:55]
    s_add_u32 m0, s44, 3072
    s_add_u32 s35, s45, 3072
    buffer_load_dwordx4 v251, s[4:7], s35 offen sc1 lds
    v_mfma_f32_16x16x32_bf16 v[56:59], v[88:91], a[196:199], v[56:59]
    v_mfma_f32_16x16x32_bf16 v[60:63], v[92:95], a[196:199], v[60:63]
    s_waitcnt lgkmcnt(0)
    v_mfma_f32_16x16x32_bf16 v[0:3], v[64:67], a[8:11], v[0:3]
    ds_read_b128 v[80:83], v129 offset:3072
    v_mfma_f32_16x16x32_bf16 v[4:7], v[68:71], a[8:11], v[4:7]
    ds_read_b128 v[84:87], v129 offset:19456
    v_mfma_f32_16x16x32_bf16 v[8:11], v[72:75], a[8:11], v[8:11]
    ds_read_b128 v[88:91], v129 offset:35840
    v_mfma_f32_16x16x32_bf16 v[12:15], v[76:79], a[8:11], v[12:15]
    ds_read_b128 v[92:95], v129 offset:52224
    v_mfma_f32_16x16x32_bf16 v[16:19], v[64:67], a[72:75], v[16:19]
    v_mfma_f32_16x16x32_bf16 v[20:23], v[68:71], a[72:75], v[20:23]
    s_add_u32 m0, s44, 4096
    s_add_u32 s35, s45, 4096
    buffer_load_dwordx4 v251, s[4:7], s35 offen sc1 lds
    v_mfma_f32_16x16x32_bf16 v[24:27], v[72:75], a[72:75], v[24:27]
    v_mfma_f32_16x16x32_bf16 v[28:31], v[76:79], a[72:75], v[28:31]
    v_mfma_f32_16x16x32_bf16 v[32:35], v[64:67], a[136:139], v[32:35]
    v_mfma_f32_16x16x32_bf16 v[36:39], v[68:71], a[136:139], v[36:39]
    buffer_store_dwordx4 v[104:107], v130, s[4:7], s60 offen offset:2048 sc1
    v_mfma_f32_16x16x32_bf16 v[40:43], v[72:75], a[136:139], v[40:43]
    v_mfma_f32_16x16x32_bf16 v[44:47], v[76:79], a[136:139], v[44:47]
    v_mfma_f32_16x16x32_bf16 v[48:51], v[64:67], a[200:203], v[48:51]
    v_mfma_f32_16x16x32_bf16 v[52:55], v[68:71], a[200:203], v[52:55]
    s_add_u32 m0, s44, 5120
    s_add_u32 s35, s45, 5120
    buffer_load_dwordx4 v251, s[4:7], s35 offen sc1 lds
    v_mfma_f32_16x16x32_bf16 v[56:59], v[72:75], a[200:203], v[56:59]
    v_mfma_f32_16x16x32_bf16 v[60:63], v[76:79], a[200:203], v[60:63]
    s_waitcnt lgkmcnt(0)
    v_mfma_f32_16x16x32_bf16 v[0:3], v[80:83], a[12:15], v[0:3]
    ds_read_b128 v[64:67], v129 offset:4096
    v_mfma_f32_16x16x32_bf16 v[4:7], v[84:87], a[12:15], v[4:7]
    ds_read_b128 v[68:71], v129 offset:20480
    v_mfma_f32_16x16x32_bf16 v[8:11], v[88:91], a[12:15], v[8:11]
    ds_read_b128 v[72:75], v129 offset:36864
    v_mfma_f32_16x16x32_bf16 v[12:15], v[92:95], a[12:15], v[12:15]
    ds_read_b128 v[76:79], v129 offset:53248
    v_mfma_f32_16x16x32_bf16 v[16:19], v[80:83], a[76:79], v[16:19]
    v_mfma_f32_16x16x32_bf16 v[20:23], v[84:87], a[76:79], v[20:23]
    s_add_u32 m0, s44, 6144
    s_add_u32 s35, s45, 6144
    buffer_load_dwordx4 v251, s[4:7], s35 offen sc1 lds
    v_mfma_f32_16x16x32_bf16 v[24:27], v[88:91], a[76:79], v[24:27]
    v_mfma_f32_16x16x32_bf16 v[28:31], v[92:95], a[76:79], v[28:31]
    v_mfma_f32_16x16x32_bf16 v[32:35], v[80:83], a[140:143], v[32:35]
    v_mfma_f32_16x16x32_bf16 v[36:39], v[84:87], a[140:143], v[36:39]
    buffer_store_dwordx4 v[108:111], v130, s[4:7], s60 offen offset:3072 sc1
    v_mfma_f32_16x16x32_bf16 v[40:43], v[88:91], a[140:143], v[40:43]
    v_mfma_f32_16x16x32_bf16 v[44:47], v[92:95], a[140:143], v[44:47]
    v_mfma_f32_16x16x32_bf16 v[48:51], v[80:83], a[204:207], v[48:51]
    v_mfma_f32_16x16x32_bf16 v[52:55], v[84:87], a[204:207], v[52:55]
    s_add_u32 m0, s44, 7168
    s_add_u32 s35, s45, 7168
    buffer_load_dwordx4 v251, s[4:7], s35 offen sc1 lds
    v_mfma_f32_16x16x32_bf16 v[56:59], v[88:91], a[204:207], v[56:59]
    v_mfma_f32_16x16x32_bf16 v[60:63], v[92:95], a[204:207], v[60:63]
    s_waitcnt lgkmcnt(0)
    v_mfma_f32_16x16x32_bf16 v[0:3], v[64:67], a[16:19], v[0:3]
    ds_read_b128 v[80:83], v129 offset:5120
    v_mfma_f32_16x16x32_bf16 v[4:7], v[68:71], a[16:19], v[4:7]
    ds_read_b128 v[84:87], v129 offset:21504
    v_mfma_f32_16x16x32_bf16 v[8:11], v[72:75], a[16:19], v[8:11]
    ds_read_b128 v[88:91], v129 offset:37888
    v_mfma_f32_16x16x32_bf16 v[12:15], v[76:79], a[16:19], v[12:15]
    ds_read_b128 v[92:95], v129 offset:54272
    v_mfma_f32_16x16x32_bf16 v[16:19], v[64:67], a[80:83], v[16:19]
    v_mfma_f32_16x16x32_bf16 v[20:23], v[68:71], a[80:83], v[20:23]
    s_add_u32 m0, s44, 8192
    s_add_u32 s35, s45, 8192
    buffer_load_dwordx4 v251, s[4:7], s35 offen sc1 lds
    v_mfma_f32_16x16x32_bf16 v[24:27], v[72:75], a[80:83], v[24:27]
    v_mfma_f32_16x16x32_bf16 v[28:31], v[76:79], a[80:83], v[28:31]
    v_mfma_f32_16x16x32_bf16 v[32:35], v[64:67], a[144:147], v[32:35]
    v_mfma_f32_16x16x32_bf16 v[36:39], v[68:71], a[144:147], v[36:39]
    buffer_store_dwordx4 v[112:115], v130, s[4:7], s61 offen offset:0 sc1
    v_mfma_f32_16x16x32_bf16 v[40:43], v[72:75], a[144:147], v[40:43]
    v_mfma_f32_16x16x32_bf16 v[44:47], v[76:79], a[144:147], v[44:47]
    v_mfma_f32_16x16x32_bf16 v[48:51], v[64:67], a[208:211], v[48:51]
    v_mfma_f32_16x16x32_bf16 v[52:55], v[68:71], a[208:211], v[52:55]
    s_add_u32 m0, s44, 9216
    s_add_u32 s35, s45, 9216
    buffer_load_dwordx4 v251, s[4:7], s35 offen sc1 lds
    v_mfma_f32_16x16x32_bf16 v[56:59], v[72:75], a[208:211], v[56:59]
    v_mfma_f32_16x16x32_bf16 v[60:63], v[76:79], a[208:211], v[60:63]
    s_waitcnt lgkmcnt(0)
    v_mfma_f32_16x16x32_bf16 v[0:3], v[80:83], a[20:23], v[0:3]
    ds_read_b128 v[64:67], v129 offset:6144
    v_mfma_f32_16x16x32_bf16 v[4:7], v[84:87], a[20:23], v[4:7]
    ds_read_b128 v[68:71], v129 offset:22528
    v_mfma_f32_16x16x32_bf16 v[8:11], v[88:91], a[20:23], v[8:11]
    ds_read_b128 v[72:75], v129 offset:38912
    v_mfma_f32_16x16x32_bf16 v[12:15], v[92:95], a[20:23], v[12:15]
    ds_read_b128 v[76:79], v129 offset:55296
    v_mfma_f32_16x16x32_bf16 v[16:19], v[80:83], a[84:87], v[16:19]
    v_mfma_f32_16x16x32_bf16 v[20:23], v[84:87], a[84:87], v[20:23]
    s_add_u32 m0, s44, 10240
    s_add_u32 s35, s45, 10240
    buffer_load_dwordx4 v251, s[4:7], s35 offen sc1 lds
    v_mfma_f32_16x16x32_bf16 v[24:27], v[88:91], a[84:87], v[24:27]
    v_mfma_f32_16x16x32_bf16 v[28:31], v[92:95], a[84:87], v[28:31]
    v_mfma_f32_16x16x32_bf16 v[32:35], v[80:83], a[148:151], v[32:35]
    v_mfma_f32_16x16x32_bf16 v[36:39], v[84:87], a[148:151], v[36:39]
    buffer_store_dwordx4 v[116:119], v130, s[4:7], s61 offen offset:1024 sc1
    v_mfma_f32_16x16x32_bf16 v[40:43], v[88:91], a[148:151], v[40:43]
    v_mfma_f32_16x16x32_bf16 v[44:47], v[92:95], a[148:151], v[44:47]
    v_mfma_f32_16x16x32_bf16 v[48:51], v[80:83], a[212:215], v[48:51]
    v_mfma_f32_16x16x32_bf16 v[52:55], v[84:87], a[212:215], v[52:55]
    s_add_u32 m0, s44, 11264
    s_add_u32 s35, s45, 11264
    buffer_load_dwordx4 v251, s[4:7], s35 offen sc1 lds
    v_mfma_f32_16x16x32_bf16 v[56:59], v[88:91], a[212:215], v[56:59]
    v_mfma_f32_16x16x32_bf16 v[60:63], v[92:95], a[212:215], v[60:63]
    s_waitcnt lgkmcnt(0)
    v_mfma_f32_16x16x32_bf16 v[0:3], v[64:67], a[24:27], v[0:3]
    ds_read_b128 v[80:83], v129 offset:7168
    v_mfma_f32_16x16x32_bf16 v[4:7], v[68:71], a[24:27], v[4:7]
    ds_read_b128 v[84:87], v129 offset:23552
    v_mfma_f32_16x16x32_bf16 v[8:11], v[72:75], a[24:27], v[8:11]
    ds_read_b128 v[88:91], v129 offset:39936
    v_mfma_f32_16x16x32_bf16 v[12:15], v[76:79], a[24:27], v[12:15]
    ds_read_b128 v[92:95], v129 offset:56320
    v_mfma_f32_16x16x32_bf16 v[16:19], v[64:67], a[88:91], v[16:19]
    v_mfma_f32_16x16x32_bf16 v[20:23], v[68:71], a[88:91], v[20:23]
    s_add_u32 m0, s44, 12288
    s_add_u32 s35, s45, 12288
    buffer_load_dwordx4 v251, s[4:7], s35 offen sc1 lds
    v_mfma_f32_16x16x32_bf16 v[24:27], v[72:75], a[88:91], v[24:27]
    v_mfma_f32_16x16x32_bf16 v[28:31], v[76:79], a[88:91], v[28:31]
    v_mfma_f32_16x16x32_bf16 v[32:35], v[64:67], a[152:155], v[32:35]
    v_mfma_f32_16x16x32_bf16 v[36:39], v[68:71], a[152:155], v[36:39]
    buffer_store_dwordx4 v[120:123], v130, s[4:7], s61 offen offset:2048 sc1
    v_mfma_f32_16x16x32_bf16 v[40:43], v[72:75], a[152:155], v[40:43]
    v_mfma_f32_16x16x32_bf16 v[44:47], v[76:79], a[152:155], v[44:47]
    v_mfma_f32_16x16x32_bf16 v[48:51], v[64:67], a[216:219], v[48:51]
    v_mfma_f32_16x16x32_bf16 v[52:55], v[68:71], a[216:219], v[52:55]
    v_mfma_f32_16x16x32_bf16 v[56:59], v[72:75], a[216:219], v[56:59]
    v_mfma_f32_16x16x32_bf16 v[60:63], v[76:79], a[216:219], v[60:63]
    s_waitcnt lgkmcnt(0)
    v_mfma_f32_16x16x32_bf16 v[0:3], v[80:83], a[28:31], v[0:3]
    ds_read_b128 v[64:67], v129 offset:8192
    v_mfma_f32_16x16x32_bf16 v[4:7], v[84:87], a[28:31], v[4:7]
    ds_read_b128 v[68:71], v129 offset:24576
    v_mfma_f32_16x16x32_bf16 v[8:11], v[88:91], a[28:31], v[8:11]
    ds_read_b128 v[72:75], v129 offset:40960
    v_mfma_f32_16x16x32_bf16 v[12:15], v[92:95], a[28:31], v[12:15]
    ds_read_b128 v[76:79], v129 offset:57344
    v_mfma_f32_16x16x32_bf16 v[16:19], v[80:83], a[92:95], v[16:19]
    v_mfma_f32_16x16x32_bf16 v[20:23], v[84:87], a[92:95], v[20:23]
    s_add_u32 m0, s44, 13312
    s_add_u32 s35, s45, 13312
    buffer_load_dwordx4 v251, s[4:7], s35 offen sc1 lds
    v_mfma_f32_16x16x32_bf16 v[24:27], v[88:91], a[92:95], v[24:27]
    v_mfma_f32_16x16x32_bf16 v[28:31], v[92:95], a[92:95], v[28:31]
    v_mfma_f32_16x16x32_bf16 v[32:35], v[80:83], a[156:159], v[32:35]
    v_mfma_f32_16x16x32_bf16 v[36:39], v[84:87], a[156:159], v[36:39]
    buffer_store_dwordx4 v[124:127], v130, s[4:7], s61 offen offset:3072 sc1
    v_mfma_f32_16x16x32_bf16 v[40:43], v[88:91], a[156:159], v[40:43]
    v_mfma_f32_16x16x32_bf16 v[44:47], v[92:95], a[156:159], v[44:47]
    v_mfma_f32_16x16x32_bf16 v[48:51], v[80:83], a[220:223], v[48:51]
    v_mfma_f32_16x16x32_bf16 v[52:55], v[84:87], a[220:223], v[52:55]
    v_mfma_f32_16x16x32_bf16 v[56:59], v[88:91], a[220:223], v[56:59]
    v_mfma_f32_16x16x32_bf16 v[60:63], v[92:95], a[220:223], v[60:63]
    s_waitcnt lgkmcnt(0)
    v_mfma_f32_16x16x32_bf16 v[0:3], v[64:67], a[32:35], v[0:3]
    ds_read_b128 v[80:83], v129 offset:9216
    v_mfma_f32_16x16x32_bf16 v[4:7], v[68:71], a[32:35], v[4:7]
    ds_read_b128 v[84:87], v129 offset:25600
    v_mfma_f32_16x16x32_bf16 v[8:11], v[72:75], a[32:35], v[8:11]
    ds_read_b128 v[88:91], v129 offset:41984
    v_mfma_f32_16x16x32_bf16 v[12:15], v[76:79], a[32:35], v[12:15]
    ds_read_b128 v[92:95], v129 offset:58368
    v_mfma_f32_16x16x32_bf16 v[16:19], v[64:67], a[96:99], v[16:19]
    v_mfma_f32_16x16x32_bf16 v[20:23], v[68:71], a[96:99], v[20:23]
    s_add_u32 m0, s44, 14336
    s_add_u32 s35, s45, 14336
    buffer_load_dwordx4 v251, s[4:7], s35 offen sc1 lds
    v_mfma_f32_16x16x32_bf16 v[24:27], v[72:75], a[96:99], v[24:27]
    v_mfma_f32_16x16x32_bf16 v[28:31], v[76:79], a[96:99], v[28:31]
    v_mfma_f32_16x16x32_bf16 v[32:35], v[64:67], a[160:163], v[32:35]
    v_mfma_f32_16x16x32_bf16 v[36:39], v[68:71], a[160:163], v[36:39]
    v_mfma_f32_16x16x32_bf16 v[40:43], v[72:75], a[160:163], v[40:43]
    v_mfma_f32_16x16x32_bf16 v[44:47], v[76:79], a[160:163], v[44:47]
    v_mfma_f32_16x16x32_bf16 v[48:51], v[64:67], a[224:227], v[48:51]
    v_mfma_f32_16x16x32_bf16 v[52:55], v[68:71], a[224:227], v[52:55]
    v_mfma_f32_16x16x32_bf16 v[56:59], v[72:75], a[224:227], v[56:59]
    v_mfma_f32_16x16x32_bf16 v[60:63], v[76:79], a[224:227], v[60:63]
    s_waitcnt lgkmcnt(0)
    v_mfma_f32_16x16x32_bf16 v[0:3], v[80:83], a[36:39], v[0:3]
    ds_read_b128 v[64:67], v129 offset:10240
    v_mfma_f32_16x16x32_bf16 v[4:7], v[84:87], a[36:39], v[4:7]
    ds_read_b128 v[68:71], v129 offset:26624
    v_mfma_f32_16x16x32_bf16 v[8:11], v[88:91], a[36:39], v[8:11]
    ds_read_b128 v[72:75], v129 offset:43008
    v_mfma_f32_16x16x32_bf16 v[12:15], v[92:95], a[36:39], v[12:15]
    ds_read_b128 v[76:79], v129 offset:59392
    v_mfma_f32_16x16x32_bf16 v[16:19], v[80:83], a[100:103], v[16:19]
    v_mfma_f32_16x16x32_bf16 v[20:23], v[84:87], a[100:103], v[20:23]
    s_add_u32 m0, s44, 15360
    s_add_u32 s35, s45, 15360
    buffer_load_dwordx4 v251, s[4:7], s35 offen sc1 lds
    v_mfma_f32_16x16x32_bf16 v[24:27], v[88:91], a[100:103], v[24:27]
    v_mfma_f32_16x16x32_bf16 v[28:31], v[92:95], a[100:103], v[28:31]
    v_mfma_f32_16x16x32_bf16 v[32:35], v[80:83], a[164:167], v[32:35]
    v_mfma_f32_16x16x32_bf16 v[36:39], v[84:87], a[164:167], v[36:39]
    v_mfma_f32_16x16x32_bf16 v[40:43], v[88:91], a[164:167], v[40:43]
    v_mfma_f32_16x16x32_bf16 v[44:47], v[92:95], a[164:167], v[44:47]
    v_mfma_f32_16x16x32_bf16 v[48:51], v[80:83], a[228:231], v[48:51]
    v_mfma_f32_16x16x32_bf16 v[52:55], v[84:87], a[228:231], v[52:55]
    v_mfma_f32_16x16x32_bf16 v[56:59], v[88:91], a[228:231], v[56:59]
    v_mfma_f32_16x16x32_bf16 v[60:63], v[92:95], a[228:231], v[60:63]
    s_waitcnt lgkmcnt(0)
    v_mfma_f32_16x16x32_bf16 v[0:3], v[64:67], a[40:43], v[0:3]
    ds_read_b128 v[80:83], v129 offset:11264
    v_mfma_f32_16x16x32_bf16 v[4:7], v[68:71], a[40:43], v[4:7]
    ds_read_b128 v[84:87], v129 offset:27648
    v_mfma_f32_16x16x32_bf16 v[8:11], v[72:75], a[40:43], v[8:11]
    ds_read_b128 v[88:91], v129 offset:44032
    v_mfma_f32_16x16x32_bf16 v[12:15], v[76:79], a[40:43], v[12:15]
    ds_read_b128 v[92:95], v129 offset:60416
    v_mfma_f32_16x16x32_bf16 v[16:19], v[64:67], a[104:107], v[16:19]
    v_mfma_f32_16x16x32_bf16 v[20:23], v[68:71], a[104:107], v[20:23]
    v_mfma_f32_16x16x32_bf16 v[24:27], v[72:75], a[104:107], v[24:27]
    v_mfma_f32_16x16x32_bf16 v[28:31], v[76:79], a[104:107], v[28:31]
    v_mfma_f32_16x16x32_bf16 v[32:35], v[64:67], a[168:171], v[32:35]
    v_mfma_f32_16x16x32_bf16 v[36:39], v[68:71], a[168:171], v[36:39]
    v_mfma_f32_16x16x32_bf16 v[40:43], v[72:75], a[168:171], v[40:43]
    v_mfma_f32_16x16x32_bf16 v[44:47], v[76:79], a[168:171], v[44:47]
    v_mfma_f32_16x16x32_bf16 v[48:51], v[64:67], a[232:235], v[48:51]
    v_mfma_f32_16x16x32_bf16 v[52:55], v[68:71], a[232:235], v[52:55]
    v_mfma_f32_16x16x32_bf16 v[56:59], v[72:75], a[232:235], v[56:59]
    v_mfma_f32_16x16x32_bf16 v[60:63], v[76:79], a[232:235], v[60:63]
    s_waitcnt lgkmcnt(0)
    v_mfma_f32_16x16x32_bf16 v[0:3], v[80:83], a[44:47], v[0:3]
    ds_read_b128 v[64:67], v129 offset:12288
    v_mfma_f32_16x16x32_bf16 v[4:7], v[84:87], a[44:47], v[4:7]
    ds_read_b128 v[68:71], v129 offset:28672
    v_mfma_f32_16x16x32_bf16 v[8:11], v[88:91], a[44:47], v[8:11]
    ds_read_b128 v[72:75], v129 offset:45056
    v_mfma_f32_16x16x32_bf16 v[12:15], v[92:95], a[44:47], v[12:15]
    ds_read_b128 v[76:79], v129 offset:61440
    v_mfma_f32_16x16x32_bf16 v[16:19], v[80:83], a[108:111], v[16:19]
    v_mfma_f32_16x16x32_bf16 v[20:23], v[84:87], a[108:111], v[20:23]
    v_mfma_f32_16x16x32_bf16 v[24:27], v[88:91], a[108:111], v[24:27]
    v_mfma_f32_16x16x32_bf16 v[28:31], v[92:95], a[108:111], v[28:31]
    v_mfma_f32_16x16x32_bf16 v[32:35], v[80:83], a[172:175], v[32:35]
    v_mfma_f32_16x16x32_bf16 v[36:39], v[84:87], a[172:175], v[36:39]
    v_mfma_f32_16x16x32_bf16 v[40:43], v[88:91], a[172:175], v[40:43]
    v_mfma_f32_16x16x32_bf16 v[44:47], v[92:95], a[172:175], v[44:47]
    v_mfma_f32_16x16x32_bf16 v[48:51], v[80:83], a[236:239], v[48:51]
    v_mfma_f32_16x16x32_bf16 v[52:55], v[84:87], a[236:239], v[52:55]
    v_mfma_f32_16x16x32_bf16 v[56:59], v[88:91], a[236:239], v[56:59]
    v_mfma_f32_16x16x32_bf16 v[60:63], v[92:95], a[236:239], v[60:63]
    s_waitcnt lgkmcnt(0)
    v_mfma_f32_16x16x32_bf16 v[0:3], v[64:67], a[48:51], v[0:3]
    ds_read_b128 v[80:83], v129 offset:13312
    v_mfma_f32_16x16x32_bf16 v[4:7], v[68:71], a[48:51], v[4:7]
    ds_read_b128 v[84:87], v129 offset:29696
    v_mfma_f32_16x16x32_bf16 v[8:11], v[72:75], a[48:51], v[8:11]
    ds_read_b128 v[88:91], v129 offset:46080
    v_mfma_f32_16x16x32_bf16 v[12:15], v[76:79], a[48:51], v[12:15]
    ds_read_b128 v[92:95], v129 offset:62464
    v_mfma_f32_16x16x32_bf16 v[16:19], v[64:67], a[112:115], v[16:19]
    v_mfma_f32_16x16x32_bf16 v[20:23], v[68:71], a[112:115], v[20:23]
    v_mfma_f32_16x16x32_bf16 v[24:27], v[72:75], a[112:115], v[24:27]
    v_mfma_f32_16x16x32_bf16 v[28:31], v[76:79], a[112:115], v[28:31]
    v_mfma_f32_16x16x32_bf16 v[32:35], v[64:67], a[176:179], v[32:35]
    v_mfma_f32_16x16x32_bf16 v[36:39], v[68:71], a[176:179], v[36:39]
    v_mfma_f32_16x16x32_bf16 v[40:43], v[72:75], a[176:179], v[40:43]
    v_mfma_f32_16x16x32_bf16 v[44:47], v[76:79], a[176:179], v[44:47]
    v_mfma_f32_16x16x32_bf16 v[48:51], v[64:67], a[240:243], v[48:51]
    v_mfma_f32_16x16x32_bf16 v[52:55], v[68:71], a[240:243], v[52:55]
    v_mfma_f32_16x16x32_bf16 v[56:59], v[72:75], a[240:243], v[56:59]
    v_mfma_f32_16x16x32_bf16 v[60:63], v[76:79], a[240:243], v[60:63]
    s_waitcnt lgkmcnt(0)
    v_mfma_f32_16x16x32_bf16 v[0:3], v[80:83], a[52:55], v[0:3]
    ds_read_b128 v[64:67], v129 offset:14336
    v_mfma_f32_16x16x32_bf16 v[4:7], v[84:87], a[52:55], v[4:7]
    ds_read_b128 v[68:71], v129 offset:30720
    v_mfma_f32_16x16x32_bf16 v[8:11], v[88:91], a[52:55], v[8:11]
    ds_read_b128 v[72:75], v129 offset:47104
    v_mfma_f32_16x16x32_bf16 v[12:15], v[92:95], a[52:55], v[12:15]
    ds_read_b128 v[76:79], v129 offset:63488
    v_mfma_f32_16x16x32_bf16 v[16:19], v[80:83], a[116:119], v[16:19]
    v_mfma_f32_16x16x32_bf16 v[20:23], v[84:87], a[116:119], v[20:23]
    v_mfma_f32_16x16x32_bf16 v[24:27], v[88:91], a[116:119], v[24:27]
    v_mfma_f32_16x16x32_bf16 v[28:31], v[92:95], a[116:119], v[28:31]
    v_mfma_f32_16x16x32_bf16 v[32:35], v[80:83], a[180:183], v[32:35]
    v_mfma_f32_16x16x32_bf16 v[36:39], v[84:87], a[180:183], v[36:39]
    v_mfma_f32_16x16x32_bf16 v[40:43], v[88:91], a[180:183], v[40:43]
    v_mfma_f32_16x16x32_bf16 v[44:47], v[92:95], a[180:183], v[44:47]
    v_mfma_f32_16x16x32_bf16 v[48:51], v[80:83], a[244:247], v[48:51]
    v_mfma_f32_16x16x32_bf16 v[52:55], v[84:87], a[244:247], v[52:55]
    v_mfma_f32_16x16x32_bf16 v[56:59], v[88:91], a[244:247], v[56:59]
    v_mfma_f32_16x16x32_bf16 v[60:63], v[92:95], a[244:247], v[60:63]
    s_waitcnt lgkmcnt(0)
    v_mfma_f32_16x16x32_bf16 v[0:3], v[64:67], a[56:59], v[0:3]
    ds_read_b128 v[80:83], v129 offset:15360
    v_mfma_f32_16x16x32_bf16 v[4:7], v[68:71], a[56:59], v[4:7]
    ds_read_b128 v[84:87], v129 offset:31744
    v_mfma_f32_16x16x32_bf16 v[8:11], v[72:75], a[56:59], v[8:11]
    ds_read_b128 v[88:91], v129 offset:48128
    v_mfma_f32_16x16x32_bf16 v[12:15], v[76:79], a[56:59], v[12:15]
    ds_read_b128 v[92:95], v129 offset:64512
    v_mfma_f32_16x16x32_bf16 v[16:19], v[64:67], a[120:123], v[16:19]
    v_mfma_f32_16x16x32_bf16 v[20:23], v[68:71], a[120:123], v[20:23]
    v_mfma_f32_16x16x32_bf16 v[24:27], v[72:75], a[120:123], v[24:27]
    v_mfma_f32_16x16x32_bf16 v[28:31], v[76:79], a[120:123], v[28:31]
    v_mfma_f32_16x16x32_bf16 v[32:35], v[64:67], a[184:187], v[32:35]
    v_mfma_f32_16x16x32_bf16 v[36:39], v[68:71], a[184:187], v[36:39]
    v_mfma_f32_16x16x32_bf16 v[40:43], v[72:75], a[184:187], v[40:43]
    v_mfma_f32_16x16x32_bf16 v[44:47], v[76:79], a[184:187], v[44:47]
    v_mfma_f32_16x16x32_bf16 v[48:51], v[64:67], a[248:251], v[48:51]
    v_mfma_f32_16x16x32_bf16 v[52:55], v[68:71], a[248:251], v[52:55]
    v_mfma_f32_16x16x32_bf16 v[56:59], v[72:75], a[248:251], v[56:59]
    v_mfma_f32_16x16x32_bf16 v[60:63], v[76:79], a[248:251], v[60:63]
    s_waitcnt lgkmcnt(0)
    v_mfma_f32_16x16x32_bf16 v[0:3], v[80:83], a[60:63], v[0:3]
    v_mfma_f32_16x16x32_bf16 v[4:7], v[84:87], a[60:63], v[4:7]
    v_mfma_f32_16x16x32_bf16 v[8:11], v[88:91], a[60:63], v[8:11]
    v_mfma_f32_16x16x32_bf16 v[12:15], v[92:95], a[60:63], v[12:15]
    v_mfma_f32_16x16x32_bf16 v[16:19], v[80:83], a[124:127], v[16:19]
    v_mfma_f32_16x16x32_bf16 v[20:23], v[84:87], a[124:127], v[20:23]
    v_mfma_f32_16x16x32_bf16 v[24:27], v[88:91], a[124:127], v[24:27]
    v_mfma_f32_16x16x32_bf16 v[28:31], v[92:95], a[124:127], v[28:31]
    v_mfma_f32_16x16x32_bf16 v[32:35], v[80:83], a[188:191], v[32:35]
    v_mfma_f32_16x16x32_bf16 v[36:39], v[84:87], a[188:191], v[36:39]
    v_mfma_f32_16x16x32_bf16 v[40:43], v[88:91], a[188:191], v[40:43]
    v_mfma_f32_16x16x32_bf16 v[44:47], v[92:95], a[188:191], v[44:47]
    v_mfma_f32_16x16x32_bf16 v[48:51], v[80:83], a[252:255], v[48:51]
    v_mfma_f32_16x16x32_bf16 v[52:55], v[84:87], a[252:255], v[52:55]
    v_mfma_f32_16x16x32_bf16 v[56:59], v[88:91], a[252:255], v[56:59]
    v_mfma_f32_16x16x32_bf16 v[60:63], v[92:95], a[252:255], v[60:63]
    s_nop 7
    s_lshl_b32 s41, s25, 19
    s_add_u32 s41, s41, s26
    v_mov_b32 v130, v251
    s_add_u32 s60, s41, 0
    v_cvt_pk_bf16_f32 v96, v0, v1
    v_cvt_pk_bf16_f32 v97, v2, v3
    v_cvt_pk_bf16_f32 v98, v4, v5
    v_cvt_pk_bf16_f32 v99, v6, v7
    v_cvt_pk_bf16_f32 v100, v16, v17
    v_cvt_pk_bf16_f32 v101, v18, v19
    v_cvt_pk_bf16_f32 v102, v20, v21
    v_cvt_pk_bf16_f32 v103, v22, v23
    v_cvt_pk_bf16_f32 v104, v32, v33
    v_cvt_pk_bf16_f32 v105, v34, v35
    v_cvt_pk_bf16_f32 v106, v36, v37
    v_cvt_pk_bf16_f32 v107, v38, v39
    v_cvt_pk_bf16_f32 v108, v48, v49
    v_cvt_pk_bf16_f32 v109, v50, v51
    v_cvt_pk_bf16_f32 v110, v52, v53
    v_cvt_pk_bf16_f32 v111, v54, v55
    s_add_u32 s61, s41, 262144
    v_cvt_pk_bf16_f32 v112, v8, v9
    v_cvt_pk_bf16_f32 v113, v10, v11
    v_cvt_pk_bf16_f32 v114, v12, v13
    v_cvt_pk_bf16_f32 v115, v14, v15
    v_cvt_pk_bf16_f32 v116, v24, v25
    v_cvt_pk_bf16_f32 v117, v26, v27
    v_cvt_pk_bf16_f32 v118, v28, v29
    v_cvt_pk_bf16_f32 v119, v30, v31
    v_cvt_pk_bf16_f32 v120, v40, v41
    v_cvt_pk_bf16_f32 v121, v42, v43
    v_cvt_pk_bf16_f32 v122, v44, v45
    v_cvt_pk_bf16_f32 v123, v46, v47
    v_cvt_pk_bf16_f32 v124, v56, v57
    v_cvt_pk_bf16_f32 v125, v58, v59
    v_cvt_pk_bf16_f32 v126, v60, v61
    v_cvt_pk_bf16_f32 v127, v62, v63
    s_lshl_b32 s42, s25, 7
    s_add_u32 s28, s42, s27
    s_mov_b32 s25, s40
    s_cmp_lt_u32 s25, 32
    s_cbranch_scc1 GL_17
GE_18:
    buffer_store_dwordx4 v[96:99], v130, s[4:7], s60 offen offset:0 sc1
    buffer_store_dwordx4 v[100:103], v130, s[4:7], s60 offen offset:1024 sc1
    buffer_store_dwordx4 v[104:107], v130, s[4:7], s60 offen offset:2048 sc1
    buffer_store_dwordx4 v[108:111], v130, s[4:7], s60 offen offset:3072 sc1
    buffer_store_dwordx4 v[112:115], v130, s[4:7], s61 offen offset:0 sc1
    buffer_store_dwordx4 v[116:119], v130, s[4:7], s61 offen offset:1024 sc1
    buffer_store_dwordx4 v[120:123], v130, s[4:7], s61 offen offset:2048 sc1
    buffer_store_dwordx4 v[124:127], v130, s[4:7], s61 offen offset:3072 sc1
    s_waitcnt vmcnt(0)
    s_barrier
    s_cmp_lt_i32 s43, 0
    s_cbranch_scc1 GF_22
    buffer_store_dwordx2 v[254:255], v253, s[4:7], s43 offen sc1
GF_22:
    buffer_store_dwordx2 v[254:255], v253, s[4:7], s28 offen sc1
WS1_14:
    s_and_b32 s28, s21, 1
    s_lshr_b32 s29, s21, 1
    s_mov_b32 s46, 0x3e0293ee
    s_mov_b32 s47, 0x3e0293ee
    s_mov_b32 s50, 0x05040100
    s_mov_b32 s51, 0x07060302
    v_and_b32 v2, 15, v250
    v_lshrrev_b32 v3, 4, v250
    v_and_b32 v4, 3, v250
    v_bfe_u32 v5, v250, 2, 2
    v_mov_b32 v6, 0x4444
    v_mov_b32 v7, 0xEEEE
    v_cmp_gt_u32 vcc, 2, v4
    s_nop 1
    v_cndmask_b32 v220, v7, v6, vcc
    v_add_u32 v6, v3, v5
    v_and_b32 v6, 3, v6
    v_lshlrev_b32 v6, 3, v6
    v_lshl_add_u32 v6, v2, 5, v6
    s_lshl_b32 s40, s28, 11
    v_add_u32 v221, s40, v6
    v_add_u32 v223, s40, v251
    s_lshl_b32 s40, s29, 11
    v_add_u32 v224, s40, v251
    v_add_u32 v6, v3, v4
    v_and_b32 v6, 3, v6
    v_lshlrev_b32 v6, 3, v6
    v_lshrrev_b32 v7, 2, v250
    v_lshl_add_u32 v222, v7, 5, v6
    v_mov_b32 v225, 0xff800000
    s_lshl_b32 s40, s21, 10
    v_add_u32 v227, s40, v251
    s_lshl_b32 s40, s28, 4
    v_lshlrev_b32 v6, 2, v3
    v_sub_u32 v6, v2, v6
    v_add_u32 v6, s40, v6
    v_cmp_le_i32 s[60:61], 0, v6
    v_cmp_le_i32 s[62:63], 1, v6
    v_cmp_le_i32 s[64:65], 2, v6
    v_cmp_le_i32 s[66:67], 3, v6
    v_cmp_le_i32 s[68:69], 16, v6
    v_cmp_le_i32 s[70:71], 17, v6
    v_cmp_le_i32 s[72:73], 18, v6
    v_cmp_le_i32 s[74:75], 19, v6
    v_mov_b32 v208, 0x3f803f80
    v_mov_b32 v209, 0x3f803f80
    v_mov_b32 v210, 0x3f803f80
    v_mov_b32 v211, 0x3f803f80
    v_mov_b32 v212, 0x3f803f80
    v_mov_b32 v213, 0
    s_lshl_b32 s40, s22, 12
    s_add_u32 s40, s40, 94502912
    s_lshr_b32 s41, s22, 1
    s_lshl_b32 s41, s41, 12
    s_add_u32 s41, s41, 94650368
    v_mov_b32 v6, s40
    v_mov_b32 v7, s41
    v_and_b32 v8, 1, v250
    v_cmp_eq_u32 vcc, 1, v8
    s_nop 1
    v_cndmask_b32 v226, v6, v7, vcc
    s_mov_b32 s25, s23
    v_and_b32 v8, 63, v250
    v_lshlrev_b32 v8, 7, v8
    s_mov_b32 s40, 94371840
CR_23:
    buffer_load_dwordx2 v[10:11], v8, s[4:7], s40 offen sc1
    s_sub_u32 s30, s30, 1
    s_cbranch_scc1 L_FAIL
    s_waitcnt vmcnt(0)
    v_and_b32 v11, 0x0fffffff, v11
    v_cmp_ne_u64 vcc, s[38:39], v[10:11]
    s_cbranch_vccnz CR_23
S1_24:
    s_lshr_b32 s40, s25, 1
    s_lshl_b32 s40, s40, 7
WF_25:
    buffer_load_dwordx2 v[214:215], v226, s[4:7], s40 offen offset:0 sc1
    s_waitcnt vmcnt(0)
    v_cmp_ne_u64 vcc, s[38:39], v[214:215]
    s_cbranch_vccz WK_26
    s_sub_u32 s30, s30, 1
    s_cbranch_scc1 L_FAIL
    s_sleep 4
    s_branch WF_25
WK_26:
    s_lshl_b32 s40, s25, 5
    s_add_u32 s40, s40, s22
    s_lshl_b32 s40, s40, 13
    s_lshl_b32 s41, s28, 12
    s_add_u32 s41, s41, s40
    s_add_u32 s41, s41, 35651584
    s_add_u32 s42, s40, 2097152
    s_add_u32 s43, s40, 2101248
    s_lshl_b32 s44, s29, 12
    s_add_u32 s44, s44, s40
    s_add_u32 s44, s44, 18874368
    buffer_load_dwordx4 v[0:3], v251, s[4:7], s41 offen offset:0 sc1
    buffer_load_dwordx4 v[4:7], v251, s[4:7], s41 offen offset:1024 sc1
    buffer_load_dwordx4 v[8:11], v251, s[4:7], s41 offen offset:2048 sc1
    buffer_load_dwordx4 v[12:15], v251, s[4:7], s41 offen offset:3072 sc1
    buffer_load_dwordx4 v[16:19], v251, s[4:7], s42 offen offset:0 sc1
    buffer_load_dwordx4 v[20:23], v251, s[4:7], s42 offen offset:1024 sc1
    buffer_load_dwordx4 v[24:27], v251, s[4:7], s42 offen offset:2048 sc1
    buffer_load_dwordx4 v[28:31], v251, s[4:7], s42 offen offset:3072 sc1
    buffer_load_dwordx4 v[32:35], v251, s[4:7], s43 offen offset:0 sc1
    buffer_load_dwordx4 v[36:39], v251, s[4:7], s43 offen offset:1024 sc1
    buffer_load_dwordx4 v[40:43], v251, s[4:7], s43 offen offset:2048 sc1
    buffer_load_dwordx4 v[44:47], v251, s[4:7], s43 offen offset:3072 sc1
    buffer_load_dwordx4 v[48:51], v251, s[4:7], s44 offen offset:0 sc1
    buffer_load_dwordx4 v[52:55], v251, s[4:7], s44 offen offset:1024 sc1
    buffer_load_dwordx4 v[56:59], v251, s[4:7], s44 offen offset:2048 sc1
    buffer_load_dwordx4 v[60:63], v251, s[4:7], s44 offen offset:3072 sc1
    s_lshl_b32 s40, s25, 13
    s_add_u32 s40, s40, 75497472
    s_add_u32 s41, s40, 4096
    s_lshl_b32 s77, s25, 1
    s_add_u32 s77, s77, s28
    s_lshl_b32 s77, s77, 6
    s_lshl_b32 s76, s22, 1
    s_add_u32 s76, s76, s29
    s_add_u32 s77, s77, s76
    s_lshl_b32 s76, s77, 11
    s_add_u32 s76, s76, 52428800
    s_lshl_b32 s77, s77, 3
    s_add_u32 s77, s77, 94437376
    s_cmp_eq_u32 s25, 63
    s_cselect_b32 s45, 0, 0x80000000
    v_or_b32 v230, s45, v253
    v_mov_b64 v[128:129], 0
    v_mov_b64 v[130:131], 0
    v_mov_b64 v[132:133], 0
    v_mov_b64 v[134:135], 0
    v_mov_b64 v[136:137], 0
    v_mov_b64 v[138:139], 0
    v_mov_b64 v[140:141], 0
    v_mov_b64 v[142:143], 0
    s_waitcnt vmcnt(4)
    v_mfma_f32_16x16x32_bf16 v[144:147], v[16:19], v[0:3], 0
    v_mfma_f32_16x16x32_bf16 v[148:151], v[32:35], v[0:3], 0
    v_mfma_f32_16x16x32_bf16 v[144:147], v[20:23], v[4:7], v[144:147]
    v_mfma_f32_16x16x32_bf16 v[148:151], v[36:39], v[4:7], v[148:151]
    v_mfma_f32_16x16x32_bf16 v[144:147], v[24:27], v[8:11], v[144:147]
    v_mfma_f32_16x16x32_bf16 v[148:151], v[40:43], v[8:11], v[148:151]
    v_mfma_f32_16x16x32_bf16 v[144:147], v[28:31], v[12:15], v[144:147]
    v_mfma_f32_16x16x32_bf16 v[148:151], v[44:47], v[12:15], v[148:151]
    s_nop 7
    v_cndmask_b32 v144, v225, v144, s[60:61]
    v_cndmask_b32 v145, v225, v145, s[62:63]
    v_cndmask_b32 v146, v225, v146, s[64:65]
    v_cndmask_b32 v147, v225, v147, s[66:67]
    v_cndmask_b32 v148, v225, v148, s[68:69]
    v_cndmask_b32 v149, v225, v149, s[70:71]
    v_cndmask_b32 v150, v225, v150, s[72:73]
    v_cndmask_b32 v151, v225, v151, s[74:75]
    s_cmp_eq_u32 s25, 0
    s_cbranch_scc1 FU_28
    s_sub_u32 s42, s40, 8192
CA_27:
    buffer_load_dword v64, v252, s[4:7], s42 offen sc1
    s_sub_u32 s30, s30, 1
    s_cbranch_scc1 L_FAIL
    s_waitcnt vmcnt(0)
    v_cmp_eq_u32 vcc, -1, v64
    s_cbranch_vccz FU_28
    s_sleep 10
    s_branch CA_27
FU_28:
    buffer_load_dwordx4 v[96:99], v227, s[4:7], s40 offen sc1
    buffer_load_dwordx4 v[100:103], v227, s[4:7], s41 offen sc1
    s_sleep 4
    buffer_load_dwordx4 v[96:99], v227, s[4:7], s40 offen sc1
    buffer_load_dwordx4 v[100:103], v227, s[4:7], s41 offen sc1
    s_sleep 4
FV_29:
    buffer_load_dwordx4 v[96:99], v227, s[4:7], s40 offen sc1
    buffer_load_dwordx4 v[100:103], v227, s[4:7], s41 offen sc1
    s_sub_u32 s30, s30, 1
    s_cbranch_scc1 L_FAIL
    s_waitcnt vmcnt(4)
    v_max3_u32 v214, v96, v97, v98
    v_max3_u32 v214, v214, v99, v100
    v_max3_u32 v214, v214, v101, v102
    v_max_u32 v214, v214, v103
    v_cmp_eq_u32 vcc, -1, v214
    s_cbranch_vccnz FV_29
    v_perm_b32 v72, v98, v96, s50
    v_perm_b32 v73, v98, v96, s51
    v_perm_b32 v74, v99, v97, s50
    v_perm_b32 v75, v99, v97, s51
    ds_write_b128 v227, v[72:75] offset:8192
    v_perm_b32 v76, v102, v100, s50
    v_perm_b32 v77, v102, v100, s51
    v_perm_b32 v78, v103, v101, s50
    v_perm_b32 v79, v103, v101, s51
    ds_write_b128 v227, v[76:79] offset:12288
    s_waitcnt lgkmcnt(0)
    s_barrier
    ds_read_b128 v[64:67], v251 offset:8192
    ds_read_b128 v[68:71], v251 offset:9216
    ds_read_b128 v[72:75], v251 offset:10240
    ds_read_b128 v[76:79], v251 offset:11264
    ds_read_b128 v[80:83], v251 offset:12288
    ds_read_b128 v[84:87], v251 offset:13312
    ds_read_b128 v[88:91], v251 offset:14336
    ds_read_b128 v[92:95], v251 offset:15360
    s_waitcnt lgkmcnt(7)
    v_smfmac_f32_16x16x64_bf16 v[128:131], v[64:67], a[0:7], v220
    v_smfmac_f32_16x16x64_bf16 v[132:135], v[64:67], a[64:71], v220
    v_smfmac_f32_16x16x64_bf16 v[136:139], v[64:67], a[128:135], v220
    v_smfmac_f32_16x16x64_bf16 v[140:143], v[64:67], a[192:199], v220
    s_waitcnt lgkmcnt(6)
    v_smfmac_f32_16x16x64_bf16 v[128:131], v[68:71], a[8:15], v220
    v_smfmac_f32_16x16x64_bf16 v[132:135], v[68:71], a[72:79], v220
    v_smfmac_f32_16x16x64_bf16 v[136:139], v[68:71], a[136:143], v220
    v_smfmac_f32_16x16x64_bf16 v[140:143], v[68:71], a[200:207], v220
    s_waitcnt lgkmcnt(5)
    v_smfmac_f32_16x16x64_bf16 v[128:131], v[72:75], a[16:23], v220
    v_smfmac_f32_16x16x64_bf16 v[132:135], v[72:75], a[80:87], v220
    v_smfmac_f32_16x16x64_bf16 v[136:139], v[72:75], a[144:151], v220
    v_smfmac_f32_16x16x64_bf16 v[140:143], v[72:75], a[208:215], v220
    s_waitcnt lgkmcnt(4)
    v_smfmac_f32_16x16x64_bf16 v[128:131], v[76:79], a[24:31], v220
    v_smfmac_f32_16x16x64_bf16 v[132:135], v[76:79], a[88:95], v220
    v_smfmac_f32_16x16x64_bf16 v[136:139], v[76:79], a[152:159], v220
    v_smfmac_f32_16x16x64_bf16 v[140:143], v[76:79], a[216:223], v220
    s_waitcnt lgkmcnt(3)
    v_smfmac_f32_16x16x64_bf16 v[128:131], v[80:83], a[32:39], v220
    v_smfmac_f32_16x16x64_bf16 v[132:135], v[80:83], a[96:103], v220
    v_smfmac_f32_16x16x64_bf16 v[136:139], v[80:83], a[160:167], v220
    v_smfmac_f32_16x16x64_bf16 v[140:143], v[80:83], a[224:231], v220
    s_waitcnt lgkmcnt(2)
    v_smfmac_f32_16x16x64_bf16 v[128:131], v[84:87], a[40:47], v220
    v_smfmac_f32_16x16x64_bf16 v[132:135], v[84:87], a[104:111], v220
    v_smfmac_f32_16x16x64_bf16 v[136:139], v[84:87], a[168:175], v220
    v_smfmac_f32_16x16x64_bf16 v[140:143], v[84:87], a[232:239], v220
    s_waitcnt lgkmcnt(1)
    v_smfmac_f32_16x16x64_bf16 v[128:131], v[88:91], a[48:55], v220
    v_smfmac_f32_16x16x64_bf16 v[132:135], v[88:91], a[112:119], v220
    v_smfmac_f32_16x16x64_bf16 v[136:139], v[88:91], a[176:183], v220
    v_smfmac_f32_16x16x64_bf16 v[140:143], v[88:91], a[240:247], v220
    s_waitcnt lgkmcnt(0)
    v_smfmac_f32_16x16x64_bf16 v[128:131], v[92:95], a[56:63], v220
    v_smfmac_f32_16x16x64_bf16 v[132:135], v[92:95], a[120:127], v220
    v_smfmac_f32_16x16x64_bf16 v[136:139], v[92:95], a[184:191], v220
    v_smfmac_f32_16x16x64_bf16 v[140:143], v[92:95], a[248:255], v220
    s_cmp_lg_u32 s29, 0
    s_nop 6
    s_cbranch_scc1 KV_30
    v_add_f32 v128, v128, v130
    v_add_f32 v129, v129, v131
    v_cvt_pk_bf16_f32 v128, v128, v129
    ds_write_b32 v221, v128 offset:0
    v_add_f32 v132, v132, v134
    v_add_f32 v133, v133, v135
    v_cvt_pk_bf16_f32 v132, v132, v133
    ds_write_b32 v221, v132 offset:512
    v_add_f32 v136, v136, v138
    v_add_f32 v137, v137, v139
    v_cvt_pk_bf16_f32 v136, v136, v137
    ds_write_b32 v221, v136 offset:1024
    v_add_f32 v140, v140, v142
    v_add_f32 v141, v141, v143
    v_cvt_pk_bf16_f32 v140, v140, v141
    ds_write_b32 v221, v140 offset:1536
    s_branch KJ_31
KV_30:
    v_cvt_pk_bf16_f32 v64, v128, v129
    v_cvt_pk_bf16_f32 v65, v130, v131
    v_cvt_pk_bf16_f32 v66, v132, v133
    v_cvt_pk_bf16_f32 v67, v134, v135
    v_cvt_pk_bf16_f32 v68, v136, v137
    v_cvt_pk_bf16_f32 v69, v138, v139
    v_cvt_pk_bf16_f32 v70, v140, v141
    v_cvt_pk_bf16_f32 v71, v142, v143
    ds_write_b128 v223, v[64:67] offset:4096
    ds_write_b128 v223, v[68:71] offset:5120
KJ_31:
    s_waitcnt lgkmcnt(0)
    s_barrier
    ds_read_b64_tr_b16 v[164:165], v222 offset:0
    ds_read_b64_tr_b16 v[166:167], v222 offset:512
    ds_read_b64_tr_b16 v[168:169], v222 offset:1024
    ds_read_b64_tr_b16 v[170:171], v222 offset:1536
    ds_read_b64_tr_b16 v[172:173], v222 offset:2048
    ds_read_b64_tr_b16 v[174:175], v222 offset:2560
    ds_read_b64_tr_b16 v[176:177], v222 offset:3072
    ds_read_b64_tr_b16 v[178:179], v222 offset:3584
    ds_read_b128 v[180:183], v224 offset:4096
    ds_read_b128 v[184:187], v224 offset:5120
    v_max3_f32 v214, v144, v145, v146
    v_max3_f32 v215, v147, v148, v149
    v_max3_f32 v214, v214, v150, v151
    v_max_f32 v214, v214, v215
    s_waitcnt lgkmcnt(0)
    s_barrier
    v_mfma_f32_16x16x32_bf16 v[152:155], v[164:167], v[0:3], 0
    v_mfma_f32_16x16x32_bf16 v[152:155], v[168:171], v[4:7], v[152:155]
    v_mfma_f32_16x16x32_bf16 v[152:155], v[172:175], v[8:11], v[152:155]
    v_mfma_f32_16x16x32_bf16 v[152:155], v[176:179], v[12:15], v[152:155]
    buffer_store_dwordx2 v[254:255], v230, s[4:7], s77 offen sc1
    s_nop 7
    v_max3_f32 v214, v214, v152, v153
    v_mov_b32 v215, v214
    s_nop 1
    v_permlane16_swap_b32 v214, v215
    v_max_f32 v214, v214, v215
    v_mov_b32 v215, v214
    s_nop 1
    v_permlane32_swap_b32 v214, v215
    v_max_f32 v214, v214, v215
    v_pk_add_f32 v[144:145], v[144:145], v[214:215] op_sel_hi:[1,0] neg_lo:[0,1] neg_hi:[0,1]
    v_pk_add_f32 v[146:147], v[146:147], v[214:215] op_sel_hi:[1,0] neg_lo:[0,1] neg_hi:[0,1]
    v_pk_add_f32 v[148:149], v[148:149], v[214:215] op_sel_hi:[1,0] neg_lo:[0,1] neg_hi:[0,1]
    v_pk_add_f32 v[150:151], v[150:151], v[214:215] op_sel_hi:[1,0] neg_lo:[0,1] neg_hi:[0,1]
    v_pk_add_f32 v[152:153], v[152:153], v[214:215] op_sel_hi:[1,0] neg_lo:[0,1] neg_hi:[0,1]
    v_pk_mul_f32 v[144:145], v[144:145], s[46:47]
    v_pk_mul_f32 v[146:147], v[146:147], s[46:47]
    v_pk_mul_f32 v[148:149], v[148:149], s[46:47]
    v_pk_mul_f32 v[150:151], v[150:151], s[46:47]
    v_pk_mul_f32 v[152:153], v[152:153], s[46:47]
    v_exp_f32 v144, v144
    v_exp_f32 v145, v145
    v_exp_f32 v146, v146
    v_exp_f32 v147, v147
    v_exp_f32 v148, v148
    v_exp_f32 v149, v149
    v_exp_f32 v150, v150
    v_exp_f32 v151, v151
    v_exp_f32 v152, v152
    v_exp_f32 v153, v153
    s_nop 0
    v_cvt_pk_bf16_f32 v156, v144, v145
    v_cvt_pk_bf16_f32 v157, v146, v147
    v_cvt_pk_bf16_f32 v158, v148, v149
    v_cvt_pk_bf16_f32 v159, v150, v151
    v_cvt_pk_bf16_f32 v160, v152, v153
    v_cvt_pk_bf16_f32 v161, v152, v153
    s_nop 1
    v_mfma_f32_16x16x32_bf16 v[204:207], v[208:211], v[156:159], 0
    s_nop 0
    v_mfma_f32_16x16x32_bf16 v[188:191], v[48:51], v[156:159], 0
    s_nop 0
    v_mfma_f32_16x16x32_bf16 v[192:195], v[52:55], v[156:159], 0
    s_nop 0
    v_mfma_f32_16x16x32_bf16 v[196:199], v[56:59], v[156:159], 0
    s_nop 0
    v_mfma_f32_16x16x32_bf16 v[200:203], v[60:63], v[156:159], 0
    s_nop 0
    v_mfma_f32_16x16x16_bf16 v[204:207], v[212:213], v[160:161], v[204:207]
    s_nop 0
    v_mfma_f32_16x16x16_bf16 v[188:191], v[180:181], v[160:161], v[188:191]
    s_nop 0
    v_mfma_f32_16x16x16_bf16 v[192:195], v[182:183], v[160:161], v[192:195]
    s_nop 0
    v_mfma_f32_16x16x16_bf16 v[196:199], v[184:185], v[160:161], v[196:199]
    s_nop 0
    v_mfma_f32_16x16x16_bf16 v[200:203], v[186:187], v[160:161], v[200:203]
    v_rcp_f32 v214, v204
    s_nop 0
    v_pk_mul_f32 v[188:189], v[188:189], v[214:215] op_sel_hi:[1,0]
    v_pk_mul_f32 v[190:191], v[190:191], v[214:215] op_sel_hi:[1,0]
    v_pk_mul_f32 v[192:193], v[192:193], v[214:215] op_sel_hi:[1,0]
    v_pk_mul_f32 v[194:195], v[194:195], v[214:215] op_sel_hi:[1,0]
    v_cvt_pk_bf16_f32 v156, v188, v189
    v_cvt_pk_bf16_f32 v157, v190, v191
    v_cvt_pk_bf16_f32 v158, v192, v193
    v_cvt_pk_bf16_f32 v159, v194, v195
    buffer_store_dwordx4 v[156:159], v251, s[4:7], s76 offen offset:0 sc1
    v_pk_mul_f32 v[196:197], v[196:197], v[214:215] op_sel_hi:[1,0]
    v_pk_mul_f32 v[198:199], v[198:199], v[214:215] op_sel_hi:[1,0]
    v_pk_mul_f32 v[200:201], v[200:201], v[214:215] op_sel_hi:[1,0]
    v_pk_mul_f32 v[202:203], v[202:203], v[214:215] op_sel_hi:[1,0]
    v_cvt_pk_bf16_f32 v160, v196, v197
    v_cvt_pk_bf16_f32 v161, v198, v199
    v_cvt_pk_bf16_f32 v162, v200, v201
    v_cvt_pk_bf16_f32 v163, v202, v203
    buffer_store_dwordx4 v[160:163], v251, s[4:7], s76 offen offset:1024 sc1
    s_cmp_eq_u32 s25, 63
    s_cbranch_scc1 LX_32
    s_waitcnt vmcnt(0)
    buffer_store_dwordx2 v[254:255], v253, s[4:7], s77 offen sc1
LX_32:
    s_add_u32 s25, s25, 3
    s_cmp_lt_u32 s25, 64
    s_cbranch_scc1 S1_24
    s_endpgm
WQ_2:
    s_sub_u32 s40, s20, 128
    s_lshr_b32 s22, s40, 2
    s_and_b32 s23, s40, 3
    s_load_dwordx2 s[52:53], s[0:1], 0
    s_mov_b32 s54, 2097152
    s_mov_b32 s55, 0x20000
    s_waitcnt lgkmcnt(0)
    v_and_b32 v1, 15, v250
    v_lshrrev_b32 v2, 4, v250
    v_lshlrev_b32 v3, 10, v1
    v_lshl_add_u32 v3, v2, 4, v3
    s_lshl_b32 s41, s40, 14
    s_lshl_b32 s42, s21, 8
    s_add_u32 s42, s42, s41
    buffer_load_dwordx4 v[32:35], v3, s[52:55], s42 offen offset:0 nt
    buffer_load_dwordx4 v[36:39], v3, s[52:55], s42 offen offset:64 nt
    buffer_load_dwordx4 v[40:43], v3, s[52:55], s42 offen offset:128 nt
    buffer_load_dwordx4 v[44:47], v3, s[52:55], s42 offen offset:192 nt
    s_add_u32 s42, s42, 1048576
    buffer_load_dwordx4 v[48:51], v3, s[52:55], s42 offen offset:0 nt
    buffer_load_dwordx4 v[52:55], v3, s[52:55], s42 offen offset:64 nt
    buffer_load_dwordx4 v[56:59], v3, s[52:55], s42 offen offset:128 nt
    buffer_load_dwordx4 v[60:63], v3, s[52:55], s42 offen offset:192 nt
    s_lshl_b32 s43, s21, 7
    v_lshlrev_b32 v4, 3, v1
    v_add_u32 v5, s43, v4
    s_lshl_b32 s42, s21, 12
    s_add_u32 s42, s42, s41
    s_lshl_b32 s44, s40, 7
    s_add_u32 s44, s44, 94404608
    s_mov_b32 s30, 1000000
TP_33:
    buffer_load_dwordx2 v[254:255], v252, s[16:19], 0 offen sc1
    s_sub_u32 s30, s30, 1
    s_cbranch_scc1 L_FAIL
    s_waitcnt vmcnt(0)
    v_readfirstlane_b32 s38, v254
    v_readfirstlane_b32 s39, v255
    s_nop 3
    s_cmp_eq_u32 s39, 0
    s_cbranch_scc1 TP_33
    s_mov_b32 s30, 0x400000
    s_bfe_u32 s32, s39, 0x30018
    s_cmp_lg_u32 s32, s3
    s_cbranch_scc1 L_RESTART
    v_lshlrev_b32 v64, 16, v32
    v_and_b32 v65, 0xffff0000, v32
    v_lshlrev_b32 v66, 16, v33
    v_and_b32 v67, 0xffff0000, v33
    v_lshlrev_b32 v68, 16, v34
    v_and_b32 v69, 0xffff0000, v34
    v_lshlrev_b32 v70, 16, v35
    v_and_b32 v71, 0xffff0000, v35
    v_lshlrev_b32 v72, 16, v36
    v_and_b32 v73, 0xffff0000, v36
    v_lshlrev_b32 v74, 16, v37
    v_and_b32 v75, 0xffff0000, v37
    v_lshlrev_b32 v76, 16, v38
    v_and_b32 v77, 0xffff0000, v38
    v_lshlrev_b32 v78, 16, v39
    v_and_b32 v79, 0xffff0000, v39
    v_lshlrev_b32 v80, 16, v40
    v_and_b32 v81, 0xffff0000, v40
    v_lshlrev_b32 v82, 16, v41
    v_and_b32 v83, 0xffff0000, v41
    v_lshlrev_b32 v84, 16, v42
    v_and_b32 v85, 0xffff0000, v42
    v_lshlrev_b32 v86, 16, v43
    v_and_b32 v87, 0xffff0000, v43
    v_lshlrev_b32 v88, 16, v44
    v_and_b32 v89, 0xffff0000, v44
    v_lshlrev_b32 v90, 16, v45
    v_and_b32 v91, 0xffff0000, v45
    v_lshlrev_b32 v92, 16, v46
    v_and_b32 v93, 0xffff0000, v46
    v_lshlrev_b32 v94, 16, v47
    v_and_b32 v95, 0xffff0000, v47
    v_pk_add_f32 v[8:9], v[64:65], v[66:67]
    v_pk_add_f32 v[8:9], v[8:9], v[68:69]
    v_pk_add_f32 v[8:9], v[8:9], v[70:71]
    v_pk_add_f32 v[8:9], v[8:9], v[72:73]
    v_pk_add_f32 v[8:9], v[8:9], v[74:75]
    v_pk_add_f32 v[8:9], v[8:9], v[76:77]
    v_pk_add_f32 v[8:9], v[8:9], v[78:79]
    v_pk_add_f32 v[8:9], v[8:9], v[80:81]
    v_pk_add_f32 v[8:9], v[8:9], v[82:83]
    v_pk_add_f32 v[8:9], v[8:9], v[84:85]
    v_pk_add_f32 v[8:9], v[8:9], v[86:87]
    v_pk_add_f32 v[8:9], v[8:9], v[88:89]
    v_pk_add_f32 v[8:9], v[8:9], v[90:91]
    v_pk_add_f32 v[8:9], v[8:9], v[92:93]
    v_pk_add_f32 v[8:9], v[8:9], v[94:95]
    v_add_f32 v8, v8, v9
    v_mov_b32 v10, v8
    s_nop 1
    v_permlane16_swap_b32 v8, v10
    v_add_f32 v8, v8, v10
    v_mov_b32 v10, v8
    s_nop 1
    v_permlane32_swap_b32 v8, v10
    v_add_f32 v8, v8, v10
    v_mul_f32 v8, 0x3c000000, v8
    v_mov_b64 v[12:13], 0
    v_pk_add_f32 v[10:11], v[64:65], v[8:9] op_sel_hi:[1,0] neg_lo:[0,1] neg_hi:[0,1]
    v_pk_fma_f32 v[12:13], v[10:11], v[10:11], v[12:13]
    v_pk_add_f32 v[10:11], v[66:67], v[8:9] op_sel_hi:[1,0] neg_lo:[0,1] neg_hi:[0,1]
    v_pk_fma_f32 v[12:13], v[10:11], v[10:11], v[12:13]
    v_pk_add_f32 v[10:11], v[68:69], v[8:9] op_sel_hi:[1,0] neg_lo:[0,1] neg_hi:[0,1]
    v_pk_fma_f32 v[12:13], v[10:11], v[10:11], v[12:13]
    v_pk_add_f32 v[10:11], v[70:71], v[8:9] op_sel_hi:[1,0] neg_lo:[0,1] neg_hi:[0,1]
    v_pk_fma_f32 v[12:13], v[10:11], v[10:11], v[12:13]
    v_pk_add_f32 v[10:11], v[72:73], v[8:9] op_sel_hi:[1,0] neg_lo:[0,1] neg_hi:[0,1]
    v_pk_fma_f32 v[12:13], v[10:11], v[10:11], v[12:13]
    v_pk_add_f32 v[10:11], v[74:75], v[8:9] op_sel_hi:[1,0] neg_lo:[0,1] neg_hi:[0,1]
    v_pk_fma_f32 v[12:13], v[10:11], v[10:11], v[12:13]
    v_pk_add_f32 v[10:11], v[76:77], v[8:9] op_sel_hi:[1,0] neg_lo:[0,1] neg_hi:[0,1]
    v_pk_fma_f32 v[12:13], v[10:11], v[10:11], v[12:13]
    v_pk_add_f32 v[10:11], v[78:79], v[8:9] op_sel_hi:[1,0] neg_lo:[0,1] neg_hi:[0,1]
    v_pk_fma_f32 v[12:13], v[10:11], v[10:11], v[12:13]
    v_pk_add_f32 v[10:11], v[80:81], v[8:9] op_sel_hi:[1,0] neg_lo:[0,1] neg_hi:[0,1]
    v_pk_fma_f32 v[12:13], v[10:11], v[10:11], v[12:13]
    v_pk_add_f32 v[10:11], v[82:83], v[8:9] op_sel_hi:[1,0] neg_lo:[0,1] neg_hi:[0,1]
    v_pk_fma_f32 v[12:13], v[10:11], v[10:11], v[12:13]
    v_pk_add_f32 v[10:11], v[84:85], v[8:9] op_sel_hi:[1,0] neg_lo:[0,1] neg_hi:[0,1]
    v_pk_fma_f32 v[12:13], v[10:11], v[10:11], v[12:13]
    v_pk_add_f32 v[10:11], v[86:87], v[8:9] op_sel_hi:[1,0] neg_lo:[0,1] neg_hi:[0,1]
    v_pk_fma_f32 v[12:13], v[10:11], v[10:11], v[12:13]
    v_pk_add_f32 v[10:11], v[88:89], v[8:9] op_sel_hi:[1,0] neg_lo:[0,1] neg_hi:[0,1]
    v_pk_fma_f32 v[12:13], v[10:11], v[10:11], v[12:13]
    v_pk_add_f32 v[10:11], v[90:91], v[8:9] op_sel_hi:[1,0] neg_lo:[0,1] neg_hi:[0,1]
    v_pk_fma_f32 v[12:13], v[10:11], v[10:11], v[12:13]
    v_pk_add_f32 v[10:11], v[92:93], v[8:9] op_sel_hi:[1,0] neg_lo:[0,1] neg_hi:[0,1]
    v_pk_fma_f32 v[12:13], v[10:11], v[10:11], v[12:13]
    v_pk_add_f32 v[10:11], v[94:95], v[8:9] op_sel_hi:[1,0] neg_lo:[0,1] neg_hi:[0,1]
    v_pk_fma_f32 v[12:13], v[10:11], v[10:11], v[12:13]
    v_add_f32 v9, v12, v13
    v_mov_b32 v10, v9
    s_nop 1
    v_permlane16_swap_b32 v9, v10
    v_add_f32 v9, v9, v10
    v_mov_b32 v10, v9
    s_nop 1
    v_permlane32_swap_b32 v9, v10
    v_add_f32 v9, v9, v10
    ds_write_b64 v5, v[8:9] offset:0
    s_waitcnt lgkmcnt(0)
    s_barrier
    ds_read_b64 v[16:17], v4 offset:0
    ds_read_b64 v[18:19], v4 offset:128
    ds_read_b64 v[20:21], v4 offset:256
    ds_read_b64 v[22:23], v4 offset:384
    s_waitcnt lgkmcnt(0)
    v_add_f32 v8, v16, v18
    v_add_f32 v9, v20, v22
    v_add_f32 v8, v8, v9
    v_mul_f32 v8, 0x3e800000, v8
    v_add_f32 v9, v17, v19
    v_add_f32 v10, v21, v23
    v_add_f32 v9, v9, v10
    v_sub_f32 v16, v16, v8
    v_sub_f32 v18, v18, v8
    v_sub_f32 v20, v20, v8
    v_sub_f32 v22, v22, v8
    v_mul_f32 v10, v16, v16
    v_fmac_f32 v10, v18, v18
    v_fmac_f32 v10, v20, v20
    v_fmac_f32 v10, v22, v22
    v_mul_f32 v10, 0x43000000, v10
    v_add_f32 v9, v9, v10
    v_mul_f32 v12, 0x3b000000, v9
    v_cvt_pk_bf16_f32 v8, v8, v8
    v_and_b32 v8, 0xffff0000, v8
    v_cvt_pk_bf16_f32 v12, v12, v12
    v_and_b32 v12, 0xffff0000, v12
    v_add_f32 v12, 0x3727c5ac, v12
    v_cvt_pk_bf16_f32 v12, v12, v12
    v_and_b32 v12, 0xffff0000, v12
    v_sqrt_f32 v12, v12
    s_nop 0
    v_cvt_pk_bf16_f32 v12, v12, v12
    v_and_b32 v12, 0xffff0000, v12
    v_rcp_f32 v12, v12
    v_pk_add_f32 v[64:65], v[64:65], v[8:9] op_sel_hi:[1,0] neg_lo:[0,1] neg_hi:[0,1]
    v_cvt_pk_bf16_f32 v10, v64, v65
    v_lshlrev_b32 v64, 16, v10
    v_and_b32 v65, 0xffff0000, v10
    v_pk_mul_f32 v[64:65], v[64:65], v[12:13] op_sel_hi:[1,0]
    v_cvt_pk_bf16_f32 v32, v64, v65
    v_pk_add_f32 v[66:67], v[66:67], v[8:9] op_sel_hi:[1,0] neg_lo:[0,1] neg_hi:[0,1]
    v_cvt_pk_bf16_f32 v10, v66, v67
    v_lshlrev_b32 v66, 16, v10
    v_and_b32 v67, 0xffff0000, v10
    v_pk_mul_f32 v[66:67], v[66:67], v[12:13] op_sel_hi:[1,0]
    v_cvt_pk_bf16_f32 v33, v66, v67
    v_pk_add_f32 v[68:69], v[68:69], v[8:9] op_sel_hi:[1,0] neg_lo:[0,1] neg_hi:[0,1]
    v_cvt_pk_bf16_f32 v10, v68, v69
    v_lshlrev_b32 v68, 16, v10
    v_and_b32 v69, 0xffff0000, v10
    v_pk_mul_f32 v[68:69], v[68:69], v[12:13] op_sel_hi:[1,0]
    v_cvt_pk_bf16_f32 v34, v68, v69
    v_pk_add_f32 v[70:71], v[70:71], v[8:9] op_sel_hi:[1,0] neg_lo:[0,1] neg_hi:[0,1]
    v_cvt_pk_bf16_f32 v10, v70, v71
    v_lshlrev_b32 v70, 16, v10
    v_and_b32 v71, 0xffff0000, v10
    v_pk_mul_f32 v[70:71], v[70:71], v[12:13] op_sel_hi:[1,0]
    v_cvt_pk_bf16_f32 v35, v70, v71
    buffer_store_dwordx4 v[32:35], v251, s[4:7], s42 offen offset:0 sc1
    v_pk_add_f32 v[72:73], v[72:73], v[8:9] op_sel_hi:[1,0] neg_lo:[0,1] neg_hi:[0,1]
    v_cvt_pk_bf16_f32 v10, v72, v73
    v_lshlrev_b32 v72, 16, v10
    v_and_b32 v73, 0xffff0000, v10
    v_pk_mul_f32 v[72:73], v[72:73], v[12:13] op_sel_hi:[1,0]
    v_cvt_pk_bf16_f32 v36, v72, v73
    v_pk_add_f32 v[74:75], v[74:75], v[8:9] op_sel_hi:[1,0] neg_lo:[0,1] neg_hi:[0,1]
    v_cvt_pk_bf16_f32 v10, v74, v75
    v_lshlrev_b32 v74, 16, v10
    v_and_b32 v75, 0xffff0000, v10
    v_pk_mul_f32 v[74:75], v[74:75], v[12:13] op_sel_hi:[1,0]
    v_cvt_pk_bf16_f32 v37, v74, v75
    v_pk_add_f32 v[76:77], v[76:77], v[8:9] op_sel_hi:[1,0] neg_lo:[0,1] neg_hi:[0,1]
    v_cvt_pk_bf16_f32 v10, v76, v77
    v_lshlrev_b32 v76, 16, v10
    v_and_b32 v77, 0xffff0000, v10
    v_pk_mul_f32 v[76:77], v[76:77], v[12:13] op_sel_hi:[1,0]
    v_cvt_pk_bf16_f32 v38, v76, v77
    v_pk_add_f32 v[78:79], v[78:79], v[8:9] op_sel_hi:[1,0] neg_lo:[0,1] neg_hi:[0,1]
    v_cvt_pk_bf16_f32 v10, v78, v79
    v_lshlrev_b32 v78, 16, v10
    v_and_b32 v79, 0xffff0000, v10
    v_pk_mul_f32 v[78:79], v[78:79], v[12:13] op_sel_hi:[1,0]
    v_cvt_pk_bf16_f32 v39, v78, v79
    buffer_store_dwordx4 v[36:39], v251, s[4:7], s42 offen offset:1024 sc1
    v_pk_add_f32 v[80:81], v[80:81], v[8:9] op_sel_hi:[1,0] neg_lo:[0,1] neg_hi:[0,1]
    v_cvt_pk_bf16_f32 v10, v80, v81
    v_lshlrev_b32 v80, 16, v10
    v_and_b32 v81, 0xffff0000, v10
    v_pk_mul_f32 v[80:81], v[80:81], v[12:13] op_sel_hi:[1,0]
    v_cvt_pk_bf16_f32 v40, v80, v81
    v_pk_add_f32 v[82:83], v[82:83], v[8:9] op_sel_hi:[1,0] neg_lo:[0,1] neg_hi:[0,1]
    v_cvt_pk_bf16_f32 v10, v82, v83
    v_lshlrev_b32 v82, 16, v10
    v_and_b32 v83, 0xffff0000, v10
    v_pk_mul_f32 v[82:83], v[82:83], v[12:13] op_sel_hi:[1,0]
    v_cvt_pk_bf16_f32 v41, v82, v83
    v_pk_add_f32 v[84:85], v[84:85], v[8:9] op_sel_hi:[1,0] neg_lo:[0,1] neg_hi:[0,1]
    v_cvt_pk_bf16_f32 v10, v84, v85
    v_lshlrev_b32 v84, 16, v10
    v_and_b32 v85, 0xffff0000, v10
    v_pk_mul_f32 v[84:85], v[84:85], v[12:13] op_sel_hi:[1,0]
    v_cvt_pk_bf16_f32 v42, v84, v85
    v_pk_add_f32 v[86:87], v[86:87], v[8:9] op_sel_hi:[1,0] neg_lo:[0,1] neg_hi:[0,1]
    v_cvt_pk_bf16_f32 v10, v86, v87
    v_lshlrev_b32 v86, 16, v10
    v_and_b32 v87, 0xffff0000, v10
    v_pk_mul_f32 v[86:87], v[86:87], v[12:13] op_sel_hi:[1,0]
    v_cvt_pk_bf16_f32 v43, v86, v87
    buffer_store_dwordx4 v[40:43], v251, s[4:7], s42 offen offset:2048 sc1
    v_pk_add_f32 v[88:89], v[88:89], v[8:9] op_sel_hi:[1,0] neg_lo:[0,1] neg_hi:[0,1]
    v_cvt_pk_bf16_f32 v10, v88, v89
    v_lshlrev_b32 v88, 16, v10
    v_and_b32 v89, 0xffff0000, v10
    v_pk_mul_f32 v[88:89], v[88:89], v[12:13] op_sel_hi:[1,0]
    v_cvt_pk_bf16_f32 v44, v88, v89
    v_pk_add_f32 v[90:91], v[90:91], v[8:9] op_sel_hi:[1,0] neg_lo:[0,1] neg_hi:[0,1]
    v_cvt_pk_bf16_f32 v10, v90, v91
    v_lshlrev_b32 v90, 16, v10
    v_and_b32 v91, 0xffff0000, v10
    v_pk_mul_f32 v[90:91], v[90:91], v[12:13] op_sel_hi:[1,0]
    v_cvt_pk_bf16_f32 v45, v90, v91
    v_pk_add_f32 v[92:93], v[92:93], v[8:9] op_sel_hi:[1,0] neg_lo:[0,1] neg_hi:[0,1]
    v_cvt_pk_bf16_f32 v10, v92, v93
    v_lshlrev_b32 v92, 16, v10
    v_and_b32 v93, 0xffff0000, v10
    v_pk_mul_f32 v[92:93], v[92:93], v[12:13] op_sel_hi:[1,0]
    v_cvt_pk_bf16_f32 v46, v92, v93
    v_pk_add_f32 v[94:95], v[94:95], v[8:9] op_sel_hi:[1,0] neg_lo:[0,1] neg_hi:[0,1]
    v_cvt_pk_bf16_f32 v10, v94, v95
    v_lshlrev_b32 v94, 16, v10
    v_and_b32 v95, 0xffff0000, v10
    v_pk_mul_f32 v[94:95], v[94:95], v[12:13] op_sel_hi:[1,0]
    v_cvt_pk_bf16_f32 v47, v94, v95
    buffer_store_dwordx4 v[44:47], v251, s[4:7], s42 offen offset:3072 sc1
    v_lshlrev_b32 v64, 16, v48
    v_and_b32 v65, 0xffff0000, v48
    v_lshlrev_b32 v66, 16, v49
    v_and_b32 v67, 0xffff0000, v49
    v_lshlrev_b32 v68, 16, v50
    v_and_b32 v69, 0xffff0000, v50
    v_lshlrev_b32 v70, 16, v51
    v_and_b32 v71, 0xffff0000, v51
    v_lshlrev_b32 v72, 16, v52
    v_and_b32 v73, 0xffff0000, v52
    v_lshlrev_b32 v74, 16, v53
    v_and_b32 v75, 0xffff0000, v53
    v_lshlrev_b32 v76, 16, v54
    v_and_b32 v77, 0xffff0000, v54
    v_lshlrev_b32 v78, 16, v55
    v_and_b32 v79, 0xffff0000, v55
    v_lshlrev_b32 v80, 16, v56
    v_and_b32 v81, 0xffff0000, v56
    v_lshlrev_b32 v82, 16, v57
    v_and_b32 v83, 0xffff0000, v57
    v_lshlrev_b32 v84, 16, v58
    v_and_b32 v85, 0xffff0000, v58
    v_lshlrev_b32 v86, 16, v59
    v_and_b32 v87, 0xffff0000, v59
    v_lshlrev_b32 v88, 16, v60
    v_and_b32 v89, 0xffff0000, v60
    v_lshlrev_b32 v90, 16, v61
    v_and_b32 v91, 0xffff0000, v61
    v_lshlrev_b32 v92, 16, v62
    v_and_b32 v93, 0xffff0000, v62
    v_lshlrev_b32 v94, 16, v63
    v_and_b32 v95, 0xffff0000, v63
    v_pk_add_f32 v[8:9], v[64:65], v[66:67]
    v_pk_add_f32 v[8:9], v[8:9], v[68:69]
    v_pk_add_f32 v[8:9], v[8:9], v[70:71]
    v_pk_add_f32 v[8:9], v[8:9], v[72:73]
    v_pk_add_f32 v[8:9], v[8:9], v[74:75]
    v_pk_add_f32 v[8:9], v[8:9], v[76:77]
    v_pk_add_f32 v[8:9], v[8:9], v[78:79]
    v_pk_add_f32 v[8:9], v[8:9], v[80:81]
    v_pk_add_f32 v[8:9], v[8:9], v[82:83]
    v_pk_add_f32 v[8:9], v[8:9], v[84:85]
    v_pk_add_f32 v[8:9], v[8:9], v[86:87]
    v_pk_add_f32 v[8:9], v[8:9], v[88:89]
    v_pk_add_f32 v[8:9], v[8:9], v[90:91]
    v_pk_add_f32 v[8:9], v[8:9], v[92:93]
    v_pk_add_f32 v[8:9], v[8:9], v[94:95]
    v_add_f32 v8, v8, v9
    v_mov_b32 v10, v8
    s_nop 1
    v_permlane16_swap_b32 v8, v10
    v_add_f32 v8, v8, v10
    v_mov_b32 v10, v8
    s_nop 1
    v_permlane32_swap_b32 v8, v10
    v_add_f32 v8, v8, v10
    v_mul_f32 v8, 0x3c000000, v8
    v_mov_b64 v[12:13], 0
    v_pk_add_f32 v[10:11], v[64:65], v[8:9] op_sel_hi:[1,0] neg_lo:[0,1] neg_hi:[0,1]
    v_pk_fma_f32 v[12:13], v[10:11], v[10:11], v[12:13]
    v_pk_add_f32 v[10:11], v[66:67], v[8:9] op_sel_hi:[1,0] neg_lo:[0,1] neg_hi:[0,1]
    v_pk_fma_f32 v[12:13], v[10:11], v[10:11], v[12:13]
    v_pk_add_f32 v[10:11], v[68:69], v[8:9] op_sel_hi:[1,0] neg_lo:[0,1] neg_hi:[0,1]
    v_pk_fma_f32 v[12:13], v[10:11], v[10:11], v[12:13]
    v_pk_add_f32 v[10:11], v[70:71], v[8:9] op_sel_hi:[1,0] neg_lo:[0,1] neg_hi:[0,1]
    v_pk_fma_f32 v[12:13], v[10:11], v[10:11], v[12:13]
    v_pk_add_f32 v[10:11], v[72:73], v[8:9] op_sel_hi:[1,0] neg_lo:[0,1] neg_hi:[0,1]
    v_pk_fma_f32 v[12:13], v[10:11], v[10:11], v[12:13]
    v_pk_add_f32 v[10:11], v[74:75], v[8:9] op_sel_hi:[1,0] neg_lo:[0,1] neg_hi:[0,1]
    v_pk_fma_f32 v[12:13], v[10:11], v[10:11], v[12:13]
    v_pk_add_f32 v[10:11], v[76:77], v[8:9] op_sel_hi:[1,0] neg_lo:[0,1] neg_hi:[0,1]
    v_pk_fma_f32 v[12:13], v[10:11], v[10:11], v[12:13]
    v_pk_add_f32 v[10:11], v[78:79], v[8:9] op_sel_hi:[1,0] neg_lo:[0,1] neg_hi:[0,1]
    v_pk_fma_f32 v[12:13], v[10:11], v[10:11], v[12:13]
    v_pk_add_f32 v[10:11], v[80:81], v[8:9] op_sel_hi:[1,0] neg_lo:[0,1] neg_hi:[0,1]
    v_pk_fma_f32 v[12:13], v[10:11], v[10:11], v[12:13]
    v_pk_add_f32 v[10:11], v[82:83], v[8:9] op_sel_hi:[1,0] neg_lo:[0,1] neg_hi:[0,1]
    v_pk_fma_f32 v[12:13], v[10:11], v[10:11], v[12:13]
    v_pk_add_f32 v[10:11], v[84:85], v[8:9] op_sel_hi:[1,0] neg_lo:[0,1] neg_hi:[0,1]
    v_pk_fma_f32 v[12:13], v[10:11], v[10:11], v[12:13]
    v_pk_add_f32 v[10:11], v[86:87], v[8:9] op_sel_hi:[1,0] neg_lo:[0,1] neg_hi:[0,1]
    v_pk_fma_f32 v[12:13], v[10:11], v[10:11], v[12:13]
    v_pk_add_f32 v[10:11], v[88:89], v[8:9] op_sel_hi:[1,0] neg_lo:[0,1] neg_hi:[0,1]
    v_pk_fma_f32 v[12:13], v[10:11], v[10:11], v[12:13]
    v_pk_add_f32 v[10:11], v[90:91], v[8:9] op_sel_hi:[1,0] neg_lo:[0,1] neg_hi:[0,1]
    v_pk_fma_f32 v[12:13], v[10:11], v[10:11], v[12:13]
    v_pk_add_f32 v[10:11], v[92:93], v[8:9] op_sel_hi:[1,0] neg_lo:[0,1] neg_hi:[0,1]
    v_pk_fma_f32 v[12:13], v[10:11], v[10:11], v[12:13]
    v_pk_add_f32 v[10:11], v[94:95], v[8:9] op_sel_hi:[1,0] neg_lo:[0,1] neg_hi:[0,1]
    v_pk_fma_f32 v[12:13], v[10:11], v[10:11], v[12:13]
    v_add_f32 v9, v12, v13
    v_mov_b32 v10, v9
    s_nop 1
    v_permlane16_swap_b32 v9, v10
    v_add_f32 v9, v9, v10
    v_mov_b32 v10, v9
    s_nop 1
    v_permlane32_swap_b32 v9, v10
    v_add_f32 v9, v9, v10
    ds_write_b64 v5, v[8:9] offset:512
    s_waitcnt lgkmcnt(0)
    s_waitcnt vmcnt(0)
    s_barrier
    buffer_store_dwordx2 v[254:255], v253, s[4:7], s44 offen sc1
    ds_read_b64 v[16:17], v4 offset:512
    ds_read_b64 v[18:19], v4 offset:640
    ds_read_b64 v[20:21], v4 offset:768
    ds_read_b64 v[22:23], v4 offset:896
    s_waitcnt lgkmcnt(0)
    v_add_f32 v8, v16, v18
    v_add_f32 v9, v20, v22
    v_add_f32 v8, v8, v9
    v_mul_f32 v8, 0x3e800000, v8
    v_add_f32 v9, v17, v19
    v_add_f32 v10, v21, v23
    v_add_f32 v9, v9, v10
    v_sub_f32 v16, v16, v8
    v_sub_f32 v18, v18, v8
    v_sub_f32 v20, v20, v8
    v_sub_f32 v22, v22, v8
    v_mul_f32 v10, v16, v16
    v_fmac_f32 v10, v18, v18
    v_fmac_f32 v10, v20, v20
    v_fmac_f32 v10, v22, v22
    v_mul_f32 v10, 0x43000000, v10
    v_add_f32 v9, v9, v10
    v_mul_f32 v12, 0x3b000000, v9
    v_cvt_pk_bf16_f32 v8, v8, v8
    v_and_b32 v8, 0xffff0000, v8
    v_cvt_pk_bf16_f32 v12, v12, v12
    v_and_b32 v12, 0xffff0000, v12
    v_add_f32 v12, 0x3727c5ac, v12
    v_cvt_pk_bf16_f32 v12, v12, v12
    v_and_b32 v12, 0xffff0000, v12
    v_sqrt_f32 v12, v12
    s_nop 0
    v_cvt_pk_bf16_f32 v12, v12, v12
    v_and_b32 v12, 0xffff0000, v12
    v_rcp_f32 v12, v12
    s_add_u32 s42, s42, 1048576
    v_pk_add_f32 v[64:65], v[64:65], v[8:9] op_sel_hi:[1,0] neg_lo:[0,1] neg_hi:[0,1]
    v_cvt_pk_bf16_f32 v10, v64, v65
    v_lshlrev_b32 v64, 16, v10
    v_and_b32 v65, 0xffff0000, v10
    v_pk_mul_f32 v[64:65], v[64:65], v[12:13] op_sel_hi:[1,0]
    v_cvt_pk_bf16_f32 v48, v64, v65
    v_pk_add_f32 v[66:67], v[66:67], v[8:9] op_sel_hi:[1,0] neg_lo:[0,1] neg_hi:[0,1]
    v_cvt_pk_bf16_f32 v10, v66, v67
    v_lshlrev_b32 v66, 16, v10
    v_and_b32 v67, 0xffff0000, v10
    v_pk_mul_f32 v[66:67], v[66:67], v[12:13] op_sel_hi:[1,0]
    v_cvt_pk_bf16_f32 v49, v66, v67
    v_pk_add_f32 v[68:69], v[68:69], v[8:9] op_sel_hi:[1,0] neg_lo:[0,1] neg_hi:[0,1]
    v_cvt_pk_bf16_f32 v10, v68, v69
    v_lshlrev_b32 v68, 16, v10
    v_and_b32 v69, 0xffff0000, v10
    v_pk_mul_f32 v[68:69], v[68:69], v[12:13] op_sel_hi:[1,0]
    v_cvt_pk_bf16_f32 v50, v68, v69
    v_pk_add_f32 v[70:71], v[70:71], v[8:9] op_sel_hi:[1,0] neg_lo:[0,1] neg_hi:[0,1]
    v_cvt_pk_bf16_f32 v10, v70, v71
    v_lshlrev_b32 v70, 16, v10
    v_and_b32 v71, 0xffff0000, v10
    v_pk_mul_f32 v[70:71], v[70:71], v[12:13] op_sel_hi:[1,0]
    v_cvt_pk_bf16_f32 v51, v70, v71
    buffer_store_dwordx4 v[48:51], v251, s[4:7], s42 offen offset:0 sc1
    v_pk_add_f32 v[72:73], v[72:73], v[8:9] op_sel_hi:[1,0] neg_lo:[0,1] neg_hi:[0,1]
    v_cvt_pk_bf16_f32 v10, v72, v73
    v_lshlrev_b32 v72, 16, v10
    v_and_b32 v73, 0xffff0000, v10
    v_pk_mul_f32 v[72:73], v[72:73], v[12:13] op_sel_hi:[1,0]
    v_cvt_pk_bf16_f32 v52, v72, v73
    v_pk_add_f32 v[74:75], v[74:75], v[8:9] op_sel_hi:[1,0] neg_lo:[0,1] neg_hi:[0,1]
    v_cvt_pk_bf16_f32 v10, v74, v75
    v_lshlrev_b32 v74, 16, v10
    v_and_b32 v75, 0xffff0000, v10
    v_pk_mul_f32 v[74:75], v[74:75], v[12:13] op_sel_hi:[1,0]
    v_cvt_pk_bf16_f32 v53, v74, v75
    v_pk_add_f32 v[76:77], v[76:77], v[8:9] op_sel_hi:[1,0] neg_lo:[0,1] neg_hi:[0,1]
    v_cvt_pk_bf16_f32 v10, v76, v77
    v_lshlrev_b32 v76, 16, v10
    v_and_b32 v77, 0xffff0000, v10
    v_pk_mul_f32 v[76:77], v[76:77], v[12:13] op_sel_hi:[1,0]
    v_cvt_pk_bf16_f32 v54, v76, v77
    v_pk_add_f32 v[78:79], v[78:79], v[8:9] op_sel_hi:[1,0] neg_lo:[0,1] neg_hi:[0,1]
    v_cvt_pk_bf16_f32 v10, v78, v79
    v_lshlrev_b32 v78, 16, v10
    v_and_b32 v79, 0xffff0000, v10
    v_pk_mul_f32 v[78:79], v[78:79], v[12:13] op_sel_hi:[1,0]
    v_cvt_pk_bf16_f32 v55, v78, v79
    buffer_store_dwordx4 v[52:55], v251, s[4:7], s42 offen offset:1024 sc1
    v_pk_add_f32 v[80:81], v[80:81], v[8:9] op_sel_hi:[1,0] neg_lo:[0,1] neg_hi:[0,1]
    v_cvt_pk_bf16_f32 v10, v80, v81
    v_lshlrev_b32 v80, 16, v10
    v_and_b32 v81, 0xffff0000, v10
    v_pk_mul_f32 v[80:81], v[80:81], v[12:13] op_sel_hi:[1,0]
    v_cvt_pk_bf16_f32 v56, v80, v81
    v_pk_add_f32 v[82:83], v[82:83], v[8:9] op_sel_hi:[1,0] neg_lo:[0,1] neg_hi:[0,1]
    v_cvt_pk_bf16_f32 v10, v82, v83
    v_lshlrev_b32 v82, 16, v10
    v_and_b32 v83, 0xffff0000, v10
    v_pk_mul_f32 v[82:83], v[82:83], v[12:13] op_sel_hi:[1,0]
    v_cvt_pk_bf16_f32 v57, v82, v83
    v_pk_add_f32 v[84:85], v[84:85], v[8:9] op_sel_hi:[1,0] neg_lo:[0,1] neg_hi:[0,1]
    v_cvt_pk_bf16_f32 v10, v84, v85
    v_lshlrev_b32 v84, 16, v10
    v_and_b32 v85, 0xffff0000, v10
    v_pk_mul_f32 v[84:85], v[84:85], v[12:13] op_sel_hi:[1,0]
    v_cvt_pk_bf16_f32 v58, v84, v85
    v_pk_add_f32 v[86:87], v[86:87], v[8:9] op_sel_hi:[1,0] neg_lo:[0,1] neg_hi:[0,1]
    v_cvt_pk_bf16_f32 v10, v86, v87
    v_lshlrev_b32 v86, 16, v10
    v_and_b32 v87, 0xffff0000, v10
    v_pk_mul_f32 v[86:87], v[86:87], v[12:13] op_sel_hi:[1,0]
    v_cvt_pk_bf16_f32 v59, v86, v87
    buffer_store_dwordx4 v[56:59], v251, s[4:7], s42 offen offset:2048 sc1
    v_pk_add_f32 v[88:89], v[88:89], v[8:9] op_sel_hi:[1,0] neg_lo:[0,1] neg_hi:[0,1]
    v_cvt_pk_bf16_f32 v10, v88, v89
    v_lshlrev_b32 v88, 16, v10
    v_and_b32 v89, 0xffff0000, v10
    v_pk_mul_f32 v[88:89], v[88:89], v[12:13] op_sel_hi:[1,0]
    v_cvt_pk_bf16_f32 v60, v88, v89
    v_pk_add_f32 v[90:91], v[90:91], v[8:9] op_sel_hi:[1,0] neg_lo:[0,1] neg_hi:[0,1]
    v_cvt_pk_bf16_f32 v10, v90, v91
    v_lshlrev_b32 v90, 16, v10
    v_and_b32 v91, 0xffff0000, v10
    v_pk_mul_f32 v[90:91], v[90:91], v[12:13] op_sel_hi:[1,0]
    v_cvt_pk_bf16_f32 v61, v90, v91
    v_pk_add_f32 v[92:93], v[92:93], v[8:9] op_sel_hi:[1,0] neg_lo:[0,1] neg_hi:[0,1]
    v_cvt_pk_bf16_f32 v10, v92, v93
    v_lshlrev_b32 v92, 16, v10
    v_and_b32 v93, 0xffff0000, v10
    v_pk_mul_f32 v[92:93], v[92:93], v[12:13] op_sel_hi:[1,0]
    v_cvt_pk_bf16_f32 v62, v92, v93
    v_pk_add_f32 v[94:95], v[94:95], v[8:9] op_sel_hi:[1,0] neg_lo:[0,1] neg_hi:[0,1]
    v_cvt_pk_bf16_f32 v10, v94, v95
    v_lshlrev_b32 v94, 16, v10
    v_and_b32 v95, 0xffff0000, v10
    v_pk_mul_f32 v[94:95], v[94:95], v[12:13] op_sel_hi:[1,0]
    v_cvt_pk_bf16_f32 v63, v94, v95
    buffer_store_dwordx4 v[60:63], v251, s[4:7], s42 offen offset:3072 sc1
    s_waitcnt vmcnt(0)
    s_barrier
    s_add_u32 s44, s44, 8192
    buffer_store_dwordx2 v[254:255], v253, s[4:7], s44 offen sc1
    s_load_dwordx2 s[8:9], s[0:1], 16
    s_mov_b32 s10, 4194304
    s_mov_b32 s11, 0x20000
    s_waitcnt lgkmcnt(0)
    s_lshl_b32 s41, s21, 7
    s_lshl_b32 s42, s22, 9
    s_add_u32 s41, s41, s42
    s_lshl_b32 s27, s22, 12
    s_add_u32 s27, s27, 94650368
    s_mov_b32 s25, s23
    s_mul_i32 s40, s21, 24576
    s_add_u32 s40, s40, 65536
    v_lshrrev_b32 v1, 3, v250
    v_lshrrev_b32 v2, 2, v250
    v_and_b32 v2, 4, v2
    v_xor_b32 v2, v2, v250
    v_and_b32 v2, 7, v2
    v_lshlrev_b32 v2, 4, v2
    v_lshl_add_u32 v3, v1, 13, v2
    s_add_u32 m0, s40, 0
    s_add_u32 s35, s41, 0
    buffer_load_dwordx4 v3, s[8:11], s35 offen  lds
    s_add_u32 m0, s40, 1024
    s_add_u32 s35, s41, 65536
    buffer_load_dwordx4 v3, s[8:11], s35 offen  lds
    s_add_u32 m0, s40, 2048
    s_add_u32 s35, s41, 131072
    buffer_load_dwordx4 v3, s[8:11], s35 offen  lds
    s_add_u32 m0, s40, 3072
    s_add_u32 s35, s41, 196608
    buffer_load_dwordx4 v3, s[8:11], s35 offen  lds
    s_add_u32 m0, s40, 4096
    s_add_u32 s35, s41, 262144
    buffer_load_dwordx4 v3, s[8:11], s35 offen  lds
    s_add_u32 m0, s40, 5120
    s_add_u32 s35, s41, 327680
    buffer_load_dwordx4 v3, s[8:11], s35 offen  lds
    s_add_u32 m0, s40, 6144
    s_add_u32 s35, s41, 393216
    buffer_load_dwordx4 v3, s[8:11], s35 offen  lds
    s_add_u32 m0, s40, 7168
    s_add_u32 s35, s41, 458752
    buffer_load_dwordx4 v3, s[8:11], s35 offen  lds
    s_add_u32 m0, s40, 8192
    s_add_u32 s35, s41, 524288
    buffer_load_dwordx4 v3, s[8:11], s35 offen  lds
    s_add_u32 m0, s40, 9216
    s_add_u32 s35, s41, 589824
    buffer_load_dwordx4 v3, s[8:11], s35 offen  lds
    s_add_u32 m0, s40, 10240
    s_add_u32 s35, s41, 655360
    buffer_load_dwordx4 v3, s[8:11], s35 offen  lds
    s_add_u32 m0, s40, 11264
    s_add_u32 s35, s41, 720896
    buffer_load_dwordx4 v3, s[8:11], s35 offen  lds
    s_add_u32 m0, s40, 12288
    s_add_u32 s35, s41, 786432
    buffer_load_dwordx4 v3, s[8:11], s35 offen  lds
    s_add_u32 m0, s40, 13312
    s_add_u32 s35, s41, 851968
    buffer_load_dwordx4 v3, s[8:11], s35 offen  lds
    s_add_u32 m0, s40, 14336
    s_add_u32 s35, s41, 917504
    buffer_load_dwordx4 v3, s[8:11], s35 offen  lds
    s_add_u32 m0, s40, 15360
    s_add_u32 s35, s41, 983040
    buffer_load_dwordx4 v3, s[8:11], s35 offen  lds
    s_add_u32 m0, s40, 16384
    s_add_u32 s35, s41, 1048576
    buffer_load_dwordx4 v3, s[8:11], s35 offen  lds
    s_add_u32 m0, s40, 17408
    s_add_u32 s35, s41, 1114112
    buffer_load_dwordx4 v3, s[8:11], s35 offen  lds
    s_add_u32 m0, s40, 18432
    s_add_u32 s35, s41, 1179648
    buffer_load_dwordx4 v3, s[8:11], s35 offen  lds
    s_add_u32 m0, s40, 19456
    s_add_u32 s35, s41, 1245184
    buffer_load_dwordx4 v3, s[8:11], s35 offen  lds
    s_add_u32 m0, s40, 20480
    s_add_u32 s35, s41, 1310720
    buffer_load_dwordx4 v3, s[8:11], s35 offen  lds
    s_add_u32 m0, s40, 21504
    s_add_u32 s35, s41, 1376256
    buffer_load_dwordx4 v3, s[8:11], s35 offen  lds
    s_add_u32 m0, s40, 22528
    s_add_u32 s35, s41, 1441792
    buffer_load_dwordx4 v3, s[8:11], s35 offen  lds
    s_add_u32 m0, s40, 23552
    s_add_u32 s35, s41, 1507328
    buffer_load_dwordx4 v3, s[8:11], s35 offen  lds
    v_lshrrev_b32 v4, 4, v250
    v_bfe_u32 v5, v250, 2, 2
    v_lshl_add_u32 v4, v4, 3, v5
    v_lshlrev_b32 v4, 7, v4
    v_lshrrev_b32 v5, 1, v5
    v_lshl_add_u32 v4, v5, 6, v4
    v_and_b32 v5, 3, v250
    v_lshl_add_u32 v4, v5, 4, v4
    v_add_u32 v4, s40, v4
    v_xor_b32 v5, 64, v4
    s_mov_b32 s64, 0
    s_lshl_b32 s43, s25, 2
    s_add_u32 s43, s43, s21
    s_lshl_b32 s43, s43, 7
    s_add_u32 s43, s43, 94404608
    s_waitcnt vmcnt(20)
    ds_read_b64_tr_b16 a[0:1], v4 offset:0
    ds_read_b64_tr_b16 a[2:3], v4 offset:512
    ds_read_b64_tr_b16 a[64:65], v4 offset:8
    ds_read_b64_tr_b16 a[66:67], v4 offset:520
    ds_read_b64_tr_b16 a[128:129], v5 offset:0
    ds_read_b64_tr_b16 a[130:131], v5 offset:512
    ds_read_b64_tr_b16 a[192:193], v5 offset:8
    ds_read_b64_tr_b16 a[194:195], v5 offset:520
    s_waitcnt lgkmcnt(0)
    s_add_u32 m0, s40, 0
    s_add_u32 s35, s41, 1572864
    buffer_load_dwordx4 v3, s[8:11], s35 offen  lds
    s_add_u32 m0, s40, 1024
    s_add_u32 s35, s41, 1638400
    buffer_load_dwordx4 v3, s[8:11], s35 offen  lds
    s_add_u32 m0, s40, 2048
    s_add_u32 s35, s41, 1703936
    buffer_load_dwordx4 v3, s[8:11], s35 offen  lds
    s_add_u32 m0, s40, 3072
    s_add_u32 s35, s41, 1769472
    buffer_load_dwordx4 v3, s[8:11], s35 offen  lds
    s_waitcnt vmcnt(20)
    ds_read_b64_tr_b16 a[4:5], v4 offset:4096
    ds_read_b64_tr_b16 a[6:7], v4 offset:4608
    ds_read_b64_tr_b16 a[68:69], v4 offset:4104
    ds_read_b64_tr_b16 a[70:71], v4 offset:4616
    ds_read_b64_tr_b16 a[132:133], v5 offset:4096
    ds_read_b64_tr_b16 a[134:135], v5 offset:4608
    ds_read_b64_tr_b16 a[196:197], v5 offset:4104
    ds_read_b64_tr_b16 a[198:199], v5 offset:4616
    s_waitcnt lgkmcnt(0)
    s_add_u32 m0, s40, 4096
    s_add_u32 s35, s41, 1835008
    buffer_load_dwordx4 v3, s[8:11], s35 offen  lds
    s_add_u32 m0, s40, 5120
    s_add_u32 s35, s41, 1900544
    buffer_load_dwordx4 v3, s[8:11], s35 offen  lds
    s_add_u32 m0, s40, 6144
    s_add_u32 s35, s41, 1966080
    buffer_load_dwordx4 v3, s[8:11], s35 offen  lds
    s_add_u32 m0, s40, 7168
    s_add_u32 s35, s41, 2031616
    buffer_load_dwordx4 v3, s[8:11], s35 offen  lds
    s_waitcnt vmcnt(20)
    ds_read_b64_tr_b16 a[8:9], v4 offset:8192
    ds_read_b64_tr_b16 a[10:11], v4 offset:8704
    ds_read_b64_tr_b16 a[72:73], v4 offset:8200
    ds_read_b64_tr_b16 a[74:75], v4 offset:8712
    ds_read_b64_tr_b16 a[136:137], v5 offset:8192
    ds_read_b64_tr_b16 a[138:139], v5 offset:8704
    ds_read_b64_tr_b16 a[200:201], v5 offset:8200
    ds_read_b64_tr_b16 a[202:203], v5 offset:8712
    s_waitcnt lgkmcnt(0)
    s_add_u32 m0, s40, 8192
    s_add_u32 s35, s41, 2097152
    buffer_load_dwordx4 v3, s[8:11], s35 offen  lds
    s_add_u32 m0, s40, 9216
    s_add_u32 s35, s41, 2162688
    buffer_load_dwordx4 v3, s[8:11], s35 offen  lds
    s_add_u32 m0, s40, 10240
    s_add_u32 s35, s41, 2228224
    buffer_load_dwordx4 v3, s[8:11], s35 offen  lds
    s_add_u32 m0, s40, 11264
    s_add_u32 s35, s41, 2293760
    buffer_load_dwordx4 v3, s[8:11], s35 offen  lds
    s_waitcnt vmcnt(20)
    ds_read_b64_tr_b16 a[12:13], v4 offset:12288
    ds_read_b64_tr_b16 a[14:15], v4 offset:12800
    ds_read_b64_tr_b16 a[76:77], v4 offset:12296
    ds_read_b64_tr_b16 a[78:79], v4 offset:12808
    ds_read_b64_tr_b16 a[140:141], v5 offset:12288
    ds_read_b64_tr_b16 a[142:143], v5 offset:12800
    ds_read_b64_tr_b16 a[204:205], v5 offset:12296
    ds_read_b64_tr_b16 a[206:207], v5 offset:12808
    s_waitcnt lgkmcnt(0)
    s_add_u32 m0, s40, 12288
    s_add_u32 s35, s41, 2359296
    buffer_load_dwordx4 v3, s[8:11], s35 offen  lds
    s_add_u32 m0, s40, 13312
    s_add_u32 s35, s41, 2424832
    buffer_load_dwordx4 v3, s[8:11], s35 offen  lds
    s_add_u32 m0, s40, 14336
    s_add_u32 s35, s41, 2490368
    buffer_load_dwordx4 v3, s[8:11], s35 offen  lds
    s_add_u32 m0, s40, 15360
    s_add_u32 s35, s41, 2555904
    buffer_load_dwordx4 v3, s[8:11], s35 offen  lds
    s_waitcnt vmcnt(20)
    ds_read_b64_tr_b16 a[16:17], v4 offset:16384
    ds_read_b64_tr_b16 a[18:19], v4 offset:16896
    ds_read_b64_tr_b16 a[80:81], v4 offset:16392
    ds_read_b64_tr_b16 a[82:83], v4 offset:16904
    ds_read_b64_tr_b16 a[144:145], v5 offset:16384
    ds_read_b64_tr_b16 a[146:147], v5 offset:16896
    ds_read_b64_tr_b16 a[208:209], v5 offset:16392
    ds_read_b64_tr_b16 a[210:211], v5 offset:16904
    s_waitcnt lgkmcnt(0)
    s_add_u32 m0, s40, 16384
    s_add_u32 s35, s41, 2621440
    buffer_load_dwordx4 v3, s[8:11], s35 offen  lds
    s_add_u32 m0, s40, 17408
    s_add_u32 s35, s41, 2686976
    buffer_load_dwordx4 v3, s[8:11], s35 offen  lds
    s_add_u32 m0, s40, 18432
    s_add_u32 s35, s41, 2752512
    buffer_load_dwordx4 v3, s[8:11], s35 offen  lds
    s_add_u32 m0, s40, 19456
    s_add_u32 s35, s41, 2818048
    buffer_load_dwordx4 v3, s[8:11], s35 offen  lds
    s_waitcnt vmcnt(20)
    ds_read_b64_tr_b16 a[20:21], v4 offset:20480
    ds_read_b64_tr_b16 a[22:23], v4 offset:20992
    ds_read_b64_tr_b16 a[84:85], v4 offset:20488
    ds_read_b64_tr_b16 a[86:87], v4 offset:21000
    ds_read_b64_tr_b16 a[148:149], v5 offset:20480
    ds_read_b64_tr_b16 a[150:151], v5 offset:20992
    ds_read_b64_tr_b16 a[212:213], v5 offset:20488
    ds_read_b64_tr_b16 a[214:215], v5 offset:21000
    s_waitcnt lgkmcnt(0)
    buffer_load_dwordx2 v[10:11], v252, s[4:7], s43 offen sc1
    s_add_u32 m0, s40, 20480
    s_add_u32 s35, s41, 2883584
    buffer_load_dwordx4 v3, s[8:11], s35 offen  lds
    s_add_u32 m0, s40, 21504
    s_add_u32 s35, s41, 2949120
    buffer_load_dwordx4 v3, s[8:11], s35 offen  lds
    s_add_u32 m0, s40, 22528
    s_add_u32 s35, s41, 3014656
    buffer_load_dwordx4 v3, s[8:11], s35 offen  lds
    s_add_u32 m0, s40, 23552
    s_add_u32 s35, s41, 3080192
    buffer_load_dwordx4 v3, s[8:11], s35 offen  lds
    s_waitcnt vmcnt(21)
    ds_read_b64_tr_b16 a[24:25], v4 offset:0
    ds_read_b64_tr_b16 a[26:27], v4 offset:512
    ds_read_b64_tr_b16 a[88:89], v4 offset:8
    ds_read_b64_tr_b16 a[90:91], v4 offset:520
    ds_read_b64_tr_b16 a[152:153], v5 offset:0
    ds_read_b64_tr_b16 a[154:155], v5 offset:512
    ds_read_b64_tr_b16 a[216:217], v5 offset:8
    ds_read_b64_tr_b16 a[218:219], v5 offset:520
    s_waitcnt lgkmcnt(0)
    s_add_u32 m0, s40, 0
    s_add_u32 s35, s41, 3145728
    buffer_load_dwordx4 v3, s[8:11], s35 offen  lds
    s_add_u32 m0, s40, 1024
    s_add_u32 s35, s41, 3211264
    buffer_load_dwordx4 v3, s[8:11], s35 offen  lds
    s_add_u32 m0, s40, 2048
    s_add_u32 s35, s41, 3276800
    buffer_load_dwordx4 v3, s[8:11], s35 offen  lds
    s_add_u32 m0, s40, 3072
    s_add_u32 s35, s41, 3342336
    buffer_load_dwordx4 v3, s[8:11], s35 offen  lds
    s_waitcnt vmcnt(21)
    ds_read_b64_tr_b16 a[28:29], v4 offset:4096
    ds_read_b64_tr_b16 a[30:31], v4 offset:4608
    ds_read_b64_tr_b16 a[92:93], v4 offset:4104
    ds_read_b64_tr_b16 a[94:95], v4 offset:4616
    ds_read_b64_tr_b16 a[156:157], v5 offset:4096
    ds_read_b64_tr_b16 a[158:159], v5 offset:4608
    ds_read_b64_tr_b16 a[220:221], v5 offset:4104
    ds_read_b64_tr_b16 a[222:223], v5 offset:4616
    s_waitcnt lgkmcnt(0)
    s_add_u32 m0, s40, 4096
    s_add_u32 s35, s41, 3407872
    buffer_load_dwordx4 v3, s[8:11], s35 offen  lds
    s_add_u32 m0, s40, 5120
    s_add_u32 s35, s41, 3473408
    buffer_load_dwordx4 v3, s[8:11], s35 offen  lds
    s_add_u32 m0, s40, 6144
    s_add_u32 s35, s41, 3538944
    buffer_load_dwordx4 v3, s[8:11], s35 offen  lds
    s_add_u32 m0, s40, 7168
    s_add_u32 s35, s41, 3604480
    buffer_load_dwordx4 v3, s[8:11], s35 offen  lds
    s_waitcnt vmcnt(21)
    ds_read_b64_tr_b16 a[32:33], v4 offset:8192
    ds_read_b64_tr_b16 a[34:35], v4 offset:8704
    ds_read_b64_tr_b16 a[96:97], v4 offset:8200
    ds_read_b64_tr_b16 a[98:99], v4 offset:8712
    ds_read_b64_tr_b16 a[160:161], v5 offset:8192
    ds_read_b64_tr_b16 a[162:163], v5 offset:8704
    ds_read_b64_tr_b16 a[224:225], v5 offset:8200
    ds_read_b64_tr_b16 a[226:227], v5 offset:8712
    s_waitcnt lgkmcnt(0)
    s_add_u32 m0, s40, 8192
    s_add_u32 s35, s41, 3670016
    buffer_load_dwordx4 v3, s[8:11], s35 offen  lds
    s_add_u32 m0, s40, 9216
    s_add_u32 s35, s41, 3735552
    buffer_load_dwordx4 v3, s[8:11], s35 offen  lds
    s_add_u32 m0, s40, 10240
    s_add_u32 s35, s41, 3801088
    buffer_load_dwordx4 v3, s[8:11], s35 offen  lds
    s_add_u32 m0, s40, 11264
    s_add_u32 s35, s41, 3866624
    buffer_load_dwordx4 v3, s[8:11], s35 offen  lds
    s_waitcnt vmcnt(21)
    ds_read_b64_tr_b16 a[36:37], v4 offset:12288
    ds_read_b64_tr_b16 a[38:39], v4 offset:12800
    ds_read_b64_tr_b16 a[100:101], v4 offset:12296
    ds_read_b64_tr_b16 a[102:103], v4 offset:12808
    ds_read_b64_tr_b16 a[164:165], v5 offset:12288
    ds_read_b64_tr_b16 a[166:167], v5 offset:12800
    ds_read_b64_tr_b16 a[228:229], v5 offset:12296
    ds_read_b64_tr_b16 a[230:231], v5 offset:12808
    s_waitcnt lgkmcnt(0)
    s_add_u32 m0, s40, 12288
    s_add_u32 s35, s41, 3932160
    buffer_load_dwordx4 v3, s[8:11], s35 offen  lds
    s_add_u32 m0, s40, 13312
    s_add_u32 s35, s41, 3997696
    buffer_load_dwordx4 v3, s[8:11], s35 offen  lds
    s_add_u32 m0, s40, 14336
    s_add_u32 s35, s41, 4063232
    buffer_load_dwordx4 v3, s[8:11], s35 offen  lds
    s_add_u32 m0, s40, 15360
    s_add_u32 s35, s41, 4128768
    buffer_load_dwordx4 v3, s[8:11], s35 offen  lds
    s_waitcnt vmcnt(21)
    ds_read_b64_tr_b16 a[40:41], v4 offset:16384
    ds_read_b64_tr_b16 a[42:43], v4 offset:16896
    ds_read_b64_tr_b16 a[104:105], v4 offset:16392
    ds_read_b64_tr_b16 a[106:107], v4 offset:16904
    ds_read_b64_tr_b16 a[168:169], v5 offset:16384
    ds_read_b64_tr_b16 a[170:171], v5 offset:16896
    ds_read_b64_tr_b16 a[232:233], v5 offset:16392
    ds_read_b64_tr_b16 a[234:235], v5 offset:16904
    s_waitcnt lgkmcnt(0)
    s_waitcnt vmcnt(16)
    ds_read_b64_tr_b16 a[44:45], v4 offset:20480
    ds_read_b64_tr_b16 a[46:47], v4 offset:20992
    ds_read_b64_tr_b16 a[108:109], v4 offset:20488
    ds_read_b64_tr_b16 a[110:111], v4 offset:21000
    ds_read_b64_tr_b16 a[172:173], v5 offset:20480
    ds_read_b64_tr_b16 a[174:175], v5 offset:20992
    ds_read_b64_tr_b16 a[236:237], v5 offset:20488
    ds_read_b64_tr_b16 a[238:239], v5 offset:21000
    s_waitcnt lgkmcnt(0)
    v_cmp_ne_u64 vcc, v[254:255], v[10:11]
    s_cbranch_vccnz EC_34
    v_cmp_eq_u32 vcc, 0, v255
    s_cbranch_vccnz EC_34
    s_lshl_b32 s44, s21, 14
    s_lshl_b32 s45, s25, 16
    s_add_u32 s45, s45, s44
    s_add_u32 m0, s44, 0
    s_add_u32 s35, s45, 0
    buffer_load_dwordx4 v251, s[4:7], s35 offen sc1 lds
    s_add_u32 m0, s44, 1024
    s_add_u32 s35, s45, 1024
    buffer_load_dwordx4 v251, s[4:7], s35 offen sc1 lds
    s_add_u32 m0, s44, 2048
    s_add_u32 s35, s45, 2048
    buffer_load_dwordx4 v251, s[4:7], s35 offen sc1 lds
    s_add_u32 m0, s44, 3072
    s_add_u32 s35, s45, 3072
    buffer_load_dwordx4 v251, s[4:7], s35 offen sc1 lds
    s_add_u32 m0, s44, 4096
    s_add_u32 s35, s45, 4096
    buffer_load_dwordx4 v251, s[4:7], s35 offen sc1 lds
    s_add_u32 m0, s44, 5120
    s_add_u32 s35, s45, 5120
    buffer_load_dwordx4 v251, s[4:7], s35 offen sc1 lds
    s_add_u32 m0, s44, 6144
    s_add_u32 s35, s45, 6144
    buffer_load_dwordx4 v251, s[4:7], s35 offen sc1 lds
    s_add_u32 m0, s44, 7168
    s_add_u32 s35, s45, 7168
    buffer_load_dwordx4 v251, s[4:7], s35 offen sc1 lds
    s_add_u32 m0, s44, 8192
    s_add_u32 s35, s45, 8192
    buffer_load_dwordx4 v251, s[4:7], s35 offen sc1 lds
    s_add_u32 m0, s44, 9216
    s_add_u32 s35, s45, 9216
    buffer_load_dwordx4 v251, s[4:7], s35 offen sc1 lds
    s_add_u32 m0, s44, 10240
    s_add_u32 s35, s45, 10240
    buffer_load_dwordx4 v251, s[4:7], s35 offen sc1 lds
    s_add_u32 m0, s44, 11264
    s_add_u32 s35, s45, 11264
    buffer_load_dwordx4 v251, s[4:7], s35 offen sc1 lds
    s_add_u32 m0, s44, 12288
    s_add_u32 s35, s45, 12288
    buffer_load_dwordx4 v251, s[4:7], s35 offen sc1 lds
    s_add_u32 m0, s44, 13312
    s_add_u32 s35, s45, 13312
    buffer_load_dwordx4 v251, s[4:7], s35 offen sc1 lds
    s_add_u32 m0, s44, 14336
    s_add_u32 s35, s45, 14336
    buffer_load_dwordx4 v251, s[4:7], s35 offen sc1 lds
    s_add_u32 m0, s44, 15360
    s_add_u32 s35, s45, 15360
    buffer_load_dwordx4 v251, s[4:7], s35 offen sc1 lds
    s_mov_b32 s64, 1
EC_34:
    s_waitcnt vmcnt(12)
    ds_read_b64_tr_b16 a[48:49], v4 offset:0
    ds_read_b64_tr_b16 a[50:51], v4 offset:512
    ds_read_b64_tr_b16 a[112:113], v4 offset:8
    ds_read_b64_tr_b16 a[114:115], v4 offset:520
    ds_read_b64_tr_b16 a[176:177], v5 offset:0
    ds_read_b64_tr_b16 a[178:179], v5 offset:512
    ds_read_b64_tr_b16 a[240:241], v5 offset:8
    ds_read_b64_tr_b16 a[242:243], v5 offset:520
    s_waitcnt lgkmcnt(0)
    s_waitcnt vmcnt(8)
    ds_read_b64_tr_b16 a[52:53], v4 offset:4096
    ds_read_b64_tr_b16 a[54:55], v4 offset:4608
    ds_read_b64_tr_b16 a[116:117], v4 offset:4104
    ds_read_b64_tr_b16 a[118:119], v4 offset:4616
    ds_read_b64_tr_b16 a[180:181], v5 offset:4096
    ds_read_b64_tr_b16 a[182:183], v5 offset:4608
    ds_read_b64_tr_b16 a[244:245], v5 offset:4104
    ds_read_b64_tr_b16 a[246:247], v5 offset:4616
    s_waitcnt lgkmcnt(0)
    s_waitcnt vmcnt(4)
    ds_read_b64_tr_b16 a[56:57], v4 offset:8192
    ds_read_b64_tr_b16 a[58:59], v4 offset:8704
    ds_read_b64_tr_b16 a[120:121], v4 offset:8200
    ds_read_b64_tr_b16 a[122:123], v4 offset:8712
    ds_read_b64_tr_b16 a[184:185], v5 offset:8192
    ds_read_b64_tr_b16 a[186:187], v5 offset:8704
    ds_read_b64_tr_b16 a[248:249], v5 offset:8200
    ds_read_b64_tr_b16 a[250:251], v5 offset:8712
    s_waitcnt lgkmcnt(0)
    s_waitcnt vmcnt(0)
    ds_read_b64_tr_b16 a[60:61], v4 offset:12288
    ds_read_b64_tr_b16 a[62:63], v4 offset:12800
    ds_read_b64_tr_b16 a[124:125], v4 offset:12296
    ds_read_b64_tr_b16 a[126:127], v4 offset:12808
    ds_read_b64_tr_b16 a[188:189], v5 offset:12288
    ds_read_b64_tr_b16 a[190:191], v5 offset:12800
    ds_read_b64_tr_b16 a[252:253], v5 offset:12296
    ds_read_b64_tr_b16 a[254:255], v5 offset:12808
    s_waitcnt lgkmcnt(0)
    s_mov_b32 s24, 4
    s_lshl_b32 s26, s22, 14
    s_lshr_b32 s40, s21, 1
    s_lshl_b32 s40, s40, 13
    s_and_b32 s41, s21, 1
    s_lshl_b32 s41, s41, 11
    s_add_u32 s26, s26, s40
    s_add_u32 s26, s26, s41
    s_add_u32 s26, s26, 35651584
    s_mov_b32 s40, 94504064
WF_35:
    buffer_load_dwordx2 v[10:11], v252, s[4:7], s40 offen offset:0 sc1
    s_waitcnt vmcnt(0)
    v_cmp_ne_u64 vcc, s[38:39], v[10:11]
    s_cbranch_vccz WK_36
    s_sub_u32 s30, s30, 1
    s_cbranch_scc1 L_FAIL
    s_sleep 32
    s_branch WF_35
WK_36:
    v_lshlrev_b32 v9, 7, v250
    s_lshl_b32 s40, s25, 2
    s_add_u32 s40, s40, s21
    s_lshl_b32 s40, s40, 7
    s_add_u32 s40, s40, 94404608
    s_cmp_lg_u32 s64, 0
    s_cbranch_scc1 GS_37
WF_38:
    buffer_load_dwordx2 v[10:11], v252, s[4:7], s40 offen offset:0 sc1
    s_waitcnt vmcnt(0)
    v_cmp_ne_u64 vcc, s[38:39], v[10:11]
    s_cbranch_vccz WK_39
    s_sub_u32 s30, s30, 1
    s_cbranch_scc1 L_FAIL
    s_sleep 8
    s_branch WF_38
WK_39:
    s_lshl_b32 s44, s21, 14
    s_lshl_b32 s45, s25, 16
    s_add_u32 s45, s45, s44
    s_add_u32 m0, s44, 0
    s_add_u32 s35, s45, 0
    buffer_load_dwordx4 v251, s[4:7], s35 offen sc1 lds
    s_add_u32 m0, s44, 1024
    s_add_u32 s35, s45, 1024
    buffer_load_dwordx4 v251, s[4:7], s35 offen sc1 lds
    s_add_u32 m0, s44, 2048
    s_add_u32 s35, s45, 2048
    buffer_load_dwordx4 v251, s[4:7], s35 offen sc1 lds
    s_add_u32 m0, s44, 3072
    s_add_u32 s35, s45, 3072
    buffer_load_dwordx4 v251, s[4:7], s35 offen sc1 lds
    s_add_u32 m0, s44, 4096
    s_add_u32 s35, s45, 4096
    buffer_load_dwordx4 v251, s[4:7], s35 offen sc1 lds
    s_add_u32 m0, s44, 5120
    s_add_u32 s35, s45, 5120
    buffer_load_dwordx4 v251, s[4:7], s35 offen sc1 lds
    s_add_u32 m0, s44, 6144
    s_add_u32 s35, s45, 6144
    buffer_load_dwordx4 v251, s[4:7], s35 offen sc1 lds
    s_add_u32 m0, s44, 7168
    s_add_u32 s35, s45, 7168
    buffer_load_dwordx4 v251, s[4:7], s35 offen sc1 lds
    s_add_u32 m0, s44, 8192
    s_add_u32 s35, s45, 8192
    buffer_load_dwordx4 v251, s[4:7], s35 offen sc1 lds
    s_add_u32 m0, s44, 9216
    s_add_u32 s35, s45, 9216
    buffer_load_dwordx4 v251, s[4:7], s35 offen sc1 lds
    s_add_u32 m0, s44, 10240
    s_add_u32 s35, s45, 10240
    buffer_load_dwordx4 v251, s[4:7], s35 offen sc1 lds
    s_add_u32 m0, s44, 11264
    s_add_u32 s35, s45, 11264
    buffer_load_dwordx4 v251, s[4:7], s35 offen sc1 lds
    s_add_u32 m0, s44, 12288
    s_add_u32 s35, s45, 12288
    buffer_load_dwordx4 v251, s[4:7], s35 offen sc1 lds
    s_add_u32 m0, s44, 13312
    s_add_u32 s35, s45, 13312
    buffer_load_dwordx4 v251, s[4:7], s35 offen sc1 lds
    s_add_u32 m0, s44, 14336
    s_add_u32 s35, s45, 14336
    buffer_load_dwordx4 v251, s[4:7], s35 offen sc1 lds
    s_add_u32 m0, s44, 15360
    s_add_u32 s35, s45, 15360
    buffer_load_dwordx4 v251, s[4:7], s35 offen sc1 lds
    s_mov_b32 s64, 1
GS_37:
    s_mov_b32 s28, -1
    s_mov_b32 s43, -1
    v_mov_b32 v128, v251
    v_add_u32 v129, 0x10000, v251
    v_mov_b32 v130, 0x80000000
    s_mov_b32 s60, 0
    s_mov_b32 s61, 0
    s_mov_b32 s62, 0
    s_mov_b32 s63, 0
    s_lshl_b32 s40, s21, 13
    s_add_u32 s40, s40, 94404608
    s_cmp_ge_u32 s21, 2
    s_cbranch_scc1 GS_40
WF_41:
    buffer_load_dwordx2 v[10:11], v9, s[4:7], s40 offen offset:0 sc1
    s_waitcnt vmcnt(0)
    v_cmp_ne_u64 vcc, s[38:39], v[10:11]
    s_cbranch_vccz WK_42
    s_sub_u32 s30, s30, 1
    s_cbranch_scc1 L_FAIL
    s_sleep 8
    s_branch WF_41
WK_42:
GS_40:
WT_15:
GL_43:
    s_waitcnt vmcnt(0)
    s_barrier
    s_add_u32 s40, s25, s24
    s_min_u32 s41, s40, 31
    s_lshl_b32 s45, s41, 16
    s_add_u32 s45, s45, s44
    ds_read_b128 v[64:67], v128 offset:0
    ds_read_b128 v[68:71], v128 offset:16384
    ds_read_b128 v[72:75], v128 offset:32768
    ds_read_b128 v[76:79], v128 offset:49152
    s_cmp_lt_i32 s43, 0
    s_cbranch_scc1 GF_45
    buffer_store_dwordx2 v[254:255], v253, s[4:7], s43 offen sc1
GF_45:
    s_mov_b32 s43, s28
    s_waitcnt lgkmcnt(0)
    v_mfma_f32_16x16x32_bf16 v[0:3], a[0:3], v[64:67], 0
    ds_read_b128 v[80:83], v128 offset:1024
    v_mfma_f32_16x16x32_bf16 v[4:7], a[0:3], v[68:71], 0
    ds_read_b128 v[84:87], v128 offset:17408
    v_mfma_f32_16x16x32_bf16 v[8:11], a[0:3], v[72:75], 0
    ds_read_b128 v[88:91], v128 offset:33792
    v_mfma_f32_16x16x32_bf16 v[12:15], a[0:3], v[76:79], 0
    ds_read_b128 v[92:95], v128 offset:50176
    v_mfma_f32_16x16x32_bf16 v[16:19], a[64:67], v[64:67], 0
    v_mfma_f32_16x16x32_bf16 v[20:23], a[64:67], v[68:71], 0
    s_add_u32 m0, s44, 65536
    s_add_u32 s35, s45, 0
    buffer_load_dwordx4 v251, s[4:7], s35 offen sc1 lds
    v_mfma_f32_16x16x32_bf16 v[24:27], a[64:67], v[72:75], 0
    v_mfma_f32_16x16x32_bf16 v[28:31], a[64:67], v[76:79], 0
    v_mfma_f32_16x16x32_bf16 v[32:35], a[128:131], v[64:67], 0
    v_mfma_f32_16x16x32_bf16 v[36:39], a[128:131], v[68:71], 0
    buffer_store_dwordx4 v[96:99], v130, s[4:7], s60 offen offset:0 sc1
    v_mfma_f32_16x16x32_bf16 v[40:43], a[128:131], v[72:75], 0
    v_mfma_f32_16x16x32_bf16 v[44:47], a[128:131], v[76:79], 0
    v_mfma_f32_16x16x32_bf16 v[48:51], a[192:195], v[64:67], 0
    v_mfma_f32_16x16x32_bf16 v[52:55], a[192:195], v[68:71], 0
    s_add_u32 m0, s44, 66560
    s_add_u32 s35, s45, 1024
    buffer_load_dwordx4 v251, s[4:7], s35 offen sc1 lds
    v_mfma_f32_16x16x32_bf16 v[56:59], a[192:195], v[72:75], 0
    v_mfma_f32_16x16x32_bf16 v[60:63], a[192:195], v[76:79], 0
    s_waitcnt lgkmcnt(0)
    v_mfma_f32_16x16x32_bf16 v[0:3], a[4:7], v[80:83], v[0:3]
    ds_read_b128 v[64:67], v128 offset:2048
    v_mfma_f32_16x16x32_bf16 v[4:7], a[4:7], v[84:87], v[4:7]
    ds_read_b128 v[68:71], v128 offset:18432
    v_mfma_f32_16x16x32_bf16 v[8:11], a[4:7], v[88:91], v[8:11]
    ds_read_b128 v[72:75], v128 offset:34816
    v_mfma_f32_16x16x32_bf16 v[12:15], a[4:7], v[92:95], v[12:15]
    ds_read_b128 v[76:79], v128 offset:51200
    v_mfma_f32_16x16x32_bf16 v[16:19], a[68:71], v[80:83], v[16:19]
    v_mfma_f32_16x16x32_bf16 v[20:23], a[68:71], v[84:87], v[20:23]
    s_add_u32 m0, s44, 67584
    s_add_u32 s35, s45, 2048
    buffer_load_dwordx4 v251, s[4:7], s35 offen sc1 lds
    v_mfma_f32_16x16x32_bf16 v[24:27], a[68:71], v[88:91], v[24:27]
    v_mfma_f32_16x16x32_bf16 v[28:31], a[68:71], v[92:95], v[28:31]
    v_mfma_f32_16x16x32_bf16 v[32:35], a[132:135], v[80:83], v[32:35]
    v_mfma_f32_16x16x32_bf16 v[36:39], a[132:135], v[84:87], v[36:39]
    buffer_store_dwordx4 v[100:103], v130, s[4:7], s60 offen offset:1024 sc1
    v_mfma_f32_16x16x32_bf16 v[40:43], a[132:135], v[88:91], v[40:43]
    v_mfma_f32_16x16x32_bf16 v[44:47], a[132:135], v[92:95], v[44:47]
    v_mfma_f32_16x16x32_bf16 v[48:51], a[196:199], v[80:83], v[48:51]
    v_mfma_f32_16x16x32_bf16 v[52:55], a[196:199], v[84:87], v[52:55]
    s_add_u32 m0, s44, 68608
    s_add_u32 s35, s45, 3072
    buffer_load_dwordx4 v251, s[4:7], s35 offen sc1 lds
    v_mfma_f32_16x16x32_bf16 v[56:59], a[196:199], v[88:91], v[56:59]
    v_mfma_f32_16x16x32_bf16 v[60:63], a[196:199], v[92:95], v[60:63]
    s_waitcnt lgkmcnt(0)
    v_mfma_f32_16x16x32_bf16 v[0:3], a[8:11], v[64:67], v[0:3]
    ds_read_b128 v[80:83], v128 offset:3072
    v_mfma_f32_16x16x32_bf16 v[4:7], a[8:11], v[68:71], v[4:7]
    ds_read_b128 v[84:87], v128 offset:19456
    v_mfma_f32_16x16x32_bf16 v[8:11], a[8:11], v[72:75], v[8:11]
    ds_read_b128 v[88:91], v128 offset:35840
    v_mfma_f32_16x16x32_bf16 v[12:15], a[8:11], v[76:79], v[12:15]
    ds_read_b128 v[92:95], v128 offset:52224
    v_mfma_f32_16x16x32_bf16 v[16:19], a[72:75], v[64:67], v[16:19]
    v_mfma_f32_16x16x32_bf16 v[20:23], a[72:75], v[68:71], v[20:23]
    s_add_u32 m0, s44, 69632
    s_add_u32 s35, s45, 4096
    buffer_load_dwordx4 v251, s[4:7], s35 offen sc1 lds
    v_mfma_f32_16x16x32_bf16 v[24:27], a[72:75], v[72:75], v[24:27]
    v_mfma_f32_16x16x32_bf16 v[28:31], a[72:75], v[76:79], v[28:31]
    v_mfma_f32_16x16x32_bf16 v[32:35], a[136:139], v[64:67], v[32:35]
    v_mfma_f32_16x16x32_bf16 v[36:39], a[136:139], v[68:71], v[36:39]
    buffer_store_dwordx4 v[104:107], v130, s[4:7], s61 offen offset:0 sc1
    v_mfma_f32_16x16x32_bf16 v[40:43], a[136:139], v[72:75], v[40:43]
    v_mfma_f32_16x16x32_bf16 v[44:47], a[136:139], v[76:79], v[44:47]
    v_mfma_f32_16x16x32_bf16 v[48:51], a[200:203], v[64:67], v[48:51]
    v_mfma_f32_16x16x32_bf16 v[52:55], a[200:203], v[68:71], v[52:55]
    s_add_u32 m0, s44, 70656
    s_add_u32 s35, s45, 5120
    buffer_load_dwordx4 v251, s[4:7], s35 offen sc1 lds
    v_mfma_f32_16x16x32_bf16 v[56:59], a[200:203], v[72:75], v[56:59]
    v_mfma_f32_16x16x32_bf16 v[60:63], a[200:203], v[76:79], v[60:63]
    s_waitcnt lgkmcnt(0)
    v_mfma_f32_16x16x32_bf16 v[0:3], a[12:15], v[80:83], v[0:3]
    ds_read_b128 v[64:67], v128 offset:4096
    v_mfma_f32_16x16x32_bf16 v[4:7], a[12:15], v[84:87], v[4:7]
    ds_read_b128 v[68:71], v128 offset:20480
    v_mfma_f32_16x16x32_bf16 v[8:11], a[12:15], v[88:91], v[8:11]
    ds_read_b128 v[72:75], v128 offset:36864
    v_mfma_f32_16x16x32_bf16 v[12:15], a[12:15], v[92:95], v[12:15]
    ds_read_b128 v[76:79], v128 offset:53248
    v_mfma_f32_16x16x32_bf16 v[16:19], a[76:79], v[80:83], v[16:19]
    v_mfma_f32_16x16x32_bf16 v[20:23], a[76:79], v[84:87], v[20:23]
    s_add_u32 m0, s44, 71680
    s_add_u32 s35, s45, 6144
    buffer_load_dwordx4 v251, s[4:7], s35 offen sc1 lds
    v_mfma_f32_16x16x32_bf16 v[24:27], a[76:79], v[88:91], v[24:27]
    v_mfma_f32_16x16x32_bf16 v[28:31], a[76:79], v[92:95], v[28:31]
    v_mfma_f32_16x16x32_bf16 v[32:35], a[140:143], v[80:83], v[32:35]
    v_mfma_f32_16x16x32_bf16 v[36:39], a[140:143], v[84:87], v[36:39]
    buffer_store_dwordx4 v[108:111], v130, s[4:7], s61 offen offset:1024 sc1
    v_mfma_f32_16x16x32_bf16 v[40:43], a[140:143], v[88:91], v[40:43]
    v_mfma_f32_16x16x32_bf16 v[44:47], a[140:143], v[92:95], v[44:47]
    v_mfma_f32_16x16x32_bf16 v[48:51], a[204:207], v[80:83], v[48:51]
    v_mfma_f32_16x16x32_bf16 v[52:55], a[204:207], v[84:87], v[52:55]
    s_add_u32 m0, s44, 72704
    s_add_u32 s35, s45, 7168
    buffer_load_dwordx4 v251, s[4:7], s35 offen sc1 lds
    v_mfma_f32_16x16x32_bf16 v[56:59], a[204:207], v[88:91], v[56:59]
    v_mfma_f32_16x16x32_bf16 v[60:63], a[204:207], v[92:95], v[60:63]
    s_waitcnt lgkmcnt(0)
    v_mfma_f32_16x16x32_bf16 v[0:3], a[16:19], v[64:67], v[0:3]
    ds_read_b128 v[80:83], v128 offset:5120
    v_mfma_f32_16x16x32_bf16 v[4:7], a[16:19], v[68:71], v[4:7]
    ds_read_b128 v[84:87], v128 offset:21504
    v_mfma_f32_16x16x32_bf16 v[8:11], a[16:19], v[72:75], v[8:11]
    ds_read_b128 v[88:91], v128 offset:37888
    v_mfma_f32_16x16x32_bf16 v[12:15], a[16:19], v[76:79], v[12:15]
    ds_read_b128 v[92:95], v128 offset:54272
    v_mfma_f32_16x16x32_bf16 v[16:19], a[80:83], v[64:67], v[16:19]
    v_mfma_f32_16x16x32_bf16 v[20:23], a[80:83], v[68:71], v[20:23]
    s_add_u32 m0, s44, 73728
    s_add_u32 s35, s45, 8192
    buffer_load_dwordx4 v251, s[4:7], s35 offen sc1 lds
    v_mfma_f32_16x16x32_bf16 v[24:27], a[80:83], v[72:75], v[24:27]
    v_mfma_f32_16x16x32_bf16 v[28:31], a[80:83], v[76:79], v[28:31]
    v_mfma_f32_16x16x32_bf16 v[32:35], a[144:147], v[64:67], v[32:35]
    v_mfma_f32_16x16x32_bf16 v[36:39], a[144:147], v[68:71], v[36:39]
    buffer_store_dwordx4 v[112:115], v130, s[4:7], s62 offen offset:0 sc1
    v_mfma_f32_16x16x32_bf16 v[40:43], a[144:147], v[72:75], v[40:43]
    v_mfma_f32_16x16x32_bf16 v[44:47], a[144:147], v[76:79], v[44:47]
    v_mfma_f32_16x16x32_bf16 v[48:51], a[208:211], v[64:67], v[48:51]
    v_mfma_f32_16x16x32_bf16 v[52:55], a[208:211], v[68:71], v[52:55]
    s_add_u32 m0, s44, 74752
    s_add_u32 s35, s45, 9216
    buffer_load_dwordx4 v251, s[4:7], s35 offen sc1 lds
    v_mfma_f32_16x16x32_bf16 v[56:59], a[208:211], v[72:75], v[56:59]
    v_mfma_f32_16x16x32_bf16 v[60:63], a[208:211], v[76:79], v[60:63]
    s_waitcnt lgkmcnt(0)
    v_mfma_f32_16x16x32_bf16 v[0:3], a[20:23], v[80:83], v[0:3]
    ds_read_b128 v[64:67], v128 offset:6144
    v_mfma_f32_16x16x32_bf16 v[4:7], a[20:23], v[84:87], v[4:7]
    ds_read_b128 v[68:71], v128 offset:22528
    v_mfma_f32_16x16x32_bf16 v[8:11], a[20:23], v[88:91], v[8:11]
    ds_read_b128 v[72:75], v128 offset:38912
    v_mfma_f32_16x16x32_bf16 v[12:15], a[20:23], v[92:95], v[12:15]
    ds_read_b128 v[76:79], v128 offset:55296
    v_mfma_f32_16x16x32_bf16 v[16:19], a[84:87], v[80:83], v[16:19]
    v_mfma_f32_16x16x32_bf16 v[20:23], a[84:87], v[84:87], v[20:23]
    s_add_u32 m0, s44, 75776
    s_add_u32 s35, s45, 10240
    buffer_load_dwordx4 v251, s[4:7], s35 offen sc1 lds
    v_mfma_f32_16x16x32_bf16 v[24:27], a[84:87], v[88:91], v[24:27]
    v_mfma_f32_16x16x32_bf16 v[28:31], a[84:87], v[92:95], v[28:31]
    v_mfma_f32_16x16x32_bf16 v[32:35], a[148:151], v[80:83], v[32:35]
    v_mfma_f32_16x16x32_bf16 v[36:39], a[148:151], v[84:87], v[36:39]
    buffer_store_dwordx4 v[116:119], v130, s[4:7], s62 offen offset:1024 sc1
    v_mfma_f32_16x16x32_bf16 v[40:43], a[148:151], v[88:91], v[40:43]
    v_mfma_f32_16x16x32_bf16 v[44:47], a[148:151], v[92:95], v[44:47]
    v_mfma_f32_16x16x32_bf16 v[48:51], a[212:215], v[80:83], v[48:51]
    v_mfma_f32_16x16x32_bf16 v[52:55], a[212:215], v[84:87], v[52:55]
    s_add_u32 m0, s44, 76800
    s_add_u32 s35, s45, 11264
    buffer_load_dwordx4 v251, s[4:7], s35 offen sc1 lds
    v_mfma_f32_16x16x32_bf16 v[56:59], a[212:215], v[88:91], v[56:59]
    v_mfma_f32_16x16x32_bf16 v[60:63], a[212:215], v[92:95], v[60:63]
    s_waitcnt lgkmcnt(0)
    v_mfma_f32_16x16x32_bf16 v[0:3], a[24:27], v[64:67], v[0:3]
    ds_read_b128 v[80:83], v128 offset:7168
    v_mfma_f32_16x16x32_bf16 v[4:7], a[24:27], v[68:71], v[4:7]
    ds_read_b128 v[84:87], v128 offset:23552
    v_mfma_f32_16x16x32_bf16 v[8:11], a[24:27], v[72:75], v[8:11]
    ds_read_b128 v[88:91], v128 offset:39936
    v_mfma_f32_16x16x32_bf16 v[12:15], a[24:27], v[76:79], v[12:15]
    ds_read_b128 v[92:95], v128 offset:56320
    v_mfma_f32_16x16x32_bf16 v[16:19], a[88:91], v[64:67], v[16:19]
    v_mfma_f32_16x16x32_bf16 v[20:23], a[88:91], v[68:71], v[20:23]
    s_add_u32 m0, s44, 77824
    s_add_u32 s35, s45, 12288
    buffer_load_dwordx4 v251, s[4:7], s35 offen sc1 lds
    v_mfma_f32_16x16x32_bf16 v[24:27], a[88:91], v[72:75], v[24:27]
    v_mfma_f32_16x16x32_bf16 v[28:31], a[88:91], v[76:79], v[28:31]
    v_mfma_f32_16x16x32_bf16 v[32:35], a[152:155], v[64:67], v[32:35]
    v_mfma_f32_16x16x32_bf16 v[36:39], a[152:155], v[68:71], v[36:39]
    buffer_store_dwordx4 v[120:123], v130, s[4:7], s63 offen offset:0 sc1
    v_mfma_f32_16x16x32_bf16 v[40:43], a[152:155], v[72:75], v[40:43]
    v_mfma_f32_16x16x32_bf16 v[44:47], a[152:155], v[76:79], v[44:47]
    v_mfma_f32_16x16x32_bf16 v[48:51], a[216:219], v[64:67], v[48:51]
    v_mfma_f32_16x16x32_bf16 v[52:55], a[216:219], v[68:71], v[52:55]
    v_mfma_f32_16x16x32_bf16 v[56:59], a[216:219], v[72:75], v[56:59]
    v_mfma_f32_16x16x32_bf16 v[60:63], a[216:219], v[76:79], v[60:63]
    s_waitcnt lgkmcnt(0)
    v_mfma_f32_16x16x32_bf16 v[0:3], a[28:31], v[80:83], v[0:3]
    ds_read_b128 v[64:67], v128 offset:8192
    v_mfma_f32_16x16x32_bf16 v[4:7], a[28:31], v[84:87], v[4:7]
    ds_read_b128 v[68:71], v128 offset:24576
    v_mfma_f32_16x16x32_bf16 v[8:11], a[28:31], v[88:91], v[8:11]
    ds_read_b128 v[72:75], v128 offset:40960
    v_mfma_f32_16x16x32_bf16 v[12:15], a[28:31], v[92:95], v[12:15]
    ds_read_b128 v[76:79], v128 offset:57344
    v_mfma_f32_16x16x32_bf16 v[16:19], a[92:95], v[80:83], v[16:19]
    v_mfma_f32_16x16x32_bf16 v[20:23], a[92:95], v[84:87], v[20:23]
    s_add_u32 m0, s44, 78848
    s_add_u32 s35, s45, 13312
    buffer_load_dwordx4 v251, s[4:7], s35 offen sc1 lds
    v_mfma_f32_16x16x32_bf16 v[24:27], a[92:95], v[88:91], v[24:27]
    v_mfma_f32_16x16x32_bf16 v[28:31], a[92:95], v[92:95], v[28:31]
    v_mfma_f32_16x16x32_bf16 v[32:35], a[156:159], v[80:83], v[32:35]
    v_mfma_f32_16x16x32_bf16 v[36:39], a[156:159], v[84:87], v[36:39]
    buffer_store_dwordx4 v[124:127], v130, s[4:7], s63 offen offset:1024 sc1
    v_mfma_f32_16x16x32_bf16 v[40:43], a[156:159], v[88:91], v[40:43]
    v_mfma_f32_16x16x32_bf16 v[44:47], a[156:159], v[92:95], v[44:47]
    v_mfma_f32_16x16x32_bf16 v[48:51], a[220:223], v[80:83], v[48:51]
    v_mfma_f32_16x16x32_bf16 v[52:55], a[220:223], v[84:87], v[52:55]
    v_mfma_f32_16x16x32_bf16 v[56:59], a[220:223], v[88:91], v[56:59]
    v_mfma_f32_16x16x32_bf16 v[60:63], a[220:223], v[92:95], v[60:63]
    s_waitcnt lgkmcnt(0)
    v_mfma_f32_16x16x32_bf16 v[0:3], a[32:35], v[64:67], v[0:3]
    ds_read_b128 v[80:83], v128 offset:9216
    v_mfma_f32_16x16x32_bf16 v[4:7], a[32:35], v[68:71], v[4:7]
    ds_read_b128 v[84:87], v128 offset:25600
    v_mfma_f32_16x16x32_bf16 v[8:11], a[32:35], v[72:75], v[8:11]
    ds_read_b128 v[88:91], v128 offset:41984
    v_mfma_f32_16x16x32_bf16 v[12:15], a[32:35], v[76:79], v[12:15]
    ds_read_b128 v[92:95], v128 offset:58368
    v_mfma_f32_16x16x32_bf16 v[16:19], a[96:99], v[64:67], v[16:19]
    v_mfma_f32_16x16x32_bf16 v[20:23], a[96:99], v[68:71], v[20:23]
    s_add_u32 m0, s44, 79872
    s_add_u32 s35, s45, 14336
    buffer_load_dwordx4 v251, s[4:7], s35 offen sc1 lds
    v_mfma_f32_16x16x32_bf16 v[24:27], a[96:99], v[72:75], v[24:27]
    v_mfma_f32_16x16x32_bf16 v[28:31], a[96:99], v[76:79], v[28:31]
    v_mfma_f32_16x16x32_bf16 v[32:35], a[160:163], v[64:67], v[32:35]
    v_mfma_f32_16x16x32_bf16 v[36:39], a[160:163], v[68:71], v[36:39]
    v_mfma_f32_16x16x32_bf16 v[40:43], a[160:163], v[72:75], v[40:43]
    v_mfma_f32_16x16x32_bf16 v[44:47], a[160:163], v[76:79], v[44:47]
    v_mfma_f32_16x16x32_bf16 v[48:51], a[224:227], v[64:67], v[48:51]
    v_mfma_f32_16x16x32_bf16 v[52:55], a[224:227], v[68:71], v[52:55]
    v_mfma_f32_16x16x32_bf16 v[56:59], a[224:227], v[72:75], v[56:59]
    v_mfma_f32_16x16x32_bf16 v[60:63], a[224:227], v[76:79], v[60:63]
    s_waitcnt lgkmcnt(0)
    v_mfma_f32_16x16x32_bf16 v[0:3], a[36:39], v[80:83], v[0:3]
    ds_read_b128 v[64:67], v128 offset:10240
    v_mfma_f32_16x16x32_bf16 v[4:7], a[36:39], v[84:87], v[4:7]
    ds_read_b128 v[68:71], v128 offset:26624
    v_mfma_f32_16x16x32_bf16 v[8:11], a[36:39], v[88:91], v[8:11]
    ds_read_b128 v[72:75], v128 offset:43008
    v_mfma_f32_16x16x32_bf16 v[12:15], a[36:39], v[92:95], v[12:15]
    ds_read_b128 v[76:79], v128 offset:59392
    v_mfma_f32_16x16x32_bf16 v[16:19], a[100:103], v[80:83], v[16:19]
    v_mfma_f32_16x16x32_bf16 v[20:23], a[100:103], v[84:87], v[20:23]
    s_add_u32 m0, s44, 80896
    s_add_u32 s35, s45, 15360
    buffer_load_dwordx4 v251, s[4:7], s35 offen sc1 lds
    v_mfma_f32_16x16x32_bf16 v[24:27], a[100:103], v[88:91], v[24:27]
    v_mfma_f32_16x16x32_bf16 v[28:31], a[100:103], v[92:95], v[28:31]
    v_mfma_f32_16x16x32_bf16 v[32:35], a[164:167], v[80:83], v[32:35]
    v_mfma_f32_16x16x32_bf16 v[36:39], a[164:167], v[84:87], v[36:39]
    v_mfma_f32_16x16x32_bf16 v[40:43], a[164:167], v[88:91], v[40:43]
    v_mfma_f32_16x16x32_bf16 v[44:47], a[164:167], v[92:95], v[44:47]
    v_mfma_f32_16x16x32_bf16 v[48:51], a[228:231], v[80:83], v[48:51]
    v_mfma_f32_16x16x32_bf16 v[52:55], a[228:231], v[84:87], v[52:55]
    v_mfma_f32_16x16x32_bf16 v[56:59], a[228:231], v[88:91], v[56:59]
    v_mfma_f32_16x16x32_bf16 v[60:63], a[228:231], v[92:95], v[60:63]
    s_waitcnt lgkmcnt(0)
    v_mfma_f32_16x16x32_bf16 v[0:3], a[40:43], v[64:67], v[0:3]
    ds_read_b128 v[80:83], v128 offset:11264
    v_mfma_f32_16x16x32_bf16 v[4:7], a[40:43], v[68:71], v[4:7]
    ds_read_b128 v[84:87], v128 offset:27648
    v_mfma_f32_16x16x32_bf16 v[8:11], a[40:43], v[72:75], v[8:11]
    ds_read_b128 v[88:91], v128 offset:44032
    v_mfma_f32_16x16x32_bf16 v[12:15], a[40:43], v[76:79], v[12:15]
    ds_read_b128 v[92:95], v128 offset:60416
    v_mfma_f32_16x16x32_bf16 v[16:19], a[104:107], v[64:67], v[16:19]
    v_mfma_f32_16x16x32_bf16 v[20:23], a[104:107], v[68:71], v[20:23]
    v_mfma_f32_16x16x32_bf16 v[24:27], a[104:107], v[72:75], v[24:27]
    v_mfma_f32_16x16x32_bf16 v[28:31], a[104:107], v[76:79], v[28:31]
    v_mfma_f32_16x16x32_bf16 v[32:35], a[168:171], v[64:67], v[32:35]
    v_mfma_f32_16x16x32_bf16 v[36:39], a[168:171], v[68:71], v[36:39]
    v_mfma_f32_16x16x32_bf16 v[40:43], a[168:171], v[72:75], v[40:43]
    v_mfma_f32_16x16x32_bf16 v[44:47], a[168:171], v[76:79], v[44:47]
    v_mfma_f32_16x16x32_bf16 v[48:51], a[232:235], v[64:67], v[48:51]
    v_mfma_f32_16x16x32_bf16 v[52:55], a[232:235], v[68:71], v[52:55]
    v_mfma_f32_16x16x32_bf16 v[56:59], a[232:235], v[72:75], v[56:59]
    v_mfma_f32_16x16x32_bf16 v[60:63], a[232:235], v[76:79], v[60:63]
    s_waitcnt lgkmcnt(0)
    v_mfma_f32_16x16x32_bf16 v[0:3], a[44:47], v[80:83], v[0:3]
    ds_read_b128 v[64:67], v128 offset:12288
    v_mfma_f32_16x16x32_bf16 v[4:7], a[44:47], v[84:87], v[4:7]
    ds_read_b128 v[68:71], v128 offset:28672
    v_mfma_f32_16x16x32_bf16 v[8:11], a[44:47], v[88:91], v[8:11]
    ds_read_b128 v[72:75], v128 offset:45056
    v_mfma_f32_16x16x32_bf16 v[12:15], a[44:47], v[92:95], v[12:15]
    ds_read_b128 v[76:79], v128 offset:61440
    v_mfma_f32_16x16x32_bf16 v[16:19], a[108:111], v[80:83], v[16:19]
    v_mfma_f32_16x16x32_bf16 v[20:23], a[108:111], v[84:87], v[20:23]
    v_mfma_f32_16x16x32_bf16 v[24:27], a[108:111], v[88:91], v[24:27]
    v_mfma_f32_16x16x32_bf16 v[28:31], a[108:111], v[92:95], v[28:31]
    v_mfma_f32_16x16x32_bf16 v[32:35], a[172:175], v[80:83], v[32:35]
    v_mfma_f32_16x16x32_bf16 v[36:39], a[172:175], v[84:87], v[36:39]
    v_mfma_f32_16x16x32_bf16 v[40:43], a[172:175], v[88:91], v[40:43]
    v_mfma_f32_16x16x32_bf16 v[44:47], a[172:175], v[92:95], v[44:47]
    v_mfma_f32_16x16x32_bf16 v[48:51], a[236:239], v[80:83], v[48:51]
    v_mfma_f32_16x16x32_bf16 v[52:55], a[236:239], v[84:87], v[52:55]
    v_mfma_f32_16x16x32_bf16 v[56:59], a[236:239], v[88:91], v[56:59]
    v_mfma_f32_16x16x32_bf16 v[60:63], a[236:239], v[92:95], v[60:63]
    s_waitcnt lgkmcnt(0)
    v_mfma_f32_16x16x32_bf16 v[0:3], a[48:51], v[64:67], v[0:3]
    ds_read_b128 v[80:83], v128 offset:13312
    v_mfma_f32_16x16x32_bf16 v[4:7], a[48:51], v[68:71], v[4:7]
    ds_read_b128 v[84:87], v128 offset:29696
    v_mfma_f32_16x16x32_bf16 v[8:11], a[48:51], v[72:75], v[8:11]
    ds_read_b128 v[88:91], v128 offset:46080
    v_mfma_f32_16x16x32_bf16 v[12:15], a[48:51], v[76:79], v[12:15]
    ds_read_b128 v[92:95], v128 offset:62464
    v_mfma_f32_16x16x32_bf16 v[16:19], a[112:115], v[64:67], v[16:19]
    v_mfma_f32_16x16x32_bf16 v[20:23], a[112:115], v[68:71], v[20:23]
    v_mfma_f32_16x16x32_bf16 v[24:27], a[112:115], v[72:75], v[24:27]
    v_mfma_f32_16x16x32_bf16 v[28:31], a[112:115], v[76:79], v[28:31]
    v_mfma_f32_16x16x32_bf16 v[32:35], a[176:179], v[64:67], v[32:35]
    v_mfma_f32_16x16x32_bf16 v[36:39], a[176:179], v[68:71], v[36:39]
    v_mfma_f32_16x16x32_bf16 v[40:43], a[176:179], v[72:75], v[40:43]
    v_mfma_f32_16x16x32_bf16 v[44:47], a[176:179], v[76:79], v[44:47]
    v_mfma_f32_16x16x32_bf16 v[48:51], a[240:243], v[64:67], v[48:51]
    v_mfma_f32_16x16x32_bf16 v[52:55], a[240:243], v[68:71], v[52:55]
    v_mfma_f32_16x16x32_bf16 v[56:59], a[240:243], v[72:75], v[56:59]
    v_mfma_f32_16x16x32_bf16 v[60:63], a[240:243], v[76:79], v[60:63]
    s_waitcnt lgkmcnt(0)
    v_mfma_f32_16x16x32_bf16 v[0:3], a[52:55], v[80:83], v[0:3]
    ds_read_b128 v[64:67], v128 offset:14336
    v_mfma_f32_16x16x32_bf16 v[4:7], a[52:55], v[84:87], v[4:7]
    ds_read_b128 v[68:71], v128 offset:30720
    v_mfma_f32_16x16x32_bf16 v[8:11], a[52:55], v[88:91], v[8:11]
    ds_read_b128 v[72:75], v128 offset:47104
    v_mfma_f32_16x16x32_bf16 v[12:15], a[52:55], v[92:95], v[12:15]
    ds_read_b128 v[76:79], v128 offset:63488
    v_mfma_f32_16x16x32_bf16 v[16:19], a[116:119], v[80:83], v[16:19]
    v_mfma_f32_16x16x32_bf16 v[20:23], a[116:119], v[84:87], v[20:23]
    v_mfma_f32_16x16x32_bf16 v[24:27], a[116:119], v[88:91], v[24:27]
    v_mfma_f32_16x16x32_bf16 v[28:31], a[116:119], v[92:95], v[28:31]
    v_mfma_f32_16x16x32_bf16 v[32:35], a[180:183], v[80:83], v[32:35]
    v_mfma_f32_16x16x32_bf16 v[36:39], a[180:183], v[84:87], v[36:39]
    v_mfma_f32_16x16x32_bf16 v[40:43], a[180:183], v[88:91], v[40:43]
    v_mfma_f32_16x16x32_bf16 v[44:47], a[180:183], v[92:95], v[44:47]
    v_mfma_f32_16x16x32_bf16 v[48:51], a[244:247], v[80:83], v[48:51]
    v_mfma_f32_16x16x32_bf16 v[52:55], a[244:247], v[84:87], v[52:55]
    v_mfma_f32_16x16x32_bf16 v[56:59], a[244:247], v[88:91], v[56:59]
    v_mfma_f32_16x16x32_bf16 v[60:63], a[244:247], v[92:95], v[60:63]
    s_waitcnt lgkmcnt(0)
    v_mfma_f32_16x16x32_bf16 v[0:3], a[56:59], v[64:67], v[0:3]
    ds_read_b128 v[80:83], v128 offset:15360
    v_mfma_f32_16x16x32_bf16 v[4:7], a[56:59], v[68:71], v[4:7]
    ds_read_b128 v[84:87], v128 offset:31744
    v_mfma_f32_16x16x32_bf16 v[8:11], a[56:59], v[72:75], v[8:11]
    ds_read_b128 v[88:91], v128 offset:48128
    v_mfma_f32_16x16x32_bf16 v[12:15], a[56:59], v[76:79], v[12:15]
    ds_read_b128 v[92:95], v128 offset:64512
    v_mfma_f32_16x16x32_bf16 v[16:19], a[120:123], v[64:67], v[16:19]
    v_mfma_f32_16x16x32_bf16 v[20:23], a[120:123], v[68:71], v[20:23]
    v_mfma_f32_16x16x32_bf16 v[24:27], a[120:123], v[72:75], v[24:27]
    v_mfma_f32_16x16x32_bf16 v[28:31], a[120:123], v[76:79], v[28:31]
    v_mfma_f32_16x16x32_bf16 v[32:35], a[184:187], v[64:67], v[32:35]
    v_mfma_f32_16x16x32_bf16 v[36:39], a[184:187], v[68:71], v[36:39]
    v_mfma_f32_16x16x32_bf16 v[40:43], a[184:187], v[72:75], v[40:43]
    v_mfma_f32_16x16x32_bf16 v[44:47], a[184:187], v[76:79], v[44:47]
    v_mfma_f32_16x16x32_bf16 v[48:51], a[248:251], v[64:67], v[48:51]
    v_mfma_f32_16x16x32_bf16 v[52:55], a[248:251], v[68:71], v[52:55]
    v_mfma_f32_16x16x32_bf16 v[56:59], a[248:251], v[72:75], v[56:59]
    v_mfma_f32_16x16x32_bf16 v[60:63], a[248:251], v[76:79], v[60:63]
    s_waitcnt lgkmcnt(0)
    v_mfma_f32_16x16x32_bf16 v[0:3], a[60:63], v[80:83], v[0:3]
    v_mfma_f32_16x16x32_bf16 v[4:7], a[60:63], v[84:87], v[4:7]
    v_mfma_f32_16x16x32_bf16 v[8:11], a[60:63], v[88:91], v[8:11]
    v_mfma_f32_16x16x32_bf16 v[12:15], a[60:63], v[92:95], v[12:15]
    v_mfma_f32_16x16x32_bf16 v[16:19], a[124:127], v[80:83], v[16:19]
    v_mfma_f32_16x16x32_bf16 v[20:23], a[124:127], v[84:87], v[20:23]
    v_mfma_f32_16x16x32_bf16 v[24:27], a[124:127], v[88:91], v[24:27]
    v_mfma_f32_16x16x32_bf16 v[28:31], a[124:127], v[92:95], v[28:31]
    v_mfma_f32_16x16x32_bf16 v[32:35], a[188:191], v[80:83], v[32:35]
    v_mfma_f32_16x16x32_bf16 v[36:39], a[188:191], v[84:87], v[36:39]
    v_mfma_f32_16x16x32_bf16 v[40:43], a[188:191], v[88:91], v[40:43]
    v_mfma_f32_16x16x32_bf16 v[44:47], a[188:191], v[92:95], v[44:47]
    v_mfma_f32_16x16x32_bf16 v[48:51], a[252:255], v[80:83], v[48:51]
    v_mfma_f32_16x16x32_bf16 v[52:55], a[252:255], v[84:87], v[52:55]
    v_mfma_f32_16x16x32_bf16 v[56:59], a[252:255], v[88:91], v[56:59]
    v_mfma_f32_16x16x32_bf16 v[60:63], a[252:255], v[92:95], v[60:63]
    s_nop 7
    s_lshl_b32 s41, s25, 19
    s_add_u32 s41, s41, s26
    v_mov_b32 v130, v251
    s_add_u32 s60, s41, 0
    v_cvt_pk_bf16_f32 v96, v0, v1
    v_cvt_pk_bf16_f32 v97, v2, v3
    v_cvt_pk_bf16_f32 v98, v16, v17
    v_cvt_pk_bf16_f32 v99, v18, v19
    v_cvt_pk_bf16_f32 v100, v32, v33
    v_cvt_pk_bf16_f32 v101, v34, v35
    v_cvt_pk_bf16_f32 v102, v48, v49
    v_cvt_pk_bf16_f32 v103, v50, v51
    s_add_u32 s61, s41, 4096
    v_cvt_pk_bf16_f32 v104, v4, v5
    v_cvt_pk_bf16_f32 v105, v6, v7
    v_cvt_pk_bf16_f32 v106, v20, v21
    v_cvt_pk_bf16_f32 v107, v22, v23
    v_cvt_pk_bf16_f32 v108, v36, v37
    v_cvt_pk_bf16_f32 v109, v38, v39
    v_cvt_pk_bf16_f32 v110, v52, v53
    v_cvt_pk_bf16_f32 v111, v54, v55
    s_add_u32 s62, s41, 262144
    v_cvt_pk_bf16_f32 v112, v8, v9
    v_cvt_pk_bf16_f32 v113, v10, v11
    v_cvt_pk_bf16_f32 v114, v24, v25
    v_cvt_pk_bf16_f32 v115, v26, v27
    v_cvt_pk_bf16_f32 v116, v40, v41
    v_cvt_pk_bf16_f32 v117, v42, v43
    v_cvt_pk_bf16_f32 v118, v56, v57
    v_cvt_pk_bf16_f32 v119, v58, v59
    s_add_u32 s63, s41, 266240
    v_cvt_pk_bf16_f32 v120, v12, v13
    v_cvt_pk_bf16_f32 v121, v14, v15
    v_cvt_pk_bf16_f32 v122, v28, v29
    v_cvt_pk_bf16_f32 v123, v30, v31
    v_cvt_pk_bf16_f32 v124, v44, v45
    v_cvt_pk_bf16_f32 v125, v46, v47
    v_cvt_pk_bf16_f32 v126, v60, v61
    v_cvt_pk_bf16_f32 v127, v62, v63
    s_cmp_ge_i32 s28, 0
    s_cbranch_scc1 G1_46
    buffer_store_dwordx4 v[96:99], v130, s[4:7], s60 offen offset:0 sc1
    buffer_store_dwordx4 v[100:103], v130, s[4:7], s60 offen offset:1024 sc1
    buffer_store_dwordx4 v[104:107], v130, s[4:7], s61 offen offset:0 sc1
    buffer_store_dwordx4 v[108:111], v130, s[4:7], s61 offen offset:1024 sc1
    buffer_store_dwordx4 v[112:115], v130, s[4:7], s62 offen offset:0 sc1
    buffer_store_dwordx4 v[116:119], v130, s[4:7], s62 offen offset:1024 sc1
    buffer_store_dwordx4 v[120:123], v130, s[4:7], s63 offen offset:0 sc1
    buffer_store_dwordx4 v[124:127], v130, s[4:7], s63 offen offset:1024 sc1
    s_lshl_b32 s43, s25, 7
    s_add_u32 s43, s43, s27
    v_mov_b32 v130, 0x80000000
G1_46:
    s_lshl_b32 s42, s25, 7
    s_add_u32 s28, s42, s27
    s_mov_b32 s25, s40
    s_cmp_ge_u32 s25, 32
    s_cbranch_scc1 GE_44
    s_waitcnt vmcnt(0)
    s_barrier
    s_add_u32 s40, s25, s24
    s_min_u32 s41, s40, 31
    s_lshl_b32 s45, s41, 16
    s_add_u32 s45, s45, s44
    ds_read_b128 v[64:67], v129 offset:0
    ds_read_b128 v[68:71], v129 offset:16384
    ds_read_b128 v[72:75], v129 offset:32768
    ds_read_b128 v[76:79], v129 offset:49152
    s_cmp_lt_i32 s43, 0
    s_cbranch_scc1 GF_47
    buffer_store_dwordx2 v[254:255], v253, s[4:7], s43 offen sc1
GF_47:
    s_mov_b32 s43, s28
    s_waitcnt lgkmcnt(0)
    v_mfma_f32_16x16x32_bf16 v[0:3], a[0:3], v[64:67], 0
    ds_read_b128 v[80:83], v129 offset:1024
    v_mfma_f32_16x16x32_bf16 v[4:7], a[0:3], v[68:71], 0
    ds_read_b128 v[84:87], v129 offset:17408
    v_mfma_f32_16x16x32_bf16 v[8:11], a[0:3], v[72:75], 0
    ds_read_b128 v[88:91], v129 offset:33792
    v_mfma_f32_16x16x32_bf16 v[12:15], a[0:3], v[76:79], 0
    ds_read_b128 v[92:95], v129 offset:50176
    v_mfma_f32_16x16x32_bf16 v[16:19], a[64:67], v[64:67], 0
    v_mfma_f32_16x16x32_bf16 v[20:23], a[64:67], v[68:71], 0
    s_add_u32 m0, s44, 0
    s_add_u32 s35, s45, 0
    buffer_load_dwordx4 v251, s[4:7], s35 offen sc1 lds
    v_mfma_f32_16x16x32_bf16 v[24:27], a[64:67], v[72:75], 0
    v_mfma_f32_16x16x32_bf16 v[28:31], a[64:67], v[76:79], 0
    v_mfma_f32_16x16x32_bf16 v[32:35], a[128:131], v[64:67], 0
    v_mfma_f32_16x16x32_bf16 v[36:39], a[128:131], v[68:71], 0
    buffer_store_dwordx4 v[96:99], v130, s[4:7], s60 offen offset:0 sc1
    v_mfma_f32_16x16x32_bf16 v[40:43], a[128:131], v[72:75], 0
    v_mfma_f32_16x16x32_bf16 v[44:47], a[128:131], v[76:79], 0
    v_mfma_f32_16x16x32_bf16 v[48:51], a[192:195], v[64:67], 0
    v_mfma_f32_16x16x32_bf16 v[52:55], a[192:195], v[68:71], 0
    s_add_u32 m0, s44, 1024
    s_add_u32 s35, s45, 1024
    buffer_load_dwordx4 v251, s[4:7], s35 offen sc1 lds
    v_mfma_f32_16x16x32_bf16 v[56:59], a[192:195], v[72:75], 0
    v_mfma_f32_16x16x32_bf16 v[60:63], a[192:195], v[76:79], 0
    s_waitcnt lgkmcnt(0)
    v_mfma_f32_16x16x32_bf16 v[0:3], a[4:7], v[80:83], v[0:3]
    ds_read_b128 v[64:67], v129 offset:2048
    v_mfma_f32_16x16x32_bf16 v[4:7], a[4:7], v[84:87], v[4:7]
    ds_read_b128 v[68:71], v129 offset:18432
    v_mfma_f32_16x16x32_bf16 v[8:11], a[4:7], v[88:91], v[8:11]
    ds_read_b128 v[72:75], v129 offset:34816
    v_mfma_f32_16x16x32_bf16 v[12:15], a[4:7], v[92:95], v[12:15]
    ds_read_b128 v[76:79], v129 offset:51200
    v_mfma_f32_16x16x32_bf16 v[16:19], a[68:71], v[80:83], v[16:19]
    v_mfma_f32_16x16x32_bf16 v[20:23], a[68:71], v[84:87], v[20:23]
    s_add_u32 m0, s44, 2048
    s_add_u32 s35, s45, 2048
    buffer_load_dwordx4 v251, s[4:7], s35 offen sc1 lds
    v_mfma_f32_16x16x32_bf16 v[24:27], a[68:71], v[88:91], v[24:27]
    v_mfma_f32_16x16x32_bf16 v[28:31], a[68:71], v[92:95], v[28:31]
    v_mfma_f32_16x16x32_bf16 v[32:35], a[132:135], v[80:83], v[32:35]
    v_mfma_f32_16x16x32_bf16 v[36:39], a[132:135], v[84:87], v[36:39]
    buffer_store_dwordx4 v[100:103], v130, s[4:7], s60 offen offset:1024 sc1
    v_mfma_f32_16x16x32_bf16 v[40:43], a[132:135], v[88:91], v[40:43]
    v_mfma_f32_16x16x32_bf16 v[44:47], a[132:135], v[92:95], v[44:47]
    v_mfma_f32_16x16x32_bf16 v[48:51], a[196:199], v[80:83], v[48:51]
    v_mfma_f32_16x16x32_bf16 v[52:55], a[196:199], v[84:87], v[52:55]
    s_add_u32 m0, s44, 3072
    s_add_u32 s35, s45, 3072
    buffer_load_dwordx4 v251, s[4:7], s35 offen sc1 lds
    v_mfma_f32_16x16x32_bf16 v[56:59], a[196:199], v[88:91], v[56:59]
    v_mfma_f32_16x16x32_bf16 v[60:63], a[196:199], v[92:95], v[60:63]
    s_waitcnt lgkmcnt(0)
    v_mfma_f32_16x16x32_bf16 v[0:3], a[8:11], v[64:67], v[0:3]
    ds_read_b128 v[80:83], v129 offset:3072
    v_mfma_f32_16x16x32_bf16 v[4:7], a[8:11], v[68:71], v[4:7]
    ds_read_b128 v[84:87], v129 offset:19456
    v_mfma_f32_16x16x32_bf16 v[8:11], a[8:11], v[72:75], v[8:11]
    ds_read_b128 v[88:91], v129 offset:35840
    v_mfma_f32_16x16x32_bf16 v[12:15], a[8:11], v[76:79], v[12:15]
    ds_read_b128 v[92:95], v129 offset:52224
    v_mfma_f32_16x16x32_bf16 v[16:19], a[72:75], v[64:67], v[16:19]
    v_mfma_f32_16x16x32_bf16 v[20:23], a[72:75], v[68:71], v[20:23]
    s_add_u32 m0, s44, 4096
    s_add_u32 s35, s45, 4096
    buffer_load_dwordx4 v251, s[4:7], s35 offen sc1 lds
    v_mfma_f32_16x16x32_bf16 v[24:27], a[72:75], v[72:75], v[24:27]
    v_mfma_f32_16x16x32_bf16 v[28:31], a[72:75], v[76:79], v[28:31]
    v_mfma_f32_16x16x32_bf16 v[32:35], a[136:139], v[64:67], v[32:35]
    v_mfma_f32_16x16x32_bf16 v[36:39], a[136:139], v[68:71], v[36:39]
    buffer_store_dwordx4 v[104:107], v130, s[4:7], s61 offen offset:0 sc1
    v_mfma_f32_16x16x32_bf16 v[40:43], a[136:139], v[72:75], v[40:43]
    v_mfma_f32_16x16x32_bf16 v[44:47], a[136:139], v[76:79], v[44:47]
    v_mfma_f32_16x16x32_bf16 v[48:51], a[200:203], v[64:67], v[48:51]
    v_mfma_f32_16x16x32_bf16 v[52:55], a[200:203], v[68:71], v[52:55]
    s_add_u32 m0, s44, 5120
    s_add_u32 s35, s45, 5120
    buffer_load_dwordx4 v251, s[4:7], s35 offen sc1 lds
    v_mfma_f32_16x16x32_bf16 v[56:59], a[200:203], v[72:75], v[56:59]
    v_mfma_f32_16x16x32_bf16 v[60:63], a[200:203], v[76:79], v[60:63]
    s_waitcnt lgkmcnt(0)
    v_mfma_f32_16x16x32_bf16 v[0:3], a[12:15], v[80:83], v[0:3]
    ds_read_b128 v[64:67], v129 offset:4096
    v_mfma_f32_16x16x32_bf16 v[4:7], a[12:15], v[84:87], v[4:7]
    ds_read_b128 v[68:71], v129 offset:20480
    v_mfma_f32_16x16x32_bf16 v[8:11], a[12:15], v[88:91], v[8:11]
    ds_read_b128 v[72:75], v129 offset:36864
    v_mfma_f32_16x16x32_bf16 v[12:15], a[12:15], v[92:95], v[12:15]
    ds_read_b128 v[76:79], v129 offset:53248
    v_mfma_f32_16x16x32_bf16 v[16:19], a[76:79], v[80:83], v[16:19]
    v_mfma_f32_16x16x32_bf16 v[20:23], a[76:79], v[84:87], v[20:23]
    s_add_u32 m0, s44, 6144
    s_add_u32 s35, s45, 6144
    buffer_load_dwordx4 v251, s[4:7], s35 offen sc1 lds
    v_mfma_f32_16x16x32_bf16 v[24:27], a[76:79], v[88:91], v[24:27]
    v_mfma_f32_16x16x32_bf16 v[28:31], a[76:79], v[92:95], v[28:31]
    v_mfma_f32_16x16x32_bf16 v[32:35], a[140:143], v[80:83], v[32:35]
    v_mfma_f32_16x16x32_bf16 v[36:39], a[140:143], v[84:87], v[36:39]
    buffer_store_dwordx4 v[108:111], v130, s[4:7], s61 offen offset:1024 sc1
    v_mfma_f32_16x16x32_bf16 v[40:43], a[140:143], v[88:91], v[40:43]
    v_mfma_f32_16x16x32_bf16 v[44:47], a[140:143], v[92:95], v[44:47]
    v_mfma_f32_16x16x32_bf16 v[48:51], a[204:207], v[80:83], v[48:51]
    v_mfma_f32_16x16x32_bf16 v[52:55], a[204:207], v[84:87], v[52:55]
    s_add_u32 m0, s44, 7168
    s_add_u32 s35, s45, 7168
    buffer_load_dwordx4 v251, s[4:7], s35 offen sc1 lds
    v_mfma_f32_16x16x32_bf16 v[56:59], a[204:207], v[88:91], v[56:59]
    v_mfma_f32_16x16x32_bf16 v[60:63], a[204:207], v[92:95], v[60:63]
    s_waitcnt lgkmcnt(0)
    v_mfma_f32_16x16x32_bf16 v[0:3], a[16:19], v[64:67], v[0:3]
    ds_read_b128 v[80:83], v129 offset:5120
    v_mfma_f32_16x16x32_bf16 v[4:7], a[16:19], v[68:71], v[4:7]
    ds_read_b128 v[84:87], v129 offset:21504
    v_mfma_f32_16x16x32_bf16 v[8:11], a[16:19], v[72:75], v[8:11]
    ds_read_b128 v[88:91], v129 offset:37888
    v_mfma_f32_16x16x32_bf16 v[12:15], a[16:19], v[76:79], v[12:15]
    ds_read_b128 v[92:95], v129 offset:54272
    v_mfma_f32_16x16x32_bf16 v[16:19], a[80:83], v[64:67], v[16:19]
    v_mfma_f32_16x16x32_bf16 v[20:23], a[80:83], v[68:71], v[20:23]
    s_add_u32 m0, s44, 8192
    s_add_u32 s35, s45, 8192
    buffer_load_dwordx4 v251, s[4:7], s35 offen sc1 lds
    v_mfma_f32_16x16x32_bf16 v[24:27], a[80:83], v[72:75], v[24:27]
    v_mfma_f32_16x16x32_bf16 v[28:31], a[80:83], v[76:79], v[28:31]
    v_mfma_f32_16x16x32_bf16 v[32:35], a[144:147], v[64:67], v[32:35]
    v_mfma_f32_16x16x32_bf16 v[36:39], a[144:147], v[68:71], v[36:39]
    buffer_store_dwordx4 v[112:115], v130, s[4:7], s62 offen offset:0 sc1
    v_mfma_f32_16x16x32_bf16 v[40:43], a[144:147], v[72:75], v[40:43]
    v_mfma_f32_16x16x32_bf16 v[44:47], a[144:147], v[76:79], v[44:47]
    v_mfma_f32_16x16x32_bf16 v[48:51], a[208:211], v[64:67], v[48:51]
    v_mfma_f32_16x16x32_bf16 v[52:55], a[208:211], v[68:71], v[52:55]
    s_add_u32 m0, s44, 9216
    s_add_u32 s35, s45, 9216
    buffer_load_dwordx4 v251, s[4:7], s35 offen sc1 lds
    v_mfma_f32_16x16x32_bf16 v[56:59], a[208:211], v[72:75], v[56:59]
    v_mfma_f32_16x16x32_bf16 v[60:63], a[208:211], v[76:79], v[60:63]
    s_waitcnt lgkmcnt(0)
    v_mfma_f32_16x16x32_bf16 v[0:3], a[20:23], v[80:83], v[0:3]
    ds_read_b128 v[64:67], v129 offset:6144
    v_mfma_f32_16x16x32_bf16 v[4:7], a[20:23], v[84:87], v[4:7]
    ds_read_b128 v[68:71], v129 offset:22528
    v_mfma_f32_16x16x32_bf16 v[8:11], a[20:23], v[88:91], v[8:11]
    ds_read_b128 v[72:75], v129 offset:38912
    v_mfma_f32_16x16x32_bf16 v[12:15], a[20:23], v[92:95], v[12:15]
    ds_read_b128 v[76:79], v129 offset:55296
    v_mfma_f32_16x16x32_bf16 v[16:19], a[84:87], v[80:83], v[16:19]
    v_mfma_f32_16x16x32_bf16 v[20:23], a[84:87], v[84:87], v[20:23]
    s_add_u32 m0, s44, 10240
    s_add_u32 s35, s45, 10240
    buffer_load_dwordx4 v251, s[4:7], s35 offen sc1 lds
    v_mfma_f32_16x16x32_bf16 v[24:27], a[84:87], v[88:91], v[24:27]
    v_mfma_f32_16x16x32_bf16 v[28:31], a[84:87], v[92:95], v[28:31]
    v_mfma_f32_16x16x32_bf16 v[32:35], a[148:151], v[80:83], v[32:35]
    v_mfma_f32_16x16x32_bf16 v[36:39], a[148:151], v[84:87], v[36:39]
    buffer_store_dwordx4 v[116:119], v130, s[4:7], s62 offen offset:1024 sc1
    v_mfma_f32_16x16x32_bf16 v[40:43], a[148:151], v[88:91], v[40:43]
    v_mfma_f32_16x16x32_bf16 v[44:47], a[148:151], v[92:95], v[44:47]
    v_mfma_f32_16x16x32_bf16 v[48:51], a[212:215], v[80:83], v[48:51]
    v_mfma_f32_16x16x32_bf16 v[52:55], a[212:215], v[84:87], v[52:55]
    s_add_u32 m0, s44, 11264
    s_add_u32 s35, s45, 11264
    buffer_load_dwordx4 v251, s[4:7], s35 offen sc1 lds
    v_mfma_f32_16x16x32_bf16 v[56:59], a[212:215], v[88:91], v[56:59]
    v_mfma_f32_16x16x32_bf16 v[60:63], a[212:215], v[92:95], v[60:63]
    s_waitcnt lgkmcnt(0)
    v_mfma_f32_16x16x32_bf16 v[0:3], a[24:27], v[64:67], v[0:3]
    ds_read_b128 v[80:83], v129 offset:7168
    v_mfma_f32_16x16x32_bf16 v[4:7], a[24:27], v[68:71], v[4:7]
    ds_read_b128 v[84:87], v129 offset:23552
    v_mfma_f32_16x16x32_bf16 v[8:11], a[24:27], v[72:75], v[8:11]
    ds_read_b128 v[88:91], v129 offset:39936
    v_mfma_f32_16x16x32_bf16 v[12:15], a[24:27], v[76:79], v[12:15]
    ds_read_b128 v[92:95], v129 offset:56320
    v_mfma_f32_16x16x32_bf16 v[16:19], a[88:91], v[64:67], v[16:19]
    v_mfma_f32_16x16x32_bf16 v[20:23], a[88:91], v[68:71], v[20:23]
    s_add_u32 m0, s44, 12288
    s_add_u32 s35, s45, 12288
    buffer_load_dwordx4 v251, s[4:7], s35 offen sc1 lds
    v_mfma_f32_16x16x32_bf16 v[24:27], a[88:91], v[72:75], v[24:27]
    v_mfma_f32_16x16x32_bf16 v[28:31], a[88:91], v[76:79], v[28:31]
    v_mfma_f32_16x16x32_bf16 v[32:35], a[152:155], v[64:67], v[32:35]
    v_mfma_f32_16x16x32_bf16 v[36:39], a[152:155], v[68:71], v[36:39]
    buffer_store_dwordx4 v[120:123], v130, s[4:7], s63 offen offset:0 sc1
    v_mfma_f32_16x16x32_bf16 v[40:43], a[152:155], v[72:75], v[40:43]
    v_mfma_f32_16x16x32_bf16 v[44:47], a[152:155], v[76:79], v[44:47]
    v_mfma_f32_16x16x32_bf16 v[48:51], a[216:219], v[64:67], v[48:51]
    v_mfma_f32_16x16x32_bf16 v[52:55], a[216:219], v[68:71], v[52:55]
    v_mfma_f32_16x16x32_bf16 v[56:59], a[216:219], v[72:75], v[56:59]
    v_mfma_f32_16x16x32_bf16 v[60:63], a[216:219], v[76:79], v[60:63]
    s_waitcnt lgkmcnt(0)
    v_mfma_f32_16x16x32_bf16 v[0:3], a[28:31], v[80:83], v[0:3]
    ds_read_b128 v[64:67], v129 offset:8192
    v_mfma_f32_16x16x32_bf16 v[4:7], a[28:31], v[84:87], v[4:7]
    ds_read_b128 v[68:71], v129 offset:24576
    v_mfma_f32_16x16x32_bf16 v[8:11], a[28:31], v[88:91], v[8:11]
    ds_read_b128 v[72:75], v129 offset:40960
    v_mfma_f32_16x16x32_bf16 v[12:15], a[28:31], v[92:95], v[12:15]
    ds_read_b128 v[76:79], v129 offset:57344
    v_mfma_f32_16x16x32_bf16 v[16:19], a[92:95], v[80:83], v[16:19]
    v_mfma_f32_16x16x32_bf16 v[20:23], a[92:95], v[84:87], v[20:23]
    s_add_u32 m0, s44, 13312
    s_add_u32 s35, s45, 13312
    buffer_load_dwordx4 v251, s[4:7], s35 offen sc1 lds
    v_mfma_f32_16x16x32_bf16 v[24:27], a[92:95], v[88:91], v[24:27]
    v_mfma_f32_16x16x32_bf16 v[28:31], a[92:95], v[92:95], v[28:31]
    v_mfma_f32_16x16x32_bf16 v[32:35], a[156:159], v[80:83], v[32:35]
    v_mfma_f32_16x16x32_bf16 v[36:39], a[156:159], v[84:87], v[36:39]
    buffer_store_dwordx4 v[124:127], v130, s[4:7], s63 offen offset:1024 sc1
    v_mfma_f32_16x16x32_bf16 v[40:43], a[156:159], v[88:91], v[40:43]
    v_mfma_f32_16x16x32_bf16 v[44:47], a[156:159], v[92:95], v[44:47]
    v_mfma_f32_16x16x32_bf16 v[48:51], a[220:223], v[80:83], v[48:51]
    v_mfma_f32_16x16x32_bf16 v[52:55], a[220:223], v[84:87], v[52:55]
    v_mfma_f32_16x16x32_bf16 v[56:59], a[220:223], v[88:91], v[56:59]
    v_mfma_f32_16x16x32_bf16 v[60:63], a[220:223], v[92:95], v[60:63]
    s_waitcnt lgkmcnt(0)
    v_mfma_f32_16x16x32_bf16 v[0:3], a[32:35], v[64:67], v[0:3]
    ds_read_b128 v[80:83], v129 offset:9216
    v_mfma_f32_16x16x32_bf16 v[4:7], a[32:35], v[68:71], v[4:7]
    ds_read_b128 v[84:87], v129 offset:25600
    v_mfma_f32_16x16x32_bf16 v[8:11], a[32:35], v[72:75], v[8:11]
    ds_read_b128 v[88:91], v129 offset:41984
    v_mfma_f32_16x16x32_bf16 v[12:15], a[32:35], v[76:79], v[12:15]
    ds_read_b128 v[92:95], v129 offset:58368
    v_mfma_f32_16x16x32_bf16 v[16:19], a[96:99], v[64:67], v[16:19]
    v_mfma_f32_16x16x32_bf16 v[20:23], a[96:99], v[68:71], v[20:23]
    s_add_u32 m0, s44, 14336
    s_add_u32 s35, s45, 14336
    buffer_load_dwordx4 v251, s[4:7], s35 offen sc1 lds
    v_mfma_f32_16x16x32_bf16 v[24:27], a[96:99], v[72:75], v[24:27]
    v_mfma_f32_16x16x32_bf16 v[28:31], a[96:99], v[76:79], v[28:31]
    v_mfma_f32_16x16x32_bf16 v[32:35], a[160:163], v[64:67], v[32:35]
    v_mfma_f32_16x16x32_bf16 v[36:39], a[160:163], v[68:71], v[36:39]
    v_mfma_f32_16x16x32_bf16 v[40:43], a[160:163], v[72:75], v[40:43]
    v_mfma_f32_16x16x32_bf16 v[44:47], a[160:163], v[76:79], v[44:47]
    v_mfma_f32_16x16x32_bf16 v[48:51], a[224:227], v[64:67], v[48:51]
    v_mfma_f32_16x16x32_bf16 v[52:55], a[224:227], v[68:71], v[52:55]
    v_mfma_f32_16x16x32_bf16 v[56:59], a[224:227], v[72:75], v[56:59]
    v_mfma_f32_16x16x32_bf16 v[60:63], a[224:227], v[76:79], v[60:63]
    s_waitcnt lgkmcnt(0)
    v_mfma_f32_16x16x32_bf16 v[0:3], a[36:39], v[80:83], v[0:3]
    ds_read_b128 v[64:67], v129 offset:10240
    v_mfma_f32_16x16x32_bf16 v[4:7], a[36:39], v[84:87], v[4:7]
    ds_read_b128 v[68:71], v129 offset:26624
    v_mfma_f32_16x16x32_bf16 v[8:11], a[36:39], v[88:91], v[8:11]
    ds_read_b128 v[72:75], v129 offset:43008
    v_mfma_f32_16x16x32_bf16 v[12:15], a[36:39], v[92:95], v[12:15]
    ds_read_b128 v[76:79], v129 offset:59392
    v_mfma_f32_16x16x32_bf16 v[16:19], a[100:103], v[80:83], v[16:19]
    v_mfma_f32_16x16x32_bf16 v[20:23], a[100:103], v[84:87], v[20:23]
    s_add_u32 m0, s44, 15360
    s_add_u32 s35, s45, 15360
    buffer_load_dwordx4 v251, s[4:7], s35 offen sc1 lds
    v_mfma_f32_16x16x32_bf16 v[24:27], a[100:103], v[88:91], v[24:27]
    v_mfma_f32_16x16x32_bf16 v[28:31], a[100:103], v[92:95], v[28:31]
    v_mfma_f32_16x16x32_bf16 v[32:35], a[164:167], v[80:83], v[32:35]
    v_mfma_f32_16x16x32_bf16 v[36:39], a[164:167], v[84:87], v[36:39]
    v_mfma_f32_16x16x32_bf16 v[40:43], a[164:167], v[88:91], v[40:43]
    v_mfma_f32_16x16x32_bf16 v[44:47], a[164:167], v[92:95], v[44:47]
    v_mfma_f32_16x16x32_bf16 v[48:51], a[228:231], v[80:83], v[48:51]
    v_mfma_f32_16x16x32_bf16 v[52:55], a[228:231], v[84:87], v[52:55]
    v_mfma_f32_16x16x32_bf16 v[56:59], a[228:231], v[88:91], v[56:59]
    v_mfma_f32_16x16x32_bf16 v[60:63], a[228:231], v[92:95], v[60:63]
    s_waitcnt lgkmcnt(0)
    v_mfma_f32_16x16x32_bf16 v[0:3], a[40:43], v[64:67], v[0:3]
    ds_read_b128 v[80:83], v129 offset:11264
    v_mfma_f32_16x16x32_bf16 v[4:7], a[40:43], v[68:71], v[4:7]
    ds_read_b128 v[84:87], v129 offset:27648
    v_mfma_f32_16x16x32_bf16 v[8:11], a[40:43], v[72:75], v[8:11]
    ds_read_b128 v[88:91], v129 offset:44032
    v_mfma_f32_16x16x32_bf16 v[12:15], a[40:43], v[76:79], v[12:15]
    ds_read_b128 v[92:95], v129 offset:60416
    v_mfma_f32_16x16x32_bf16 v[16:19], a[104:107], v[64:67], v[16:19]
    v_mfma_f32_16x16x32_bf16 v[20:23], a[104:107], v[68:71], v[20:23]
    v_mfma_f32_16x16x32_bf16 v[24:27], a[104:107], v[72:75], v[24:27]
    v_mfma_f32_16x16x32_bf16 v[28:31], a[104:107], v[76:79], v[28:31]
    v_mfma_f32_16x16x32_bf16 v[32:35], a[168:171], v[64:67], v[32:35]
    v_mfma_f32_16x16x32_bf16 v[36:39], a[168:171], v[68:71], v[36:39]
    v_mfma_f32_16x16x32_bf16 v[40:43], a[168:171], v[72:75], v[40:43]
    v_mfma_f32_16x16x32_bf16 v[44:47], a[168:171], v[76:79], v[44:47]
    v_mfma_f32_16x16x32_bf16 v[48:51], a[232:235], v[64:67], v[48:51]
    v_mfma_f32_16x16x32_bf16 v[52:55], a[232:235], v[68:71], v[52:55]
    v_mfma_f32_16x16x32_bf16 v[56:59], a[232:235], v[72:75], v[56:59]
    v_mfma_f32_16x16x32_bf16 v[60:63], a[232:235], v[76:79], v[60:63]
    s_waitcnt lgkmcnt(0)
    v_mfma_f32_16x16x32_bf16 v[0:3], a[44:47], v[80:83], v[0:3]
    ds_read_b128 v[64:67], v129 offset:12288
    v_mfma_f32_16x16x32_bf16 v[4:7], a[44:47], v[84:87], v[4:7]
    ds_read_b128 v[68:71], v129 offset:28672
    v_mfma_f32_16x16x32_bf16 v[8:11], a[44:47], v[88:91], v[8:11]
    ds_read_b128 v[72:75], v129 offset:45056
    v_mfma_f32_16x16x32_bf16 v[12:15], a[44:47], v[92:95], v[12:15]
    ds_read_b128 v[76:79], v129 offset:61440
    v_mfma_f32_16x16x32_bf16 v[16:19], a[108:111], v[80:83], v[16:19]
    v_mfma_f32_16x16x32_bf16 v[20:23], a[108:111], v[84:87], v[20:23]
    v_mfma_f32_16x16x32_bf16 v[24:27], a[108:111], v[88:91], v[24:27]
    v_mfma_f32_16x16x32_bf16 v[28:31], a[108:111], v[92:95], v[28:31]
    v_mfma_f32_16x16x32_bf16 v[32:35], a[172:175], v[80:83], v[32:35]
    v_mfma_f32_16x16x32_bf16 v[36:39], a[172:175], v[84:87], v[36:39]
    v_mfma_f32_16x16x32_bf16 v[40:43], a[172:175], v[88:91], v[40:43]
    v_mfma_f32_16x16x32_bf16 v[44:47], a[172:175], v[92:95], v[44:47]
    v_mfma_f32_16x16x32_bf16 v[48:51], a[236:239], v[80:83], v[48:51]
    v_mfma_f32_16x16x32_bf16 v[52:55], a[236:239], v[84:87], v[52:55]
    v_mfma_f32_16x16x32_bf16 v[56:59], a[236:239], v[88:91], v[56:59]
    v_mfma_f32_16x16x32_bf16 v[60:63], a[236:239], v[92:95], v[60:63]
    s_waitcnt lgkmcnt(0)
    v_mfma_f32_16x16x32_bf16 v[0:3], a[48:51], v[64:67], v[0:3]
    ds_read_b128 v[80:83], v129 offset:13312
    v_mfma_f32_16x16x32_bf16 v[4:7], a[48:51], v[68:71], v[4:7]
    ds_read_b128 v[84:87], v129 offset:29696
    v_mfma_f32_16x16x32_bf16 v[8:11], a[48:51], v[72:75], v[8:11]
    ds_read_b128 v[88:91], v129 offset:46080
    v_mfma_f32_16x16x32_bf16 v[12:15], a[48:51], v[76:79], v[12:15]
    ds_read_b128 v[92:95], v129 offset:62464
    v_mfma_f32_16x16x32_bf16 v[16:19], a[112:115], v[64:67], v[16:19]
    v_mfma_f32_16x16x32_bf16 v[20:23], a[112:115], v[68:71], v[20:23]
    v_mfma_f32_16x16x32_bf16 v[24:27], a[112:115], v[72:75], v[24:27]
    v_mfma_f32_16x16x32_bf16 v[28:31], a[112:115], v[76:79], v[28:31]
    v_mfma_f32_16x16x32_bf16 v[32:35], a[176:179], v[64:67], v[32:35]
    v_mfma_f32_16x16x32_bf16 v[36:39], a[176:179], v[68:71], v[36:39]
    v_mfma_f32_16x16x32_bf16 v[40:43], a[176:179], v[72:75], v[40:43]
    v_mfma_f32_16x16x32_bf16 v[44:47], a[176:179], v[76:79], v[44:47]
    v_mfma_f32_16x16x32_bf16 v[48:51], a[240:243], v[64:67], v[48:51]
    v_mfma_f32_16x16x32_bf16 v[52:55], a[240:243], v[68:71], v[52:55]
    v_mfma_f32_16x16x32_bf16 v[56:59], a[240:243], v[72:75], v[56:59]
    v_mfma_f32_16x16x32_bf16 v[60:63], a[240:243], v[76:79], v[60:63]
    s_waitcnt lgkmcnt(0)
    v_mfma_f32_16x16x32_bf16 v[0:3], a[52:55], v[80:83], v[0:3]
    ds_read_b128 v[64:67], v129 offset:14336
    v_mfma_f32_16x16x32_bf16 v[4:7], a[52:55], v[84:87], v[4:7]
    ds_read_b128 v[68:71], v129 offset:30720
    v_mfma_f32_16x16x32_bf16 v[8:11], a[52:55], v[88:91], v[8:11]
    ds_read_b128 v[72:75], v129 offset:47104
    v_mfma_f32_16x16x32_bf16 v[12:15], a[52:55], v[92:95], v[12:15]
    ds_read_b128 v[76:79], v129 offset:63488
    v_mfma_f32_16x16x32_bf16 v[16:19], a[116:119], v[80:83], v[16:19]
    v_mfma_f32_16x16x32_bf16 v[20:23], a[116:119], v[84:87], v[20:23]
    v_mfma_f32_16x16x32_bf16 v[24:27], a[116:119], v[88:91], v[24:27]
    v_mfma_f32_16x16x32_bf16 v[28:31], a[116:119], v[92:95], v[28:31]
    v_mfma_f32_16x16x32_bf16 v[32:35], a[180:183], v[80:83], v[32:35]
    v_mfma_f32_16x16x32_bf16 v[36:39], a[180:183], v[84:87], v[36:39]
    v_mfma_f32_16x16x32_bf16 v[40:43], a[180:183], v[88:91], v[40:43]
    v_mfma_f32_16x16x32_bf16 v[44:47], a[180:183], v[92:95], v[44:47]
    v_mfma_f32_16x16x32_bf16 v[48:51], a[244:247], v[80:83], v[48:51]
    v_mfma_f32_16x16x32_bf16 v[52:55], a[244:247], v[84:87], v[52:55]
    v_mfma_f32_16x16x32_bf16 v[56:59], a[244:247], v[88:91], v[56:59]
    v_mfma_f32_16x16x32_bf16 v[60:63], a[244:247], v[92:95], v[60:63]
    s_waitcnt lgkmcnt(0)
    v_mfma_f32_16x16x32_bf16 v[0:3], a[56:59], v[64:67], v[0:3]
    ds_read_b128 v[80:83], v129 offset:15360
    v_mfma_f32_16x16x32_bf16 v[4:7], a[56:59], v[68:71], v[4:7]
    ds_read_b128 v[84:87], v129 offset:31744
    v_mfma_f32_16x16x32_bf16 v[8:11], a[56:59], v[72:75], v[8:11]
    ds_read_b128 v[88:91], v129 offset:48128
    v_mfma_f32_16x16x32_bf16 v[12:15], a[56:59], v[76:79], v[12:15]
    ds_read_b128 v[92:95], v129 offset:64512
    v_mfma_f32_16x16x32_bf16 v[16:19], a[120:123], v[64:67], v[16:19]
    v_mfma_f32_16x16x32_bf16 v[20:23], a[120:123], v[68:71], v[20:23]
    v_mfma_f32_16x16x32_bf16 v[24:27], a[120:123], v[72:75], v[24:27]
    v_mfma_f32_16x16x32_bf16 v[28:31], a[120:123], v[76:79], v[28:31]
    v_mfma_f32_16x16x32_bf16 v[32:35], a[184:187], v[64:67], v[32:35]
    v_mfma_f32_16x16x32_bf16 v[36:39], a[184:187], v[68:71], v[36:39]
    v_mfma_f32_16x16x32_bf16 v[40:43], a[184:187], v[72:75], v[40:43]
    v_mfma_f32_16x16x32_bf16 v[44:47], a[184:187], v[76:79], v[44:47]
    v_mfma_f32_16x16x32_bf16 v[48:51], a[248:251], v[64:67], v[48:51]
    v_mfma_f32_16x16x32_bf16 v[52:55], a[248:251], v[68:71], v[52:55]
    v_mfma_f32_16x16x32_bf16 v[56:59], a[248:251], v[72:75], v[56:59]
    v_mfma_f32_16x16x32_bf16 v[60:63], a[248:251], v[76:79], v[60:63]
    s_waitcnt lgkmcnt(0)
    v_mfma_f32_16x16x32_bf16 v[0:3], a[60:63], v[80:83], v[0:3]
    v_mfma_f32_16x16x32_bf16 v[4:7], a[60:63], v[84:87], v[4:7]
    v_mfma_f32_16x16x32_bf16 v[8:11], a[60:63], v[88:91], v[8:11]
    v_mfma_f32_16x16x32_bf16 v[12:15], a[60:63], v[92:95], v[12:15]
    v_mfma_f32_16x16x32_bf16 v[16:19], a[124:127], v[80:83], v[16:19]
    v_mfma_f32_16x16x32_bf16 v[20:23], a[124:127], v[84:87], v[20:23]
    v_mfma_f32_16x16x32_bf16 v[24:27], a[124:127], v[88:91], v[24:27]
    v_mfma_f32_16x16x32_bf16 v[28:31], a[124:127], v[92:95], v[28:31]
    v_mfma_f32_16x16x32_bf16 v[32:35], a[188:191], v[80:83], v[32:35]
    v_mfma_f32_16x16x32_bf16 v[36:39], a[188:191], v[84:87], v[36:39]
    v_mfma_f32_16x16x32_bf16 v[40:43], a[188:191], v[88:91], v[40:43]
    v_mfma_f32_16x16x32_bf16 v[44:47], a[188:191], v[92:95], v[44:47]
    v_mfma_f32_16x16x32_bf16 v[48:51], a[252:255], v[80:83], v[48:51]
    v_mfma_f32_16x16x32_bf16 v[52:55], a[252:255], v[84:87], v[52:55]
    v_mfma_f32_16x16x32_bf16 v[56:59], a[252:255], v[88:91], v[56:59]
    v_mfma_f32_16x16x32_bf16 v[60:63], a[252:255], v[92:95], v[60:63]
    s_nop 7
    s_lshl_b32 s41, s25, 19
    s_add_u32 s41, s41, s26
    v_mov_b32 v130, v251
    s_add_u32 s60, s41, 0
    v_cvt_pk_bf16_f32 v96, v0, v1
    v_cvt_pk_bf16_f32 v97, v2, v3
    v_cvt_pk_bf16_f32 v98, v16, v17
    v_cvt_pk_bf16_f32 v99, v18, v19
    v_cvt_pk_bf16_f32 v100, v32, v33
    v_cvt_pk_bf16_f32 v101, v34, v35
    v_cvt_pk_bf16_f32 v102, v48, v49
    v_cvt_pk_bf16_f32 v103, v50, v51
    s_add_u32 s61, s41, 4096
    v_cvt_pk_bf16_f32 v104, v4, v5
    v_cvt_pk_bf16_f32 v105, v6, v7
    v_cvt_pk_bf16_f32 v106, v20, v21
    v_cvt_pk_bf16_f32 v107, v22, v23
    v_cvt_pk_bf16_f32 v108, v36, v37
    v_cvt_pk_bf16_f32 v109, v38, v39
    v_cvt_pk_bf16_f32 v110, v52, v53
    v_cvt_pk_bf16_f32 v111, v54, v55
    s_add_u32 s62, s41, 262144
    v_cvt_pk_bf16_f32 v112, v8, v9
    v_cvt_pk_bf16_f32 v113, v10, v11
    v_cvt_pk_bf16_f32 v114, v24, v25
    v_cvt_pk_bf16_f32 v115, v26, v27
    v_cvt_pk_bf16_f32 v116, v40, v41
    v_cvt_pk_bf16_f32 v117, v42, v43
    v_cvt_pk_bf16_f32 v118, v56, v57
    v_cvt_pk_bf16_f32 v119, v58, v59
    s_add_u32 s63, s41, 266240
    v_cvt_pk_bf16_f32 v120, v12, v13
    v_cvt_pk_bf16_f32 v121, v14, v15
    v_cvt_pk_bf16_f32 v122, v28, v29
    v_cvt_pk_bf16_f32 v123, v30, v31
    v_cvt_pk_bf16_f32 v124, v44, v45
    v_cvt_pk_bf16_f32 v125, v46, v47
    v_cvt_pk_bf16_f32 v126, v60, v61
    v_cvt_pk_bf16_f32 v127, v62, v63
    s_lshl_b32 s42, s25, 7
    s_add_u32 s28, s42, s27
    s_mov_b32 s25, s40
    s_cmp_lt_u32 s25, 32
    s_cbranch_scc1 GL_43
GE_44:
    buffer_store_dwordx4 v[96:99], v130, s[4:7], s60 offen offset:0 sc1
    buffer_store_dwordx4 v[100:103], v130, s[4:7], s60 offen offset:1024 sc1
    buffer_store_dwordx4 v[104:107], v130, s[4:7], s61 offen offset:0 sc1
    buffer_store_dwordx4 v[108:111], v130, s[4:7], s61 offen offset:1024 sc1
    buffer_store_dwordx4 v[112:115], v130, s[4:7], s62 offen offset:0 sc1
    buffer_store_dwordx4 v[116:119], v130, s[4:7], s62 offen offset:1024 sc1
    buffer_store_dwordx4 v[120:123], v130, s[4:7], s63 offen offset:0 sc1
    buffer_store_dwordx4 v[124:127], v130, s[4:7], s63 offen offset:1024 sc1
    s_waitcnt vmcnt(0)
    s_barrier
    s_cmp_lt_i32 s43, 0
    s_cbranch_scc1 GF_48
    buffer_store_dwordx2 v[254:255], v253, s[4:7], s43 offen sc1
GF_48:
    buffer_store_dwordx2 v[254:255], v253, s[4:7], s28 offen sc1
    s_cmp_lt_u32 s20, 128
    s_cbranch_scc1 WS1_14
    s_branch WS2_16
WFF_3:
    s_sub_u32 s40, s20, 192
    s_mul_i32 s22, s40, 86
    s_lshr_b32 s22, s22, 8
    s_mul_i32 s41, s22, 3
    s_sub_u32 s25, s40, s41
    s_cmp_lt_u32 s20, 32
    s_cselect_b32 s24, 32, 3
    s_cselect_b32 s22, 10, s22
    s_cselect_b32 s25, s20, s25
    s_load_dwordx2 s[8:9], s[0:1], 64
    s_mov_b32 s10, 1409024
    s_mov_b32 s11, 0x20000
    s_waitcnt lgkmcnt(0)
    s_load_dwordx2 s[12:13], s[0:1], 72
    s_mov_b32 s14, 1409024
    s_mov_b32 s15, 0x20000
    s_waitcnt lgkmcnt(0)
    s_lshl_b32 s42, s22, 2
    s_add_u32 s42, s42, s21
    s_lshl_b32 s41, s42, 6
    s_lshl_b32 s26, s42, 10
    s_add_u32 s26, s26, 69206016
    s_lshl_b32 s27, s22, 3
    s_add_u32 s27, s27, 94396416
    s_lshl_b32 s40, s21, 15
    s_mov_b32 s30, 1000000
TP_49:
    buffer_load_dwordx2 v[254:255], v252, s[16:19], 0 offen sc1
    s_sub_u32 s30, s30, 1
    s_cbranch_scc1 L_FAIL
    s_waitcnt vmcnt(0)
    v_readfirstlane_b32 s38, v254
    v_readfirstlane_b32 s39, v255
    s_nop 3
    s_cmp_eq_u32 s39, 0
    s_cbranch_scc1 TP_49
    s_mov_b32 s30, 0x400000
    s_bfe_u32 s32, s39, 0x30018
    s_cmp_lg_u32 s32, s3
    s_cbranch_scc1 L_RESTART
    s_cmp_ge_u32 s20, 222
    s_cbranch_scc1 WS2_16
    s_cmp_ge_u32 s20, 32
    s_cbranch_scc1 PO_50
    v_mov_b64 v[8:9], -1
    v_mov_b64 v[10:11], -1
    s_lshl_b32 s43, s20, 14
    s_lshl_b32 s44, s21, 12
    s_add_u32 s43, s43, s44
    s_add_u32 s43, s43, 75497472
    buffer_store_dwordx4 v[8:11], v251, s[4:7], s43 offen offset:0 sc1
    buffer_store_dwordx4 v[8:11], v251, s[4:7], s43 offen offset:1024 sc1
    buffer_store_dwordx4 v[8:11], v251, s[4:7], s43 offen offset:2048 sc1
    buffer_store_dwordx4 v[8:11], v251, s[4:7], s43 offen offset:3072 sc1
    s_lshl_b32 s43, s20, 13
    s_lshl_b32 s44, s21, 11
    s_add_u32 s43, s43, s44
    s_add_u32 s43, s43, 68943872
    buffer_store_dwordx4 v[8:11], v251, s[4:7], s43 offen offset:0 sc1
    buffer_store_dwordx4 v[8:11], v251, s[4:7], s43 offen offset:1024 sc1
    s_lshl_b32 s43, s20, 7
    s_add_u32 s43, s43, 94375936
    s_waitcnt vmcnt(0)
    s_barrier
    buffer_store_dwordx2 v[254:255], v253, s[4:7], s43 offen sc1
PO_50:
    s_mov_b32 s64, 0
    v_lshrrev_b32 v1, 2, v250
    v_and_b32 v2, 3, v250
    v_lshlrev_b32 v2, 4, v2
    s_mov_b32 s35, 2752
    v_mul_lo_u32 v3, v1, s35
    v_add_u32 v3, v3, v2
    v_lshrrev_b32 v6, 4, v250
    v_lshlrev_b32 v6, 3, v6
    v_and_b32 v1, 3, v1
    v_add_u32 v6, v6, v1
    v_lshlrev_b32 v6, 6, v6
    v_add_u32 v6, v6, v2
    v_add_u32 v6, s40, v6
    s_add_u32 m0, s40, 0
    s_add_u32 s35, s41, 0
    buffer_load_dwordx4 v3, s[8:11], s35 offen nt lds
    s_add_u32 m0, s40, 1024
    s_add_u32 s35, s41, 44032
    buffer_load_dwordx4 v3, s[8:11], s35 offen nt lds
    s_add_u32 m0, s40, 2048
    s_add_u32 s35, s41, 88064
    buffer_load_dwordx4 v3, s[8:11], s35 offen nt lds
    s_add_u32 m0, s40, 3072
    s_add_u32 s35, s41, 132096
    buffer_load_dwordx4 v3, s[8:11], s35 offen nt lds
    s_add_u32 m0, s40, 4096
    s_add_u32 s35, s41, 0
    buffer_load_dwordx4 v3, s[12:15], s35 offen nt lds
    s_add_u32 m0, s40, 5120
    s_add_u32 s35, s41, 44032
    buffer_load_dwordx4 v3, s[12:15], s35 offen nt lds
    s_add_u32 m0, s40, 6144
    s_add_u32 s35, s41, 88064
    buffer_load_dwordx4 v3, s[12:15], s35 offen nt lds
    s_add_u32 m0, s40, 7168
    s_add_u32 s35, s41, 132096
    buffer_load_dwordx4 v3, s[12:15], s35 offen nt lds
    s_add_u32 m0, s40, 8192
    s_add_u32 s35, s41, 176128
    buffer_load_dwordx4 v3, s[8:11], s35 offen nt lds
    s_add_u32 m0, s40, 9216
    s_add_u32 s35, s41, 220160
    buffer_load_dwordx4 v3, s[8:11], s35 offen nt lds
    s_add_u32 m0, s40, 10240
    s_add_u32 s35, s41, 264192
    buffer_load_dwordx4 v3, s[8:11], s35 offen nt lds
    s_add_u32 m0, s40, 11264
    s_add_u32 s35, s41, 308224
    buffer_load_dwordx4 v3, s[8:11], s35 offen nt lds
    s_add_u32 m0, s40, 12288
    s_add_u32 s35, s41, 176128
    buffer_load_dwordx4 v3, s[12:15], s35 offen nt lds
    s_add_u32 m0, s40, 13312
    s_add_u32 s35, s41, 220160
    buffer_load_dwordx4 v3, s[12:15], s35 offen nt lds
    s_add_u32 m0, s40, 14336
    s_add_u32 s35, s41, 264192
    buffer_load_dwordx4 v3, s[12:15], s35 offen nt lds
    s_add_u32 m0, s40, 15360
    s_add_u32 s35, s41, 308224
    buffer_load_dwordx4 v3, s[12:15], s35 offen nt lds
    s_add_u32 m0, s40, 16384
    s_add_u32 s35, s41, 352256
    buffer_load_dwordx4 v3, s[8:11], s35 offen nt lds
    s_add_u32 m0, s40, 17408
    s_add_u32 s35, s41, 396288
    buffer_load_dwordx4 v3, s[8:11], s35 offen nt lds
    s_add_u32 m0, s40, 18432
    s_add_u32 s35, s41, 440320
    buffer_load_dwordx4 v3, s[8:11], s35 offen nt lds
    s_add_u32 m0, s40, 19456
    s_add_u32 s35, s41, 484352
    buffer_load_dwordx4 v3, s[8:11], s35 offen nt lds
    s_add_u32 m0, s40, 20480
    s_add_u32 s35, s41, 352256
    buffer_load_dwordx4 v3, s[12:15], s35 offen nt lds
    s_add_u32 m0, s40, 21504
    s_add_u32 s35, s41, 396288
    buffer_load_dwordx4 v3, s[12:15], s35 offen nt lds
    s_add_u32 m0, s40, 22528
    s_add_u32 s35, s41, 440320
    buffer_load_dwordx4 v3, s[12:15], s35 offen nt lds
    s_add_u32 m0, s40, 23552
    s_add_u32 s35, s41, 484352
    buffer_load_dwordx4 v3, s[12:15], s35 offen nt lds
    s_add_u32 m0, s40, 24576
    s_add_u32 s35, s41, 528384
    buffer_load_dwordx4 v3, s[8:11], s35 offen nt lds
    s_add_u32 m0, s40, 25600
    s_add_u32 s35, s41, 572416
    buffer_load_dwordx4 v3, s[8:11], s35 offen nt lds
    s_add_u32 m0, s40, 26624
    s_add_u32 s35, s41, 616448
    buffer_load_dwordx4 v3, s[8:11], s35 offen nt lds
    s_add_u32 m0, s40, 27648
    s_add_u32 s35, s41, 660480
    buffer_load_dwordx4 v3, s[8:11], s35 offen nt lds
    s_add_u32 m0, s40, 28672
    s_add_u32 s35, s41, 528384
    buffer_load_dwordx4 v3, s[12:15], s35 offen nt lds
    s_add_u32 m0, s40, 29696
    s_add_u32 s35, s41, 572416
    buffer_load_dwordx4 v3, s[12:15], s35 offen nt lds
    s_add_u32 m0, s40, 30720
    s_add_u32 s35, s41, 616448
    buffer_load_dwordx4 v3, s[12:15], s35 offen nt lds
    s_add_u32 m0, s40, 31744
    s_add_u32 s35, s41, 660480
    buffer_load_dwordx4 v3, s[12:15], s35 offen nt lds
    s_waitcnt vmcnt(28)
    ds_read_b64_tr_b16 a[0:1], v6 offset:0
    ds_read_b64_tr_b16 a[2:3], v6 offset:256
    ds_read_b64_tr_b16 a[4:5], v6 offset:2048
    ds_read_b64_tr_b16 a[6:7], v6 offset:2304
    ds_read_b64_tr_b16 a[64:65], v6 offset:8
    ds_read_b64_tr_b16 a[66:67], v6 offset:264
    ds_read_b64_tr_b16 a[68:69], v6 offset:2056
    ds_read_b64_tr_b16 a[70:71], v6 offset:2312
    s_waitcnt lgkmcnt(0)
    s_add_u32 m0, s40, 0
    s_add_u32 s35, s41, 704512
    buffer_load_dwordx4 v3, s[8:11], s35 offen nt lds
    s_add_u32 m0, s40, 1024
    s_add_u32 s35, s41, 748544
    buffer_load_dwordx4 v3, s[8:11], s35 offen nt lds
    s_add_u32 m0, s40, 2048
    s_add_u32 s35, s41, 792576
    buffer_load_dwordx4 v3, s[8:11], s35 offen nt lds
    s_add_u32 m0, s40, 3072
    s_add_u32 s35, s41, 836608
    buffer_load_dwordx4 v3, s[8:11], s35 offen nt lds
    s_waitcnt vmcnt(28)
    ds_read_b64_tr_b16 a[128:129], v6 offset:4096
    ds_read_b64_tr_b16 a[130:131], v6 offset:4352
    ds_read_b64_tr_b16 a[132:133], v6 offset:6144
    ds_read_b64_tr_b16 a[134:135], v6 offset:6400
    ds_read_b64_tr_b16 a[192:193], v6 offset:4104
    ds_read_b64_tr_b16 a[194:195], v6 offset:4360
    ds_read_b64_tr_b16 a[196:197], v6 offset:6152
    ds_read_b64_tr_b16 a[198:199], v6 offset:6408
    s_waitcnt lgkmcnt(0)
    s_add_u32 m0, s40, 4096
    s_add_u32 s35, s41, 704512
    buffer_load_dwordx4 v3, s[12:15], s35 offen nt lds
    s_add_u32 m0, s40, 5120
    s_add_u32 s35, s41, 748544
    buffer_load_dwordx4 v3, s[12:15], s35 offen nt lds
    s_add_u32 m0, s40, 6144
    s_add_u32 s35, s41, 792576
    buffer_load_dwordx4 v3, s[12:15], s35 offen nt lds
    s_add_u32 m0, s40, 7168
    s_add_u32 s35, s41, 836608
    buffer_load_dwordx4 v3, s[12:15], s35 offen nt lds
    s_waitcnt vmcnt(28)
    ds_read_b64_tr_b16 a[8:9], v6 offset:8192
    ds_read_b64_tr_b16 a[10:11], v6 offset:8448
    ds_read_b64_tr_b16 a[12:13], v6 offset:10240
    ds_read_b64_tr_b16 a[14:15], v6 offset:10496
    ds_read_b64_tr_b16 a[72:73], v6 offset:8200
    ds_read_b64_tr_b16 a[74:75], v6 offset:8456
    ds_read_b64_tr_b16 a[76:77], v6 offset:10248
    ds_read_b64_tr_b16 a[78:79], v6 offset:10504
    s_waitcnt lgkmcnt(0)
    s_add_u32 m0, s40, 8192
    s_add_u32 s35, s41, 880640
    buffer_load_dwordx4 v3, s[8:11], s35 offen nt lds
    s_add_u32 m0, s40, 9216
    s_add_u32 s35, s41, 924672
    buffer_load_dwordx4 v3, s[8:11], s35 offen nt lds
    s_add_u32 m0, s40, 10240
    s_add_u32 s35, s41, 968704
    buffer_load_dwordx4 v3, s[8:11], s35 offen nt lds
    s_add_u32 m0, s40, 11264
    s_add_u32 s35, s41, 1012736
    buffer_load_dwordx4 v3, s[8:11], s35 offen nt lds
    s_waitcnt vmcnt(28)
    ds_read_b64_tr_b16 a[136:137], v6 offset:12288
    ds_read_b64_tr_b16 a[138:139], v6 offset:12544
    ds_read_b64_tr_b16 a[140:141], v6 offset:14336
    ds_read_b64_tr_b16 a[142:143], v6 offset:14592
    ds_read_b64_tr_b16 a[200:201], v6 offset:12296
    ds_read_b64_tr_b16 a[202:203], v6 offset:12552
    ds_read_b64_tr_b16 a[204:205], v6 offset:14344
    ds_read_b64_tr_b16 a[206:207], v6 offset:14600
    s_waitcnt lgkmcnt(0)
    s_add_u32 m0, s40, 12288
    s_add_u32 s35, s41, 880640
    buffer_load_dwordx4 v3, s[12:15], s35 offen nt lds
    s_add_u32 m0, s40, 13312
    s_add_u32 s35, s41, 924672
    buffer_load_dwordx4 v3, s[12:15], s35 offen nt lds
    s_add_u32 m0, s40, 14336
    s_add_u32 s35, s41, 968704
    buffer_load_dwordx4 v3, s[12:15], s35 offen nt lds
    s_add_u32 m0, s40, 15360
    s_add_u32 s35, s41, 1012736
    buffer_load_dwordx4 v3, s[12:15], s35 offen nt lds
    s_waitcnt vmcnt(28)
    ds_read_b64_tr_b16 a[16:17], v6 offset:16384
    ds_read_b64_tr_b16 a[18:19], v6 offset:16640
    ds_read_b64_tr_b16 a[20:21], v6 offset:18432
    ds_read_b64_tr_b16 a[22:23], v6 offset:18688
    ds_read_b64_tr_b16 a[80:81], v6 offset:16392
    ds_read_b64_tr_b16 a[82:83], v6 offset:16648
    ds_read_b64_tr_b16 a[84:85], v6 offset:18440
    ds_read_b64_tr_b16 a[86:87], v6 offset:18696
    s_waitcnt lgkmcnt(0)
    s_add_u32 m0, s40, 16384
    s_add_u32 s35, s41, 1056768
    buffer_load_dwordx4 v3, s[8:11], s35 offen nt lds
    s_add_u32 m0, s40, 17408
    s_add_u32 s35, s41, 1100800
    buffer_load_dwordx4 v3, s[8:11], s35 offen nt lds
    s_add_u32 m0, s40, 18432
    s_add_u32 s35, s41, 1144832
    buffer_load_dwordx4 v3, s[8:11], s35 offen nt lds
    s_add_u32 m0, s40, 19456
    s_add_u32 s35, s41, 1188864
    buffer_load_dwordx4 v3, s[8:11], s35 offen nt lds
    s_waitcnt vmcnt(28)
    ds_read_b64_tr_b16 a[144:145], v6 offset:20480
    ds_read_b64_tr_b16 a[146:147], v6 offset:20736
    ds_read_b64_tr_b16 a[148:149], v6 offset:22528
    ds_read_b64_tr_b16 a[150:151], v6 offset:22784
    ds_read_b64_tr_b16 a[208:209], v6 offset:20488
    ds_read_b64_tr_b16 a[210:211], v6 offset:20744
    ds_read_b64_tr_b16 a[212:213], v6 offset:22536
    ds_read_b64_tr_b16 a[214:215], v6 offset:22792
    s_waitcnt lgkmcnt(0)
    s_add_u32 m0, s40, 20480
    s_add_u32 s35, s41, 1056768
    buffer_load_dwordx4 v3, s[12:15], s35 offen nt lds
    s_add_u32 m0, s40, 21504
    s_add_u32 s35, s41, 1100800
    buffer_load_dwordx4 v3, s[12:15], s35 offen nt lds
    s_add_u32 m0, s40, 22528
    s_add_u32 s35, s41, 1144832
    buffer_load_dwordx4 v3, s[12:15], s35 offen nt lds
    s_add_u32 m0, s40, 23552
    s_add_u32 s35, s41, 1188864
    buffer_load_dwordx4 v3, s[12:15], s35 offen nt lds
    s_waitcnt vmcnt(28)
    ds_read_b64_tr_b16 a[24:25], v6 offset:24576
    ds_read_b64_tr_b16 a[26:27], v6 offset:24832
    ds_read_b64_tr_b16 a[28:29], v6 offset:26624
    ds_read_b64_tr_b16 a[30:31], v6 offset:26880
    ds_read_b64_tr_b16 a[88:89], v6 offset:24584
    ds_read_b64_tr_b16 a[90:91], v6 offset:24840
    ds_read_b64_tr_b16 a[92:93], v6 offset:26632
    ds_read_b64_tr_b16 a[94:95], v6 offset:26888
    s_waitcnt lgkmcnt(0)
    s_add_u32 m0, s40, 24576
    s_add_u32 s35, s41, 1232896
    buffer_load_dwordx4 v3, s[8:11], s35 offen nt lds
    s_add_u32 m0, s40, 25600
    s_add_u32 s35, s41, 1276928
    buffer_load_dwordx4 v3, s[8:11], s35 offen nt lds
    s_add_u32 m0, s40, 26624
    s_add_u32 s35, s41, 1320960
    buffer_load_dwordx4 v3, s[8:11], s35 offen nt lds
    s_add_u32 m0, s40, 27648
    s_add_u32 s35, s41, 1364992
    buffer_load_dwordx4 v3, s[8:11], s35 offen nt lds
    s_waitcnt vmcnt(28)
    ds_read_b64_tr_b16 a[152:153], v6 offset:28672
    ds_read_b64_tr_b16 a[154:155], v6 offset:28928
    ds_read_b64_tr_b16 a[156:157], v6 offset:30720
    ds_read_b64_tr_b16 a[158:159], v6 offset:30976
    ds_read_b64_tr_b16 a[216:217], v6 offset:28680
    ds_read_b64_tr_b16 a[218:219], v6 offset:28936
    ds_read_b64_tr_b16 a[220:221], v6 offset:30728
    ds_read_b64_tr_b16 a[222:223], v6 offset:30984
    s_waitcnt lgkmcnt(0)
    s_add_u32 m0, s40, 28672
    s_add_u32 s35, s41, 1232896
    buffer_load_dwordx4 v3, s[12:15], s35 offen nt lds
    s_add_u32 m0, s40, 29696
    s_add_u32 s35, s41, 1276928
    buffer_load_dwordx4 v3, s[12:15], s35 offen nt lds
    s_add_u32 m0, s40, 30720
    s_add_u32 s35, s41, 1320960
    buffer_load_dwordx4 v3, s[12:15], s35 offen nt lds
    s_add_u32 m0, s40, 31744
    s_add_u32 s35, s41, 1364992
    buffer_load_dwordx4 v3, s[12:15], s35 offen nt lds
    s_waitcnt vmcnt(28)
    ds_read_b64_tr_b16 a[32:33], v6 offset:0
    ds_read_b64_tr_b16 a[34:35], v6 offset:256
    ds_read_b64_tr_b16 a[36:37], v6 offset:2048
    ds_read_b64_tr_b16 a[38:39], v6 offset:2304
    ds_read_b64_tr_b16 a[96:97], v6 offset:8
    ds_read_b64_tr_b16 a[98:99], v6 offset:264
    ds_read_b64_tr_b16 a[100:101], v6 offset:2056
    ds_read_b64_tr_b16 a[102:103], v6 offset:2312
    s_waitcnt lgkmcnt(0)
    s_waitcnt vmcnt(24)
    ds_read_b64_tr_b16 a[160:161], v6 offset:4096
    ds_read_b64_tr_b16 a[162:163], v6 offset:4352
    ds_read_b64_tr_b16 a[164:165], v6 offset:6144
    ds_read_b64_tr_b16 a[166:167], v6 offset:6400
    ds_read_b64_tr_b16 a[224:225], v6 offset:4104
    ds_read_b64_tr_b16 a[226:227], v6 offset:4360
    ds_read_b64_tr_b16 a[228:229], v6 offset:6152
    ds_read_b64_tr_b16 a[230:231], v6 offset:6408
    s_waitcnt lgkmcnt(0)
    s_waitcnt vmcnt(20)
    ds_read_b64_tr_b16 a[40:41], v6 offset:8192
    ds_read_b64_tr_b16 a[42:43], v6 offset:8448
    ds_read_b64_tr_b16 a[44:45], v6 offset:10240
    ds_read_b64_tr_b16 a[46:47], v6 offset:10496
    ds_read_b64_tr_b16 a[104:105], v6 offset:8200
    ds_read_b64_tr_b16 a[106:107], v6 offset:8456
    ds_read_b64_tr_b16 a[108:109], v6 offset:10248
    ds_read_b64_tr_b16 a[110:111], v6 offset:10504
    s_waitcnt lgkmcnt(0)
    s_waitcnt vmcnt(16)
    ds_read_b64_tr_b16 a[168:169], v6 offset:12288
    ds_read_b64_tr_b16 a[170:171], v6 offset:12544
    ds_read_b64_tr_b16 a[172:173], v6 offset:14336
    ds_read_b64_tr_b16 a[174:175], v6 offset:14592
    ds_read_b64_tr_b16 a[232:233], v6 offset:12296
    ds_read_b64_tr_b16 a[234:235], v6 offset:12552
    ds_read_b64_tr_b16 a[236:237], v6 offset:14344
    ds_read_b64_tr_b16 a[238:239], v6 offset:14600
    s_waitcnt lgkmcnt(0)
    s_waitcnt vmcnt(12)
    ds_read_b64_tr_b16 a[48:49], v6 offset:16384
    ds_read_b64_tr_b16 a[50:51], v6 offset:16640
    ds_read_b64_tr_b16 a[52:53], v6 offset:18432
    ds_read_b64_tr_b16 a[54:55], v6 offset:18688
    ds_read_b64_tr_b16 a[112:113], v6 offset:16392
    ds_read_b64_tr_b16 a[114:115], v6 offset:16648
    ds_read_b64_tr_b16 a[116:117], v6 offset:18440
    ds_read_b64_tr_b16 a[118:119], v6 offset:18696
    s_waitcnt lgkmcnt(0)
    s_waitcnt vmcnt(8)
    ds_read_b64_tr_b16 a[176:177], v6 offset:20480
    ds_read_b64_tr_b16 a[178:179], v6 offset:20736
    ds_read_b64_tr_b16 a[180:181], v6 offset:22528
    ds_read_b64_tr_b16 a[182:183], v6 offset:22784
    ds_read_b64_tr_b16 a[240:241], v6 offset:20488
    ds_read_b64_tr_b16 a[242:243], v6 offset:20744
    ds_read_b64_tr_b16 a[244:245], v6 offset:22536
    ds_read_b64_tr_b16 a[246:247], v6 offset:22792
    s_waitcnt lgkmcnt(0)
    s_waitcnt vmcnt(4)
    ds_read_b64_tr_b16 a[56:57], v6 offset:24576
    ds_read_b64_tr_b16 a[58:59], v6 offset:24832
    ds_read_b64_tr_b16 a[60:61], v6 offset:26624
    ds_read_b64_tr_b16 a[62:63], v6 offset:26880
    ds_read_b64_tr_b16 a[120:121], v6 offset:24584
    ds_read_b64_tr_b16 a[122:123], v6 offset:24840
    ds_read_b64_tr_b16 a[124:125], v6 offset:26632
    ds_read_b64_tr_b16 a[126:127], v6 offset:26888
    s_waitcnt lgkmcnt(0)
    s_waitcnt vmcnt(0)
    ds_read_b64_tr_b16 a[184:185], v6 offset:28672
    ds_read_b64_tr_b16 a[186:187], v6 offset:28928
    ds_read_b64_tr_b16 a[188:189], v6 offset:30720
    ds_read_b64_tr_b16 a[190:191], v6 offset:30976
    ds_read_b64_tr_b16 a[248:249], v6 offset:28680
    ds_read_b64_tr_b16 a[250:251], v6 offset:28936
    ds_read_b64_tr_b16 a[252:253], v6 offset:30728
    ds_read_b64_tr_b16 a[254:255], v6 offset:30984
    s_waitcnt lgkmcnt(0)
    s_barrier
    v_lshlrev_b32 v9, 7, v250
    s_lshl_b32 s40, s25, 2
    s_add_u32 s40, s40, s21
    s_lshl_b32 s40, s40, 7
    s_add_u32 s40, s40, 94404608
    s_cmp_lg_u32 s64, 0
    s_cbranch_scc1 GS_51
WF_52:
    buffer_load_dwordx2 v[10:11], v252, s[4:7], s40 offen offset:0 sc1
    s_waitcnt vmcnt(0)
    v_cmp_ne_u64 vcc, s[38:39], v[10:11]
    s_cbranch_vccz WK_53
    s_sub_u32 s30, s30, 1
    s_cbranch_scc1 L_FAIL
    s_sleep 8
    s_branch WF_52
WK_53:
    s_lshl_b32 s44, s21, 14
    s_lshl_b32 s45, s25, 16
    s_add_u32 s45, s45, s44
    s_add_u32 m0, s44, 0
    s_add_u32 s35, s45, 0
    buffer_load_dwordx4 v251, s[4:7], s35 offen sc1 lds
    s_add_u32 m0, s44, 1024
    s_add_u32 s35, s45, 1024
    buffer_load_dwordx4 v251, s[4:7], s35 offen sc1 lds
    s_add_u32 m0, s44, 2048
    s_add_u32 s35, s45, 2048
    buffer_load_dwordx4 v251, s[4:7], s35 offen sc1 lds
    s_add_u32 m0, s44, 3072
    s_add_u32 s35, s45, 3072
    buffer_load_dwordx4 v251, s[4:7], s35 offen sc1 lds
    s_add_u32 m0, s44, 4096
    s_add_u32 s35, s45, 4096
    buffer_load_dwordx4 v251, s[4:7], s35 offen sc1 lds
    s_add_u32 m0, s44, 5120
    s_add_u32 s35, s45, 5120
    buffer_load_dwordx4 v251, s[4:7], s35 offen sc1 lds
    s_add_u32 m0, s44, 6144
    s_add_u32 s35, s45, 6144
    buffer_load_dwordx4 v251, s[4:7], s35 offen sc1 lds
    s_add_u32 m0, s44, 7168
    s_add_u32 s35, s45, 7168
    buffer_load_dwordx4 v251, s[4:7], s35 offen sc1 lds
    s_add_u32 m0, s44, 8192
    s_add_u32 s35, s45, 8192
    buffer_load_dwordx4 v251, s[4:7], s35 offen sc1 lds
    s_add_u32 m0, s44, 9216
    s_add_u32 s35, s45, 9216
    buffer_load_dwordx4 v251, s[4:7], s35 offen sc1 lds
    s_add_u32 m0, s44, 10240
    s_add_u32 s35, s45, 10240
    buffer_load_dwordx4 v251, s[4:7], s35 offen sc1 lds
    s_add_u32 m0, s44, 11264
    s_add_u32 s35, s45, 11264
    buffer_load_dwordx4 v251, s[4:7], s35 offen sc1 lds
    s_add_u32 m0, s44, 12288
    s_add_u32 s35, s45, 12288
    buffer_load_dwordx4 v251, s[4:7], s35 offen sc1 lds
    s_add_u32 m0, s44, 13312
    s_add_u32 s35, s45, 13312
    buffer_load_dwordx4 v251, s[4:7], s35 offen sc1 lds
    s_add_u32 m0, s44, 14336
    s_add_u32 s35, s45, 14336
    buffer_load_dwordx4 v251, s[4:7], s35 offen sc1 lds
    s_add_u32 m0, s44, 15360
    s_add_u32 s35, s45, 15360
    buffer_load_dwordx4 v251, s[4:7], s35 offen sc1 lds
    s_mov_b32 s64, 1
GS_51:
    s_mov_b32 s28, -1
    s_mov_b32 s43, -1
    v_mov_b32 v128, v251
    v_add_u32 v129, 0x10000, v251
    v_mov_b32 v130, 0x80000000
    s_mov_b32 s60, 0
    s_mov_b32 s61, 0
    s_mov_b32 s62, 0
    s_mov_b32 s63, 0
    s_lshl_b32 s40, s21, 13
    s_add_u32 s40, s40, 94404608
    s_cmp_ge_u32 s21, 2
    s_cbranch_scc1 GS_54
WF_55:
    buffer_load_dwordx2 v[10:11], v9, s[4:7], s40 offen offset:0 sc1
    s_waitcnt vmcnt(0)
    v_cmp_ne_u64 vcc, s[38:39], v[10:11]
    s_cbranch_vccz WK_56
    s_sub_u32 s30, s30, 1
    s_cbranch_scc1 L_FAIL
    s_sleep 8
    s_branch WF_55
WK_56:
GS_54:
GL_57:
    s_waitcnt vmcnt(0)
    s_barrier
    s_add_u32 s40, s25, s24
    s_min_u32 s41, s40, 31
    s_lshl_b32 s45, s41, 16
    s_add_u32 s45, s45, s44
    ds_read_b128 v[64:67], v128 offset:0
    ds_read_b128 v[68:71], v128 offset:16384
    ds_read_b128 v[72:75], v128 offset:32768
    ds_read_b128 v[76:79], v128 offset:49152
    s_cmp_lt_i32 s43, 0
    s_cbranch_scc1 GF_59
    buffer_store_dwordx2 v[254:255], v253, s[4:7], s43 offen sc1
GF_59:
    s_mov_b32 s43, s28
    s_waitcnt lgkmcnt(0)
    v_mfma_f32_16x16x32_bf16 v[0:3], a[0:3], v[64:67], 0
    ds_read_b128 v[80:83], v128 offset:1024
    v_mfma_f32_16x16x32_bf16 v[4:7], a[0:3], v[68:71], 0
    ds_read_b128 v[84:87], v128 offset:17408
    v_mfma_f32_16x16x32_bf16 v[8:11], a[0:3], v[72:75], 0
    ds_read_b128 v[88:91], v128 offset:33792
    v_mfma_f32_16x16x32_bf16 v[12:15], a[0:3], v[76:79], 0
    ds_read_b128 v[92:95], v128 offset:50176
    v_mfma_f32_16x16x32_bf16 v[16:19], a[64:67], v[64:67], 0
    v_mfma_f32_16x16x32_bf16 v[20:23], a[64:67], v[68:71], 0
    s_add_u32 m0, s44, 65536
    s_add_u32 s35, s45, 0
    buffer_load_dwordx4 v251, s[4:7], s35 offen sc1 lds
    v_mfma_f32_16x16x32_bf16 v[24:27], a[64:67], v[72:75], 0
    v_mfma_f32_16x16x32_bf16 v[28:31], a[64:67], v[76:79], 0
    v_mfma_f32_16x16x32_bf16 v[32:35], a[128:131], v[64:67], 0
    v_mfma_f32_16x16x32_bf16 v[36:39], a[128:131], v[68:71], 0
    buffer_store_dwordx4 v[96:99], v130, s[4:7], s60 offen offset:0 sc1
    v_mfma_f32_16x16x32_bf16 v[40:43], a[128:131], v[72:75], 0
    v_mfma_f32_16x16x32_bf16 v[44:47], a[128:131], v[76:79], 0
    v_mfma_f32_16x16x32_bf16 v[48:51], a[192:195], v[64:67], 0
    v_mfma_f32_16x16x32_bf16 v[52:55], a[192:195], v[68:71], 0
    s_add_u32 m0, s44, 66560
    s_add_u32 s35, s45, 1024
    buffer_load_dwordx4 v251, s[4:7], s35 offen sc1 lds
    v_mfma_f32_16x16x32_bf16 v[56:59], a[192:195], v[72:75], 0
    v_mfma_f32_16x16x32_bf16 v[60:63], a[192:195], v[76:79], 0
    s_waitcnt lgkmcnt(0)
    v_mfma_f32_16x16x32_bf16 v[0:3], a[4:7], v[80:83], v[0:3]
    ds_read_b128 v[64:67], v128 offset:2048
    v_mfma_f32_16x16x32_bf16 v[4:7], a[4:7], v[84:87], v[4:7]
    ds_read_b128 v[68:71], v128 offset:18432
    v_mfma_f32_16x16x32_bf16 v[8:11], a[4:7], v[88:91], v[8:11]
    ds_read_b128 v[72:75], v128 offset:34816
    v_mfma_f32_16x16x32_bf16 v[12:15], a[4:7], v[92:95], v[12:15]
    ds_read_b128 v[76:79], v128 offset:51200
    v_mfma_f32_16x16x32_bf16 v[16:19], a[68:71], v[80:83], v[16:19]
    v_mfma_f32_16x16x32_bf16 v[20:23], a[68:71], v[84:87], v[20:23]
    s_add_u32 m0, s44, 67584
    s_add_u32 s35, s45, 2048
    buffer_load_dwordx4 v251, s[4:7], s35 offen sc1 lds
    v_mfma_f32_16x16x32_bf16 v[24:27], a[68:71], v[88:91], v[24:27]
    v_mfma_f32_16x16x32_bf16 v[28:31], a[68:71], v[92:95], v[28:31]
    v_mfma_f32_16x16x32_bf16 v[32:35], a[132:135], v[80:83], v[32:35]
    v_mfma_f32_16x16x32_bf16 v[36:39], a[132:135], v[84:87], v[36:39]
    buffer_store_dwordx4 v[100:103], v130, s[4:7], s61 offen offset:0 sc1
    v_mfma_f32_16x16x32_bf16 v[40:43], a[132:135], v[88:91], v[40:43]
    v_mfma_f32_16x16x32_bf16 v[44:47], a[132:135], v[92:95], v[44:47]
    v_mfma_f32_16x16x32_bf16 v[48:51], a[196:199], v[80:83], v[48:51]
    v_mfma_f32_16x16x32_bf16 v[52:55], a[196:199], v[84:87], v[52:55]
    s_add_u32 m0, s44, 68608
    s_add_u32 s35, s45, 3072
    buffer_load_dwordx4 v251, s[4:7], s35 offen sc1 lds
    v_mfma_f32_16x16x32_bf16 v[56:59], a[196:199], v[88:91], v[56:59]
    v_mfma_f32_16x16x32_bf16 v[60:63], a[196:199], v[92:95], v[60:63]
    s_waitcnt lgkmcnt(0)
    v_mfma_f32_16x16x32_bf16 v[0:3], a[8:11], v[64:67], v[0:3]
    ds_read_b128 v[80:83], v128 offset:3072
    v_mfma_f32_16x16x32_bf16 v[4:7], a[8:11], v[68:71], v[4:7]
    ds_read_b128 v[84:87], v128 offset:19456
    v_mfma_f32_16x16x32_bf16 v[8:11], a[8:11], v[72:75], v[8:11]
    ds_read_b128 v[88:91], v128 offset:35840
    v_mfma_f32_16x16x32_bf16 v[12:15], a[8:11], v[76:79], v[12:15]
    ds_read_b128 v[92:95], v128 offset:52224
    v_mfma_f32_16x16x32_bf16 v[16:19], a[72:75], v[64:67], v[16:19]
    v_mfma_f32_16x16x32_bf16 v[20:23], a[72:75], v[68:71], v[20:23]
    s_add_u32 m0, s44, 69632
    s_add_u32 s35, s45, 4096
    buffer_load_dwordx4 v251, s[4:7], s35 offen sc1 lds
    v_mfma_f32_16x16x32_bf16 v[24:27], a[72:75], v[72:75], v[24:27]
    v_mfma_f32_16x16x32_bf16 v[28:31], a[72:75], v[76:79], v[28:31]
    v_mfma_f32_16x16x32_bf16 v[32:35], a[136:139], v[64:67], v[32:35]
    v_mfma_f32_16x16x32_bf16 v[36:39], a[136:139], v[68:71], v[36:39]
    buffer_store_dwordx4 v[104:107], v130, s[4:7], s62 offen offset:0 sc1
    v_mfma_f32_16x16x32_bf16 v[40:43], a[136:139], v[72:75], v[40:43]
    v_mfma_f32_16x16x32_bf16 v[44:47], a[136:139], v[76:79], v[44:47]
    v_mfma_f32_16x16x32_bf16 v[48:51], a[200:203], v[64:67], v[48:51]
    v_mfma_f32_16x16x32_bf16 v[52:55], a[200:203], v[68:71], v[52:55]
    s_add_u32 m0, s44, 70656
    s_add_u32 s35, s45, 5120
    buffer_load_dwordx4 v251, s[4:7], s35 offen sc1 lds
    v_mfma_f32_16x16x32_bf16 v[56:59], a[200:203], v[72:75], v[56:59]
    v_mfma_f32_16x16x32_bf16 v[60:63], a[200:203], v[76:79], v[60:63]
    s_waitcnt lgkmcnt(0)
    v_mfma_f32_16x16x32_bf16 v[0:3], a[12:15], v[80:83], v[0:3]
    ds_read_b128 v[64:67], v128 offset:4096
    v_mfma_f32_16x16x32_bf16 v[4:7], a[12:15], v[84:87], v[4:7]
    ds_read_b128 v[68:71], v128 offset:20480
    v_mfma_f32_16x16x32_bf16 v[8:11], a[12:15], v[88:91], v[8:11]
    ds_read_b128 v[72:75], v128 offset:36864
    v_mfma_f32_16x16x32_bf16 v[12:15], a[12:15], v[92:95], v[12:15]
    ds_read_b128 v[76:79], v128 offset:53248
    v_mfma_f32_16x16x32_bf16 v[16:19], a[76:79], v[80:83], v[16:19]
    v_mfma_f32_16x16x32_bf16 v[20:23], a[76:79], v[84:87], v[20:23]
    s_add_u32 m0, s44, 71680
    s_add_u32 s35, s45, 6144
    buffer_load_dwordx4 v251, s[4:7], s35 offen sc1 lds
    v_mfma_f32_16x16x32_bf16 v[24:27], a[76:79], v[88:91], v[24:27]
    v_mfma_f32_16x16x32_bf16 v[28:31], a[76:79], v[92:95], v[28:31]
    v_mfma_f32_16x16x32_bf16 v[32:35], a[140:143], v[80:83], v[32:35]
    v_mfma_f32_16x16x32_bf16 v[36:39], a[140:143], v[84:87], v[36:39]
    buffer_store_dwordx4 v[108:111], v130, s[4:7], s63 offen offset:0 sc1
    v_mfma_f32_16x16x32_bf16 v[40:43], a[140:143], v[88:91], v[40:43]
    v_mfma_f32_16x16x32_bf16 v[44:47], a[140:143], v[92:95], v[44:47]
    v_mfma_f32_16x16x32_bf16 v[48:51], a[204:207], v[80:83], v[48:51]
    v_mfma_f32_16x16x32_bf16 v[52:55], a[204:207], v[84:87], v[52:55]
    s_add_u32 m0, s44, 72704
    s_add_u32 s35, s45, 7168
    buffer_load_dwordx4 v251, s[4:7], s35 offen sc1 lds
    v_mfma_f32_16x16x32_bf16 v[56:59], a[204:207], v[88:91], v[56:59]
    v_mfma_f32_16x16x32_bf16 v[60:63], a[204:207], v[92:95], v[60:63]
    s_waitcnt lgkmcnt(0)
    v_mfma_f32_16x16x32_bf16 v[0:3], a[16:19], v[64:67], v[0:3]
    ds_read_b128 v[80:83], v128 offset:5120
    v_mfma_f32_16x16x32_bf16 v[4:7], a[16:19], v[68:71], v[4:7]
    ds_read_b128 v[84:87], v128 offset:21504
    v_mfma_f32_16x16x32_bf16 v[8:11], a[16:19], v[72:75], v[8:11]
    ds_read_b128 v[88:91], v128 offset:37888
    v_mfma_f32_16x16x32_bf16 v[12:15], a[16:19], v[76:79], v[12:15]
    ds_read_b128 v[92:95], v128 offset:54272
    v_mfma_f32_16x16x32_bf16 v[16:19], a[80:83], v[64:67], v[16:19]
    v_mfma_f32_16x16x32_bf16 v[20:23], a[80:83], v[68:71], v[20:23]
    s_add_u32 m0, s44, 73728
    s_add_u32 s35, s45, 8192
    buffer_load_dwordx4 v251, s[4:7], s35 offen sc1 lds
    v_mfma_f32_16x16x32_bf16 v[24:27], a[80:83], v[72:75], v[24:27]
    v_mfma_f32_16x16x32_bf16 v[28:31], a[80:83], v[76:79], v[28:31]
    v_mfma_f32_16x16x32_bf16 v[32:35], a[144:147], v[64:67], v[32:35]
    v_mfma_f32_16x16x32_bf16 v[36:39], a[144:147], v[68:71], v[36:39]
    v_mfma_f32_16x16x32_bf16 v[40:43], a[144:147], v[72:75], v[40:43]
    v_mfma_f32_16x16x32_bf16 v[44:47], a[144:147], v[76:79], v[44:47]
    v_mfma_f32_16x16x32_bf16 v[48:51], a[208:211], v[64:67], v[48:51]
    v_mfma_f32_16x16x32_bf16 v[52:55], a[208:211], v[68:71], v[52:55]
    s_add_u32 m0, s44, 74752
    s_add_u32 s35, s45, 9216
    buffer_load_dwordx4 v251, s[4:7], s35 offen sc1 lds
    v_mfma_f32_16x16x32_bf16 v[56:59], a[208:211], v[72:75], v[56:59]
    v_mfma_f32_16x16x32_bf16 v[60:63], a[208:211], v[76:79], v[60:63]
    s_waitcnt lgkmcnt(0)
    v_mfma_f32_16x16x32_bf16 v[0:3], a[20:23], v[80:83], v[0:3]
    ds_read_b128 v[64:67], v128 offset:6144
    v_mfma_f32_16x16x32_bf16 v[4:7], a[20:23], v[84:87], v[4:7]
    ds_read_b128 v[68:71], v128 offset:22528
    v_mfma_f32_16x16x32_bf16 v[8:11], a[20:23], v[88:91], v[8:11]
    ds_read_b128 v[72:75], v128 offset:38912
    v_mfma_f32_16x16x32_bf16 v[12:15], a[20:23], v[92:95], v[12:15]
    ds_read_b128 v[76:79], v128 offset:55296
    v_mfma_f32_16x16x32_bf16 v[16:19], a[84:87], v[80:83], v[16:19]
    v_mfma_f32_16x16x32_bf16 v[20:23], a[84:87], v[84:87], v[20:23]
    s_add_u32 m0, s44, 75776
    s_add_u32 s35, s45, 10240
    buffer_load_dwordx4 v251, s[4:7], s35 offen sc1 lds
    v_mfma_f32_16x16x32_bf16 v[24:27], a[84:87], v[88:91], v[24:27]
    v_mfma_f32_16x16x32_bf16 v[28:31], a[84:87], v[92:95], v[28:31]
    v_mfma_f32_16x16x32_bf16 v[32:35], a[148:151], v[80:83], v[32:35]
    v_mfma_f32_16x16x32_bf16 v[36:39], a[148:151], v[84:87], v[36:39]
    v_mfma_f32_16x16x32_bf16 v[40:43], a[148:151], v[88:91], v[40:43]
    v_mfma_f32_16x16x32_bf16 v[44:47], a[148:151], v[92:95], v[44:47]
    v_mfma_f32_16x16x32_bf16 v[48:51], a[212:215], v[80:83], v[48:51]
    v_mfma_f32_16x16x32_bf16 v[52:55], a[212:215], v[84:87], v[52:55]
    s_add_u32 m0, s44, 76800
    s_add_u32 s35, s45, 11264
    buffer_load_dwordx4 v251, s[4:7], s35 offen sc1 lds
    v_mfma_f32_16x16x32_bf16 v[56:59], a[212:215], v[88:91], v[56:59]
    v_mfma_f32_16x16x32_bf16 v[60:63], a[212:215], v[92:95], v[60:63]
    s_waitcnt lgkmcnt(0)
    v_mfma_f32_16x16x32_bf16 v[0:3], a[24:27], v[64:67], v[0:3]
    ds_read_b128 v[80:83], v128 offset:7168
    v_mfma_f32_16x16x32_bf16 v[4:7], a[24:27], v[68:71], v[4:7]
    ds_read_b128 v[84:87], v128 offset:23552
    v_mfma_f32_16x16x32_bf16 v[8:11], a[24:27], v[72:75], v[8:11]
    ds_read_b128 v[88:91], v128 offset:39936
    v_mfma_f32_16x16x32_bf16 v[12:15], a[24:27], v[76:79], v[12:15]
    ds_read_b128 v[92:95], v128 offset:56320
    v_mfma_f32_16x16x32_bf16 v[16:19], a[88:91], v[64:67], v[16:19]
    v_mfma_f32_16x16x32_bf16 v[20:23], a[88:91], v[68:71], v[20:23]
    s_add_u32 m0, s44, 77824
    s_add_u32 s35, s45, 12288
    buffer_load_dwordx4 v251, s[4:7], s35 offen sc1 lds
    v_mfma_f32_16x16x32_bf16 v[24:27], a[88:91], v[72:75], v[24:27]
    v_mfma_f32_16x16x32_bf16 v[28:31], a[88:91], v[76:79], v[28:31]
    v_mfma_f32_16x16x32_bf16 v[32:35], a[152:155], v[64:67], v[32:35]
    v_mfma_f32_16x16x32_bf16 v[36:39], a[152:155], v[68:71], v[36:39]
    v_mfma_f32_16x16x32_bf16 v[40:43], a[152:155], v[72:75], v[40:43]
    v_mfma_f32_16x16x32_bf16 v[44:47], a[152:155], v[76:79], v[44:47]
    v_mfma_f32_16x16x32_bf16 v[48:51], a[216:219], v[64:67], v[48:51]
    v_mfma_f32_16x16x32_bf16 v[52:55], a[216:219], v[68:71], v[52:55]
    v_mfma_f32_16x16x32_bf16 v[56:59], a[216:219], v[72:75], v[56:59]
    v_mfma_f32_16x16x32_bf16 v[60:63], a[216:219], v[76:79], v[60:63]
    s_waitcnt lgkmcnt(0)
    v_mfma_f32_16x16x32_bf16 v[0:3], a[28:31], v[80:83], v[0:3]
    ds_read_b128 v[64:67], v128 offset:8192
    v_mfma_f32_16x16x32_bf16 v[4:7], a[28:31], v[84:87], v[4:7]
    ds_read_b128 v[68:71], v128 offset:24576
    v_mfma_f32_16x16x32_bf16 v[8:11], a[28:31], v[88:91], v[8:11]
    ds_read_b128 v[72:75], v128 offset:40960
    v_mfma_f32_16x16x32_bf16 v[12:15], a[28:31], v[92:95], v[12:15]
    ds_read_b128 v[76:79], v128 offset:57344
    v_mfma_f32_16x16x32_bf16 v[16:19], a[92:95], v[80:83], v[16:19]
    v_mfma_f32_16x16x32_bf16 v[20:23], a[92:95], v[84:87], v[20:23]
    s_add_u32 m0, s44, 78848
    s_add_u32 s35, s45, 13312
    buffer_load_dwordx4 v251, s[4:7], s35 offen sc1 lds
    v_mfma_f32_16x16x32_bf16 v[24:27], a[92:95], v[88:91], v[24:27]
    v_mfma_f32_16x16x32_bf16 v[28:31], a[92:95], v[92:95], v[28:31]
    v_mfma_f32_16x16x32_bf16 v[32:35], a[156:159], v[80:83], v[32:35]
    v_mfma_f32_16x16x32_bf16 v[36:39], a[156:159], v[84:87], v[36:39]
    v_mfma_f32_16x16x32_bf16 v[40:43], a[156:159], v[88:91], v[40:43]
    v_mfma_f32_16x16x32_bf16 v[44:47], a[156:159], v[92:95], v[44:47]
    v_mfma_f32_16x16x32_bf16 v[48:51], a[220:223], v[80:83], v[48:51]
    v_mfma_f32_16x16x32_bf16 v[52:55], a[220:223], v[84:87], v[52:55]
    v_mfma_f32_16x16x32_bf16 v[56:59], a[220:223], v[88:91], v[56:59]
    v_mfma_f32_16x16x32_bf16 v[60:63], a[220:223], v[92:95], v[60:63]
    s_waitcnt lgkmcnt(0)
    v_mfma_f32_16x16x32_bf16 v[0:3], a[32:35], v[64:67], v[0:3]
    ds_read_b128 v[80:83], v128 offset:9216
    v_mfma_f32_16x16x32_bf16 v[4:7], a[32:35], v[68:71], v[4:7]
    ds_read_b128 v[84:87], v128 offset:25600
    v_mfma_f32_16x16x32_bf16 v[8:11], a[32:35], v[72:75], v[8:11]
    ds_read_b128 v[88:91], v128 offset:41984
    v_mfma_f32_16x16x32_bf16 v[12:15], a[32:35], v[76:79], v[12:15]
    ds_read_b128 v[92:95], v128 offset:58368
    v_mfma_f32_16x16x32_bf16 v[16:19], a[96:99], v[64:67], v[16:19]
    v_mfma_f32_16x16x32_bf16 v[20:23], a[96:99], v[68:71], v[20:23]
    s_add_u32 m0, s44, 79872
    s_add_u32 s35, s45, 14336
    buffer_load_dwordx4 v251, s[4:7], s35 offen sc1 lds
    v_mfma_f32_16x16x32_bf16 v[24:27], a[96:99], v[72:75], v[24:27]
    v_mfma_f32_16x16x32_bf16 v[28:31], a[96:99], v[76:79], v[28:31]
    v_mfma_f32_16x16x32_bf16 v[32:35], a[160:163], v[64:67], v[32:35]
    v_mfma_f32_16x16x32_bf16 v[36:39], a[160:163], v[68:71], v[36:39]
    v_mfma_f32_16x16x32_bf16 v[40:43], a[160:163], v[72:75], v[40:43]
    v_mfma_f32_16x16x32_bf16 v[44:47], a[160:163], v[76:79], v[44:47]
    v_mfma_f32_16x16x32_bf16 v[48:51], a[224:227], v[64:67], v[48:51]
    v_mfma_f32_16x16x32_bf16 v[52:55], a[224:227], v[68:71], v[52:55]
    v_mfma_f32_16x16x32_bf16 v[56:59], a[224:227], v[72:75], v[56:59]
    v_mfma_f32_16x16x32_bf16 v[60:63], a[224:227], v[76:79], v[60:63]
    s_waitcnt lgkmcnt(0)
    v_mfma_f32_16x16x32_bf16 v[0:3], a[36:39], v[80:83], v[0:3]
    ds_read_b128 v[64:67], v128 offset:10240
    v_mfma_f32_16x16x32_bf16 v[4:7], a[36:39], v[84:87], v[4:7]
    ds_read_b128 v[68:71], v128 offset:26624
    v_mfma_f32_16x16x32_bf16 v[8:11], a[36:39], v[88:91], v[8:11]
    ds_read_b128 v[72:75], v128 offset:43008
    v_mfma_f32_16x16x32_bf16 v[12:15], a[36:39], v[92:95], v[12:15]
    ds_read_b128 v[76:79], v128 offset:59392
    v_mfma_f32_16x16x32_bf16 v[16:19], a[100:103], v[80:83], v[16:19]
    v_mfma_f32_16x16x32_bf16 v[20:23], a[100:103], v[84:87], v[20:23]
    s_add_u32 m0, s44, 80896
    s_add_u32 s35, s45, 15360
    buffer_load_dwordx4 v251, s[4:7], s35 offen sc1 lds
    v_mfma_f32_16x16x32_bf16 v[24:27], a[100:103], v[88:91], v[24:27]
    v_mfma_f32_16x16x32_bf16 v[28:31], a[100:103], v[92:95], v[28:31]
    v_mfma_f32_16x16x32_bf16 v[32:35], a[164:167], v[80:83], v[32:35]
    v_mfma_f32_16x16x32_bf16 v[36:39], a[164:167], v[84:87], v[36:39]
    v_mfma_f32_16x16x32_bf16 v[40:43], a[164:167], v[88:91], v[40:43]
    v_mfma_f32_16x16x32_bf16 v[44:47], a[164:167], v[92:95], v[44:47]
    v_mfma_f32_16x16x32_bf16 v[48:51], a[228:231], v[80:83], v[48:51]
    v_mfma_f32_16x16x32_bf16 v[52:55], a[228:231], v[84:87], v[52:55]
    v_mfma_f32_16x16x32_bf16 v[56:59], a[228:231], v[88:91], v[56:59]
    v_mfma_f32_16x16x32_bf16 v[60:63], a[228:231], v[92:95], v[60:63]
    s_waitcnt lgkmcnt(0)
    v_mfma_f32_16x16x32_bf16 v[0:3], a[40:43], v[64:67], v[0:3]
    ds_read_b128 v[80:83], v128 offset:11264
    v_mfma_f32_16x16x32_bf16 v[4:7], a[40:43], v[68:71], v[4:7]
    ds_read_b128 v[84:87], v128 offset:27648
    v_mfma_f32_16x16x32_bf16 v[8:11], a[40:43], v[72:75], v[8:11]
    ds_read_b128 v[88:91], v128 offset:44032
    v_mfma_f32_16x16x32_bf16 v[12:15], a[40:43], v[76:79], v[12:15]
    ds_read_b128 v[92:95], v128 offset:60416
    v_mfma_f32_16x16x32_bf16 v[16:19], a[104:107], v[64:67], v[16:19]
    v_mfma_f32_16x16x32_bf16 v[20:23], a[104:107], v[68:71], v[20:23]
    v_mfma_f32_16x16x32_bf16 v[24:27], a[104:107], v[72:75], v[24:27]
    v_mfma_f32_16x16x32_bf16 v[28:31], a[104:107], v[76:79], v[28:31]
    v_mfma_f32_16x16x32_bf16 v[32:35], a[168:171], v[64:67], v[32:35]
    v_mfma_f32_16x16x32_bf16 v[36:39], a[168:171], v[68:71], v[36:39]
    v_mfma_f32_16x16x32_bf16 v[40:43], a[168:171], v[72:75], v[40:43]
    v_mfma_f32_16x16x32_bf16 v[44:47], a[168:171], v[76:79], v[44:47]
    v_mfma_f32_16x16x32_bf16 v[48:51], a[232:235], v[64:67], v[48:51]
    v_mfma_f32_16x16x32_bf16 v[52:55], a[232:235], v[68:71], v[52:55]
    v_mfma_f32_16x16x32_bf16 v[56:59], a[232:235], v[72:75], v[56:59]
    v_mfma_f32_16x16x32_bf16 v[60:63], a[232:235], v[76:79], v[60:63]
    s_waitcnt lgkmcnt(0)
    v_mfma_f32_16x16x32_bf16 v[0:3], a[44:47], v[80:83], v[0:3]
    ds_read_b128 v[64:67], v128 offset:12288
    v_mfma_f32_16x16x32_bf16 v[4:7], a[44:47], v[84:87], v[4:7]
    ds_read_b128 v[68:71], v128 offset:28672
    v_mfma_f32_16x16x32_bf16 v[8:11], a[44:47], v[88:91], v[8:11]
    ds_read_b128 v[72:75], v128 offset:45056
    v_mfma_f32_16x16x32_bf16 v[12:15], a[44:47], v[92:95], v[12:15]
    ds_read_b128 v[76:79], v128 offset:61440
    v_mfma_f32_16x16x32_bf16 v[16:19], a[108:111], v[80:83], v[16:19]
    v_mfma_f32_16x16x32_bf16 v[20:23], a[108:111], v[84:87], v[20:23]
    v_mfma_f32_16x16x32_bf16 v[24:27], a[108:111], v[88:91], v[24:27]
    v_mfma_f32_16x16x32_bf16 v[28:31], a[108:111], v[92:95], v[28:31]
    v_mfma_f32_16x16x32_bf16 v[32:35], a[172:175], v[80:83], v[32:35]
    v_mfma_f32_16x16x32_bf16 v[36:39], a[172:175], v[84:87], v[36:39]
    v_mfma_f32_16x16x32_bf16 v[40:43], a[172:175], v[88:91], v[40:43]
    v_mfma_f32_16x16x32_bf16 v[44:47], a[172:175], v[92:95], v[44:47]
    v_mfma_f32_16x16x32_bf16 v[48:51], a[236:239], v[80:83], v[48:51]
    v_mfma_f32_16x16x32_bf16 v[52:55], a[236:239], v[84:87], v[52:55]
    v_mfma_f32_16x16x32_bf16 v[56:59], a[236:239], v[88:91], v[56:59]
    v_mfma_f32_16x16x32_bf16 v[60:63], a[236:239], v[92:95], v[60:63]
    s_waitcnt lgkmcnt(0)
    v_mfma_f32_16x16x32_bf16 v[0:3], a[48:51], v[64:67], v[0:3]
    ds_read_b128 v[80:83], v128 offset:13312
    v_mfma_f32_16x16x32_bf16 v[4:7], a[48:51], v[68:71], v[4:7]
    ds_read_b128 v[84:87], v128 offset:29696
    v_mfma_f32_16x16x32_bf16 v[8:11], a[48:51], v[72:75], v[8:11]
    ds_read_b128 v[88:91], v128 offset:46080
    v_mfma_f32_16x16x32_bf16 v[12:15], a[48:51], v[76:79], v[12:15]
    ds_read_b128 v[92:95], v128 offset:62464
    v_mfma_f32_16x16x32_bf16 v[16:19], a[112:115], v[64:67], v[16:19]
    v_mfma_f32_16x16x32_bf16 v[20:23], a[112:115], v[68:71], v[20:23]
    v_mfma_f32_16x16x32_bf16 v[24:27], a[112:115], v[72:75], v[24:27]
    v_mfma_f32_16x16x32_bf16 v[28:31], a[112:115], v[76:79], v[28:31]
    v_mfma_f32_16x16x32_bf16 v[32:35], a[176:179], v[64:67], v[32:35]
    v_mfma_f32_16x16x32_bf16 v[36:39], a[176:179], v[68:71], v[36:39]
    v_mfma_f32_16x16x32_bf16 v[40:43], a[176:179], v[72:75], v[40:43]
    v_mfma_f32_16x16x32_bf16 v[44:47], a[176:179], v[76:79], v[44:47]
    v_mfma_f32_16x16x32_bf16 v[48:51], a[240:243], v[64:67], v[48:51]
    v_mfma_f32_16x16x32_bf16 v[52:55], a[240:243], v[68:71], v[52:55]
    v_mfma_f32_16x16x32_bf16 v[56:59], a[240:243], v[72:75], v[56:59]
    v_mfma_f32_16x16x32_bf16 v[60:63], a[240:243], v[76:79], v[60:63]
    s_waitcnt lgkmcnt(0)
    v_mfma_f32_16x16x32_bf16 v[0:3], a[52:55], v[80:83], v[0:3]
    ds_read_b128 v[64:67], v128 offset:14336
    v_mfma_f32_16x16x32_bf16 v[4:7], a[52:55], v[84:87], v[4:7]
    ds_read_b128 v[68:71], v128 offset:30720
    v_mfma_f32_16x16x32_bf16 v[8:11], a[52:55], v[88:91], v[8:11]
    ds_read_b128 v[72:75], v128 offset:47104
    v_mfma_f32_16x16x32_bf16 v[12:15], a[52:55], v[92:95], v[12:15]
    ds_read_b128 v[76:79], v128 offset:63488
    v_mfma_f32_16x16x32_bf16 v[16:19], a[116:119], v[80:83], v[16:19]
    v_mfma_f32_16x16x32_bf16 v[20:23], a[116:119], v[84:87], v[20:23]
    v_mfma_f32_16x16x32_bf16 v[24:27], a[116:119], v[88:91], v[24:27]
    v_mfma_f32_16x16x32_bf16 v[28:31], a[116:119], v[92:95], v[28:31]
    v_mfma_f32_16x16x32_bf16 v[32:35], a[180:183], v[80:83], v[32:35]
    v_mfma_f32_16x16x32_bf16 v[36:39], a[180:183], v[84:87], v[36:39]
    v_mfma_f32_16x16x32_bf16 v[40:43], a[180:183], v[88:91], v[40:43]
    v_mfma_f32_16x16x32_bf16 v[44:47], a[180:183], v[92:95], v[44:47]
    v_mfma_f32_16x16x32_bf16 v[48:51], a[244:247], v[80:83], v[48:51]
    v_mfma_f32_16x16x32_bf16 v[52:55], a[244:247], v[84:87], v[52:55]
    v_mfma_f32_16x16x32_bf16 v[56:59], a[244:247], v[88:91], v[56:59]
    v_mfma_f32_16x16x32_bf16 v[60:63], a[244:247], v[92:95], v[60:63]
    s_waitcnt lgkmcnt(0)
    v_mfma_f32_16x16x32_bf16 v[0:3], a[56:59], v[64:67], v[0:3]
    ds_read_b128 v[80:83], v128 offset:15360
    v_mfma_f32_16x16x32_bf16 v[4:7], a[56:59], v[68:71], v[4:7]
    ds_read_b128 v[84:87], v128 offset:31744
    v_mfma_f32_16x16x32_bf16 v[8:11], a[56:59], v[72:75], v[8:11]
    ds_read_b128 v[88:91], v128 offset:48128
    v_mfma_f32_16x16x32_bf16 v[12:15], a[56:59], v[76:79], v[12:15]
    ds_read_b128 v[92:95], v128 offset:64512
    v_mfma_f32_16x16x32_bf16 v[16:19], a[120:123], v[64:67], v[16:19]
    v_mfma_f32_16x16x32_bf16 v[20:23], a[120:123], v[68:71], v[20:23]
    v_mfma_f32_16x16x32_bf16 v[24:27], a[120:123], v[72:75], v[24:27]
    v_mfma_f32_16x16x32_bf16 v[28:31], a[120:123], v[76:79], v[28:31]
    v_mfma_f32_16x16x32_bf16 v[32:35], a[184:187], v[64:67], v[32:35]
    v_mfma_f32_16x16x32_bf16 v[36:39], a[184:187], v[68:71], v[36:39]
    v_mfma_f32_16x16x32_bf16 v[40:43], a[184:187], v[72:75], v[40:43]
    v_mfma_f32_16x16x32_bf16 v[44:47], a[184:187], v[76:79], v[44:47]
    v_mfma_f32_16x16x32_bf16 v[48:51], a[248:251], v[64:67], v[48:51]
    v_mfma_f32_16x16x32_bf16 v[52:55], a[248:251], v[68:71], v[52:55]
    v_mfma_f32_16x16x32_bf16 v[56:59], a[248:251], v[72:75], v[56:59]
    v_mfma_f32_16x16x32_bf16 v[60:63], a[248:251], v[76:79], v[60:63]
    s_waitcnt lgkmcnt(0)
    v_mfma_f32_16x16x32_bf16 v[0:3], a[60:63], v[80:83], v[0:3]
    v_mfma_f32_16x16x32_bf16 v[4:7], a[60:63], v[84:87], v[4:7]
    v_mfma_f32_16x16x32_bf16 v[8:11], a[60:63], v[88:91], v[8:11]
    v_mfma_f32_16x16x32_bf16 v[12:15], a[60:63], v[92:95], v[12:15]
    v_mfma_f32_16x16x32_bf16 v[16:19], a[124:127], v[80:83], v[16:19]
    v_mfma_f32_16x16x32_bf16 v[20:23], a[124:127], v[84:87], v[20:23]
    v_mfma_f32_16x16x32_bf16 v[24:27], a[124:127], v[88:91], v[24:27]
    v_mfma_f32_16x16x32_bf16 v[28:31], a[124:127], v[92:95], v[28:31]
    v_mfma_f32_16x16x32_bf16 v[32:35], a[188:191], v[80:83], v[32:35]
    v_mfma_f32_16x16x32_bf16 v[36:39], a[188:191], v[84:87], v[36:39]
    v_mfma_f32_16x16x32_bf16 v[40:43], a[188:191], v[88:91], v[40:43]
    v_mfma_f32_16x16x32_bf16 v[44:47], a[188:191], v[92:95], v[44:47]
    v_mfma_f32_16x16x32_bf16 v[48:51], a[252:255], v[80:83], v[48:51]
    v_mfma_f32_16x16x32_bf16 v[52:55], a[252:255], v[84:87], v[52:55]
    v_mfma_f32_16x16x32_bf16 v[56:59], a[252:255], v[88:91], v[56:59]
    v_mfma_f32_16x16x32_bf16 v[60:63], a[252:255], v[92:95], v[60:63]
    s_nop 7
    s_mul_i32 s41, s25, 180224
    s_add_u32 s41, s41, s26
    v_mov_b32 v130, v251
    s_add_u32 s60, s41, 0
    v_cvt_pk_bf16_f32 v1, v0, v1
    v_lshlrev_b32 v0, 16, v1
    v_and_b32 v1, 0xffff0000, v1
    v_cvt_pk_bf16_f32 v33, v32, v33
    v_lshlrev_b32 v32, 16, v33
    v_and_b32 v33, 0xffff0000, v33
    v_cvt_pk_bf16_f32 v3, v2, v3
    v_lshlrev_b32 v2, 16, v3
    v_and_b32 v3, 0xffff0000, v3
    v_cvt_pk_bf16_f32 v35, v34, v35
    v_lshlrev_b32 v34, 16, v35
    v_and_b32 v35, 0xffff0000, v35
    v_cmp_lt_f32 vcc, 0, v0
    v_mul_f32 v127, 0, v0
    s_nop 0
    v_cndmask_b32 v0, v127, v0, vcc
    v_mul_f32 v0, v0, v32
    v_cmp_lt_f32 vcc, 0, v1
    v_mul_f32 v127, 0, v1
    s_nop 0
    v_cndmask_b32 v1, v127, v1, vcc
    v_mul_f32 v1, v1, v33
    v_cmp_lt_f32 vcc, 0, v2
    v_mul_f32 v127, 0, v2
    s_nop 0
    v_cndmask_b32 v2, v127, v2, vcc
    v_mul_f32 v2, v2, v34
    v_cmp_lt_f32 vcc, 0, v3
    v_mul_f32 v127, 0, v3
    s_nop 0
    v_cndmask_b32 v3, v127, v3, vcc
    v_mul_f32 v3, v3, v35
    v_cvt_pk_bf16_f32 v17, v16, v17
    v_lshlrev_b32 v16, 16, v17
    v_and_b32 v17, 0xffff0000, v17
    v_cvt_pk_bf16_f32 v49, v48, v49
    v_lshlrev_b32 v48, 16, v49
    v_and_b32 v49, 0xffff0000, v49
    v_cvt_pk_bf16_f32 v19, v18, v19
    v_lshlrev_b32 v18, 16, v19
    v_and_b32 v19, 0xffff0000, v19
    v_cvt_pk_bf16_f32 v51, v50, v51
    v_lshlrev_b32 v50, 16, v51
    v_and_b32 v51, 0xffff0000, v51
    v_cmp_lt_f32 vcc, 0, v16
    v_mul_f32 v127, 0, v16
    s_nop 0
    v_cndmask_b32 v16, v127, v16, vcc
    v_mul_f32 v16, v16, v48
    v_cmp_lt_f32 vcc, 0, v17
    v_mul_f32 v127, 0, v17
    s_nop 0
    v_cndmask_b32 v17, v127, v17, vcc
    v_mul_f32 v17, v17, v49
    v_cmp_lt_f32 vcc, 0, v18
    v_mul_f32 v127, 0, v18
    s_nop 0
    v_cndmask_b32 v18, v127, v18, vcc
    v_mul_f32 v18, v18, v50
    v_cmp_lt_f32 vcc, 0, v19
    v_mul_f32 v127, 0, v19
    s_nop 0
    v_cndmask_b32 v19, v127, v19, vcc
    v_mul_f32 v19, v19, v51
    v_cvt_pk_bf16_f32 v96, v0, v1
    v_cvt_pk_bf16_f32 v97, v2, v3
    v_cvt_pk_bf16_f32 v98, v16, v17
    v_cvt_pk_bf16_f32 v99, v18, v19
    s_add_u32 s61, s41, 45056
    v_cvt_pk_bf16_f32 v5, v4, v5
    v_lshlrev_b32 v4, 16, v5
    v_and_b32 v5, 0xffff0000, v5
    v_cvt_pk_bf16_f32 v37, v36, v37
    v_lshlrev_b32 v36, 16, v37
    v_and_b32 v37, 0xffff0000, v37
    v_cvt_pk_bf16_f32 v7, v6, v7
    v_lshlrev_b32 v6, 16, v7
    v_and_b32 v7, 0xffff0000, v7
    v_cvt_pk_bf16_f32 v39, v38, v39
    v_lshlrev_b32 v38, 16, v39
    v_and_b32 v39, 0xffff0000, v39
    v_cmp_lt_f32 vcc, 0, v4
    v_mul_f32 v127, 0, v4
    s_nop 0
    v_cndmask_b32 v4, v127, v4, vcc
    v_mul_f32 v4, v4, v36
    v_cmp_lt_f32 vcc, 0, v5
    v_mul_f32 v127, 0, v5
    s_nop 0
    v_cndmask_b32 v5, v127, v5, vcc
    v_mul_f32 v5, v5, v37
    v_cmp_lt_f32 vcc, 0, v6
    v_mul_f32 v127, 0, v6
    s_nop 0
    v_cndmask_b32 v6, v127, v6, vcc
    v_mul_f32 v6, v6, v38
    v_cmp_lt_f32 vcc, 0, v7
    v_mul_f32 v127, 0, v7
    s_nop 0
    v_cndmask_b32 v7, v127, v7, vcc
    v_mul_f32 v7, v7, v39
    v_cvt_pk_bf16_f32 v21, v20, v21
    v_lshlrev_b32 v20, 16, v21
    v_and_b32 v21, 0xffff0000, v21
    v_cvt_pk_bf16_f32 v53, v52, v53
    v_lshlrev_b32 v52, 16, v53
    v_and_b32 v53, 0xffff0000, v53
    v_cvt_pk_bf16_f32 v23, v22, v23
    v_lshlrev_b32 v22, 16, v23
    v_and_b32 v23, 0xffff0000, v23
    v_cvt_pk_bf16_f32 v55, v54, v55
    v_lshlrev_b32 v54, 16, v55
    v_and_b32 v55, 0xffff0000, v55
    v_cmp_lt_f32 vcc, 0, v20
    v_mul_f32 v127, 0, v20
    s_nop 0
    v_cndmask_b32 v20, v127, v20, vcc
    v_mul_f32 v20, v20, v52
    v_cmp_lt_f32 vcc, 0, v21
    v_mul_f32 v127, 0, v21
    s_nop 0
    v_cndmask_b32 v21, v127, v21, vcc
    v_mul_f32 v21, v21, v53
    v_cmp_lt_f32 vcc, 0, v22
    v_mul_f32 v127, 0, v22
    s_nop 0
    v_cndmask_b32 v22, v127, v22, vcc
    v_mul_f32 v22, v22, v54
    v_cmp_lt_f32 vcc, 0, v23
    v_mul_f32 v127, 0, v23
    s_nop 0
    v_cndmask_b32 v23, v127, v23, vcc
    v_mul_f32 v23, v23, v55
    v_cvt_pk_bf16_f32 v100, v4, v5
    v_cvt_pk_bf16_f32 v101, v6, v7
    v_cvt_pk_bf16_f32 v102, v20, v21
    v_cvt_pk_bf16_f32 v103, v22, v23
    s_add_u32 s62, s41, 90112
    v_cvt_pk_bf16_f32 v9, v8, v9
    v_lshlrev_b32 v8, 16, v9
    v_and_b32 v9, 0xffff0000, v9
    v_cvt_pk_bf16_f32 v41, v40, v41
    v_lshlrev_b32 v40, 16, v41
    v_and_b32 v41, 0xffff0000, v41
    v_cvt_pk_bf16_f32 v11, v10, v11
    v_lshlrev_b32 v10, 16, v11
    v_and_b32 v11, 0xffff0000, v11
    v_cvt_pk_bf16_f32 v43, v42, v43
    v_lshlrev_b32 v42, 16, v43
    v_and_b32 v43, 0xffff0000, v43
    v_cmp_lt_f32 vcc, 0, v8
    v_mul_f32 v127, 0, v8
    s_nop 0
    v_cndmask_b32 v8, v127, v8, vcc
    v_mul_f32 v8, v8, v40
    v_cmp_lt_f32 vcc, 0, v9
    v_mul_f32 v127, 0, v9
    s_nop 0
    v_cndmask_b32 v9, v127, v9, vcc
    v_mul_f32 v9, v9, v41
    v_cmp_lt_f32 vcc, 0, v10
    v_mul_f32 v127, 0, v10
    s_nop 0
    v_cndmask_b32 v10, v127, v10, vcc
    v_mul_f32 v10, v10, v42
    v_cmp_lt_f32 vcc, 0, v11
    v_mul_f32 v127, 0, v11
    s_nop 0
    v_cndmask_b32 v11, v127, v11, vcc
    v_mul_f32 v11, v11, v43
    v_cvt_pk_bf16_f32 v25, v24, v25
    v_lshlrev_b32 v24, 16, v25
    v_and_b32 v25, 0xffff0000, v25
    v_cvt_pk_bf16_f32 v57, v56, v57
    v_lshlrev_b32 v56, 16, v57
    v_and_b32 v57, 0xffff0000, v57
    v_cvt_pk_bf16_f32 v27, v26, v27
    v_lshlrev_b32 v26, 16, v27
    v_and_b32 v27, 0xffff0000, v27
    v_cvt_pk_bf16_f32 v59, v58, v59
    v_lshlrev_b32 v58, 16, v59
    v_and_b32 v59, 0xffff0000, v59
    v_cmp_lt_f32 vcc, 0, v24
    v_mul_f32 v127, 0, v24
    s_nop 0
    v_cndmask_b32 v24, v127, v24, vcc
    v_mul_f32 v24, v24, v56
    v_cmp_lt_f32 vcc, 0, v25
    v_mul_f32 v127, 0, v25
    s_nop 0
    v_cndmask_b32 v25, v127, v25, vcc
    v_mul_f32 v25, v25, v57
    v_cmp_lt_f32 vcc, 0, v26
    v_mul_f32 v127, 0, v26
    s_nop 0
    v_cndmask_b32 v26, v127, v26, vcc
    v_mul_f32 v26, v26, v58
    v_cmp_lt_f32 vcc, 0, v27
    v_mul_f32 v127, 0, v27
    s_nop 0
    v_cndmask_b32 v27, v127, v27, vcc
    v_mul_f32 v27, v27, v59
    v_cvt_pk_bf16_f32 v104, v8, v9
    v_cvt_pk_bf16_f32 v105, v10, v11
    v_cvt_pk_bf16_f32 v106, v24, v25
    v_cvt_pk_bf16_f32 v107, v26, v27
    s_add_u32 s63, s41, 135168
    v_cvt_pk_bf16_f32 v13, v12, v13
    v_lshlrev_b32 v12, 16, v13
    v_and_b32 v13, 0xffff0000, v13
    v_cvt_pk_bf16_f32 v45, v44, v45
    v_lshlrev_b32 v44, 16, v45
    v_and_b32 v45, 0xffff0000, v45
    v_cvt_pk_bf16_f32 v15, v14, v15
    v_lshlrev_b32 v14, 16, v15
    v_and_b32 v15, 0xffff0000, v15
    v_cvt_pk_bf16_f32 v47, v46, v47
    v_lshlrev_b32 v46, 16, v47
    v_and_b32 v47, 0xffff0000, v47
    v_cmp_lt_f32 vcc, 0, v12
    v_mul_f32 v127, 0, v12
    s_nop 0
    v_cndmask_b32 v12, v127, v12, vcc
    v_mul_f32 v12, v12, v44
    v_cmp_lt_f32 vcc, 0, v13
    v_mul_f32 v127, 0, v13
    s_nop 0
    v_cndmask_b32 v13, v127, v13, vcc
    v_mul_f32 v13, v13, v45
    v_cmp_lt_f32 vcc, 0, v14
    v_mul_f32 v127, 0, v14
    s_nop 0
    v_cndmask_b32 v14, v127, v14, vcc
    v_mul_f32 v14, v14, v46
    v_cmp_lt_f32 vcc, 0, v15
    v_mul_f32 v127, 0, v15
    s_nop 0
    v_cndmask_b32 v15, v127, v15, vcc
    v_mul_f32 v15, v15, v47
    v_cvt_pk_bf16_f32 v29, v28, v29
    v_lshlrev_b32 v28, 16, v29
    v_and_b32 v29, 0xffff0000, v29
    v_cvt_pk_bf16_f32 v61, v60, v61
    v_lshlrev_b32 v60, 16, v61
    v_and_b32 v61, 0xffff0000, v61
    v_cvt_pk_bf16_f32 v31, v30, v31
    v_lshlrev_b32 v30, 16, v31
    v_and_b32 v31, 0xffff0000, v31
    v_cvt_pk_bf16_f32 v63, v62, v63
    v_lshlrev_b32 v62, 16, v63
    v_and_b32 v63, 0xffff0000, v63
    v_cmp_lt_f32 vcc, 0, v28
    v_mul_f32 v127, 0, v28
    s_nop 0
    v_cndmask_b32 v28, v127, v28, vcc
    v_mul_f32 v28, v28, v60
    v_cmp_lt_f32 vcc, 0, v29
    v_mul_f32 v127, 0, v29
    s_nop 0
    v_cndmask_b32 v29, v127, v29, vcc
    v_mul_f32 v29, v29, v61
    v_cmp_lt_f32 vcc, 0, v30
    v_mul_f32 v127, 0, v30
    s_nop 0
    v_cndmask_b32 v30, v127, v30, vcc
    v_mul_f32 v30, v30, v62
    v_cmp_lt_f32 vcc, 0, v31
    v_mul_f32 v127, 0, v31
    s_nop 0
    v_cndmask_b32 v31, v127, v31, vcc
    v_mul_f32 v31, v31, v63
    v_cvt_pk_bf16_f32 v108, v12, v13
    v_cvt_pk_bf16_f32 v109, v14, v15
    v_cvt_pk_bf16_f32 v110, v28, v29
    v_cvt_pk_bf16_f32 v111, v30, v31
    s_lshl_b32 s42, s25, 7
    s_add_u32 s28, s42, s27
    s_mov_b32 s25, s40
    s_cmp_ge_u32 s25, 32
    s_cbranch_scc1 GE_58
    s_waitcnt vmcnt(0)
    s_barrier
    s_add_u32 s40, s25, s24
    s_min_u32 s41, s40, 31
    s_lshl_b32 s45, s41, 16
    s_add_u32 s45, s45, s44
    ds_read_b128 v[64:67], v129 offset:0
    ds_read_b128 v[68:71], v129 offset:16384
    ds_read_b128 v[72:75], v129 offset:32768
    ds_read_b128 v[76:79], v129 offset:49152
    s_cmp_lt_i32 s43, 0
    s_cbranch_scc1 GF_60
    buffer_store_dwordx2 v[254:255], v253, s[4:7], s43 offen sc1
GF_60:
    s_mov_b32 s43, s28
    s_waitcnt lgkmcnt(0)
    v_mfma_f32_16x16x32_bf16 v[0:3], a[0:3], v[64:67], 0
    ds_read_b128 v[80:83], v129 offset:1024
    v_mfma_f32_16x16x32_bf16 v[4:7], a[0:3], v[68:71], 0
    ds_read_b128 v[84:87], v129 offset:17408
    v_mfma_f32_16x16x32_bf16 v[8:11], a[0:3], v[72:75], 0
    ds_read_b128 v[88:91], v129 offset:33792
    v_mfma_f32_16x16x32_bf16 v[12:15], a[0:3], v[76:79], 0
    ds_read_b128 v[92:95], v129 offset:50176
    v_mfma_f32_16x16x32_bf16 v[16:19], a[64:67], v[64:67], 0
    v_mfma_f32_16x16x32_bf16 v[20:23], a[64:67], v[68:71], 0
    s_add_u32 m0, s44, 0
    s_add_u32 s35, s45, 0
    buffer_load_dwordx4 v251, s[4:7], s35 offen sc1 lds
    v_mfma_f32_16x16x32_bf16 v[24:27], a[64:67], v[72:75], 0
    v_mfma_f32_16x16x32_bf16 v[28:31], a[64:67], v[76:79], 0
    v_mfma_f32_16x16x32_bf16 v[32:35], a[128:131], v[64:67], 0
    v_mfma_f32_16x16x32_bf16 v[36:39], a[128:131], v[68:71], 0
    buffer_store_dwordx4 v[96:99], v130, s[4:7], s60 offen offset:0 sc1
    v_mfma_f32_16x16x32_bf16 v[40:43], a[128:131], v[72:75], 0
    v_mfma_f32_16x16x32_bf16 v[44:47], a[128:131], v[76:79], 0
    v_mfma_f32_16x16x32_bf16 v[48:51], a[192:195], v[64:67], 0
    v_mfma_f32_16x16x32_bf16 v[52:55], a[192:195], v[68:71], 0
    s_add_u32 m0, s44, 1024
    s_add_u32 s35, s45, 1024
    buffer_load_dwordx4 v251, s[4:7], s35 offen sc1 lds
    v_mfma_f32_16x16x32_bf16 v[56:59], a[192:195], v[72:75], 0
    v_mfma_f32_16x16x32_bf16 v[60:63], a[192:195], v[76:79], 0
    s_waitcnt lgkmcnt(0)
    v_mfma_f32_16x16x32_bf16 v[0:3], a[4:7], v[80:83], v[0:3]
    ds_read_b128 v[64:67], v129 offset:2048
    v_mfma_f32_16x16x32_bf16 v[4:7], a[4:7], v[84:87], v[4:7]
    ds_read_b128 v[68:71], v129 offset:18432
    v_mfma_f32_16x16x32_bf16 v[8:11], a[4:7], v[88:91], v[8:11]
    ds_read_b128 v[72:75], v129 offset:34816
    v_mfma_f32_16x16x32_bf16 v[12:15], a[4:7], v[92:95], v[12:15]
    ds_read_b128 v[76:79], v129 offset:51200
    v_mfma_f32_16x16x32_bf16 v[16:19], a[68:71], v[80:83], v[16:19]
    v_mfma_f32_16x16x32_bf16 v[20:23], a[68:71], v[84:87], v[20:23]
    s_add_u32 m0, s44, 2048
    s_add_u32 s35, s45, 2048
    buffer_load_dwordx4 v251, s[4:7], s35 offen sc1 lds
    v_mfma_f32_16x16x32_bf16 v[24:27], a[68:71], v[88:91], v[24:27]
    v_mfma_f32_16x16x32_bf16 v[28:31], a[68:71], v[92:95], v[28:31]
    v_mfma_f32_16x16x32_bf16 v[32:35], a[132:135], v[80:83], v[32:35]
    v_mfma_f32_16x16x32_bf16 v[36:39], a[132:135], v[84:87], v[36:39]
    buffer_store_dwordx4 v[100:103], v130, s[4:7], s61 offen offset:0 sc1
    v_mfma_f32_16x16x32_bf16 v[40:43], a[132:135], v[88:91], v[40:43]
    v_mfma_f32_16x16x32_bf16 v[44:47], a[132:135], v[92:95], v[44:47]
    v_mfma_f32_16x16x32_bf16 v[48:51], a[196:199], v[80:83], v[48:51]
    v_mfma_f32_16x16x32_bf16 v[52:55], a[196:199], v[84:87], v[52:55]
    s_add_u32 m0, s44, 3072
    s_add_u32 s35, s45, 3072
    buffer_load_dwordx4 v251, s[4:7], s35 offen sc1 lds
    v_mfma_f32_16x16x32_bf16 v[56:59], a[196:199], v[88:91], v[56:59]
    v_mfma_f32_16x16x32_bf16 v[60:63], a[196:199], v[92:95], v[60:63]
    s_waitcnt lgkmcnt(0)
    v_mfma_f32_16x16x32_bf16 v[0:3], a[8:11], v[64:67], v[0:3]
    ds_read_b128 v[80:83], v129 offset:3072
    v_mfma_f32_16x16x32_bf16 v[4:7], a[8:11], v[68:71], v[4:7]
    ds_read_b128 v[84:87], v129 offset:19456
    v_mfma_f32_16x16x32_bf16 v[8:11], a[8:11], v[72:75], v[8:11]
    ds_read_b128 v[88:91], v129 offset:35840
    v_mfma_f32_16x16x32_bf16 v[12:15], a[8:11], v[76:79], v[12:15]
    ds_read_b128 v[92:95], v129 offset:52224
    v_mfma_f32_16x16x32_bf16 v[16:19], a[72:75], v[64:67], v[16:19]
    v_mfma_f32_16x16x32_bf16 v[20:23], a[72:75], v[68:71], v[20:23]
    s_add_u32 m0, s44, 4096
    s_add_u32 s35, s45, 4096
    buffer_load_dwordx4 v251, s[4:7], s35 offen sc1 lds
    v_mfma_f32_16x16x32_bf16 v[24:27], a[72:75], v[72:75], v[24:27]
    v_mfma_f32_16x16x32_bf16 v[28:31], a[72:75], v[76:79], v[28:31]
    v_mfma_f32_16x16x32_bf16 v[32:35], a[136:139], v[64:67], v[32:35]
    v_mfma_f32_16x16x32_bf16 v[36:39], a[136:139], v[68:71], v[36:39]
    buffer_store_dwordx4 v[104:107], v130, s[4:7], s62 offen offset:0 sc1
    v_mfma_f32_16x16x32_bf16 v[40:43], a[136:139], v[72:75], v[40:43]
    v_mfma_f32_16x16x32_bf16 v[44:47], a[136:139], v[76:79], v[44:47]
    v_mfma_f32_16x16x32_bf16 v[48:51], a[200:203], v[64:67], v[48:51]
    v_mfma_f32_16x16x32_bf16 v[52:55], a[200:203], v[68:71], v[52:55]
    s_add_u32 m0, s44, 5120
    s_add_u32 s35, s45, 5120
    buffer_load_dwordx4 v251, s[4:7], s35 offen sc1 lds
    v_mfma_f32_16x16x32_bf16 v[56:59], a[200:203], v[72:75], v[56:59]
    v_mfma_f32_16x16x32_bf16 v[60:63], a[200:203], v[76:79], v[60:63]
    s_waitcnt lgkmcnt(0)
    v_mfma_f32_16x16x32_bf16 v[0:3], a[12:15], v[80:83], v[0:3]
    ds_read_b128 v[64:67], v129 offset:4096
    v_mfma_f32_16x16x32_bf16 v[4:7], a[12:15], v[84:87], v[4:7]
    ds_read_b128 v[68:71], v129 offset:20480
    v_mfma_f32_16x16x32_bf16 v[8:11], a[12:15], v[88:91], v[8:11]
    ds_read_b128 v[72:75], v129 offset:36864
    v_mfma_f32_16x16x32_bf16 v[12:15], a[12:15], v[92:95], v[12:15]
    ds_read_b128 v[76:79], v129 offset:53248
    v_mfma_f32_16x16x32_bf16 v[16:19], a[76:79], v[80:83], v[16:19]
    v_mfma_f32_16x16x32_bf16 v[20:23], a[76:79], v[84:87], v[20:23]
    s_add_u32 m0, s44, 6144
    s_add_u32 s35, s45, 6144
    buffer_load_dwordx4 v251, s[4:7], s35 offen sc1 lds
    v_mfma_f32_16x16x32_bf16 v[24:27], a[76:79], v[88:91], v[24:27]
    v_mfma_f32_16x16x32_bf16 v[28:31], a[76:79], v[92:95], v[28:31]
    v_mfma_f32_16x16x32_bf16 v[32:35], a[140:143], v[80:83], v[32:35]
    v_mfma_f32_16x16x32_bf16 v[36:39], a[140:143], v[84:87], v[36:39]
    buffer_store_dwordx4 v[108:111], v130, s[4:7], s63 offen offset:0 sc1
    v_mfma_f32_16x16x32_bf16 v[40:43], a[140:143], v[88:91], v[40:43]
    v_mfma_f32_16x16x32_bf16 v[44:47], a[140:143], v[92:95], v[44:47]
    v_mfma_f32_16x16x32_bf16 v[48:51], a[204:207], v[80:83], v[48:51]
    v_mfma_f32_16x16x32_bf16 v[52:55], a[204:207], v[84:87], v[52:55]
    s_add_u32 m0, s44, 7168
    s_add_u32 s35, s45, 7168
    buffer_load_dwordx4 v251, s[4:7], s35 offen sc1 lds
    v_mfma_f32_16x16x32_bf16 v[56:59], a[204:207], v[88:91], v[56:59]
    v_mfma_f32_16x16x32_bf16 v[60:63], a[204:207], v[92:95], v[60:63]
    s_waitcnt lgkmcnt(0)
    v_mfma_f32_16x16x32_bf16 v[0:3], a[16:19], v[64:67], v[0:3]
    ds_read_b128 v[80:83], v129 offset:5120
    v_mfma_f32_16x16x32_bf16 v[4:7], a[16:19], v[68:71], v[4:7]
    ds_read_b128 v[84:87], v129 offset:21504
    v_mfma_f32_16x16x32_bf16 v[8:11], a[16:19], v[72:75], v[8:11]
    ds_read_b128 v[88:91], v129 offset:37888
    v_mfma_f32_16x16x32_bf16 v[12:15], a[16:19], v[76:79], v[12:15]
    ds_read_b128 v[92:95], v129 offset:54272
    v_mfma_f32_16x16x32_bf16 v[16:19], a[80:83], v[64:67], v[16:19]
    v_mfma_f32_16x16x32_bf16 v[20:23], a[80:83], v[68:71], v[20:23]
    s_add_u32 m0, s44, 8192
    s_add_u32 s35, s45, 8192
    buffer_load_dwordx4 v251, s[4:7], s35 offen sc1 lds
    v_mfma_f32_16x16x32_bf16 v[24:27], a[80:83], v[72:75], v[24:27]
    v_mfma_f32_16x16x32_bf16 v[28:31], a[80:83], v[76:79], v[28:31]
    v_mfma_f32_16x16x32_bf16 v[32:35], a[144:147], v[64:67], v[32:35]
    v_mfma_f32_16x16x32_bf16 v[36:39], a[144:147], v[68:71], v[36:39]
    v_mfma_f32_16x16x32_bf16 v[40:43], a[144:147], v[72:75], v[40:43]
    v_mfma_f32_16x16x32_bf16 v[44:47], a[144:147], v[76:79], v[44:47]
    v_mfma_f32_16x16x32_bf16 v[48:51], a[208:211], v[64:67], v[48:51]
    v_mfma_f32_16x16x32_bf16 v[52:55], a[208:211], v[68:71], v[52:55]
    s_add_u32 m0, s44, 9216
    s_add_u32 s35, s45, 9216
    buffer_load_dwordx4 v251, s[4:7], s35 offen sc1 lds
    v_mfma_f32_16x16x32_bf16 v[56:59], a[208:211], v[72:75], v[56:59]
    v_mfma_f32_16x16x32_bf16 v[60:63], a[208:211], v[76:79], v[60:63]
    s_waitcnt lgkmcnt(0)
    v_mfma_f32_16x16x32_bf16 v[0:3], a[20:23], v[80:83], v[0:3]
    ds_read_b128 v[64:67], v129 offset:6144
    v_mfma_f32_16x16x32_bf16 v[4:7], a[20:23], v[84:87], v[4:7]
    ds_read_b128 v[68:71], v129 offset:22528
    v_mfma_f32_16x16x32_bf16 v[8:11], a[20:23], v[88:91], v[8:11]
    ds_read_b128 v[72:75], v129 offset:38912
    v_mfma_f32_16x16x32_bf16 v[12:15], a[20:23], v[92:95], v[12:15]
    ds_read_b128 v[76:79], v129 offset:55296
    v_mfma_f32_16x16x32_bf16 v[16:19], a[84:87], v[80:83], v[16:19]
    v_mfma_f32_16x16x32_bf16 v[20:23], a[84:87], v[84:87], v[20:23]
    s_add_u32 m0, s44, 10240
    s_add_u32 s35, s45, 10240
    buffer_load_dwordx4 v251, s[4:7], s35 offen sc1 lds
    v_mfma_f32_16x16x32_bf16 v[24:27], a[84:87], v[88:91], v[24:27]
    v_mfma_f32_16x16x32_bf16 v[28:31], a[84:87], v[92:95], v[28:31]
    v_mfma_f32_16x16x32_bf16 v[32:35], a[148:151], v[80:83], v[32:35]
    v_mfma_f32_16x16x32_bf16 v[36:39], a[148:151], v[84:87], v[36:39]
    v_mfma_f32_16x16x32_bf16 v[40:43], a[148:151], v[88:91], v[40:43]
    v_mfma_f32_16x16x32_bf16 v[44:47], a[148:151], v[92:95], v[44:47]
    v_mfma_f32_16x16x32_bf16 v[48:51], a[212:215], v[80:83], v[48:51]
    v_mfma_f32_16x16x32_bf16 v[52:55], a[212:215], v[84:87], v[52:55]
    s_add_u32 m0, s44, 11264
    s_add_u32 s35, s45, 11264
    buffer_load_dwordx4 v251, s[4:7], s35 offen sc1 lds
    v_mfma_f32_16x16x32_bf16 v[56:59], a[212:215], v[88:91], v[56:59]
    v_mfma_f32_16x16x32_bf16 v[60:63], a[212:215], v[92:95], v[60:63]
    s_waitcnt lgkmcnt(0)
    v_mfma_f32_16x16x32_bf16 v[0:3], a[24:27], v[64:67], v[0:3]
    ds_read_b128 v[80:83], v129 offset:7168
    v_mfma_f32_16x16x32_bf16 v[4:7], a[24:27], v[68:71], v[4:7]
    ds_read_b128 v[84:87], v129 offset:23552
    v_mfma_f32_16x16x32_bf16 v[8:11], a[24:27], v[72:75], v[8:11]
    ds_read_b128 v[88:91], v129 offset:39936
    v_mfma_f32_16x16x32_bf16 v[12:15], a[24:27], v[76:79], v[12:15]
    ds_read_b128 v[92:95], v129 offset:56320
    v_mfma_f32_16x16x32_bf16 v[16:19], a[88:91], v[64:67], v[16:19]
    v_mfma_f32_16x16x32_bf16 v[20:23], a[88:91], v[68:71], v[20:23]
    s_add_u32 m0, s44, 12288
    s_add_u32 s35, s45, 12288
    buffer_load_dwordx4 v251, s[4:7], s35 offen sc1 lds
    v_mfma_f32_16x16x32_bf16 v[24:27], a[88:91], v[72:75], v[24:27]
    v_mfma_f32_16x16x32_bf16 v[28:31], a[88:91], v[76:79], v[28:31]
    v_mfma_f32_16x16x32_bf16 v[32:35], a[152:155], v[64:67], v[32:35]
    v_mfma_f32_16x16x32_bf16 v[36:39], a[152:155], v[68:71], v[36:39]
    v_mfma_f32_16x16x32_bf16 v[40:43], a[152:155], v[72:75], v[40:43]
    v_mfma_f32_16x16x32_bf16 v[44:47], a[152:155], v[76:79], v[44:47]
    v_mfma_f32_16x16x32_bf16 v[48:51], a[216:219], v[64:67], v[48:51]
    v_mfma_f32_16x16x32_bf16 v[52:55], a[216:219], v[68:71], v[52:55]
    v_mfma_f32_16x16x32_bf16 v[56:59], a[216:219], v[72:75], v[56:59]
    v_mfma_f32_16x16x32_bf16 v[60:63], a[216:219], v[76:79], v[60:63]
    s_waitcnt lgkmcnt(0)
    v_mfma_f32_16x16x32_bf16 v[0:3], a[28:31], v[80:83], v[0:3]
    ds_read_b128 v[64:67], v129 offset:8192
    v_mfma_f32_16x16x32_bf16 v[4:7], a[28:31], v[84:87], v[4:7]
    ds_read_b128 v[68:71], v129 offset:24576
    v_mfma_f32_16x16x32_bf16 v[8:11], a[28:31], v[88:91], v[8:11]
    ds_read_b128 v[72:75], v129 offset:40960
    v_mfma_f32_16x16x32_bf16 v[12:15], a[28:31], v[92:95], v[12:15]
    ds_read_b128 v[76:79], v129 offset:57344
    v_mfma_f32_16x16x32_bf16 v[16:19], a[92:95], v[80:83], v[16:19]
    v_mfma_f32_16x16x32_bf16 v[20:23], a[92:95], v[84:87], v[20:23]
    s_add_u32 m0, s44, 13312
    s_add_u32 s35, s45, 13312
    buffer_load_dwordx4 v251, s[4:7], s35 offen sc1 lds
    v_mfma_f32_16x16x32_bf16 v[24:27], a[92:95], v[88:91], v[24:27]
    v_mfma_f32_16x16x32_bf16 v[28:31], a[92:95], v[92:95], v[28:31]
    v_mfma_f32_16x16x32_bf16 v[32:35], a[156:159], v[80:83], v[32:35]
    v_mfma_f32_16x16x32_bf16 v[36:39], a[156:159], v[84:87], v[36:39]
    v_mfma_f32_16x16x32_bf16 v[40:43], a[156:159], v[88:91], v[40:43]
    v_mfma_f32_16x16x32_bf16 v[44:47], a[156:159], v[92:95], v[44:47]
    v_mfma_f32_16x16x32_bf16 v[48:51], a[220:223], v[80:83], v[48:51]
    v_mfma_f32_16x16x32_bf16 v[52:55], a[220:223], v[84:87], v[52:55]
    v_mfma_f32_16x16x32_bf16 v[56:59], a[220:223], v[88:91], v[56:59]
    v_mfma_f32_16x16x32_bf16 v[60:63], a[220:223], v[92:95], v[60:63]
    s_waitcnt lgkmcnt(0)
    v_mfma_f32_16x16x32_bf16 v[0:3], a[32:35], v[64:67], v[0:3]
    ds_read_b128 v[80:83], v129 offset:9216
    v_mfma_f32_16x16x32_bf16 v[4:7], a[32:35], v[68:71], v[4:7]
    ds_read_b128 v[84:87], v129 offset:25600
    v_mfma_f32_16x16x32_bf16 v[8:11], a[32:35], v[72:75], v[8:11]
    ds_read_b128 v[88:91], v129 offset:41984
    v_mfma_f32_16x16x32_bf16 v[12:15], a[32:35], v[76:79], v[12:15]
    ds_read_b128 v[92:95], v129 offset:58368
    v_mfma_f32_16x16x32_bf16 v[16:19], a[96:99], v[64:67], v[16:19]
    v_mfma_f32_16x16x32_bf16 v[20:23], a[96:99], v[68:71], v[20:23]
    s_add_u32 m0, s44, 14336
    s_add_u32 s35, s45, 14336
    buffer_load_dwordx4 v251, s[4:7], s35 offen sc1 lds
    v_mfma_f32_16x16x32_bf16 v[24:27], a[96:99], v[72:75], v[24:27]
    v_mfma_f32_16x16x32_bf16 v[28:31], a[96:99], v[76:79], v[28:31]
    v_mfma_f32_16x16x32_bf16 v[32:35], a[160:163], v[64:67], v[32:35]
    v_mfma_f32_16x16x32_bf16 v[36:39], a[160:163], v[68:71], v[36:39]
    v_mfma_f32_16x16x32_bf16 v[40:43], a[160:163], v[72:75], v[40:43]
    v_mfma_f32_16x16x32_bf16 v[44:47], a[160:163], v[76:79], v[44:47]
    v_mfma_f32_16x16x32_bf16 v[48:51], a[224:227], v[64:67], v[48:51]
    v_mfma_f32_16x16x32_bf16 v[52:55], a[224:227], v[68:71], v[52:55]
    v_mfma_f32_16x16x32_bf16 v[56:59], a[224:227], v[72:75], v[56:59]
    v_mfma_f32_16x16x32_bf16 v[60:63], a[224:227], v[76:79], v[60:63]
    s_waitcnt lgkmcnt(0)
    v_mfma_f32_16x16x32_bf16 v[0:3], a[36:39], v[80:83], v[0:3]
    ds_read_b128 v[64:67], v129 offset:10240
    v_mfma_f32_16x16x32_bf16 v[4:7], a[36:39], v[84:87], v[4:7]
    ds_read_b128 v[68:71], v129 offset:26624
    v_mfma_f32_16x16x32_bf16 v[8:11], a[36:39], v[88:91], v[8:11]
    ds_read_b128 v[72:75], v129 offset:43008
    v_mfma_f32_16x16x32_bf16 v[12:15], a[36:39], v[92:95], v[12:15]
    ds_read_b128 v[76:79], v129 offset:59392
    v_mfma_f32_16x16x32_bf16 v[16:19], a[100:103], v[80:83], v[16:19]
    v_mfma_f32_16x16x32_bf16 v[20:23], a[100:103], v[84:87], v[20:23]
    s_add_u32 m0, s44, 15360
    s_add_u32 s35, s45, 15360
    buffer_load_dwordx4 v251, s[4:7], s35 offen sc1 lds
    v_mfma_f32_16x16x32_bf16 v[24:27], a[100:103], v[88:91], v[24:27]
    v_mfma_f32_16x16x32_bf16 v[28:31], a[100:103], v[92:95], v[28:31]
    v_mfma_f32_16x16x32_bf16 v[32:35], a[164:167], v[80:83], v[32:35]
    v_mfma_f32_16x16x32_bf16 v[36:39], a[164:167], v[84:87], v[36:39]
    v_mfma_f32_16x16x32_bf16 v[40:43], a[164:167], v[88:91], v[40:43]
    v_mfma_f32_16x16x32_bf16 v[44:47], a[164:167], v[92:95], v[44:47]
    v_mfma_f32_16x16x32_bf16 v[48:51], a[228:231], v[80:83], v[48:51]
    v_mfma_f32_16x16x32_bf16 v[52:55], a[228:231], v[84:87], v[52:55]
    v_mfma_f32_16x16x32_bf16 v[56:59], a[228:231], v[88:91], v[56:59]
    v_mfma_f32_16x16x32_bf16 v[60:63], a[228:231], v[92:95], v[60:63]
    s_waitcnt lgkmcnt(0)
    v_mfma_f32_16x16x32_bf16 v[0:3], a[40:43], v[64:67], v[0:3]
    ds_read_b128 v[80:83], v129 offset:11264
    v_mfma_f32_16x16x32_bf16 v[4:7], a[40:43], v[68:71], v[4:7]
    ds_read_b128 v[84:87], v129 offset:27648
    v_mfma_f32_16x16x32_bf16 v[8:11], a[40:43], v[72:75], v[8:11]
    ds_read_b128 v[88:91], v129 offset:44032
    v_mfma_f32_16x16x32_bf16 v[12:15], a[40:43], v[76:79], v[12:15]
    ds_read_b128 v[92:95], v129 offset:60416
    v_mfma_f32_16x16x32_bf16 v[16:19], a[104:107], v[64:67], v[16:19]
    v_mfma_f32_16x16x32_bf16 v[20:23], a[104:107], v[68:71], v[20:23]
    v_mfma_f32_16x16x32_bf16 v[24:27], a[104:107], v[72:75], v[24:27]
    v_mfma_f32_16x16x32_bf16 v[28:31], a[104:107], v[76:79], v[28:31]
    v_mfma_f32_16x16x32_bf16 v[32:35], a[168:171], v[64:67], v[32:35]
    v_mfma_f32_16x16x32_bf16 v[36:39], a[168:171], v[68:71], v[36:39]
    v_mfma_f32_16x16x32_bf16 v[40:43], a[168:171], v[72:75], v[40:43]
    v_mfma_f32_16x16x32_bf16 v[44:47], a[168:171], v[76:79], v[44:47]
    v_mfma_f32_16x16x32_bf16 v[48:51], a[232:235], v[64:67], v[48:51]
    v_mfma_f32_16x16x32_bf16 v[52:55], a[232:235], v[68:71], v[52:55]
    v_mfma_f32_16x16x32_bf16 v[56:59], a[232:235], v[72:75], v[56:59]
    v_mfma_f32_16x16x32_bf16 v[60:63], a[232:235], v[76:79], v[60:63]
    s_waitcnt lgkmcnt(0)
    v_mfma_f32_16x16x32_bf16 v[0:3], a[44:47], v[80:83], v[0:3]
    ds_read_b128 v[64:67], v129 offset:12288
    v_mfma_f32_16x16x32_bf16 v[4:7], a[44:47], v[84:87], v[4:7]
    ds_read_b128 v[68:71], v129 offset:28672
    v_mfma_f32_16x16x32_bf16 v[8:11], a[44:47], v[88:91], v[8:11]
    ds_read_b128 v[72:75], v129 offset:45056
    v_mfma_f32_16x16x32_bf16 v[12:15], a[44:47], v[92:95], v[12:15]
    ds_read_b128 v[76:79], v129 offset:61440
    v_mfma_f32_16x16x32_bf16 v[16:19], a[108:111], v[80:83], v[16:19]
    v_mfma_f32_16x16x32_bf16 v[20:23], a[108:111], v[84:87], v[20:23]
    v_mfma_f32_16x16x32_bf16 v[24:27], a[108:111], v[88:91], v[24:27]
    v_mfma_f32_16x16x32_bf16 v[28:31], a[108:111], v[92:95], v[28:31]
    v_mfma_f32_16x16x32_bf16 v[32:35], a[172:175], v[80:83], v[32:35]
    v_mfma_f32_16x16x32_bf16 v[36:39], a[172:175], v[84:87], v[36:39]
    v_mfma_f32_16x16x32_bf16 v[40:43], a[172:175], v[88:91], v[40:43]
    v_mfma_f32_16x16x32_bf16 v[44:47], a[172:175], v[92:95], v[44:47]
    v_mfma_f32_16x16x32_bf16 v[48:51], a[236:239], v[80:83], v[48:51]
    v_mfma_f32_16x16x32_bf16 v[52:55], a[236:239], v[84:87], v[52:55]
    v_mfma_f32_16x16x32_bf16 v[56:59], a[236:239], v[88:91], v[56:59]
    v_mfma_f32_16x16x32_bf16 v[60:63], a[236:239], v[92:95], v[60:63]
    s_waitcnt lgkmcnt(0)
    v_mfma_f32_16x16x32_bf16 v[0:3], a[48:51], v[64:67], v[0:3]
    ds_read_b128 v[80:83], v129 offset:13312
    v_mfma_f32_16x16x32_bf16 v[4:7], a[48:51], v[68:71], v[4:7]
    ds_read_b128 v[84:87], v129 offset:29696
    v_mfma_f32_16x16x32_bf16 v[8:11], a[48:51], v[72:75], v[8:11]
    ds_read_b128 v[88:91], v129 offset:46080
    v_mfma_f32_16x16x32_bf16 v[12:15], a[48:51], v[76:79], v[12:15]
    ds_read_b128 v[92:95], v129 offset:62464
    v_mfma_f32_16x16x32_bf16 v[16:19], a[112:115], v[64:67], v[16:19]
    v_mfma_f32_16x16x32_bf16 v[20:23], a[112:115], v[68:71], v[20:23]
    v_mfma_f32_16x16x32_bf16 v[24:27], a[112:115], v[72:75], v[24:27]
    v_mfma_f32_16x16x32_bf16 v[28:31], a[112:115], v[76:79], v[28:31]
    v_mfma_f32_16x16x32_bf16 v[32:35], a[176:179], v[64:67], v[32:35]
    v_mfma_f32_16x16x32_bf16 v[36:39], a[176:179], v[68:71], v[36:39]
    v_mfma_f32_16x16x32_bf16 v[40:43], a[176:179], v[72:75], v[40:43]
    v_mfma_f32_16x16x32_bf16 v[44:47], a[176:179], v[76:79], v[44:47]
    v_mfma_f32_16x16x32_bf16 v[48:51], a[240:243], v[64:67], v[48:51]
    v_mfma_f32_16x16x32_bf16 v[52:55], a[240:243], v[68:71], v[52:55]
    v_mfma_f32_16x16x32_bf16 v[56:59], a[240:243], v[72:75], v[56:59]
    v_mfma_f32_16x16x32_bf16 v[60:63], a[240:243], v[76:79], v[60:63]
    s_waitcnt lgkmcnt(0)
    v_mfma_f32_16x16x32_bf16 v[0:3], a[52:55], v[80:83], v[0:3]
    ds_read_b128 v[64:67], v129 offset:14336
    v_mfma_f32_16x16x32_bf16 v[4:7], a[52:55], v[84:87], v[4:7]
    ds_read_b128 v[68:71], v129 offset:30720
    v_mfma_f32_16x16x32_bf16 v[8:11], a[52:55], v[88:91], v[8:11]
    ds_read_b128 v[72:75], v129 offset:47104
    v_mfma_f32_16x16x32_bf16 v[12:15], a[52:55], v[92:95], v[12:15]
    ds_read_b128 v[76:79], v129 offset:63488
    v_mfma_f32_16x16x32_bf16 v[16:19], a[116:119], v[80:83], v[16:19]
    v_mfma_f32_16x16x32_bf16 v[20:23], a[116:119], v[84:87], v[20:23]
    v_mfma_f32_16x16x32_bf16 v[24:27], a[116:119], v[88:91], v[24:27]
    v_mfma_f32_16x16x32_bf16 v[28:31], a[116:119], v[92:95], v[28:31]
    v_mfma_f32_16x16x32_bf16 v[32:35], a[180:183], v[80:83], v[32:35]
    v_mfma_f32_16x16x32_bf16 v[36:39], a[180:183], v[84:87], v[36:39]
    v_mfma_f32_16x16x32_bf16 v[40:43], a[180:183], v[88:91], v[40:43]
    v_mfma_f32_16x16x32_bf16 v[44:47], a[180:183], v[92:95], v[44:47]
    v_mfma_f32_16x16x32_bf16 v[48:51], a[244:247], v[80:83], v[48:51]
    v_mfma_f32_16x16x32_bf16 v[52:55], a[244:247], v[84:87], v[52:55]
    v_mfma_f32_16x16x32_bf16 v[56:59], a[244:247], v[88:91], v[56:59]
    v_mfma_f32_16x16x32_bf16 v[60:63], a[244:247], v[92:95], v[60:63]
    s_waitcnt lgkmcnt(0)
    v_mfma_f32_16x16x32_bf16 v[0:3], a[56:59], v[64:67], v[0:3]
    ds_read_b128 v[80:83], v129 offset:15360
    v_mfma_f32_16x16x32_bf16 v[4:7], a[56:59], v[68:71], v[4:7]
    ds_read_b128 v[84:87], v129 offset:31744
    v_mfma_f32_16x16x32_bf16 v[8:11], a[56:59], v[72:75], v[8:11]
    ds_read_b128 v[88:91], v129 offset:48128
    v_mfma_f32_16x16x32_bf16 v[12:15], a[56:59], v[76:79], v[12:15]
    ds_read_b128 v[92:95], v129 offset:64512
    v_mfma_f32_16x16x32_bf16 v[16:19], a[120:123], v[64:67], v[16:19]
    v_mfma_f32_16x16x32_bf16 v[20:23], a[120:123], v[68:71], v[20:23]
    v_mfma_f32_16x16x32_bf16 v[24:27], a[120:123], v[72:75], v[24:27]
    v_mfma_f32_16x16x32_bf16 v[28:31], a[120:123], v[76:79], v[28:31]
    v_mfma_f32_16x16x32_bf16 v[32:35], a[184:187], v[64:67], v[32:35]
    v_mfma_f32_16x16x32_bf16 v[36:39], a[184:187], v[68:71], v[36:39]
    v_mfma_f32_16x16x32_bf16 v[40:43], a[184:187], v[72:75], v[40:43]
    v_mfma_f32_16x16x32_bf16 v[44:47], a[184:187], v[76:79], v[44:47]
    v_mfma_f32_16x16x32_bf16 v[48:51], a[248:251], v[64:67], v[48:51]
    v_mfma_f32_16x16x32_bf16 v[52:55], a[248:251], v[68:71], v[52:55]
    v_mfma_f32_16x16x32_bf16 v[56:59], a[248:251], v[72:75], v[56:59]
    v_mfma_f32_16x16x32_bf16 v[60:63], a[248:251], v[76:79], v[60:63]
    s_waitcnt lgkmcnt(0)
    v_mfma_f32_16x16x32_bf16 v[0:3], a[60:63], v[80:83], v[0:3]
    v_mfma_f32_16x16x32_bf16 v[4:7], a[60:63], v[84:87], v[4:7]
    v_mfma_f32_16x16x32_bf16 v[8:11], a[60:63], v[88:91], v[8:11]
    v_mfma_f32_16x16x32_bf16 v[12:15], a[60:63], v[92:95], v[12:15]
    v_mfma_f32_16x16x32_bf16 v[16:19], a[124:127], v[80:83], v[16:19]
    v_mfma_f32_16x16x32_bf16 v[20:23], a[124:127], v[84:87], v[20:23]
    v_mfma_f32_16x16x32_bf16 v[24:27], a[124:127], v[88:91], v[24:27]
    v_mfma_f32_16x16x32_bf16 v[28:31], a[124:127], v[92:95], v[28:31]
    v_mfma_f32_16x16x32_bf16 v[32:35], a[188:191], v[80:83], v[32:35]
    v_mfma_f32_16x16x32_bf16 v[36:39], a[188:191], v[84:87], v[36:39]
    v_mfma_f32_16x16x32_bf16 v[40:43], a[188:191], v[88:91], v[40:43]
    v_mfma_f32_16x16x32_bf16 v[44:47], a[188:191], v[92:95], v[44:47]
    v_mfma_f32_16x16x32_bf16 v[48:51], a[252:255], v[80:83], v[48:51]
    v_mfma_f32_16x16x32_bf16 v[52:55], a[252:255], v[84:87], v[52:55]
    v_mfma_f32_16x16x32_bf16 v[56:59], a[252:255], v[88:91], v[56:59]
    v_mfma_f32_16x16x32_bf16 v[60:63], a[252:255], v[92:95], v[60:63]
    s_nop 7
    s_mul_i32 s41, s25, 180224
    s_add_u32 s41, s41, s26
    v_mov_b32 v130, v251
    s_add_u32 s60, s41, 0
    v_cvt_pk_bf16_f32 v1, v0, v1
    v_lshlrev_b32 v0, 16, v1
    v_and_b32 v1, 0xffff0000, v1
    v_cvt_pk_bf16_f32 v33, v32, v33
    v_lshlrev_b32 v32, 16, v33
    v_and_b32 v33, 0xffff0000, v33
    v_cvt_pk_bf16_f32 v3, v2, v3
    v_lshlrev_b32 v2, 16, v3
    v_and_b32 v3, 0xffff0000, v3
    v_cvt_pk_bf16_f32 v35, v34, v35
    v_lshlrev_b32 v34, 16, v35
    v_and_b32 v35, 0xffff0000, v35
    v_cmp_lt_f32 vcc, 0, v0
    v_mul_f32 v127, 0, v0
    s_nop 0
    v_cndmask_b32 v0, v127, v0, vcc
    v_mul_f32 v0, v0, v32
    v_cmp_lt_f32 vcc, 0, v1
    v_mul_f32 v127, 0, v1
    s_nop 0
    v_cndmask_b32 v1, v127, v1, vcc
    v_mul_f32 v1, v1, v33
    v_cmp_lt_f32 vcc, 0, v2
    v_mul_f32 v127, 0, v2
    s_nop 0
    v_cndmask_b32 v2, v127, v2, vcc
    v_mul_f32 v2, v2, v34
    v_cmp_lt_f32 vcc, 0, v3
    v_mul_f32 v127, 0, v3
    s_nop 0
    v_cndmask_b32 v3, v127, v3, vcc
    v_mul_f32 v3, v3, v35
    v_cvt_pk_bf16_f32 v17, v16, v17
    v_lshlrev_b32 v16, 16, v17
    v_and_b32 v17, 0xffff0000, v17
    v_cvt_pk_bf16_f32 v49, v48, v49
    v_lshlrev_b32 v48, 16, v49
    v_and_b32 v49, 0xffff0000, v49
    v_cvt_pk_bf16_f32 v19, v18, v19
    v_lshlrev_b32 v18, 16, v19
    v_and_b32 v19, 0xffff0000, v19
    v_cvt_pk_bf16_f32 v51, v50, v51
    v_lshlrev_b32 v50, 16, v51
    v_and_b32 v51, 0xffff0000, v51
    v_cmp_lt_f32 vcc, 0, v16
    v_mul_f32 v127, 0, v16
    s_nop 0
    v_cndmask_b32 v16, v127, v16, vcc
    v_mul_f32 v16, v16, v48
    v_cmp_lt_f32 vcc, 0, v17
    v_mul_f32 v127, 0, v17
    s_nop 0
    v_cndmask_b32 v17, v127, v17, vcc
    v_mul_f32 v17, v17, v49
    v_cmp_lt_f32 vcc, 0, v18
    v_mul_f32 v127, 0, v18
    s_nop 0
    v_cndmask_b32 v18, v127, v18, vcc
    v_mul_f32 v18, v18, v50
    v_cmp_lt_f32 vcc, 0, v19
    v_mul_f32 v127, 0, v19
    s_nop 0
    v_cndmask_b32 v19, v127, v19, vcc
    v_mul_f32 v19, v19, v51
    v_cvt_pk_bf16_f32 v96, v0, v1
    v_cvt_pk_bf16_f32 v97, v2, v3
    v_cvt_pk_bf16_f32 v98, v16, v17
    v_cvt_pk_bf16_f32 v99, v18, v19
    s_add_u32 s61, s41, 45056
    v_cvt_pk_bf16_f32 v5, v4, v5
    v_lshlrev_b32 v4, 16, v5
    v_and_b32 v5, 0xffff0000, v5
    v_cvt_pk_bf16_f32 v37, v36, v37
    v_lshlrev_b32 v36, 16, v37
    v_and_b32 v37, 0xffff0000, v37
    v_cvt_pk_bf16_f32 v7, v6, v7
    v_lshlrev_b32 v6, 16, v7
    v_and_b32 v7, 0xffff0000, v7
    v_cvt_pk_bf16_f32 v39, v38, v39
    v_lshlrev_b32 v38, 16, v39
    v_and_b32 v39, 0xffff0000, v39
    v_cmp_lt_f32 vcc, 0, v4
    v_mul_f32 v127, 0, v4
    s_nop 0
    v_cndmask_b32 v4, v127, v4, vcc
    v_mul_f32 v4, v4, v36
    v_cmp_lt_f32 vcc, 0, v5
    v_mul_f32 v127, 0, v5
    s_nop 0
    v_cndmask_b32 v5, v127, v5, vcc
    v_mul_f32 v5, v5, v37
    v_cmp_lt_f32 vcc, 0, v6
    v_mul_f32 v127, 0, v6
    s_nop 0
    v_cndmask_b32 v6, v127, v6, vcc
    v_mul_f32 v6, v6, v38
    v_cmp_lt_f32 vcc, 0, v7
    v_mul_f32 v127, 0, v7
    s_nop 0
    v_cndmask_b32 v7, v127, v7, vcc
    v_mul_f32 v7, v7, v39
    v_cvt_pk_bf16_f32 v21, v20, v21
    v_lshlrev_b32 v20, 16, v21
    v_and_b32 v21, 0xffff0000, v21
    v_cvt_pk_bf16_f32 v53, v52, v53
    v_lshlrev_b32 v52, 16, v53
    v_and_b32 v53, 0xffff0000, v53
    v_cvt_pk_bf16_f32 v23, v22, v23
    v_lshlrev_b32 v22, 16, v23
    v_and_b32 v23, 0xffff0000, v23
    v_cvt_pk_bf16_f32 v55, v54, v55
    v_lshlrev_b32 v54, 16, v55
    v_and_b32 v55, 0xffff0000, v55
    v_cmp_lt_f32 vcc, 0, v20
    v_mul_f32 v127, 0, v20
    s_nop 0
    v_cndmask_b32 v20, v127, v20, vcc
    v_mul_f32 v20, v20, v52
    v_cmp_lt_f32 vcc, 0, v21
    v_mul_f32 v127, 0, v21
    s_nop 0
    v_cndmask_b32 v21, v127, v21, vcc
    v_mul_f32 v21, v21, v53
    v_cmp_lt_f32 vcc, 0, v22
    v_mul_f32 v127, 0, v22
    s_nop 0
    v_cndmask_b32 v22, v127, v22, vcc
    v_mul_f32 v22, v22, v54
    v_cmp_lt_f32 vcc, 0, v23
    v_mul_f32 v127, 0, v23
    s_nop 0
    v_cndmask_b32 v23, v127, v23, vcc
    v_mul_f32 v23, v23, v55
    v_cvt_pk_bf16_f32 v100, v4, v5
    v_cvt_pk_bf16_f32 v101, v6, v7
    v_cvt_pk_bf16_f32 v102, v20, v21
    v_cvt_pk_bf16_f32 v103, v22, v23
    s_add_u32 s62, s41, 90112
    v_cvt_pk_bf16_f32 v9, v8, v9
    v_lshlrev_b32 v8, 16, v9
    v_and_b32 v9, 0xffff0000, v9
    v_cvt_pk_bf16_f32 v41, v40, v41
    v_lshlrev_b32 v40, 16, v41
    v_and_b32 v41, 0xffff0000, v41
    v_cvt_pk_bf16_f32 v11, v10, v11
    v_lshlrev_b32 v10, 16, v11
    v_and_b32 v11, 0xffff0000, v11
    v_cvt_pk_bf16_f32 v43, v42, v43
    v_lshlrev_b32 v42, 16, v43
    v_and_b32 v43, 0xffff0000, v43
    v_cmp_lt_f32 vcc, 0, v8
    v_mul_f32 v127, 0, v8
    s_nop 0
    v_cndmask_b32 v8, v127, v8, vcc
    v_mul_f32 v8, v8, v40
    v_cmp_lt_f32 vcc, 0, v9
    v_mul_f32 v127, 0, v9
    s_nop 0
    v_cndmask_b32 v9, v127, v9, vcc
    v_mul_f32 v9, v9, v41
    v_cmp_lt_f32 vcc, 0, v10
    v_mul_f32 v127, 0, v10
    s_nop 0
    v_cndmask_b32 v10, v127, v10, vcc
    v_mul_f32 v10, v10, v42
    v_cmp_lt_f32 vcc, 0, v11
    v_mul_f32 v127, 0, v11
    s_nop 0
    v_cndmask_b32 v11, v127, v11, vcc
    v_mul_f32 v11, v11, v43
    v_cvt_pk_bf16_f32 v25, v24, v25
    v_lshlrev_b32 v24, 16, v25
    v_and_b32 v25, 0xffff0000, v25
    v_cvt_pk_bf16_f32 v57, v56, v57
    v_lshlrev_b32 v56, 16, v57
    v_and_b32 v57, 0xffff0000, v57
    v_cvt_pk_bf16_f32 v27, v26, v27
    v_lshlrev_b32 v26, 16, v27
    v_and_b32 v27, 0xffff0000, v27
    v_cvt_pk_bf16_f32 v59, v58, v59
    v_lshlrev_b32 v58, 16, v59
    v_and_b32 v59, 0xffff0000, v59
    v_cmp_lt_f32 vcc, 0, v24
    v_mul_f32 v127, 0, v24
    s_nop 0
    v_cndmask_b32 v24, v127, v24, vcc
    v_mul_f32 v24, v24, v56
    v_cmp_lt_f32 vcc, 0, v25
    v_mul_f32 v127, 0, v25
    s_nop 0
    v_cndmask_b32 v25, v127, v25, vcc
    v_mul_f32 v25, v25, v57
    v_cmp_lt_f32 vcc, 0, v26
    v_mul_f32 v127, 0, v26
    s_nop 0
    v_cndmask_b32 v26, v127, v26, vcc
    v_mul_f32 v26, v26, v58
    v_cmp_lt_f32 vcc, 0, v27
    v_mul_f32 v127, 0, v27
    s_nop 0
    v_cndmask_b32 v27, v127, v27, vcc
    v_mul_f32 v27, v27, v59
    v_cvt_pk_bf16_f32 v104, v8, v9
    v_cvt_pk_bf16_f32 v105, v10, v11
    v_cvt_pk_bf16_f32 v106, v24, v25
    v_cvt_pk_bf16_f32 v107, v26, v27
    s_add_u32 s63, s41, 135168
    v_cvt_pk_bf16_f32 v13, v12, v13
    v_lshlrev_b32 v12, 16, v13
    v_and_b32 v13, 0xffff0000, v13
    v_cvt_pk_bf16_f32 v45, v44, v45
    v_lshlrev_b32 v44, 16, v45
    v_and_b32 v45, 0xffff0000, v45
    v_cvt_pk_bf16_f32 v15, v14, v15
    v_lshlrev_b32 v14, 16, v15
    v_and_b32 v15, 0xffff0000, v15
    v_cvt_pk_bf16_f32 v47, v46, v47
    v_lshlrev_b32 v46, 16, v47
    v_and_b32 v47, 0xffff0000, v47
    v_cmp_lt_f32 vcc, 0, v12
    v_mul_f32 v127, 0, v12
    s_nop 0
    v_cndmask_b32 v12, v127, v12, vcc
    v_mul_f32 v12, v12, v44
    v_cmp_lt_f32 vcc, 0, v13
    v_mul_f32 v127, 0, v13
    s_nop 0
    v_cndmask_b32 v13, v127, v13, vcc
    v_mul_f32 v13, v13, v45
    v_cmp_lt_f32 vcc, 0, v14
    v_mul_f32 v127, 0, v14
    s_nop 0
    v_cndmask_b32 v14, v127, v14, vcc
    v_mul_f32 v14, v14, v46
    v_cmp_lt_f32 vcc, 0, v15
    v_mul_f32 v127, 0, v15
    s_nop 0
    v_cndmask_b32 v15, v127, v15, vcc
    v_mul_f32 v15, v15, v47
    v_cvt_pk_bf16_f32 v29, v28, v29
    v_lshlrev_b32 v28, 16, v29
    v_and_b32 v29, 0xffff0000, v29
    v_cvt_pk_bf16_f32 v61, v60, v61
    v_lshlrev_b32 v60, 16, v61
    v_and_b32 v61, 0xffff0000, v61
    v_cvt_pk_bf16_f32 v31, v30, v31
    v_lshlrev_b32 v30, 16, v31
    v_and_b32 v31, 0xffff0000, v31
    v_cvt_pk_bf16_f32 v63, v62, v63
    v_lshlrev_b32 v62, 16, v63
    v_and_b32 v63, 0xffff0000, v63
    v_cmp_lt_f32 vcc, 0, v28
    v_mul_f32 v127, 0, v28
    s_nop 0
    v_cndmask_b32 v28, v127, v28, vcc
    v_mul_f32 v28, v28, v60
    v_cmp_lt_f32 vcc, 0, v29
    v_mul_f32 v127, 0, v29
    s_nop 0
    v_cndmask_b32 v29, v127, v29, vcc
    v_mul_f32 v29, v29, v61
    v_cmp_lt_f32 vcc, 0, v30
    v_mul_f32 v127, 0, v30
    s_nop 0
    v_cndmask_b32 v30, v127, v30, vcc
    v_mul_f32 v30, v30, v62
    v_cmp_lt_f32 vcc, 0, v31
    v_mul_f32 v127, 0, v31
    s_nop 0
    v_cndmask_b32 v31, v127, v31, vcc
    v_mul_f32 v31, v31, v63
    v_cvt_pk_bf16_f32 v108, v12, v13
    v_cvt_pk_bf16_f32 v109, v14, v15
    v_cvt_pk_bf16_f32 v110, v28, v29
    v_cvt_pk_bf16_f32 v111, v30, v31
    s_lshl_b32 s42, s25, 7
    s_add_u32 s28, s42, s27
    s_mov_b32 s25, s40
    s_cmp_lt_u32 s25, 32
    s_cbranch_scc1 GL_57
GE_58:
    buffer_store_dwordx4 v[96:99], v130, s[4:7], s60 offen offset:0 sc1
    buffer_store_dwordx4 v[100:103], v130, s[4:7], s61 offen offset:0 sc1
    buffer_store_dwordx4 v[104:107], v130, s[4:7], s62 offen offset:0 sc1
    buffer_store_dwordx4 v[108:111], v130, s[4:7], s63 offen offset:0 sc1
    s_waitcnt vmcnt(0)
    s_barrier
    s_cmp_lt_i32 s43, 0
    s_cbranch_scc1 GF_61
    buffer_store_dwordx2 v[254:255], v253, s[4:7], s43 offen sc1
GF_61:
    buffer_store_dwordx2 v[254:255], v253, s[4:7], s28 offen sc1
    s_cmp_lt_u32 s20, 32
    s_cbranch_scc0 WS2_16
    s_mov_b32 s40, 94503680
WF_62:
    buffer_load_dwordx2 v[10:11], v252, s[4:7], s40 offen offset:0 sc1
    s_waitcnt vmcnt(0)
    v_cmp_ne_u64 vcc, s[38:39], v[10:11]
    s_cbranch_vccz WK_63
    s_sub_u32 s30, s30, 1
    s_cbranch_scc1 L_FAIL
    s_sleep 32
    s_branch WF_62
WK_63:
    s_load_dwordx2 s[56:57], s[0:1], 40
    s_mov_b32 s58, 4194304
    s_mov_b32 s59, 0x20000
    s_waitcnt lgkmcnt(0)
    s_load_dwordx2 s[12:13], s[0:1], 80
    s_mov_b32 s14, 1409024
    s_mov_b32 s15, 0x20000
    s_waitcnt lgkmcnt(0)
    s_sub_u32 s68, s20, 0
    s_mul_i32 s72, s21, 24576
    s_add_u32 s72, s72, 65536
    v_lshrrev_b32 v1, 2, v250
    v_and_b32 v2, 3, v250
    v_lshlrev_b32 v2, 4, v2
    s_mov_b32 s35, 1024
    v_mul_lo_u32 v3, v1, s35
    v_add_u32 v3, v3, v2
    v_lshrrev_b32 v6, 4, v250
    v_lshlrev_b32 v6, 3, v6
    v_and_b32 v1, 3, v1
    v_add_u32 v6, v6, v1
    v_lshlrev_b32 v6, 6, v6
    v_add_u32 v6, v6, v2
    v_add_u32 v6, s72, v6
    s_lshl_b32 s70, s68, 16
    s_lshr_b32 s69, s68, 4
    s_and_b32 s41, s68, 15
    s_lshl_b32 s41, s41, 12
    s_lshl_b32 s42, s21, 8
    s_add_u32 s70, s70, s42
    s_lshl_b32 s73, s21, 4
    s_add_u32 s73, s73, s69
    s_mul_i32 s73, s73, 90112
    s_add_u32 s73, s73, s41
    s_add_u32 s73, s73, 77594624
    s_add_u32 m0, s72, 0
    s_add_u32 s35, s70, 0
    buffer_load_dwordx4 v3, s[56:59], s35 offen  lds
    s_add_u32 m0, s72, 1024
    s_add_u32 s35, s70, 16384
    buffer_load_dwordx4 v3, s[56:59], s35 offen  lds
    s_add_u32 m0, s72, 2048
    s_add_u32 s35, s70, 32768
    buffer_load_dwordx4 v3, s[56:59], s35 offen  lds
    s_add_u32 m0, s72, 3072
    s_add_u32 s35, s70, 49152
    buffer_load_dwordx4 v3, s[56:59], s35 offen  lds
    s_add_u32 m0, s72, 4096
    s_add_u32 s35, s70, 64
    buffer_load_dwordx4 v3, s[56:59], s35 offen  lds
    s_add_u32 m0, s72, 5120
    s_add_u32 s35, s70, 16448
    buffer_load_dwordx4 v3, s[56:59], s35 offen  lds
    s_add_u32 m0, s72, 6144
    s_add_u32 s35, s70, 32832
    buffer_load_dwordx4 v3, s[56:59], s35 offen  lds
    s_add_u32 m0, s72, 7168
    s_add_u32 s35, s70, 49216
    buffer_load_dwordx4 v3, s[56:59], s35 offen  lds
    s_add_u32 m0, s72, 8192
    s_add_u32 s35, s70, 128
    buffer_load_dwordx4 v3, s[56:59], s35 offen  lds
    s_add_u32 m0, s72, 9216
    s_add_u32 s35, s70, 16512
    buffer_load_dwordx4 v3, s[56:59], s35 offen  lds
    s_add_u32 m0, s72, 10240
    s_add_u32 s35, s70, 32896
    buffer_load_dwordx4 v3, s[56:59], s35 offen  lds
    s_add_u32 m0, s72, 11264
    s_add_u32 s35, s70, 49280
    buffer_load_dwordx4 v3, s[56:59], s35 offen  lds
    s_add_u32 m0, s72, 12288
    s_add_u32 s35, s70, 192
    buffer_load_dwordx4 v3, s[56:59], s35 offen  lds
    s_add_u32 m0, s72, 13312
    s_add_u32 s35, s70, 16576
    buffer_load_dwordx4 v3, s[56:59], s35 offen  lds
    s_add_u32 m0, s72, 14336
    s_add_u32 s35, s70, 32960
    buffer_load_dwordx4 v3, s[56:59], s35 offen  lds
    s_add_u32 m0, s72, 15360
    s_add_u32 s35, s70, 49344
    buffer_load_dwordx4 v3, s[56:59], s35 offen  lds
    s_waitcnt vmcnt(12)
    ds_read_b64_tr_b16 v[8:9], v6 offset:0
    ds_read_b64_tr_b16 v[10:11], v6 offset:256
    ds_read_b64_tr_b16 v[16:17], v6 offset:2048
    ds_read_b64_tr_b16 v[18:19], v6 offset:2304
    ds_read_b64_tr_b16 v[12:13], v6 offset:8
    ds_read_b64_tr_b16 v[14:15], v6 offset:264
    ds_read_b64_tr_b16 v[20:21], v6 offset:2056
    ds_read_b64_tr_b16 v[22:23], v6 offset:2312
    s_waitcnt lgkmcnt(0)
    s_waitcnt vmcnt(8)
    ds_read_b64_tr_b16 v[24:25], v6 offset:4096
    ds_read_b64_tr_b16 v[26:27], v6 offset:4352
    ds_read_b64_tr_b16 v[32:33], v6 offset:6144
    ds_read_b64_tr_b16 v[34:35], v6 offset:6400
    ds_read_b64_tr_b16 v[28:29], v6 offset:4104
    ds_read_b64_tr_b16 v[30:31], v6 offset:4360
    ds_read_b64_tr_b16 v[36:37], v6 offset:6152
    ds_read_b64_tr_b16 v[38:39], v6 offset:6408
    s_waitcnt lgkmcnt(0)
    s_waitcnt vmcnt(4)
    ds_read_b64_tr_b16 v[40:41], v6 offset:8192
    ds_read_b64_tr_b16 v[42:43], v6 offset:8448
    ds_read_b64_tr_b16 v[48:49], v6 offset:10240
    ds_read_b64_tr_b16 v[50:51], v6 offset:10496
    ds_read_b64_tr_b16 v[44:45], v6 offset:8200
    ds_read_b64_tr_b16 v[46:47], v6 offset:8456
    ds_read_b64_tr_b16 v[52:53], v6 offset:10248
    ds_read_b64_tr_b16 v[54:55], v6 offset:10504
    s_waitcnt lgkmcnt(0)
    s_waitcnt vmcnt(0)
    ds_read_b64_tr_b16 v[56:57], v6 offset:12288
    ds_read_b64_tr_b16 v[58:59], v6 offset:12544
    ds_read_b64_tr_b16 v[64:65], v6 offset:14336
    ds_read_b64_tr_b16 v[66:67], v6 offset:14592
    ds_read_b64_tr_b16 v[60:61], v6 offset:12296
    ds_read_b64_tr_b16 v[62:63], v6 offset:12552
    ds_read_b64_tr_b16 v[68:69], v6 offset:14344
    ds_read_b64_tr_b16 v[70:71], v6 offset:14600
    s_waitcnt lgkmcnt(0)
    buffer_store_dwordx4 v[8:11], v251, s[4:7], s73 offen offset:0 sc1
    buffer_store_dwordx4 v[12:15], v251, s[4:7], s73 offen offset:1024 sc1
    buffer_store_dwordx4 v[16:19], v251, s[4:7], s73 offen offset:2048 sc1
    buffer_store_dwordx4 v[20:23], v251, s[4:7], s73 offen offset:3072 sc1
    s_add_u32 s73, s73, 360448
    buffer_store_dwordx4 v[24:27], v251, s[4:7], s73 offen offset:0 sc1
    buffer_store_dwordx4 v[28:31], v251, s[4:7], s73 offen offset:1024 sc1
    buffer_store_dwordx4 v[32:35], v251, s[4:7], s73 offen offset:2048 sc1
    buffer_store_dwordx4 v[36:39], v251, s[4:7], s73 offen offset:3072 sc1
    s_add_u32 s73, s73, 360448
    buffer_store_dwordx4 v[40:43], v251, s[4:7], s73 offen offset:0 sc1
    buffer_store_dwordx4 v[44:47], v251, s[4:7], s73 offen offset:1024 sc1
    buffer_store_dwordx4 v[48:51], v251, s[4:7], s73 offen offset:2048 sc1
    buffer_store_dwordx4 v[52:55], v251, s[4:7], s73 offen offset:3072 sc1
    s_add_u32 s73, s73, 360448
    buffer_store_dwordx4 v[56:59], v251, s[4:7], s73 offen offset:0 sc1
    buffer_store_dwordx4 v[60:63], v251, s[4:7], s73 offen offset:1024 sc1
    buffer_store_dwordx4 v[64:67], v251, s[4:7], s73 offen offset:2048 sc1
    buffer_store_dwordx4 v[68:71], v251, s[4:7], s73 offen offset:3072 sc1
    s_add_u32 s41, s68, 32
    s_lshl_b32 s70, s41, 16
    s_lshr_b32 s69, s41, 4
    s_and_b32 s41, s41, 15
    s_lshl_b32 s41, s41, 12
    s_lshl_b32 s42, s21, 8
    s_add_u32 s70, s70, s42
    s_lshl_b32 s73, s21, 4
    s_add_u32 s73, s73, s69
    s_mul_i32 s73, s73, 90112
    s_add_u32 s73, s73, s41
    s_add_u32 s73, s73, 77594624
    s_add_u32 m0, s72, 0
    s_add_u32 s35, s70, 0
    buffer_load_dwordx4 v3, s[56:59], s35 offen  lds
    s_add_u32 m0, s72, 1024
    s_add_u32 s35, s70, 16384
    buffer_load_dwordx4 v3, s[56:59], s35 offen  lds
    s_add_u32 m0, s72, 2048
    s_add_u32 s35, s70, 32768
    buffer_load_dwordx4 v3, s[56:59], s35 offen  lds
    s_add_u32 m0, s72, 3072
    s_add_u32 s35, s70, 49152
    buffer_load_dwordx4 v3, s[56:59], s35 offen  lds
    s_add_u32 m0, s72, 4096
    s_add_u32 s35, s70, 64
    buffer_load_dwordx4 v3, s[56:59], s35 offen  lds
    s_add_u32 m0, s72, 5120
    s_add_u32 s35, s70, 16448
    buffer_load_dwordx4 v3, s[56:59], s35 offen  lds
    s_add_u32 m0, s72, 6144
    s_add_u32 s35, s70, 32832
    buffer_load_dwordx4 v3, s[56:59], s35 offen  lds
    s_add_u32 m0, s72, 7168
    s_add_u32 s35, s70, 49216
    buffer_load_dwordx4 v3, s[56:59], s35 offen  lds
    s_add_u32 m0, s72, 8192
    s_add_u32 s35, s70, 128
    buffer_load_dwordx4 v3, s[56:59], s35 offen  lds
    s_add_u32 m0, s72, 9216
    s_add_u32 s35, s70, 16512
    buffer_load_dwordx4 v3, s[56:59], s35 offen  lds
    s_add_u32 m0, s72, 10240
    s_add_u32 s35, s70, 32896
    buffer_load_dwordx4 v3, s[56:59], s35 offen  lds
    s_add_u32 m0, s72, 11264
    s_add_u32 s35, s70, 49280
    buffer_load_dwordx4 v3, s[56:59], s35 offen  lds
    s_add_u32 m0, s72, 12288
    s_add_u32 s35, s70, 192
    buffer_load_dwordx4 v3, s[56:59], s35 offen  lds
    s_add_u32 m0, s72, 13312
    s_add_u32 s35, s70, 16576
    buffer_load_dwordx4 v3, s[56:59], s35 offen  lds
    s_add_u32 m0, s72, 14336
    s_add_u32 s35, s70, 32960
    buffer_load_dwordx4 v3, s[56:59], s35 offen  lds
    s_add_u32 m0, s72, 15360
    s_add_u32 s35, s70, 49344
    buffer_load_dwordx4 v3, s[56:59], s35 offen  lds
    s_waitcnt vmcnt(12)
    ds_read_b64_tr_b16 v[8:9], v6 offset:0
    ds_read_b64_tr_b16 v[10:11], v6 offset:256
    ds_read_b64_tr_b16 v[16:17], v6 offset:2048
    ds_read_b64_tr_b16 v[18:19], v6 offset:2304
    ds_read_b64_tr_b16 v[12:13], v6 offset:8
    ds_read_b64_tr_b16 v[14:15], v6 offset:264
    ds_read_b64_tr_b16 v[20:21], v6 offset:2056
    ds_read_b64_tr_b16 v[22:23], v6 offset:2312
    s_waitcnt lgkmcnt(0)
    s_waitcnt vmcnt(8)
    ds_read_b64_tr_b16 v[24:25], v6 offset:4096
    ds_read_b64_tr_b16 v[26:27], v6 offset:4352
    ds_read_b64_tr_b16 v[32:33], v6 offset:6144
    ds_read_b64_tr_b16 v[34:35], v6 offset:6400
    ds_read_b64_tr_b16 v[28:29], v6 offset:4104
    ds_read_b64_tr_b16 v[30:31], v6 offset:4360
    ds_read_b64_tr_b16 v[36:37], v6 offset:6152
    ds_read_b64_tr_b16 v[38:39], v6 offset:6408
    s_waitcnt lgkmcnt(0)
    s_waitcnt vmcnt(4)
    ds_read_b64_tr_b16 v[40:41], v6 offset:8192
    ds_read_b64_tr_b16 v[42:43], v6 offset:8448
    ds_read_b64_tr_b16 v[48:49], v6 offset:10240
    ds_read_b64_tr_b16 v[50:51], v6 offset:10496
    ds_read_b64_tr_b16 v[44:45], v6 offset:8200
    ds_read_b64_tr_b16 v[46:47], v6 offset:8456
    ds_read_b64_tr_b16 v[52:53], v6 offset:10248
    ds_read_b64_tr_b16 v[54:55], v6 offset:10504
    s_waitcnt lgkmcnt(0)
    s_waitcnt vmcnt(0)
    ds_read_b64_tr_b16 v[56:57], v6 offset:12288
    ds_read_b64_tr_b16 v[58:59], v6 offset:12544
    ds_read_b64_tr_b16 v[64:65], v6 offset:14336
    ds_read_b64_tr_b16 v[66:67], v6 offset:14592
    ds_read_b64_tr_b16 v[60:61], v6 offset:12296
    ds_read_b64_tr_b16 v[62:63], v6 offset:12552
    ds_read_b64_tr_b16 v[68:69], v6 offset:14344
    ds_read_b64_tr_b16 v[70:71], v6 offset:14600
    s_waitcnt lgkmcnt(0)
    buffer_store_dwordx4 v[8:11], v251, s[4:7], s73 offen offset:0 sc1
    buffer_store_dwordx4 v[12:15], v251, s[4:7], s73 offen offset:1024 sc1
    buffer_store_dwordx4 v[16:19], v251, s[4:7], s73 offen offset:2048 sc1
    buffer_store_dwordx4 v[20:23], v251, s[4:7], s73 offen offset:3072 sc1
    s_add_u32 s73, s73, 360448
    buffer_store_dwordx4 v[24:27], v251, s[4:7], s73 offen offset:0 sc1
    buffer_store_dwordx4 v[28:31], v251, s[4:7], s73 offen offset:1024 sc1
    buffer_store_dwordx4 v[32:35], v251, s[4:7], s73 offen offset:2048 sc1
    buffer_store_dwordx4 v[36:39], v251, s[4:7], s73 offen offset:3072 sc1
    s_add_u32 s73, s73, 360448
    buffer_store_dwordx4 v[40:43], v251, s[4:7], s73 offen offset:0 sc1
    buffer_store_dwordx4 v[44:47], v251, s[4:7], s73 offen offset:1024 sc1
    buffer_store_dwordx4 v[48:51], v251, s[4:7], s73 offen offset:2048 sc1
    buffer_store_dwordx4 v[52:55], v251, s[4:7], s73 offen offset:3072 sc1
    s_add_u32 s73, s73, 360448
    buffer_store_dwordx4 v[56:59], v251, s[4:7], s73 offen offset:0 sc1
    buffer_store_dwordx4 v[60:63], v251, s[4:7], s73 offen offset:1024 sc1
    buffer_store_dwordx4 v[64:67], v251, s[4:7], s73 offen offset:2048 sc1
    buffer_store_dwordx4 v[68:71], v251, s[4:7], s73 offen offset:3072 sc1
    s_cmp_ge_u32 s68, 24
    s_cbranch_scc1 PW_64
    s_and_b32 s69, s68, 3
    s_lshr_b32 s41, s68, 2
    s_mul_i32 s70, s69, 360448
    s_lshl_b32 s42, s41, 16
    s_add_u32 s70, s70, s42
    s_lshl_b32 s41, s41, 12
    s_add_u32 s41, s41, 65536
    s_lshl_b32 s42, s21, 8
    s_add_u32 s70, s70, s42
    s_lshl_b32 s73, s21, 4
    s_add_u32 s73, s73, s69
    s_mul_i32 s73, s73, 90112
    s_add_u32 s73, s73, s41
    s_add_u32 s73, s73, 77594624
    s_add_u32 m0, s72, 0
    s_add_u32 s35, s70, 0
    buffer_load_dwordx4 v3, s[12:15], s35 offen  lds
    s_add_u32 m0, s72, 1024
    s_add_u32 s35, s70, 16384
    buffer_load_dwordx4 v3, s[12:15], s35 offen  lds
    s_add_u32 m0, s72, 2048
    s_add_u32 s35, s70, 32768
    buffer_load_dwordx4 v3, s[12:15], s35 offen  lds
    s_add_u32 m0, s72, 3072
    s_add_u32 s35, s70, 49152
    buffer_load_dwordx4 v3, s[12:15], s35 offen  lds
    s_add_u32 m0, s72, 4096
    s_add_u32 s35, s70, 64
    buffer_load_dwordx4 v3, s[12:15], s35 offen  lds
    s_add_u32 m0, s72, 5120
    s_add_u32 s35, s70, 16448
    buffer_load_dwordx4 v3, s[12:15], s35 offen  lds
    s_add_u32 m0, s72, 6144
    s_add_u32 s35, s70, 32832
    buffer_load_dwordx4 v3, s[12:15], s35 offen  lds
    s_add_u32 m0, s72, 7168
    s_add_u32 s35, s70, 49216
    buffer_load_dwordx4 v3, s[12:15], s35 offen  lds
    s_add_u32 m0, s72, 8192
    s_add_u32 s35, s70, 128
    buffer_load_dwordx4 v3, s[12:15], s35 offen  lds
    s_add_u32 m0, s72, 9216
    s_add_u32 s35, s70, 16512
    buffer_load_dwordx4 v3, s[12:15], s35 offen  lds
    s_add_u32 m0, s72, 10240
    s_add_u32 s35, s70, 32896
    buffer_load_dwordx4 v3, s[12:15], s35 offen  lds
    s_add_u32 m0, s72, 11264
    s_add_u32 s35, s70, 49280
    buffer_load_dwordx4 v3, s[12:15], s35 offen  lds
    s_add_u32 m0, s72, 12288
    s_add_u32 s35, s70, 192
    buffer_load_dwordx4 v3, s[12:15], s35 offen  lds
    s_add_u32 m0, s72, 13312
    s_add_u32 s35, s70, 16576
    buffer_load_dwordx4 v3, s[12:15], s35 offen  lds
    s_add_u32 m0, s72, 14336
    s_add_u32 s35, s70, 32960
    buffer_load_dwordx4 v3, s[12:15], s35 offen  lds
    s_add_u32 m0, s72, 15360
    s_add_u32 s35, s70, 49344
    buffer_load_dwordx4 v3, s[12:15], s35 offen  lds
    s_waitcnt vmcnt(12)
    ds_read_b64_tr_b16 v[8:9], v6 offset:0
    ds_read_b64_tr_b16 v[10:11], v6 offset:256
    ds_read_b64_tr_b16 v[16:17], v6 offset:2048
    ds_read_b64_tr_b16 v[18:19], v6 offset:2304
    ds_read_b64_tr_b16 v[12:13], v6 offset:8
    ds_read_b64_tr_b16 v[14:15], v6 offset:264
    ds_read_b64_tr_b16 v[20:21], v6 offset:2056
    ds_read_b64_tr_b16 v[22:23], v6 offset:2312
    s_waitcnt lgkmcnt(0)
    s_waitcnt vmcnt(8)
    ds_read_b64_tr_b16 v[24:25], v6 offset:4096
    ds_read_b64_tr_b16 v[26:27], v6 offset:4352
    ds_read_b64_tr_b16 v[32:33], v6 offset:6144
    ds_read_b64_tr_b16 v[34:35], v6 offset:6400
    ds_read_b64_tr_b16 v[28:29], v6 offset:4104
    ds_read_b64_tr_b16 v[30:31], v6 offset:4360
    ds_read_b64_tr_b16 v[36:37], v6 offset:6152
    ds_read_b64_tr_b16 v[38:39], v6 offset:6408
    s_waitcnt lgkmcnt(0)
    s_waitcnt vmcnt(4)
    ds_read_b64_tr_b16 v[40:41], v6 offset:8192
    ds_read_b64_tr_b16 v[42:43], v6 offset:8448
    ds_read_b64_tr_b16 v[48:49], v6 offset:10240
    ds_read_b64_tr_b16 v[50:51], v6 offset:10496
    ds_read_b64_tr_b16 v[44:45], v6 offset:8200
    ds_read_b64_tr_b16 v[46:47], v6 offset:8456
    ds_read_b64_tr_b16 v[52:53], v6 offset:10248
    ds_read_b64_tr_b16 v[54:55], v6 offset:10504
    s_waitcnt lgkmcnt(0)
    s_waitcnt vmcnt(0)
    ds_read_b64_tr_b16 v[56:57], v6 offset:12288
    ds_read_b64_tr_b16 v[58:59], v6 offset:12544
    ds_read_b64_tr_b16 v[64:65], v6 offset:14336
    ds_read_b64_tr_b16 v[66:67], v6 offset:14592
    ds_read_b64_tr_b16 v[60:61], v6 offset:12296
    ds_read_b64_tr_b16 v[62:63], v6 offset:12552
    ds_read_b64_tr_b16 v[68:69], v6 offset:14344
    ds_read_b64_tr_b16 v[70:71], v6 offset:14600
    s_waitcnt lgkmcnt(0)
    buffer_store_dwordx4 v[8:11], v251, s[4:7], s73 offen offset:0 sc1
    buffer_store_dwordx4 v[12:15], v251, s[4:7], s73 offen offset:1024 sc1
    buffer_store_dwordx4 v[16:19], v251, s[4:7], s73 offen offset:2048 sc1
    buffer_store_dwordx4 v[20:23], v251, s[4:7], s73 offen offset:3072 sc1
    s_add_u32 s73, s73, 360448
    buffer_store_dwordx4 v[24:27], v251, s[4:7], s73 offen offset:0 sc1
    buffer_store_dwordx4 v[28:31], v251, s[4:7], s73 offen offset:1024 sc1
    buffer_store_dwordx4 v[32:35], v251, s[4:7], s73 offen offset:2048 sc1
    buffer_store_dwordx4 v[36:39], v251, s[4:7], s73 offen offset:3072 sc1
    s_add_u32 s73, s73, 360448
    buffer_store_dwordx4 v[40:43], v251, s[4:7], s73 offen offset:0 sc1
    buffer_store_dwordx4 v[44:47], v251, s[4:7], s73 offen offset:1024 sc1
    buffer_store_dwordx4 v[48:51], v251, s[4:7], s73 offen offset:2048 sc1
    buffer_store_dwordx4 v[52:55], v251, s[4:7], s73 offen offset:3072 sc1
    s_add_u32 s73, s73, 360448
    buffer_store_dwordx4 v[56:59], v251, s[4:7], s73 offen offset:0 sc1
    buffer_store_dwordx4 v[60:63], v251, s[4:7], s73 offen offset:1024 sc1
    buffer_store_dwordx4 v[64:67], v251, s[4:7], s73 offen offset:2048 sc1
    buffer_store_dwordx4 v[68:71], v251, s[4:7], s73 offen offset:3072 sc1
PW_64:
    s_lshl_b32 s41, s68, 7
    s_add_u32 s41, s41, 94420992
    s_waitcnt vmcnt(0)
    s_barrier
    buffer_store_dwordx2 v[254:255], v253, s[4:7], s41 offen sc1
    s_branch L_END
WS2_16:
    s_sub_u32 s40, s20, 128
    s_and_b32 s22, s40, 15
    s_lshr_b32 s23, s40, 4
    s_barrier
    s_load_dwordx2 s[8:9], s[0:1], 40
    s_mov_b32 s10, 4194304
    s_mov_b32 s11, 0x20000
    s_waitcnt lgkmcnt(0)
    s_load_dwordx2 s[12:13], s[0:1], 80
    s_mov_b32 s14, 1409024
    s_mov_b32 s15, 0x20000
    s_waitcnt lgkmcnt(0)
    s_load_dwordx2 s[52:53], s[0:1], 0
    s_mov_b32 s54, 2097152
    s_mov_b32 s55, 0x20000
    s_waitcnt lgkmcnt(0)
    s_load_dwordx2 s[56:57], s[0:1], 88
    s_mov_b32 s58, 2097152
    s_mov_b32 s59, 0x20000
    s_waitcnt lgkmcnt(0)
    s_lshl_b32 s40, s21, 15
    s_lshl_b32 s41, s22, 6
    s_lshl_b32 s42, s21, 20
    s_add_u32 s42, s42, s41
    s_mul_i32 s44, s21, 360448
    s_add_u32 s44, s44, s41
    s_lshr_b32 s65, s22, 1
    s_mul_i32 s65, s65, 1
    s_lshl_b32 s43, s65, 17
    s_lshl_b32 s65, s65, 12
    v_and_b32 v1, 31, v250
    v_lshlrev_b32 v1, 7, v1
    s_mov_b32 s42, 94420992
    v_add_u32 v7, s40, v251
WF_65:
    buffer_load_dwordx2 v[4:5], v1, s[4:7], s42 offen offset:0 sc1
    s_waitcnt vmcnt(0)
    v_cmp_ne_u64 vcc, s[38:39], v[4:5]
    s_cbranch_vccz WK_66
    s_sub_u32 s30, s30, 1
    s_cbranch_scc1 L_FAIL
    s_sleep 16
    s_branch WF_65
WK_66:
    s_lshl_b32 s42, s22, 2
    s_add_u32 s42, s42, s21
    s_mul_i32 s42, s42, 90112
    s_add_u32 s42, s42, 77594624
    s_lshl_b32 s43, s65, 1
    s_add_u32 m0, s40, 0
    s_add_u32 s35, s42, 65536
    buffer_load_dwordx4 v251, s[4:7], s35 offen sc1 lds
    s_add_u32 m0, s40, 1024
    s_add_u32 s35, s42, 66560
    buffer_load_dwordx4 v251, s[4:7], s35 offen sc1 lds
    s_add_u32 m0, s40, 2048
    s_add_u32 s35, s42, 67584
    buffer_load_dwordx4 v251, s[4:7], s35 offen sc1 lds
    s_add_u32 m0, s40, 3072
    s_add_u32 s35, s42, 68608
    buffer_load_dwordx4 v251, s[4:7], s35 offen sc1 lds
    s_add_u32 m0, s40, 4096
    s_add_u32 s35, s42, 69632
    buffer_load_dwordx4 v251, s[4:7], s35 offen sc1 lds
    s_add_u32 m0, s40, 5120
    s_add_u32 s35, s42, 70656
    buffer_load_dwordx4 v251, s[4:7], s35 offen sc1 lds
    s_add_u32 m0, s40, 6144
    s_add_u32 s35, s42, 71680
    buffer_load_dwordx4 v251, s[4:7], s35 offen sc1 lds
    s_add_u32 m0, s40, 7168
    s_add_u32 s35, s42, 72704
    buffer_load_dwordx4 v251, s[4:7], s35 offen sc1 lds
    s_add_u32 m0, s40, 8192
    s_add_u32 s35, s42, 73728
    buffer_load_dwordx4 v251, s[4:7], s35 offen sc1 lds
    s_add_u32 m0, s40, 9216
    s_add_u32 s35, s42, 74752
    buffer_load_dwordx4 v251, s[4:7], s35 offen sc1 lds
    s_add_u32 m0, s40, 10240
    s_add_u32 s35, s42, 75776
    buffer_load_dwordx4 v251, s[4:7], s35 offen sc1 lds
    s_add_u32 m0, s40, 11264
    s_add_u32 s35, s42, 76800
    buffer_load_dwordx4 v251, s[4:7], s35 offen sc1 lds
    s_add_u32 m0, s40, 12288
    s_add_u32 s35, s42, 77824
    buffer_load_dwordx4 v251, s[4:7], s35 offen sc1 lds
    s_add_u32 m0, s40, 13312
    s_add_u32 s35, s42, 78848
    buffer_load_dwordx4 v251, s[4:7], s35 offen sc1 lds
    s_add_u32 m0, s40, 14336
    s_add_u32 s35, s42, 79872
    buffer_load_dwordx4 v251, s[4:7], s35 offen sc1 lds
    s_add_u32 m0, s40, 15360
    s_add_u32 s35, s42, 80896
    buffer_load_dwordx4 v251, s[4:7], s35 offen sc1 lds
    s_add_u32 m0, s40, 16384
    s_add_u32 s35, s42, 81920
    buffer_load_dwordx4 v251, s[4:7], s35 offen sc1 lds
    s_add_u32 m0, s40, 17408
    s_add_u32 s35, s42, 82944
    buffer_load_dwordx4 v251, s[4:7], s35 offen sc1 lds
    s_add_u32 m0, s40, 18432
    s_add_u32 s35, s42, 83968
    buffer_load_dwordx4 v251, s[4:7], s35 offen sc1 lds
    s_add_u32 m0, s40, 19456
    s_add_u32 s35, s42, 84992
    buffer_load_dwordx4 v251, s[4:7], s35 offen sc1 lds
    s_add_u32 m0, s40, 20480
    s_add_u32 s35, s42, 86016
    buffer_load_dwordx4 v251, s[4:7], s35 offen sc1 lds
    s_add_u32 m0, s40, 21504
    s_add_u32 s35, s42, 87040
    buffer_load_dwordx4 v251, s[4:7], s35 offen sc1 lds
    s_add_u32 s35, s43, 0
    s_and_b32 s35, s35, 0xffff
    s_add_u32 s35, s35, s42
    buffer_load_dwordx4 a[0:3], v251, s[4:7], s35 offen offset:0 sc1
    buffer_load_dwordx4 a[128:131], v251, s[4:7], s35 offen offset:1024 sc1
    buffer_load_dwordx4 a[4:7], v251, s[4:7], s35 offen offset:2048 sc1
    buffer_load_dwordx4 a[132:135], v251, s[4:7], s35 offen offset:3072 sc1
    s_add_u32 s35, s43, 4096
    s_and_b32 s35, s35, 0xffff
    s_add_u32 s35, s35, s42
    buffer_load_dwordx4 a[8:11], v251, s[4:7], s35 offen offset:0 sc1
    buffer_load_dwordx4 a[136:139], v251, s[4:7], s35 offen offset:1024 sc1
    buffer_load_dwordx4 a[12:15], v251, s[4:7], s35 offen offset:2048 sc1
    buffer_load_dwordx4 a[140:143], v251, s[4:7], s35 offen offset:3072 sc1
    s_add_u32 s35, s43, 8192
    s_and_b32 s35, s35, 0xffff
    s_add_u32 s35, s35, s42
    buffer_load_dwordx4 a[16:19], v251, s[4:7], s35 offen offset:0 sc1
    buffer_load_dwordx4 a[144:147], v251, s[4:7], s35 offen offset:1024 sc1
    buffer_load_dwordx4 a[20:23], v251, s[4:7], s35 offen offset:2048 sc1
    buffer_load_dwordx4 a[148:151], v251, s[4:7], s35 offen offset:3072 sc1
    s_add_u32 s35, s43, 12288
    s_and_b32 s35, s35, 0xffff
    s_add_u32 s35, s35, s42
    buffer_load_dwordx4 a[24:27], v251, s[4:7], s35 offen offset:0 sc1
    buffer_load_dwordx4 a[152:155], v251, s[4:7], s35 offen offset:1024 sc1
    buffer_load_dwordx4 a[28:31], v251, s[4:7], s35 offen offset:2048 sc1
    buffer_load_dwordx4 a[156:159], v251, s[4:7], s35 offen offset:3072 sc1
    s_add_u32 s35, s43, 16384
    s_and_b32 s35, s35, 0xffff
    s_add_u32 s35, s35, s42
    buffer_load_dwordx4 a[32:35], v251, s[4:7], s35 offen offset:0 sc1
    buffer_load_dwordx4 a[160:163], v251, s[4:7], s35 offen offset:1024 sc1
    buffer_load_dwordx4 a[36:39], v251, s[4:7], s35 offen offset:2048 sc1
    buffer_load_dwordx4 a[164:167], v251, s[4:7], s35 offen offset:3072 sc1
    s_add_u32 s35, s43, 20480
    s_and_b32 s35, s35, 0xffff
    s_add_u32 s35, s35, s42
    buffer_load_dwordx4 a[40:43], v251, s[4:7], s35 offen offset:0 sc1
    buffer_load_dwordx4 a[168:171], v251, s[4:7], s35 offen offset:1024 sc1
    buffer_load_dwordx4 a[44:47], v251, s[4:7], s35 offen offset:2048 sc1
    buffer_load_dwordx4 a[172:175], v251, s[4:7], s35 offen offset:3072 sc1
    s_add_u32 s35, s43, 24576
    s_and_b32 s35, s35, 0xffff
    s_add_u32 s35, s35, s42
    buffer_load_dwordx4 a[48:51], v251, s[4:7], s35 offen offset:0 sc1
    buffer_load_dwordx4 a[176:179], v251, s[4:7], s35 offen offset:1024 sc1
    buffer_load_dwordx4 a[52:55], v251, s[4:7], s35 offen offset:2048 sc1
    buffer_load_dwordx4 a[180:183], v251, s[4:7], s35 offen offset:3072 sc1
    s_add_u32 s35, s43, 28672
    s_and_b32 s35, s35, 0xffff
    s_add_u32 s35, s35, s42
    buffer_load_dwordx4 a[56:59], v251, s[4:7], s35 offen offset:0 sc1
    buffer_load_dwordx4 a[184:187], v251, s[4:7], s35 offen offset:1024 sc1
    buffer_load_dwordx4 a[60:63], v251, s[4:7], s35 offen offset:2048 sc1
    buffer_load_dwordx4 a[188:191], v251, s[4:7], s35 offen offset:3072 sc1
    s_add_u32 s35, s43, 32768
    s_and_b32 s35, s35, 0xffff
    s_add_u32 s35, s35, s42
    s_waitcnt vmcnt(24)
    buffer_load_dwordx4 a[64:67], v251, s[4:7], s35 offen offset:0 sc1
    buffer_load_dwordx4 a[192:195], v251, s[4:7], s35 offen offset:1024 sc1
    buffer_load_dwordx4 a[68:71], v251, s[4:7], s35 offen offset:2048 sc1
    buffer_load_dwordx4 a[196:199], v251, s[4:7], s35 offen offset:3072 sc1
    s_add_u32 s35, s43, 36864
    s_and_b32 s35, s35, 0xffff
    s_add_u32 s35, s35, s42
    buffer_load_dwordx4 a[72:75], v251, s[4:7], s35 offen offset:0 sc1
    buffer_load_dwordx4 a[200:203], v251, s[4:7], s35 offen offset:1024 sc1
    buffer_load_dwordx4 a[76:79], v251, s[4:7], s35 offen offset:2048 sc1
    buffer_load_dwordx4 a[204:207], v251, s[4:7], s35 offen offset:3072 sc1
    s_add_u32 s35, s43, 40960
    s_and_b32 s35, s35, 0xffff
    s_add_u32 s35, s35, s42
    buffer_load_dwordx4 a[80:83], v251, s[4:7], s35 offen offset:0 sc1
    buffer_load_dwordx4 a[208:211], v251, s[4:7], s35 offen offset:1024 sc1
    buffer_load_dwordx4 a[84:87], v251, s[4:7], s35 offen offset:2048 sc1
    buffer_load_dwordx4 a[212:215], v251, s[4:7], s35 offen offset:3072 sc1
    s_add_u32 s35, s43, 45056
    s_and_b32 s35, s35, 0xffff
    s_add_u32 s35, s35, s42
    buffer_load_dwordx4 a[88:91], v251, s[4:7], s35 offen offset:0 sc1
    buffer_load_dwordx4 a[216:219], v251, s[4:7], s35 offen offset:1024 sc1
    buffer_load_dwordx4 a[92:95], v251, s[4:7], s35 offen offset:2048 sc1
    buffer_load_dwordx4 a[220:223], v251, s[4:7], s35 offen offset:3072 sc1
    s_add_u32 s35, s43, 49152
    s_and_b32 s35, s35, 0xffff
    s_add_u32 s35, s35, s42
    buffer_load_dwordx4 a[96:99], v251, s[4:7], s35 offen offset:0 sc1
    buffer_load_dwordx4 a[224:227], v251, s[4:7], s35 offen offset:1024 sc1
    buffer_load_dwordx4 a[100:103], v251, s[4:7], s35 offen offset:2048 sc1
    buffer_load_dwordx4 a[228:231], v251, s[4:7], s35 offen offset:3072 sc1
    s_add_u32 s35, s43, 53248
    s_and_b32 s35, s35, 0xffff
    s_add_u32 s35, s35, s42
    buffer_load_dwordx4 a[104:107], v251, s[4:7], s35 offen offset:0 sc1
    buffer_load_dwordx4 a[232:235], v251, s[4:7], s35 offen offset:1024 sc1
    buffer_load_dwordx4 a[108:111], v251, s[4:7], s35 offen offset:2048 sc1
    buffer_load_dwordx4 a[236:239], v251, s[4:7], s35 offen offset:3072 sc1
    s_add_u32 s35, s43, 57344
    s_and_b32 s35, s35, 0xffff
    s_add_u32 s35, s35, s42
    buffer_load_dwordx4 a[112:115], v251, s[4:7], s35 offen offset:0 sc1
    buffer_load_dwordx4 a[240:243], v251, s[4:7], s35 offen offset:1024 sc1
    buffer_load_dwordx4 a[116:119], v251, s[4:7], s35 offen offset:2048 sc1
    buffer_load_dwordx4 a[244:247], v251, s[4:7], s35 offen offset:3072 sc1
    s_add_u32 s35, s43, 61440
    s_and_b32 s35, s35, 0xffff
    s_add_u32 s35, s35, s42
    buffer_load_dwordx4 a[120:123], v251, s[4:7], s35 offen offset:0 sc1
    buffer_load_dwordx4 a[248:251], v251, s[4:7], s35 offen offset:1024 sc1
    buffer_load_dwordx4 a[124:127], v251, s[4:7], s35 offen offset:2048 sc1
    buffer_load_dwordx4 a[252:255], v251, s[4:7], s35 offen offset:3072 sc1
    s_waitcnt vmcnt(0)
    v_and_b32 v244, 15, v250
    v_lshlrev_b32 v244, 3, v244
    s_lshl_b32 s40, s21, 7
    v_add_u32 v244, s40, v244
    v_min_u32 v245, 10, v250
    v_lshlrev_b32 v245, 3, v245
    v_and_b32 v1, 15, v250
    v_lshrrev_b32 v2, 4, v250
    v_lshlrev_b32 v1, 10, v1
    v_lshl_add_u32 v1, v2, 4, v1
    s_lshl_b32 s40, s21, 2
    s_add_u32 s40, s40, s41
    v_add_u32 v246, s40, v1
    s_lshl_b32 s40, s21, 12
    s_add_u32 s40, s40, 131072
    v_add_u32 v247, s40, v251
    s_lshr_b32 s40, s21, 1
    s_lshl_b32 s40, s40, 10
    s_and_b32 s42, s21, 1
    s_lshl_b32 s42, s42, 3
    s_add_u32 s40, s40, s42
    s_add_u32 s40, s40, 131072
    v_add_u32 v6, s40, v251
    s_cmp_ge_u32 s23, 4
    s_cselect_b32 s25, 0, 0
    s_add_u32 s25, s25, s23
    s_waitcnt lgkmcnt(0)
    s_cmp_ge_u32 s23, 4
    s_cbranch_scc1 S2E_72
    s_and_b32 s24, s23, 1
    s_add_u32 s24, s24, 126
    s_min_u32 s44, s24, 127
    s_lshr_b32 s42, s44, 2
    s_lshl_b32 s42, s42, 7
    s_add_u32 s42, s42, 94396416
    s_lshl_b32 s43, s44, 9
    s_add_u32 s43, s43, 94437376
WF_74:
    buffer_load_dwordx2 v[4:5], v245, s[4:7], s42 offen offset:0 sc1
    s_waitcnt vmcnt(0)
    v_cmp_ne_u64 vcc, s[38:39], v[4:5]
    s_cbranch_vccz WK_75
    s_sub_u32 s30, s30, 1
    s_cbranch_scc1 L_FAIL
    s_sleep 16
    s_branch WF_74
WK_75:
    s_cmp_lt_u32 s24, 0
    s_cselect_b32 s40, 4, 6
    s_add_u32 s40, s40, s24
    s_min_u32 s44, s40, 127
    s_lshr_b32 s42, s44, 2
    s_lshl_b32 s42, s42, 7
    s_add_u32 s42, s42, 94396416
    s_lshl_b32 s43, s44, 9
    s_add_u32 s43, s43, 94437376
    buffer_load_dwordx2 v[0:1], v245, s[4:7], s42 offen sc1
    buffer_load_dwordx2 v[2:3], v244, s[4:7], s43 offen sc1
    s_mul_i32 s27, s24, 45056
    s_mul_i32 s41, s21, 11264
    s_add_u32 s27, s27, s41
    s_add_u32 s27, s27, 69206016
    s_lshl_b32 s67, s24, 14
    s_lshl_b32 s26, s24, 17
    s_lshl_b32 s41, s21, 15
    s_add_u32 s26, s26, s41
    s_add_u32 s26, s26, 52428800
    buffer_load_dwordx4 v[136:139], v251, s[4:7], s27 offen offset:0 sc1
    buffer_load_dwordx4 v[140:143], v251, s[4:7], s27 offen offset:1024 sc1
    buffer_load_dwordx4 v[144:147], v251, s[4:7], s27 offen offset:2048 sc1
    buffer_load_dwordx4 v[148:151], v251, s[4:7], s27 offen offset:3072 sc1
    s_add_u32 s27, s27, 4096
    buffer_load_dwordx4 v[152:155], v251, s[4:7], s27 offen offset:0 sc1
    buffer_load_dwordx4 v[156:159], v251, s[4:7], s27 offen offset:1024 sc1
    buffer_load_dwordx4 v[160:163], v251, s[4:7], s27 offen offset:2048 sc1
    buffer_load_dwordx4 v[164:167], v251, s[4:7], s27 offen offset:3072 sc1
    s_add_u32 s27, s27, 4096
    buffer_load_dwordx4 v[168:171], v251, s[4:7], s27 offen offset:0 sc1
    buffer_load_dwordx4 v[172:175], v251, s[4:7], s27 offen offset:1024 sc1
    buffer_load_dwordx4 v[176:179], v251, s[4:7], s27 offen offset:2048 sc1
    buffer_load_dword v216, v246, s[52:55], s67 offen
    ds_read_b128 v[180:183], v7 offset:0
    ds_read_b128 v[184:187], v7 offset:1024
    ds_read_b128 v[188:191], v7 offset:2048
    ds_read_b128 v[192:195], v7 offset:3072
    s_waitcnt vmcnt(11) lgkmcnt(2)
    v_mfma_f32_16x16x32_bf16 v[204:207], v[180:183], v[136:139], 0
    v_mfma_f32_16x16x32_bf16 v[208:211], v[184:187], v[136:139], 0
    ds_read_b128 v[180:183], v7 offset:4096
    ds_read_b128 v[184:187], v7 offset:5120
    s_waitcnt vmcnt(10) lgkmcnt(2)
    v_mfma_f32_16x16x32_bf16 v[204:207], v[188:191], v[140:143], v[204:207]
    v_mfma_f32_16x16x32_bf16 v[208:211], v[192:195], v[140:143], v[208:211]
    ds_read_b128 v[188:191], v7 offset:6144
    ds_read_b128 v[192:195], v7 offset:7168
    s_waitcnt vmcnt(9) lgkmcnt(2)
    v_mfma_f32_16x16x32_bf16 v[204:207], v[180:183], v[144:147], v[204:207]
    v_mfma_f32_16x16x32_bf16 v[208:211], v[184:187], v[144:147], v[208:211]
    ds_read_b128 v[180:183], v7 offset:8192
    ds_read_b128 v[184:187], v7 offset:9216
    s_waitcnt vmcnt(8) lgkmcnt(2)
    v_mfma_f32_16x16x32_bf16 v[204:207], v[188:191], v[148:151], v[204:207]
    v_mfma_f32_16x16x32_bf16 v[208:211], v[192:195], v[148:151], v[208:211]
    ds_read_b128 v[188:191], v7 offset:10240
    ds_read_b128 v[192:195], v7 offset:11264
    s_waitcnt vmcnt(7) lgkmcnt(2)
    v_mfma_f32_16x16x32_bf16 v[204:207], v[180:183], v[152:155], v[204:207]
    v_mfma_f32_16x16x32_bf16 v[208:211], v[184:187], v[152:155], v[208:211]
    ds_read_b128 v[180:183], v7 offset:12288
    ds_read_b128 v[184:187], v7 offset:13312
    s_waitcnt vmcnt(6) lgkmcnt(2)
    v_mfma_f32_16x16x32_bf16 v[204:207], v[188:191], v[156:159], v[204:207]
    v_mfma_f32_16x16x32_bf16 v[208:211], v[192:195], v[156:159], v[208:211]
    ds_read_b128 v[188:191], v7 offset:14336
    ds_read_b128 v[192:195], v7 offset:15360
    s_waitcnt vmcnt(5) lgkmcnt(2)
    v_mfma_f32_16x16x32_bf16 v[204:207], v[180:183], v[160:163], v[204:207]
    v_mfma_f32_16x16x32_bf16 v[208:211], v[184:187], v[160:163], v[208:211]
    ds_read_b128 v[180:183], v7 offset:16384
    ds_read_b128 v[184:187], v7 offset:17408
    s_waitcnt vmcnt(4) lgkmcnt(2)
    v_mfma_f32_16x16x32_bf16 v[204:207], v[188:191], v[164:167], v[204:207]
    v_mfma_f32_16x16x32_bf16 v[208:211], v[192:195], v[164:167], v[208:211]
    ds_read_b128 v[188:191], v7 offset:18432
    ds_read_b128 v[192:195], v7 offset:19456
    s_waitcnt vmcnt(3) lgkmcnt(2)
    v_mfma_f32_16x16x32_bf16 v[204:207], v[180:183], v[168:171], v[204:207]
    v_mfma_f32_16x16x32_bf16 v[208:211], v[184:187], v[168:171], v[208:211]
    ds_read_b128 v[180:183], v7 offset:20480
    ds_read_b128 v[184:187], v7 offset:21504
    s_waitcnt vmcnt(2) lgkmcnt(2)
    v_mfma_f32_16x16x32_bf16 v[204:207], v[188:191], v[172:175], v[204:207]
    v_mfma_f32_16x16x32_bf16 v[208:211], v[192:195], v[172:175], v[208:211]
    s_waitcnt vmcnt(1) lgkmcnt(0)
    v_mfma_f32_16x16x32_bf16 v[204:207], v[180:183], v[176:179], v[204:207]
    v_mfma_f32_16x16x32_bf16 v[208:211], v[184:187], v[176:179], v[208:211]
    s_waitcnt vmcnt(0)
    v_mov_b32 v212, v216
    v_mov_b32 v213, v212
    s_nop 5
    ds_write_b128 v7, v[204:207] offset:22528
    ds_write_b128 v7, v[208:211] offset:23552
    v_mov_b32 v220, v251
    s_mov_b32 s24, 0
    s_mov_b32 s26, 268435456
    s_mov_b32 s44, -1
    s_branch S2Y_73
S2E_72:
    v_mov_b64 v[0:1], 0
S2C_67:
    s_min_u32 s44, s25, 127
    s_lshr_b32 s42, s44, 2
    s_lshl_b32 s42, s42, 7
    s_add_u32 s42, s42, 94396416
    s_lshl_b32 s43, s44, 9
    s_add_u32 s43, s43, 94437376
    s_mov_b32 s45, s43
    v_cmp_ne_u64 vcc, s[38:39], v[0:1]
    s_cbranch_vccz S2H_76
WF_77:
    buffer_load_dwordx2 v[4:5], v245, s[4:7], s42 offen offset:0 sc1
    s_waitcnt vmcnt(0)
    v_cmp_ne_u64 vcc, s[38:39], v[4:5]
    s_cbranch_vccz WK_78
    s_sub_u32 s30, s30, 1
    s_cbranch_scc1 L_FAIL
    s_sleep 16
    s_branch WF_77
WK_78:
S2H_76:
    s_cmp_lt_u32 s25, 0
    s_cselect_b32 s40, 4, 6
    s_add_u32 s40, s40, s25
    s_min_u32 s44, s40, 127
    s_lshr_b32 s42, s44, 2
    s_lshl_b32 s42, s42, 7
    s_add_u32 s42, s42, 94396416
    s_lshl_b32 s43, s44, 9
    s_add_u32 s43, s43, 94437376
    buffer_load_dwordx2 v[0:1], v245, s[4:7], s42 offen sc1
    buffer_load_dwordx2 v[2:3], v244, s[4:7], s43 offen sc1
    s_mul_i32 s27, s25, 45056
    s_mul_i32 s41, s21, 11264
    s_add_u32 s27, s27, s41
    s_add_u32 s27, s27, 69206016
    s_lshl_b32 s67, s25, 14
    s_lshl_b32 s26, s25, 17
    s_lshl_b32 s41, s21, 15
    s_add_u32 s26, s26, s41
    s_add_u32 s26, s26, 52428800
    buffer_load_dwordx4 v[136:139], v251, s[4:7], s27 offen offset:0 sc1
    buffer_load_dwordx4 v[140:143], v251, s[4:7], s27 offen offset:1024 sc1
    buffer_load_dwordx4 v[144:147], v251, s[4:7], s27 offen offset:2048 sc1
    buffer_load_dwordx4 v[148:151], v251, s[4:7], s27 offen offset:3072 sc1
    s_add_u32 s27, s27, 4096
    buffer_load_dwordx4 v[152:155], v251, s[4:7], s27 offen offset:0 sc1
    buffer_load_dwordx4 v[156:159], v251, s[4:7], s27 offen offset:1024 sc1
    buffer_load_dwordx4 v[160:163], v251, s[4:7], s27 offen offset:2048 sc1
    buffer_load_dwordx4 v[164:167], v251, s[4:7], s27 offen offset:3072 sc1
    s_add_u32 s27, s27, 4096
    buffer_load_dwordx4 v[168:171], v251, s[4:7], s27 offen offset:0 sc1
    buffer_load_dwordx4 v[172:175], v251, s[4:7], s27 offen offset:1024 sc1
    buffer_load_dwordx4 v[176:179], v251, s[4:7], s27 offen offset:2048 sc1
    buffer_load_dword v216, v246, s[52:55], s67 offen
    ds_read_b128 v[180:183], v7 offset:0
    ds_read_b128 v[184:187], v7 offset:1024
    ds_read_b128 v[188:191], v7 offset:2048
    ds_read_b128 v[192:195], v7 offset:3072
    s_waitcnt vmcnt(11) lgkmcnt(2)
    v_mfma_f32_16x16x32_bf16 v[204:207], v[180:183], v[136:139], 0
    v_mfma_f32_16x16x32_bf16 v[208:211], v[184:187], v[136:139], 0
    ds_read_b128 v[180:183], v7 offset:4096
    ds_read_b128 v[184:187], v7 offset:5120
    s_waitcnt vmcnt(10) lgkmcnt(2)
    v_mfma_f32_16x16x32_bf16 v[204:207], v[188:191], v[140:143], v[204:207]
    v_mfma_f32_16x16x32_bf16 v[208:211], v[192:195], v[140:143], v[208:211]
    ds_read_b128 v[188:191], v7 offset:6144
    ds_read_b128 v[192:195], v7 offset:7168
    s_waitcnt vmcnt(9) lgkmcnt(2)
    v_mfma_f32_16x16x32_bf16 v[204:207], v[180:183], v[144:147], v[204:207]
    v_mfma_f32_16x16x32_bf16 v[208:211], v[184:187], v[144:147], v[208:211]
    ds_read_b128 v[180:183], v7 offset:8192
    ds_read_b128 v[184:187], v7 offset:9216
    s_waitcnt vmcnt(8) lgkmcnt(2)
    v_mfma_f32_16x16x32_bf16 v[204:207], v[188:191], v[148:151], v[204:207]
    v_mfma_f32_16x16x32_bf16 v[208:211], v[192:195], v[148:151], v[208:211]
    ds_read_b128 v[188:191], v7 offset:10240
    ds_read_b128 v[192:195], v7 offset:11264
    s_waitcnt vmcnt(7) lgkmcnt(2)
    v_mfma_f32_16x16x32_bf16 v[204:207], v[180:183], v[152:155], v[204:207]
    v_mfma_f32_16x16x32_bf16 v[208:211], v[184:187], v[152:155], v[208:211]
    ds_read_b128 v[180:183], v7 offset:12288
    ds_read_b128 v[184:187], v7 offset:13312
    s_waitcnt vmcnt(6) lgkmcnt(2)
    v_mfma_f32_16x16x32_bf16 v[204:207], v[188:191], v[156:159], v[204:207]
    v_mfma_f32_16x16x32_bf16 v[208:211], v[192:195], v[156:159], v[208:211]
    ds_read_b128 v[188:191], v7 offset:14336
    ds_read_b128 v[192:195], v7 offset:15360
    s_waitcnt vmcnt(5) lgkmcnt(2)
    v_mfma_f32_16x16x32_bf16 v[204:207], v[180:183], v[160:163], v[204:207]
    v_mfma_f32_16x16x32_bf16 v[208:211], v[184:187], v[160:163], v[208:211]
    ds_read_b128 v[180:183], v7 offset:16384
    ds_read_b128 v[184:187], v7 offset:17408
    s_waitcnt vmcnt(4) lgkmcnt(2)
    v_mfma_f32_16x16x32_bf16 v[204:207], v[188:191], v[164:167], v[204:207]
    v_mfma_f32_16x16x32_bf16 v[208:211], v[192:195], v[164:167], v[208:211]
    ds_read_b128 v[188:191], v7 offset:18432
    ds_read_b128 v[192:195], v7 offset:19456
    s_waitcnt vmcnt(3) lgkmcnt(2)
    v_mfma_f32_16x16x32_bf16 v[204:207], v[180:183], v[168:171], v[204:207]
    v_mfma_f32_16x16x32_bf16 v[208:211], v[184:187], v[168:171], v[208:211]
    ds_read_b128 v[180:183], v7 offset:20480
    ds_read_b128 v[184:187], v7 offset:21504
    s_waitcnt vmcnt(2) lgkmcnt(2)
    v_mfma_f32_16x16x32_bf16 v[204:207], v[188:191], v[172:175], v[204:207]
    v_mfma_f32_16x16x32_bf16 v[208:211], v[192:195], v[172:175], v[208:211]
    s_waitcnt vmcnt(1) lgkmcnt(0)
    v_mfma_f32_16x16x32_bf16 v[204:207], v[180:183], v[176:179], v[204:207]
    v_mfma_f32_16x16x32_bf16 v[208:211], v[184:187], v[176:179], v[208:211]
    s_waitcnt vmcnt(0)
    v_mov_b32 v212, v216
    v_mov_b64 v[4:5], 0
    buffer_load_dwordx2 v[4:5], v244, s[4:7], s45 offen sc1
    s_sleep 3
    buffer_load_dwordx2 v[4:5], v244, s[4:7], s45 offen sc1
    s_sleep 3
WP_79:
    buffer_load_dwordx2 v[4:5], v244, s[4:7], s45 offen sc1
    s_sub_u32 s30, s30, 1
    s_cbranch_scc1 L_FAIL
    s_waitcnt vmcnt(2)
    v_cmp_ne_u64 vcc, s[38:39], v[4:5]
    s_cbranch_vccnz WP_79
    s_add_u32 s66, s65, 0
    s_and_b32 s66, s66, 0x7fff
    s_add_u32 s66, s66, s26
    buffer_load_dwordx4 v[8:11], v251, s[4:7], s66 offen offset:0 sc1
    buffer_load_dwordx4 v[12:15], v251, s[4:7], s66 offen offset:1024 sc1
    buffer_load_dwordx4 v[16:19], v251, s[4:7], s66 offen offset:2048 sc1
    buffer_load_dwordx4 v[20:23], v251, s[4:7], s66 offen offset:3072 sc1
    s_add_u32 s66, s65, 4096
    s_and_b32 s66, s66, 0x7fff
    s_add_u32 s66, s66, s26
    buffer_load_dwordx4 v[24:27], v251, s[4:7], s66 offen offset:0 sc1
    buffer_load_dwordx4 v[28:31], v251, s[4:7], s66 offen offset:1024 sc1
    buffer_load_dwordx4 v[32:35], v251, s[4:7], s66 offen offset:2048 sc1
    buffer_load_dwordx4 v[36:39], v251, s[4:7], s66 offen offset:3072 sc1
    s_add_u32 s66, s65, 8192
    s_and_b32 s66, s66, 0x7fff
    s_add_u32 s66, s66, s26
    buffer_load_dwordx4 v[40:43], v251, s[4:7], s66 offen offset:0 sc1
    buffer_load_dwordx4 v[44:47], v251, s[4:7], s66 offen offset:1024 sc1
    buffer_load_dwordx4 v[48:51], v251, s[4:7], s66 offen offset:2048 sc1
    buffer_load_dwordx4 v[52:55], v251, s[4:7], s66 offen offset:3072 sc1
    s_add_u32 s66, s65, 12288
    s_and_b32 s66, s66, 0x7fff
    s_add_u32 s66, s66, s26
    buffer_load_dwordx4 v[56:59], v251, s[4:7], s66 offen offset:0 sc1
    buffer_load_dwordx4 v[60:63], v251, s[4:7], s66 offen offset:1024 sc1
    buffer_load_dwordx4 v[64:67], v251, s[4:7], s66 offen offset:2048 sc1
    buffer_load_dwordx4 v[68:71], v251, s[4:7], s66 offen offset:3072 sc1
    s_add_u32 s66, s65, 16384
    s_and_b32 s66, s66, 0x7fff
    s_add_u32 s66, s66, s26
    buffer_load_dwordx4 v[72:75], v251, s[4:7], s66 offen offset:0 sc1
    buffer_load_dwordx4 v[76:79], v251, s[4:7], s66 offen offset:1024 sc1
    buffer_load_dwordx4 v[80:83], v251, s[4:7], s66 offen offset:2048 sc1
    buffer_load_dwordx4 v[84:87], v251, s[4:7], s66 offen offset:3072 sc1
    s_add_u32 s66, s65, 20480
    s_and_b32 s66, s66, 0x7fff
    s_add_u32 s66, s66, s26
    buffer_load_dwordx4 v[88:91], v251, s[4:7], s66 offen offset:0 sc1
    buffer_load_dwordx4 v[92:95], v251, s[4:7], s66 offen offset:1024 sc1
    buffer_load_dwordx4 v[96:99], v251, s[4:7], s66 offen offset:2048 sc1
    buffer_load_dwordx4 v[100:103], v251, s[4:7], s66 offen offset:3072 sc1
    s_add_u32 s66, s65, 24576
    s_and_b32 s66, s66, 0x7fff
    s_add_u32 s66, s66, s26
    buffer_load_dwordx4 v[104:107], v251, s[4:7], s66 offen offset:0 sc1
    buffer_load_dwordx4 v[108:111], v251, s[4:7], s66 offen offset:1024 sc1
    buffer_load_dwordx4 v[112:115], v251, s[4:7], s66 offen offset:2048 sc1
    buffer_load_dwordx4 v[116:119], v251, s[4:7], s66 offen offset:3072 sc1
    s_add_u32 s66, s65, 28672
    s_and_b32 s66, s66, 0x7fff
    s_add_u32 s66, s66, s26
    buffer_load_dwordx4 v[120:123], v251, s[4:7], s66 offen offset:0 sc1
    buffer_load_dwordx4 v[124:127], v251, s[4:7], s66 offen offset:1024 sc1
    buffer_load_dwordx4 v[128:131], v251, s[4:7], s66 offen offset:2048 sc1
    buffer_load_dwordx4 v[132:135], v251, s[4:7], s66 offen offset:3072 sc1
    s_cmp_lt_u32 s25, 0
    s_cselect_b32 s24, 4, 6
    s_add_u32 s24, s24, s25
    s_mov_b32 s28, 0
    s_cmp_ge_u32 s24, 126
    s_cbranch_scc1 S2N_70
    v_cmp_ne_u64 vcc, s[38:39], v[0:1]
    s_cbranch_vccnz S2N_70
    v_cmp_ne_u64 vcc, s[38:39], v[2:3]
    s_cbranch_vccnz S2N_70
    s_mov_b32 s28, 1
    s_cmp_lt_u32 s24, 0
    s_cselect_b32 s40, 4, 6
    s_add_u32 s40, s40, s24
    s_min_u32 s44, s40, 127
    s_lshr_b32 s42, s44, 2
    s_lshl_b32 s42, s42, 7
    s_add_u32 s42, s42, 94396416
    s_lshl_b32 s43, s44, 9
    s_add_u32 s43, s43, 94437376
    buffer_load_dwordx2 v[0:1], v245, s[4:7], s42 offen sc1
    buffer_load_dwordx2 v[2:3], v244, s[4:7], s43 offen sc1
    s_mul_i32 s27, s24, 45056
    s_mul_i32 s41, s21, 11264
    s_add_u32 s27, s27, s41
    s_add_u32 s27, s27, 69206016
    s_lshl_b32 s67, s24, 14
    s_lshl_b32 s26, s24, 17
    s_lshl_b32 s41, s21, 15
    s_add_u32 s26, s26, s41
    s_add_u32 s26, s26, 52428800
    buffer_load_dwordx4 v[136:139], v251, s[4:7], s27 offen offset:0 sc1
    buffer_load_dwordx4 v[140:143], v251, s[4:7], s27 offen offset:1024 sc1
    buffer_load_dwordx4 v[144:147], v251, s[4:7], s27 offen offset:2048 sc1
    buffer_load_dwordx4 v[148:151], v251, s[4:7], s27 offen offset:3072 sc1
    s_add_u32 s27, s27, 4096
    buffer_load_dwordx4 v[152:155], v251, s[4:7], s27 offen offset:0 sc1
    buffer_load_dwordx4 v[156:159], v251, s[4:7], s27 offen offset:1024 sc1
    buffer_load_dwordx4 v[160:163], v251, s[4:7], s27 offen offset:2048 sc1
    buffer_load_dwordx4 v[164:167], v251, s[4:7], s27 offen offset:3072 sc1
    s_add_u32 s27, s27, 4096
    buffer_load_dwordx4 v[168:171], v251, s[4:7], s27 offen offset:0 sc1
    buffer_load_dwordx4 v[172:175], v251, s[4:7], s27 offen offset:1024 sc1
    buffer_load_dwordx4 v[176:179], v251, s[4:7], s27 offen offset:2048 sc1
    buffer_load_dword v216, v246, s[52:55], s67 offen
    s_branch S2O_69
S2P_68:
    s_waitcnt vmcnt(44)
    s_cmp_lt_u32 s25, 0
    s_cselect_b32 s24, 4, 6
    s_add_u32 s24, s24, s25
    s_mov_b32 s28, 0
    s_cmp_ge_u32 s24, 126
    s_cbranch_scc1 S2Q_80
    v_cmp_ne_u64 vcc, s[38:39], v[0:1]
    s_cbranch_vccnz S2Q_80
    v_cmp_ne_u64 vcc, s[38:39], v[2:3]
    s_cbranch_vccnz S2Q_80
    s_mov_b32 s28, 1
    s_cmp_lt_u32 s24, 0
    s_cselect_b32 s40, 4, 6
    s_add_u32 s40, s40, s24
    s_min_u32 s44, s40, 127
    s_lshr_b32 s42, s44, 2
    s_lshl_b32 s42, s42, 7
    s_add_u32 s42, s42, 94396416
    s_lshl_b32 s43, s44, 9
    s_add_u32 s43, s43, 94437376
    buffer_load_dwordx2 v[0:1], v245, s[4:7], s42 offen sc1
    buffer_load_dwordx2 v[2:3], v244, s[4:7], s43 offen sc1
    s_mul_i32 s27, s24, 45056
    s_mul_i32 s41, s21, 11264
    s_add_u32 s27, s27, s41
    s_add_u32 s27, s27, 69206016
    s_lshl_b32 s67, s24, 14
    s_lshl_b32 s26, s24, 17
    s_lshl_b32 s41, s21, 15
    s_add_u32 s26, s26, s41
    s_add_u32 s26, s26, 52428800
    ds_read_b128 v[180:183], v7 offset:0
    ds_read_b128 v[184:187], v7 offset:1024
    ds_read_b128 v[188:191], v7 offset:2048
    ds_read_b128 v[192:195], v7 offset:3072
    s_waitcnt vmcnt(45) lgkmcnt(2)
    v_mfma_f32_16x16x32_bf16 v[204:207], v[180:183], v[136:139], 0
    v_mfma_f32_16x16x32_bf16 v[208:211], v[184:187], v[136:139], 0
    buffer_load_dwordx4 v[136:139], v251, s[4:7], s27 offen offset:0 sc1
    ds_read_b128 v[180:183], v7 offset:4096
    ds_read_b128 v[184:187], v7 offset:5120
    s_waitcnt vmcnt(45) lgkmcnt(2)
    v_mfma_f32_16x16x32_bf16 v[204:207], v[188:191], v[140:143], v[204:207]
    v_mfma_f32_16x16x32_bf16 v[208:211], v[192:195], v[140:143], v[208:211]
    buffer_load_dwordx4 v[140:143], v251, s[4:7], s27 offen offset:1024 sc1
    ds_read_b128 v[188:191], v7 offset:6144
    ds_read_b128 v[192:195], v7 offset:7168
    s_waitcnt vmcnt(45) lgkmcnt(2)
    v_mfma_f32_16x16x32_bf16 v[204:207], v[180:183], v[144:147], v[204:207]
    v_mfma_f32_16x16x32_bf16 v[208:211], v[184:187], v[144:147], v[208:211]
    buffer_load_dwordx4 v[144:147], v251, s[4:7], s27 offen offset:2048 sc1
    ds_read_b128 v[180:183], v7 offset:8192
    ds_read_b128 v[184:187], v7 offset:9216
    s_waitcnt vmcnt(45) lgkmcnt(2)
    v_mfma_f32_16x16x32_bf16 v[204:207], v[188:191], v[148:151], v[204:207]
    v_mfma_f32_16x16x32_bf16 v[208:211], v[192:195], v[148:151], v[208:211]
    buffer_load_dwordx4 v[148:151], v251, s[4:7], s27 offen offset:3072 sc1
    ds_read_b128 v[188:191], v7 offset:10240
    ds_read_b128 v[192:195], v7 offset:11264
    s_waitcnt vmcnt(45) lgkmcnt(2)
    v_mfma_f32_16x16x32_bf16 v[204:207], v[180:183], v[152:155], v[204:207]
    v_mfma_f32_16x16x32_bf16 v[208:211], v[184:187], v[152:155], v[208:211]
    s_add_u32 s27, s27, 4096
    buffer_load_dwordx4 v[152:155], v251, s[4:7], s27 offen offset:0 sc1
    ds_read_b128 v[180:183], v7 offset:12288
    ds_read_b128 v[184:187], v7 offset:13312
    s_waitcnt vmcnt(45) lgkmcnt(2)
    v_mfma_f32_16x16x32_bf16 v[204:207], v[188:191], v[156:159], v[204:207]
    v_mfma_f32_16x16x32_bf16 v[208:211], v[192:195], v[156:159], v[208:211]
    buffer_load_dwordx4 v[156:159], v251, s[4:7], s27 offen offset:1024 sc1
    ds_read_b128 v[188:191], v7 offset:14336
    ds_read_b128 v[192:195], v7 offset:15360
    s_waitcnt vmcnt(45) lgkmcnt(2)
    v_mfma_f32_16x16x32_bf16 v[204:207], v[180:183], v[160:163], v[204:207]
    v_mfma_f32_16x16x32_bf16 v[208:211], v[184:187], v[160:163], v[208:211]
    buffer_load_dwordx4 v[160:163], v251, s[4:7], s27 offen offset:2048 sc1
    ds_read_b128 v[180:183], v7 offset:16384
    ds_read_b128 v[184:187], v7 offset:17408
    s_waitcnt vmcnt(45) lgkmcnt(2)
    v_mfma_f32_16x16x32_bf16 v[204:207], v[188:191], v[164:167], v[204:207]
    v_mfma_f32_16x16x32_bf16 v[208:211], v[192:195], v[164:167], v[208:211]
    buffer_load_dwordx4 v[164:167], v251, s[4:7], s27 offen offset:3072 sc1
    ds_read_b128 v[188:191], v7 offset:18432
    ds_read_b128 v[192:195], v7 offset:19456
    s_waitcnt vmcnt(45) lgkmcnt(2)
    v_mfma_f32_16x16x32_bf16 v[204:207], v[180:183], v[168:171], v[204:207]
    v_mfma_f32_16x16x32_bf16 v[208:211], v[184:187], v[168:171], v[208:211]
    s_add_u32 s27, s27, 4096
    buffer_load_dwordx4 v[168:171], v251, s[4:7], s27 offen offset:0 sc1
    ds_read_b128 v[180:183], v7 offset:20480
    ds_read_b128 v[184:187], v7 offset:21504
    s_waitcnt vmcnt(45) lgkmcnt(2)
    v_mfma_f32_16x16x32_bf16 v[204:207], v[188:191], v[172:175], v[204:207]
    v_mfma_f32_16x16x32_bf16 v[208:211], v[192:195], v[172:175], v[208:211]
    buffer_load_dwordx4 v[172:175], v251, s[4:7], s27 offen offset:1024 sc1
    s_waitcnt vmcnt(45) lgkmcnt(0)
    v_mfma_f32_16x16x32_bf16 v[204:207], v[180:183], v[176:179], v[204:207]
    v_mfma_f32_16x16x32_bf16 v[208:211], v[184:187], v[176:179], v[208:211]
    buffer_load_dwordx4 v[176:179], v251, s[4:7], s27 offen offset:2048 sc1
    s_waitcnt vmcnt(45)
    v_mov_b32 v212, v216
    buffer_load_dword v216, v246, s[52:55], s67 offen
S2O_69:
    s_waitcnt vmcnt(45)
    v_mfma_f32_16x16x32_bf16 v[196:199], a[0:3], v[8:11], 0
    v_mfma_f32_16x16x32_bf16 v[200:203], a[128:131], v[8:11], 0
    s_add_u32 s66, s65, 0
    s_and_b32 s66, s66, 0x7fff
    s_add_u32 s66, s66, s26
    buffer_load_dwordx4 v[8:11], v251, s[4:7], s66 offen offset:0 sc1
    s_waitcnt vmcnt(45)
    v_mfma_f32_16x16x32_bf16 v[196:199], a[4:7], v[12:15], v[196:199]
    v_mfma_f32_16x16x32_bf16 v[200:203], a[132:135], v[12:15], v[200:203]
    buffer_load_dwordx4 v[12:15], v251, s[4:7], s66 offen offset:1024 sc1
    s_waitcnt vmcnt(45)
    v_mfma_f32_16x16x32_bf16 v[196:199], a[8:11], v[16:19], v[196:199]
    v_mfma_f32_16x16x32_bf16 v[200:203], a[136:139], v[16:19], v[200:203]
    buffer_load_dwordx4 v[16:19], v251, s[4:7], s66 offen offset:2048 sc1
    s_waitcnt vmcnt(45)
    v_mfma_f32_16x16x32_bf16 v[196:199], a[12:15], v[20:23], v[196:199]
    v_mfma_f32_16x16x32_bf16 v[200:203], a[140:143], v[20:23], v[200:203]
    buffer_load_dwordx4 v[20:23], v251, s[4:7], s66 offen offset:3072 sc1
    s_waitcnt vmcnt(45)
    v_mfma_f32_16x16x32_bf16 v[196:199], a[16:19], v[24:27], v[196:199]
    v_mfma_f32_16x16x32_bf16 v[200:203], a[144:147], v[24:27], v[200:203]
    s_add_u32 s66, s65, 4096
    s_and_b32 s66, s66, 0x7fff
    s_add_u32 s66, s66, s26
    buffer_load_dwordx4 v[24:27], v251, s[4:7], s66 offen offset:0 sc1
    ds_write_b128 v247, v[204:207] offset:2048
    ds_write_b128 v247, v[208:211] offset:3072
    s_waitcnt vmcnt(45)
    v_mfma_f32_16x16x32_bf16 v[196:199], a[20:23], v[28:31], v[196:199]
    v_mfma_f32_16x16x32_bf16 v[200:203], a[148:151], v[28:31], v[200:203]
    buffer_load_dwordx4 v[28:31], v251, s[4:7], s66 offen offset:1024 sc1
    s_waitcnt vmcnt(45)
    v_mfma_f32_16x16x32_bf16 v[196:199], a[24:27], v[32:35], v[196:199]
    v_mfma_f32_16x16x32_bf16 v[200:203], a[152:155], v[32:35], v[200:203]
    buffer_load_dwordx4 v[32:35], v251, s[4:7], s66 offen offset:2048 sc1
    s_waitcnt vmcnt(45)
    v_mfma_f32_16x16x32_bf16 v[196:199], a[28:31], v[36:39], v[196:199]
    v_mfma_f32_16x16x32_bf16 v[200:203], a[156:159], v[36:39], v[200:203]
    buffer_load_dwordx4 v[36:39], v251, s[4:7], s66 offen offset:3072 sc1
    s_waitcnt vmcnt(45)
    v_mfma_f32_16x16x32_bf16 v[196:199], a[32:35], v[40:43], v[196:199]
    v_mfma_f32_16x16x32_bf16 v[200:203], a[160:163], v[40:43], v[200:203]
    s_add_u32 s66, s65, 8192
    s_and_b32 s66, s66, 0x7fff
    s_add_u32 s66, s66, s26
    buffer_load_dwordx4 v[40:43], v251, s[4:7], s66 offen offset:0 sc1
    s_waitcnt vmcnt(45)
    v_mfma_f32_16x16x32_bf16 v[196:199], a[36:39], v[44:47], v[196:199]
    v_mfma_f32_16x16x32_bf16 v[200:203], a[164:167], v[44:47], v[200:203]
    buffer_load_dwordx4 v[44:47], v251, s[4:7], s66 offen offset:1024 sc1
    s_waitcnt vmcnt(45)
    v_mfma_f32_16x16x32_bf16 v[196:199], a[40:43], v[48:51], v[196:199]
    v_mfma_f32_16x16x32_bf16 v[200:203], a[168:171], v[48:51], v[200:203]
    buffer_load_dwordx4 v[48:51], v251, s[4:7], s66 offen offset:2048 sc1
    s_waitcnt vmcnt(45)
    v_mfma_f32_16x16x32_bf16 v[196:199], a[44:47], v[52:55], v[196:199]
    v_mfma_f32_16x16x32_bf16 v[200:203], a[172:175], v[52:55], v[200:203]
    buffer_load_dwordx4 v[52:55], v251, s[4:7], s66 offen offset:3072 sc1
    s_waitcnt vmcnt(45)
    v_mfma_f32_16x16x32_bf16 v[196:199], a[48:51], v[56:59], v[196:199]
    v_mfma_f32_16x16x32_bf16 v[200:203], a[176:179], v[56:59], v[200:203]
    s_add_u32 s66, s65, 12288
    s_and_b32 s66, s66, 0x7fff
    s_add_u32 s66, s66, s26
    buffer_load_dwordx4 v[56:59], v251, s[4:7], s66 offen offset:0 sc1
    s_waitcnt vmcnt(45)
    v_mfma_f32_16x16x32_bf16 v[196:199], a[52:55], v[60:63], v[196:199]
    v_mfma_f32_16x16x32_bf16 v[200:203], a[180:183], v[60:63], v[200:203]
    buffer_load_dwordx4 v[60:63], v251, s[4:7], s66 offen offset:1024 sc1
    s_waitcnt vmcnt(45)
    v_mfma_f32_16x16x32_bf16 v[196:199], a[56:59], v[64:67], v[196:199]
    v_mfma_f32_16x16x32_bf16 v[200:203], a[184:187], v[64:67], v[200:203]
    buffer_load_dwordx4 v[64:67], v251, s[4:7], s66 offen offset:2048 sc1
    s_waitcnt vmcnt(45)
    v_mfma_f32_16x16x32_bf16 v[196:199], a[60:63], v[68:71], v[196:199]
    v_mfma_f32_16x16x32_bf16 v[200:203], a[188:191], v[68:71], v[200:203]
    buffer_load_dwordx4 v[68:71], v251, s[4:7], s66 offen offset:3072 sc1
    s_waitcnt vmcnt(45)
    v_mfma_f32_16x16x32_bf16 v[196:199], a[64:67], v[72:75], v[196:199]
    v_mfma_f32_16x16x32_bf16 v[200:203], a[192:195], v[72:75], v[200:203]
    s_add_u32 s66, s65, 16384
    s_and_b32 s66, s66, 0x7fff
    s_add_u32 s66, s66, s26
    buffer_load_dwordx4 v[72:75], v251, s[4:7], s66 offen offset:0 sc1
    s_waitcnt vmcnt(45)
    v_mfma_f32_16x16x32_bf16 v[196:199], a[68:71], v[76:79], v[196:199]
    v_mfma_f32_16x16x32_bf16 v[200:203], a[196:199], v[76:79], v[200:203]
    buffer_load_dwordx4 v[76:79], v251, s[4:7], s66 offen offset:1024 sc1
    s_waitcnt vmcnt(45)
    v_mfma_f32_16x16x32_bf16 v[196:199], a[72:75], v[80:83], v[196:199]
    v_mfma_f32_16x16x32_bf16 v[200:203], a[200:203], v[80:83], v[200:203]
    buffer_load_dwordx4 v[80:83], v251, s[4:7], s66 offen offset:2048 sc1
    s_waitcnt vmcnt(45)
    v_mfma_f32_16x16x32_bf16 v[196:199], a[76:79], v[84:87], v[196:199]
    v_mfma_f32_16x16x32_bf16 v[200:203], a[204:207], v[84:87], v[200:203]
    buffer_load_dwordx4 v[84:87], v251, s[4:7], s66 offen offset:3072 sc1
    s_waitcnt vmcnt(45)
    v_mfma_f32_16x16x32_bf16 v[196:199], a[80:83], v[88:91], v[196:199]
    v_mfma_f32_16x16x32_bf16 v[200:203], a[208:211], v[88:91], v[200:203]
    s_add_u32 s66, s65, 20480
    s_and_b32 s66, s66, 0x7fff
    s_add_u32 s66, s66, s26
    buffer_load_dwordx4 v[88:91], v251, s[4:7], s66 offen offset:0 sc1
    s_waitcnt vmcnt(45)
    v_mfma_f32_16x16x32_bf16 v[196:199], a[84:87], v[92:95], v[196:199]
    v_mfma_f32_16x16x32_bf16 v[200:203], a[212:215], v[92:95], v[200:203]
    buffer_load_dwordx4 v[92:95], v251, s[4:7], s66 offen offset:1024 sc1
    s_waitcnt vmcnt(45)
    v_mfma_f32_16x16x32_bf16 v[196:199], a[88:91], v[96:99], v[196:199]
    v_mfma_f32_16x16x32_bf16 v[200:203], a[216:219], v[96:99], v[200:203]
    buffer_load_dwordx4 v[96:99], v251, s[4:7], s66 offen offset:2048 sc1
    s_waitcnt vmcnt(45)
    v_mfma_f32_16x16x32_bf16 v[196:199], a[92:95], v[100:103], v[196:199]
    v_mfma_f32_16x16x32_bf16 v[200:203], a[220:223], v[100:103], v[200:203]
    buffer_load_dwordx4 v[100:103], v251, s[4:7], s66 offen offset:3072 sc1
    s_waitcnt vmcnt(45)
    v_mfma_f32_16x16x32_bf16 v[196:199], a[96:99], v[104:107], v[196:199]
    v_mfma_f32_16x16x32_bf16 v[200:203], a[224:227], v[104:107], v[200:203]
    s_add_u32 s66, s65, 24576
    s_and_b32 s66, s66, 0x7fff
    s_add_u32 s66, s66, s26
    buffer_load_dwordx4 v[104:107], v251, s[4:7], s66 offen offset:0 sc1
    s_waitcnt vmcnt(45)
    v_mfma_f32_16x16x32_bf16 v[196:199], a[100:103], v[108:111], v[196:199]
    v_mfma_f32_16x16x32_bf16 v[200:203], a[228:231], v[108:111], v[200:203]
    buffer_load_dwordx4 v[108:111], v251, s[4:7], s66 offen offset:1024 sc1
    s_waitcnt vmcnt(45)
    v_mfma_f32_16x16x32_bf16 v[196:199], a[104:107], v[112:115], v[196:199]
    v_mfma_f32_16x16x32_bf16 v[200:203], a[232:235], v[112:115], v[200:203]
    buffer_load_dwordx4 v[112:115], v251, s[4:7], s66 offen offset:2048 sc1
    s_waitcnt vmcnt(45)
    v_mfma_f32_16x16x32_bf16 v[196:199], a[108:111], v[116:119], v[196:199]
    v_mfma_f32_16x16x32_bf16 v[200:203], a[236:239], v[116:119], v[200:203]
    buffer_load_dwordx4 v[116:119], v251, s[4:7], s66 offen offset:3072 sc1
    s_waitcnt vmcnt(45)
    v_mfma_f32_16x16x32_bf16 v[196:199], a[112:115], v[120:123], v[196:199]
    v_mfma_f32_16x16x32_bf16 v[200:203], a[240:243], v[120:123], v[200:203]
    s_add_u32 s66, s65, 28672
    s_and_b32 s66, s66, 0x7fff
    s_add_u32 s66, s66, s26
    buffer_load_dwordx4 v[120:123], v251, s[4:7], s66 offen offset:0 sc1
    s_waitcnt vmcnt(45)
    v_mfma_f32_16x16x32_bf16 v[196:199], a[116:119], v[124:127], v[196:199]
    v_mfma_f32_16x16x32_bf16 v[200:203], a[244:247], v[124:127], v[200:203]
    buffer_load_dwordx4 v[124:127], v251, s[4:7], s66 offen offset:1024 sc1
    s_waitcnt vmcnt(45)
    v_mfma_f32_16x16x32_bf16 v[196:199], a[120:123], v[128:131], v[196:199]
    v_mfma_f32_16x16x32_bf16 v[200:203], a[248:251], v[128:131], v[200:203]
    buffer_load_dwordx4 v[128:131], v251, s[4:7], s66 offen offset:2048 sc1
    s_waitcnt vmcnt(45)
    v_mfma_f32_16x16x32_bf16 v[196:199], a[124:127], v[132:135], v[196:199]
    v_mfma_f32_16x16x32_bf16 v[200:203], a[252:255], v[132:135], v[200:203]
    buffer_load_dwordx4 v[132:135], v251, s[4:7], s66 offen offset:3072 sc1
    s_branch S2F_71
S2Q_80:
    ds_read_b128 v[180:183], v7 offset:0
    ds_read_b128 v[184:187], v7 offset:1024
    ds_read_b128 v[188:191], v7 offset:2048
    ds_read_b128 v[192:195], v7 offset:3072
    s_waitcnt vmcnt(43) lgkmcnt(2)
    v_mfma_f32_16x16x32_bf16 v[204:207], v[180:183], v[136:139], 0
    v_mfma_f32_16x16x32_bf16 v[208:211], v[184:187], v[136:139], 0
    ds_read_b128 v[180:183], v7 offset:4096
    ds_read_b128 v[184:187], v7 offset:5120
    s_waitcnt vmcnt(42) lgkmcnt(2)
    v_mfma_f32_16x16x32_bf16 v[204:207], v[188:191], v[140:143], v[204:207]
    v_mfma_f32_16x16x32_bf16 v[208:211], v[192:195], v[140:143], v[208:211]
    ds_read_b128 v[188:191], v7 offset:6144
    ds_read_b128 v[192:195], v7 offset:7168
    s_waitcnt vmcnt(41) lgkmcnt(2)
    v_mfma_f32_16x16x32_bf16 v[204:207], v[180:183], v[144:147], v[204:207]
    v_mfma_f32_16x16x32_bf16 v[208:211], v[184:187], v[144:147], v[208:211]
    ds_read_b128 v[180:183], v7 offset:8192
    ds_read_b128 v[184:187], v7 offset:9216
    s_waitcnt vmcnt(40) lgkmcnt(2)
    v_mfma_f32_16x16x32_bf16 v[204:207], v[188:191], v[148:151], v[204:207]
    v_mfma_f32_16x16x32_bf16 v[208:211], v[192:195], v[148:151], v[208:211]
    ds_read_b128 v[188:191], v7 offset:10240
    ds_read_b128 v[192:195], v7 offset:11264
    s_waitcnt vmcnt(39) lgkmcnt(2)
    v_mfma_f32_16x16x32_bf16 v[204:207], v[180:183], v[152:155], v[204:207]
    v_mfma_f32_16x16x32_bf16 v[208:211], v[184:187], v[152:155], v[208:211]
    ds_read_b128 v[180:183], v7 offset:12288
    ds_read_b128 v[184:187], v7 offset:13312
    s_waitcnt vmcnt(38) lgkmcnt(2)
    v_mfma_f32_16x16x32_bf16 v[204:207], v[188:191], v[156:159], v[204:207]
    v_mfma_f32_16x16x32_bf16 v[208:211], v[192:195], v[156:159], v[208:211]
    ds_read_b128 v[188:191], v7 offset:14336
    ds_read_b128 v[192:195], v7 offset:15360
    s_waitcnt vmcnt(37) lgkmcnt(2)
    v_mfma_f32_16x16x32_bf16 v[204:207], v[180:183], v[160:163], v[204:207]
    v_mfma_f32_16x16x32_bf16 v[208:211], v[184:187], v[160:163], v[208:211]
    ds_read_b128 v[180:183], v7 offset:16384
    ds_read_b128 v[184:187], v7 offset:17408
    s_waitcnt vmcnt(36) lgkmcnt(2)
    v_mfma_f32_16x16x32_bf16 v[204:207], v[188:191], v[164:167], v[204:207]
    v_mfma_f32_16x16x32_bf16 v[208:211], v[192:195], v[164:167], v[208:211]
    ds_read_b128 v[188:191], v7 offset:18432
    ds_read_b128 v[192:195], v7 offset:19456
    s_waitcnt vmcnt(35) lgkmcnt(2)
    v_mfma_f32_16x16x32_bf16 v[204:207], v[180:183], v[168:171], v[204:207]
    v_mfma_f32_16x16x32_bf16 v[208:211], v[184:187], v[168:171], v[208:211]
    ds_read_b128 v[180:183], v7 offset:20480
    ds_read_b128 v[184:187], v7 offset:21504
    s_waitcnt vmcnt(34) lgkmcnt(2)
    v_mfma_f32_16x16x32_bf16 v[204:207], v[188:191], v[172:175], v[204:207]
    v_mfma_f32_16x16x32_bf16 v[208:211], v[192:195], v[172:175], v[208:211]
    s_waitcnt vmcnt(33) lgkmcnt(0)
    v_mfma_f32_16x16x32_bf16 v[204:207], v[180:183], v[176:179], v[204:207]
    v_mfma_f32_16x16x32_bf16 v[208:211], v[184:187], v[176:179], v[208:211]
    s_waitcnt vmcnt(32)
    v_mov_b32 v212, v216
S2N_70:
    s_waitcnt vmcnt(31)
    v_mfma_f32_16x16x32_bf16 v[196:199], a[0:3], v[8:11], 0
    v_mfma_f32_16x16x32_bf16 v[200:203], a[128:131], v[8:11], 0
    s_waitcnt vmcnt(30)
    v_mfma_f32_16x16x32_bf16 v[196:199], a[4:7], v[12:15], v[196:199]
    v_mfma_f32_16x16x32_bf16 v[200:203], a[132:135], v[12:15], v[200:203]
    s_waitcnt vmcnt(29)
    v_mfma_f32_16x16x32_bf16 v[196:199], a[8:11], v[16:19], v[196:199]
    v_mfma_f32_16x16x32_bf16 v[200:203], a[136:139], v[16:19], v[200:203]
    s_waitcnt vmcnt(28)
    v_mfma_f32_16x16x32_bf16 v[196:199], a[12:15], v[20:23], v[196:199]
    v_mfma_f32_16x16x32_bf16 v[200:203], a[140:143], v[20:23], v[200:203]
    s_waitcnt vmcnt(27)
    v_mfma_f32_16x16x32_bf16 v[196:199], a[16:19], v[24:27], v[196:199]
    v_mfma_f32_16x16x32_bf16 v[200:203], a[144:147], v[24:27], v[200:203]
    ds_write_b128 v247, v[204:207] offset:2048
    ds_write_b128 v247, v[208:211] offset:3072
    s_waitcnt vmcnt(26)
    v_mfma_f32_16x16x32_bf16 v[196:199], a[20:23], v[28:31], v[196:199]
    v_mfma_f32_16x16x32_bf16 v[200:203], a[148:151], v[28:31], v[200:203]
    s_waitcnt vmcnt(25)
    v_mfma_f32_16x16x32_bf16 v[196:199], a[24:27], v[32:35], v[196:199]
    v_mfma_f32_16x16x32_bf16 v[200:203], a[152:155], v[32:35], v[200:203]
    s_waitcnt vmcnt(24)
    v_mfma_f32_16x16x32_bf16 v[196:199], a[28:31], v[36:39], v[196:199]
    v_mfma_f32_16x16x32_bf16 v[200:203], a[156:159], v[36:39], v[200:203]
    s_waitcnt vmcnt(23)
    v_mfma_f32_16x16x32_bf16 v[196:199], a[32:35], v[40:43], v[196:199]
    v_mfma_f32_16x16x32_bf16 v[200:203], a[160:163], v[40:43], v[200:203]
    s_waitcnt vmcnt(22)
    v_mfma_f32_16x16x32_bf16 v[196:199], a[36:39], v[44:47], v[196:199]
    v_mfma_f32_16x16x32_bf16 v[200:203], a[164:167], v[44:47], v[200:203]
    s_waitcnt vmcnt(21)
    v_mfma_f32_16x16x32_bf16 v[196:199], a[40:43], v[48:51], v[196:199]
    v_mfma_f32_16x16x32_bf16 v[200:203], a[168:171], v[48:51], v[200:203]
    s_waitcnt vmcnt(20)
    v_mfma_f32_16x16x32_bf16 v[196:199], a[44:47], v[52:55], v[196:199]
    v_mfma_f32_16x16x32_bf16 v[200:203], a[172:175], v[52:55], v[200:203]
    s_waitcnt vmcnt(19)
    v_mfma_f32_16x16x32_bf16 v[196:199], a[48:51], v[56:59], v[196:199]
    v_mfma_f32_16x16x32_bf16 v[200:203], a[176:179], v[56:59], v[200:203]
    s_waitcnt vmcnt(18)
    v_mfma_f32_16x16x32_bf16 v[196:199], a[52:55], v[60:63], v[196:199]
    v_mfma_f32_16x16x32_bf16 v[200:203], a[180:183], v[60:63], v[200:203]
    s_waitcnt vmcnt(17)
    v_mfma_f32_16x16x32_bf16 v[196:199], a[56:59], v[64:67], v[196:199]
    v_mfma_f32_16x16x32_bf16 v[200:203], a[184:187], v[64:67], v[200:203]
    s_waitcnt vmcnt(16)
    v_mfma_f32_16x16x32_bf16 v[196:199], a[60:63], v[68:71], v[196:199]
    v_mfma_f32_16x16x32_bf16 v[200:203], a[188:191], v[68:71], v[200:203]
    s_waitcnt vmcnt(15)
    v_mfma_f32_16x16x32_bf16 v[196:199], a[64:67], v[72:75], v[196:199]
    v_mfma_f32_16x16x32_bf16 v[200:203], a[192:195], v[72:75], v[200:203]
    s_waitcnt vmcnt(14)
    v_mfma_f32_16x16x32_bf16 v[196:199], a[68:71], v[76:79], v[196:199]
    v_mfma_f32_16x16x32_bf16 v[200:203], a[196:199], v[76:79], v[200:203]
    s_waitcnt vmcnt(13)
    v_mfma_f32_16x16x32_bf16 v[196:199], a[72:75], v[80:83], v[196:199]
    v_mfma_f32_16x16x32_bf16 v[200:203], a[200:203], v[80:83], v[200:203]
    s_waitcnt vmcnt(12)
    v_mfma_f32_16x16x32_bf16 v[196:199], a[76:79], v[84:87], v[196:199]
    v_mfma_f32_16x16x32_bf16 v[200:203], a[204:207], v[84:87], v[200:203]
    s_waitcnt vmcnt(11)
    v_mfma_f32_16x16x32_bf16 v[196:199], a[80:83], v[88:91], v[196:199]
    v_mfma_f32_16x16x32_bf16 v[200:203], a[208:211], v[88:91], v[200:203]
    s_waitcnt vmcnt(10)
    v_mfma_f32_16x16x32_bf16 v[196:199], a[84:87], v[92:95], v[196:199]
    v_mfma_f32_16x16x32_bf16 v[200:203], a[212:215], v[92:95], v[200:203]
    s_waitcnt vmcnt(9)
    v_mfma_f32_16x16x32_bf16 v[196:199], a[88:91], v[96:99], v[196:199]
    v_mfma_f32_16x16x32_bf16 v[200:203], a[216:219], v[96:99], v[200:203]
    s_waitcnt vmcnt(8)
    v_mfma_f32_16x16x32_bf16 v[196:199], a[92:95], v[100:103], v[196:199]
    v_mfma_f32_16x16x32_bf16 v[200:203], a[220:223], v[100:103], v[200:203]
    s_waitcnt vmcnt(7)
    v_mfma_f32_16x16x32_bf16 v[196:199], a[96:99], v[104:107], v[196:199]
    v_mfma_f32_16x16x32_bf16 v[200:203], a[224:227], v[104:107], v[200:203]
    s_waitcnt vmcnt(6)
    v_mfma_f32_16x16x32_bf16 v[196:199], a[100:103], v[108:111], v[196:199]
    v_mfma_f32_16x16x32_bf16 v[200:203], a[228:231], v[108:111], v[200:203]
    s_waitcnt vmcnt(5)
    v_mfma_f32_16x16x32_bf16 v[196:199], a[104:107], v[112:115], v[196:199]
    v_mfma_f32_16x16x32_bf16 v[200:203], a[232:235], v[112:115], v[200:203]
    s_waitcnt vmcnt(4)
    v_mfma_f32_16x16x32_bf16 v[196:199], a[108:111], v[116:119], v[196:199]
    v_mfma_f32_16x16x32_bf16 v[200:203], a[236:239], v[116:119], v[200:203]
    s_waitcnt vmcnt(3)
    v_mfma_f32_16x16x32_bf16 v[196:199], a[112:115], v[120:123], v[196:199]
    v_mfma_f32_16x16x32_bf16 v[200:203], a[240:243], v[120:123], v[200:203]
    s_waitcnt vmcnt(2)
    v_mfma_f32_16x16x32_bf16 v[196:199], a[116:119], v[124:127], v[196:199]
    v_mfma_f32_16x16x32_bf16 v[200:203], a[244:247], v[124:127], v[200:203]
    s_waitcnt vmcnt(1)
    v_mfma_f32_16x16x32_bf16 v[196:199], a[120:123], v[128:131], v[196:199]
    v_mfma_f32_16x16x32_bf16 v[200:203], a[248:251], v[128:131], v[200:203]
    s_waitcnt vmcnt(0)
    v_mfma_f32_16x16x32_bf16 v[196:199], a[124:127], v[132:135], v[196:199]
    v_mfma_f32_16x16x32_bf16 v[200:203], a[252:255], v[132:135], v[200:203]
S2F_71:
    s_nop 7
S2G_81:
    ds_write_b128 v247, v[196:199]
    ds_write_b128 v247, v[200:203] offset:1024
    s_waitcnt lgkmcnt(0)
    s_barrier
    ds_read_b64 v[228:229], v6 offset:2048
    ds_read_b64 v[230:231], v6 offset:6144
    ds_read_b64 v[232:233], v6 offset:10240
    ds_read_b64 v[234:235], v6 offset:14336
    ds_read_b64 v[220:221], v6 offset:0
    ds_read_b64 v[222:223], v6 offset:4096
    ds_read_b64 v[224:225], v6 offset:8192
    ds_read_b64 v[226:227], v6 offset:12288
    v_lshlrev_b32 v238, 16, v212
    v_and_b32 v239, 0xffff0000, v212
    s_lshl_b32 s40, s25, 14
    s_waitcnt lgkmcnt(4)
    v_pk_add_f32 v[228:229], v[228:229], v[230:231]
    v_pk_add_f32 v[232:233], v[232:233], v[234:235]
    v_pk_add_f32 v[228:229], v[228:229], v[232:233]
    v_cvt_pk_bf16_f32 v229, v228, v229
    v_lshlrev_b32 v228, 16, v229
    v_and_b32 v229, 0xffff0000, v229
    v_mul_f32 v236, 0xbfb8aa3b, v228
    v_mul_f32 v237, 0xbfb8aa3b, v229
    v_exp_f32 v236, v236
    v_exp_f32 v237, v237
    s_waitcnt lgkmcnt(0)
    v_add_f32 v236, 1.0, v236
    v_add_f32 v237, 1.0, v237
    v_rcp_f32 v236, v236
    v_rcp_f32 v237, v237
    v_pk_add_f32 v[220:221], v[220:221], v[222:223]
    v_pk_add_f32 v[224:225], v[224:225], v[226:227]
    v_pk_add_f32 v[220:221], v[220:221], v[224:225]
    v_cvt_pk_bf16_f32 v221, v220, v221
    v_lshlrev_b32 v220, 16, v221
    v_and_b32 v221, 0xffff0000, v221
    v_pk_mul_f32 v[228:229], v[228:229], v[236:237]
    v_cvt_pk_bf16_f32 v229, v228, v229
    v_lshlrev_b32 v228, 16, v229
    v_and_b32 v229, 0xffff0000, v229
    v_pk_mul_f32 v[220:221], v[220:221], v[228:229]
    v_cvt_pk_bf16_f32 v221, v220, v221
    v_lshlrev_b32 v220, 16, v221
    v_and_b32 v221, 0xffff0000, v221
    v_pk_add_f32 v[220:221], v[220:221], v[238:239]
    v_cvt_pk_bf16_f32 v236, v220, v221
    buffer_store_dword v236, v246, s[56:59], s40 offen
    v_xor_b32 v247, 0x4000, v247
    v_xor_b32 v6, 0x4000, v6
    s_mov_b32 s25, s24
    s_cmp_lg_u32 s28, 0
    s_cbranch_scc1 S2P_68
    s_cmp_lt_u32 s25, 126
    s_cbranch_scc1 S2C_67
    s_cmp_ge_u32 s25, 130
    s_cbranch_scc1 S2D_82
    s_sub_u32 s29, s25, 126
    s_and_b32 s25, s25, 1
    s_add_u32 s25, s25, 126
    s_lshr_b32 s29, s29, 1
    s_min_u32 s44, s25, 127
    s_lshr_b32 s42, s44, 2
    s_lshl_b32 s42, s42, 7
    s_add_u32 s42, s42, 94396416
    s_lshl_b32 s43, s44, 9
    s_add_u32 s43, s43, 94437376
    s_mov_b32 s45, s43
    ds_read_b128 v[204:207], v7 offset:22528
    ds_read_b128 v[208:211], v7 offset:23552
    v_mov_b32 v212, v213
    s_lshl_b32 s26, s25, 17
    s_lshl_b32 s41, s21, 15
    s_add_u32 s26, s26, s41
    s_add_u32 s26, s26, 52428800
    s_waitcnt lgkmcnt(0)
    ds_write_b128 v247, v[204:207] offset:2048
    ds_write_b128 v247, v[208:211] offset:3072
    v_bfe_u32 v221, v250, 3, 1
    v_xor_b32 v221, s29, v221
    v_and_b32 v220, 0x370, v251
    s_lshl_b32 s40, s29, 7
    v_add_u32 v220, s40, v220
    v_lshl_add_u32 v220, v221, 10, v220
    v_lshlrev_b32 v221, 31, v221
    v_or_b32 v246, v221, v246
    s_mov_b32 s24, 200
    s_mov_b32 s44, -1
    s_mov_b32 s28, 0
    v_mov_b64 v[4:5], 0
    buffer_load_dwordx2 v[4:5], v244, s[4:7], s45 offen sc1
    s_sleep 3
    buffer_load_dwordx2 v[4:5], v244, s[4:7], s45 offen sc1
    s_sleep 3
WP_83:
    buffer_load_dwordx2 v[4:5], v244, s[4:7], s45 offen sc1
    s_sub_u32 s30, s30, 1
    s_cbranch_scc1 L_FAIL
    s_waitcnt vmcnt(2)
    v_cmp_ne_u64 vcc, s[38:39], v[4:5]
    s_cbranch_vccnz WP_83
S2Y_73:
    s_add_u32 s66, s65, 0
    s_and_b32 s66, s66, 0x7fff
    s_add_u32 s66, s66, s26
    buffer_load_dwordx4 v[8:11], v220, s[4:7], s66 offen offset:0 sc1
    buffer_load_dwordx4 v[12:15], v220, s[4:7], s66 offen offset:2048 sc1
    s_add_u32 s66, s65, 4096
    s_and_b32 s66, s66, 0x7fff
    s_add_u32 s66, s66, s26
    buffer_load_dwordx4 v[16:19], v220, s[4:7], s66 offen offset:0 sc1
    buffer_load_dwordx4 v[20:23], v220, s[4:7], s66 offen offset:2048 sc1
    s_add_u32 s66, s65, 8192
    s_and_b32 s66, s66, 0x7fff
    s_add_u32 s66, s66, s26
    buffer_load_dwordx4 v[24:27], v220, s[4:7], s66 offen offset:0 sc1
    buffer_load_dwordx4 v[28:31], v220, s[4:7], s66 offen offset:2048 sc1
    s_add_u32 s66, s65, 12288
    s_and_b32 s66, s66, 0x7fff
    s_add_u32 s66, s66, s26
    buffer_load_dwordx4 v[32:35], v220, s[4:7], s66 offen offset:0 sc1
    buffer_load_dwordx4 v[36:39], v220, s[4:7], s66 offen offset:2048 sc1
    s_add_u32 s66, s65, 16384
    s_and_b32 s66, s66, 0x7fff
    s_add_u32 s66, s66, s26
    buffer_load_dwordx4 v[40:43], v220, s[4:7], s66 offen offset:0 sc1
    buffer_load_dwordx4 v[44:47], v220, s[4:7], s66 offen offset:2048 sc1
    s_add_u32 s66, s65, 20480
    s_and_b32 s66, s66, 0x7fff
    s_add_u32 s66, s66, s26
    buffer_load_dwordx4 v[48:51], v220, s[4:7], s66 offen offset:0 sc1
    buffer_load_dwordx4 v[52:55], v220, s[4:7], s66 offen offset:2048 sc1
    s_add_u32 s66, s65, 24576
    s_and_b32 s66, s66, 0x7fff
    s_add_u32 s66, s66, s26
    buffer_load_dwordx4 v[56:59], v220, s[4:7], s66 offen offset:0 sc1
    buffer_load_dwordx4 v[60:63], v220, s[4:7], s66 offen offset:2048 sc1
    s_add_u32 s66, s65, 28672
    s_and_b32 s66, s66, 0x7fff
    s_add_u32 s66, s66, s26
    buffer_load_dwordx4 v[64:67], v220, s[4:7], s66 offen offset:0 sc1
    buffer_load_dwordx4 v[68:71], v220, s[4:7], s66 offen offset:2048 sc1
    s_waitcnt vmcnt(15)
    v_mfma_f32_16x16x32_bf16 v[72:75], a[4:7], v[8:11], 0
    v_max_u32 v222, v8, v9
    v_mfma_f32_16x16x32_bf16 v[76:79], a[132:135], v[8:11], 0
    v_max3_u32 v222, v222, v10, v11
    v_mfma_f32_16x16x32_bf16 v[196:199], a[0:3], v[8:11], 0
    v_mfma_f32_16x16x32_bf16 v[200:203], a[128:131], v[8:11], 0
    s_waitcnt vmcnt(14)
    v_mfma_f32_16x16x32_bf16 v[72:75], a[12:15], v[12:15], v[72:75]
    v_max3_u32 v222, v222, v12, v13
    v_mfma_f32_16x16x32_bf16 v[76:79], a[140:143], v[12:15], v[76:79]
    v_max3_u32 v222, v222, v14, v15
    v_mfma_f32_16x16x32_bf16 v[196:199], a[8:11], v[12:15], v[196:199]
    v_mfma_f32_16x16x32_bf16 v[200:203], a[136:139], v[12:15], v[200:203]
    s_waitcnt vmcnt(13)
    v_mfma_f32_16x16x32_bf16 v[72:75], a[20:23], v[16:19], v[72:75]
    v_max3_u32 v222, v222, v16, v17
    v_mfma_f32_16x16x32_bf16 v[76:79], a[148:151], v[16:19], v[76:79]
    v_max3_u32 v222, v222, v18, v19
    v_mfma_f32_16x16x32_bf16 v[196:199], a[16:19], v[16:19], v[196:199]
    v_mfma_f32_16x16x32_bf16 v[200:203], a[144:147], v[16:19], v[200:203]
    s_waitcnt vmcnt(12)
    v_mfma_f32_16x16x32_bf16 v[72:75], a[28:31], v[20:23], v[72:75]
    v_max3_u32 v222, v222, v20, v21
    v_mfma_f32_16x16x32_bf16 v[76:79], a[156:159], v[20:23], v[76:79]
    v_max3_u32 v222, v222, v22, v23
    v_mfma_f32_16x16x32_bf16 v[196:199], a[24:27], v[20:23], v[196:199]
    v_mfma_f32_16x16x32_bf16 v[200:203], a[152:155], v[20:23], v[200:203]
    s_waitcnt vmcnt(11)
    v_mfma_f32_16x16x32_bf16 v[72:75], a[36:39], v[24:27], v[72:75]
    v_max3_u32 v222, v222, v24, v25
    v_mfma_f32_16x16x32_bf16 v[76:79], a[164:167], v[24:27], v[76:79]
    v_max3_u32 v222, v222, v26, v27
    v_mfma_f32_16x16x32_bf16 v[196:199], a[32:35], v[24:27], v[196:199]
    v_mfma_f32_16x16x32_bf16 v[200:203], a[160:163], v[24:27], v[200:203]
    s_waitcnt vmcnt(10)
    v_mfma_f32_16x16x32_bf16 v[72:75], a[44:47], v[28:31], v[72:75]
    v_max3_u32 v222, v222, v28, v29
    v_mfma_f32_16x16x32_bf16 v[76:79], a[172:175], v[28:31], v[76:79]
    v_max3_u32 v222, v222, v30, v31
    v_mfma_f32_16x16x32_bf16 v[196:199], a[40:43], v[28:31], v[196:199]
    v_mfma_f32_16x16x32_bf16 v[200:203], a[168:171], v[28:31], v[200:203]
    s_waitcnt vmcnt(9)
    v_mfma_f32_16x16x32_bf16 v[72:75], a[52:55], v[32:35], v[72:75]
    v_max3_u32 v222, v222, v32, v33
    v_mfma_f32_16x16x32_bf16 v[76:79], a[180:183], v[32:35], v[76:79]
    v_max3_u32 v222, v222, v34, v35
    v_mfma_f32_16x16x32_bf16 v[196:199], a[48:51], v[32:35], v[196:199]
    v_mfma_f32_16x16x32_bf16 v[200:203], a[176:179], v[32:35], v[200:203]
    s_waitcnt vmcnt(8)
    v_mfma_f32_16x16x32_bf16 v[72:75], a[60:63], v[36:39], v[72:75]
    v_max3_u32 v222, v222, v36, v37
    v_mfma_f32_16x16x32_bf16 v[76:79], a[188:191], v[36:39], v[76:79]
    v_max3_u32 v222, v222, v38, v39
    v_mfma_f32_16x16x32_bf16 v[196:199], a[56:59], v[36:39], v[196:199]
    v_mfma_f32_16x16x32_bf16 v[200:203], a[184:187], v[36:39], v[200:203]
    s_waitcnt vmcnt(7)
    v_mfma_f32_16x16x32_bf16 v[72:75], a[68:71], v[40:43], v[72:75]
    v_max3_u32 v222, v222, v40, v41
    v_mfma_f32_16x16x32_bf16 v[76:79], a[196:199], v[40:43], v[76:79]
    v_max3_u32 v222, v222, v42, v43
    v_mfma_f32_16x16x32_bf16 v[196:199], a[64:67], v[40:43], v[196:199]
    v_mfma_f32_16x16x32_bf16 v[200:203], a[192:195], v[40:43], v[200:203]
    s_waitcnt vmcnt(6)
    v_mfma_f32_16x16x32_bf16 v[72:75], a[76:79], v[44:47], v[72:75]
    v_max3_u32 v222, v222, v44, v45
    v_mfma_f32_16x16x32_bf16 v[76:79], a[204:207], v[44:47], v[76:79]
    v_max3_u32 v222, v222, v46, v47
    v_mfma_f32_16x16x32_bf16 v[196:199], a[72:75], v[44:47], v[196:199]
    v_mfma_f32_16x16x32_bf16 v[200:203], a[200:203], v[44:47], v[200:203]
    s_waitcnt vmcnt(5)
    v_mfma_f32_16x16x32_bf16 v[72:75], a[84:87], v[48:51], v[72:75]
    v_max3_u32 v222, v222, v48, v49
    v_mfma_f32_16x16x32_bf16 v[76:79], a[212:215], v[48:51], v[76:79]
    v_max3_u32 v222, v222, v50, v51
    v_mfma_f32_16x16x32_bf16 v[196:199], a[80:83], v[48:51], v[196:199]
    v_mfma_f32_16x16x32_bf16 v[200:203], a[208:211], v[48:51], v[200:203]
    s_waitcnt vmcnt(4)
    v_mfma_f32_16x16x32_bf16 v[72:75], a[92:95], v[52:55], v[72:75]
    v_max3_u32 v222, v222, v52, v53
    v_mfma_f32_16x16x32_bf16 v[76:79], a[220:223], v[52:55], v[76:79]
    v_max3_u32 v222, v222, v54, v55
    v_mfma_f32_16x16x32_bf16 v[196:199], a[88:91], v[52:55], v[196:199]
    v_mfma_f32_16x16x32_bf16 v[200:203], a[216:219], v[52:55], v[200:203]
    s_waitcnt vmcnt(3)
    v_mfma_f32_16x16x32_bf16 v[72:75], a[100:103], v[56:59], v[72:75]
    v_max3_u32 v222, v222, v56, v57
    v_mfma_f32_16x16x32_bf16 v[76:79], a[228:231], v[56:59], v[76:79]
    v_max3_u32 v222, v222, v58, v59
    v_mfma_f32_16x16x32_bf16 v[196:199], a[96:99], v[56:59], v[196:199]
    v_mfma_f32_16x16x32_bf16 v[200:203], a[224:227], v[56:59], v[200:203]
    s_waitcnt vmcnt(2)
    v_mfma_f32_16x16x32_bf16 v[72:75], a[108:111], v[60:63], v[72:75]
    v_max3_u32 v222, v222, v60, v61
    v_mfma_f32_16x16x32_bf16 v[76:79], a[236:239], v[60:63], v[76:79]
    v_max3_u32 v222, v222, v62, v63
    v_mfma_f32_16x16x32_bf16 v[196:199], a[104:107], v[60:63], v[196:199]
    v_mfma_f32_16x16x32_bf16 v[200:203], a[232:235], v[60:63], v[200:203]
    s_waitcnt vmcnt(1)
    v_mfma_f32_16x16x32_bf16 v[72:75], a[116:119], v[64:67], v[72:75]
    v_max3_u32 v222, v222, v64, v65
    v_mfma_f32_16x16x32_bf16 v[76:79], a[244:247], v[64:67], v[76:79]
    v_max3_u32 v222, v222, v66, v67
    v_mfma_f32_16x16x32_bf16 v[196:199], a[112:115], v[64:67], v[196:199]
    v_mfma_f32_16x16x32_bf16 v[200:203], a[240:243], v[64:67], v[200:203]
    s_waitcnt vmcnt(0)
    v_mfma_f32_16x16x32_bf16 v[72:75], a[124:127], v[68:71], v[72:75]
    v_max3_u32 v222, v222, v68, v69
    v_mfma_f32_16x16x32_bf16 v[76:79], a[252:255], v[68:71], v[76:79]
    v_max3_u32 v222, v222, v70, v71
    v_mfma_f32_16x16x32_bf16 v[196:199], a[120:123], v[68:71], v[196:199]
    v_cmp_eq_u32 vcc, s44, v222
    v_mfma_f32_16x16x32_bf16 v[200:203], a[248:251], v[68:71], v[200:203]
    s_sub_u32 s30, s30, 1
    s_cbranch_scc1 L_FAIL
    s_cbranch_vccnz S2Y_73
    s_cmp_eq_u32 s24, 0
    s_nop 3
    v_add_f32_dpp v196, v72, v196 row_ror:8 row_mask:0xf bank_mask:0xf
    v_add_f32_dpp v197, v73, v197 row_ror:8 row_mask:0xf bank_mask:0xf
    v_add_f32_dpp v198, v74, v198 row_ror:8 row_mask:0xf bank_mask:0xf
    v_add_f32_dpp v199, v75, v199 row_ror:8 row_mask:0xf bank_mask:0xf
    v_add_f32_dpp v200, v76, v200 row_ror:8 row_mask:0xf bank_mask:0xf
    v_add_f32_dpp v201, v77, v201 row_ror:8 row_mask:0xf bank_mask:0xf
    v_add_f32_dpp v202, v78, v202 row_ror:8 row_mask:0xf bank_mask:0xf
    v_add_f32_dpp v203, v79, v203 row_ror:8 row_mask:0xf bank_mask:0xf
    s_cbranch_scc0 S2G_81
    s_branch S2E_72
S2D_82:
    s_endpgm
L_RESTART:
    s_mov_b32 s3, s32
    s_waitcnt vmcnt(0) lgkmcnt(0)
    s_barrier
    v_mbcnt_lo_u32_b32 v0, -1, 0
    v_mbcnt_hi_u32_b32 v0, -1, v0
    s_lshl_b32 s32, s21, 6
    v_add_u32 v0, s32, v0
    s_branch L_ROLE
L_FAIL:
    v_mov_b32 v20, 0xdead
    v_mov_b32 v21, 16
    buffer_store_dword v20, v21, s[16:19], 0 offen
L_END:
    s_waitcnt vmcnt(0)
    s_endpgm
L_CHAIN:
    s_getpc_b64 s[96:97]
    v_lshlrev_b32 v8, 6, v0
    global_load_dword v240, v8, s[96:97]
    s_mov_b32 s78, 0x400000
    s_mov_b32 s79, 0x20000
    s_mov_b32 s82, 0x400000
    s_mov_b32 s83, 0x20000
    s_mov_b32 s86, 0x400000
    s_mov_b32 s87, 0x20000
    s_mov_b32 s90, 0x400000
    s_mov_b32 s91, 0x20000
    v_and_b32 v1, 63, v0
    s_and_b32 s32, s21, 3
    s_lshl_b32 s32, s32, 2
    v_xor_b32 v2, s32, v1
    v_lshlrev_b32 v113, 4, v2
    v_lshrrev_b32 v3, 4, v1
    v_and_b32 v4, 3, v3
    v_lshlrev_b32 v4, 2, v4
    v_xor_b32 v4, v4, v1
    v_and_b32 v4, 15, v4
    v_lshlrev_b32 v4, 4, v4
    v_and_b32 v5, 1, v3
    v_lshrrev_b32 v6, 1, v3
    v_lshl_add_u32 v5, v5, 2, v6
    v_lshl_add_u32 v112, v5, 13, v4
    s_lshl_b32 s92, s21, 19
    s_lshl_b32 s32, s20, 8
    s_add_u32 s92, s92, s32
    s_lshr_b32 s32, s21, 1
    s_lshl_b32 s32, s32, 2
    s_and_b32 s33, s21, 1
    s_add_u32 s32, s32, s33
    s_lshl_b32 s32, s32, 10
    s_lshl_b32 s93, s20, 17
    s_add_u32 s93, s93, s32
    s_lshl_b32 s94, s21, 13
    s_lshl_b32 s95, s21, 10
    s_add_u32 m0, s95, 131072
    s_add_u32 s35, s93, 0
    buffer_load_dwordx4 v113, s[84:87], s35 offen nt lds
    s_add_u32 m0, s95, 135168
    s_add_u32 s35, s93, 8192
    buffer_load_dwordx4 v113, s[84:87], s35 offen nt lds
    s_add_u32 m0, s95, 139264
    s_add_u32 s35, s93, 32768
    buffer_load_dwordx4 v113, s[84:87], s35 offen nt lds
    s_add_u32 m0, s95, 143360
    s_add_u32 s35, s93, 40960
    buffer_load_dwordx4 v113, s[84:87], s35 offen nt lds
    s_add_u32 m0, s95, 147456
    s_add_u32 s35, s93, 65536
    buffer_load_dwordx4 v113, s[84:87], s35 offen nt lds
    s_add_u32 m0, s95, 151552
    s_add_u32 s35, s93, 73728
    buffer_load_dwordx4 v113, s[84:87], s35 offen nt lds
    s_add_u32 m0, s95, 155648
    s_add_u32 s35, s93, 98304
    buffer_load_dwordx4 v113, s[84:87], s35 offen nt lds
    s_add_u32 m0, s95, 159744
    s_add_u32 s35, s93, 106496
    buffer_load_dwordx4 v113, s[84:87], s35 offen nt lds
    s_add_u32 m0, s95, 0
    s_add_u32 s35, s93, 2048
    buffer_load_dwordx4 v113, s[84:87], s35 offen nt lds
    s_add_u32 m0, s95, 4096
    s_add_u32 s35, s93, 10240
    buffer_load_dwordx4 v113, s[84:87], s35 offen nt lds
    s_add_u32 m0, s95, 8192
    s_add_u32 s35, s93, 34816
    buffer_load_dwordx4 v113, s[84:87], s35 offen nt lds
    s_add_u32 m0, s95, 12288
    s_add_u32 s35, s93, 43008
    buffer_load_dwordx4 v113, s[84:87], s35 offen nt lds
    s_add_u32 m0, s95, 16384
    s_add_u32 s35, s93, 67584
    buffer_load_dwordx4 v113, s[84:87], s35 offen nt lds
    s_add_u32 m0, s95, 20480
    s_add_u32 s35, s93, 75776
    buffer_load_dwordx4 v113, s[84:87], s35 offen nt lds
    s_add_u32 m0, s95, 24576
    s_add_u32 s35, s93, 100352
    buffer_load_dwordx4 v113, s[84:87], s35 offen nt lds
    s_add_u32 m0, s95, 28672
    s_add_u32 s35, s93, 108544
    buffer_load_dwordx4 v113, s[84:87], s35 offen nt lds
    s_add_u32 m0, s95, 32768
    s_add_u32 s35, s93, 16384
    buffer_load_dwordx4 v113, s[84:87], s35 offen nt lds
    s_add_u32 m0, s95, 36864
    s_add_u32 s35, s93, 24576
    buffer_load_dwordx4 v113, s[84:87], s35 offen nt lds
    s_add_u32 m0, s95, 40960
    s_add_u32 s35, s93, 49152
    buffer_load_dwordx4 v113, s[84:87], s35 offen nt lds
    s_add_u32 m0, s95, 45056
    s_add_u32 s35, s93, 57344
    buffer_load_dwordx4 v113, s[84:87], s35 offen nt lds
    s_add_u32 m0, s95, 49152
    s_add_u32 s35, s93, 81920
    buffer_load_dwordx4 v113, s[84:87], s35 offen nt lds
    s_add_u32 m0, s95, 53248
    s_add_u32 s35, s93, 90112
    buffer_load_dwordx4 v113, s[84:87], s35 offen nt lds
    s_add_u32 m0, s95, 57344
    s_add_u32 s35, s93, 114688
    buffer_load_dwordx4 v113, s[84:87], s35 offen nt lds
    s_add_u32 m0, s95, 61440
    s_add_u32 s35, s93, 122880
    buffer_load_dwordx4 v113, s[84:87], s35 offen nt lds
    v_and_b32 v1, 63, v0
    v_lshlrev_b32 v121, 4, v1
    v_and_b32 v2, 15, v1
    v_lshrrev_b32 v3, 4, v1
    v_and_b32 v4, 3, v1
    v_bfe_u32 v5, v1, 2, 2
    v_mov_b32 v6, 0x4444
    v_mov_b32 v7, 0xEEEE
    v_cmp_gt_u32 vcc, 2, v4
    s_nop 1
    v_cndmask_b32 v120, v7, v6, vcc
    s_lshl_b32 s33, s21, 9
    v_mov_b32 v6, 28672
    v_mov_b32 v7, 20480
    v_cndmask_b32 v6, v7, v6, vcc
    v_and_b32 v7, 1, v2
    v_lshl_add_u32 v7, v5, 1, v7
    v_and_b32 v8, 2, v2
    v_lshlrev_b32 v8, 1, v8
    v_xor_b32 v7, v7, v8
    v_lshl_add_u32 v6, v7, 4, v6
    v_lshl_add_u32 v6, v3, 7, v6
    v_add_u32 v123, s33, v6
    s_lshr_b32 s32, s21, 1
    s_lshl_b32 s32, s32, 16
    s_and_b32 s34, s21, 1
    s_lshl_b32 s34, s34, 14
    s_add_u32 s32, s32, s34
    s_add_u32 s32, s32, 32768
    v_add_u32 v122, s32, v121
    s_lshl_b32 s33, s21, 10
    s_add_u32 s33, s33, 16384
    v_add_u32 v6, v3, v5
    v_and_b32 v6, 3, v6
    v_lshlrev_b32 v6, 3, v6
    v_lshl_add_u32 v6, v2, 5, v6
    v_add_u32 v124, s33, v6
    v_add_u32 v6, v3, v4
    v_and_b32 v6, 3, v6
    v_lshlrev_b32 v6, 3, v6
    v_lshrrev_b32 v7, 2, v1
    v_lshl_add_u32 v6, v7, 5, v6
    v_add_u32 v125, 16384, v6
    s_mul_i32 s34, s21, 32768
    s_lshl_b32 s33, s21, 2
    s_mul_i32 s33, s33, 0
    s_add_u32 s33, s33, s20
    v_mul_u32_u24 v7, 0, v3
    v_add_u32 v7, s33, v7
    v_and_b32 v7, 31, v7
    v_mul_u32_u24 v6, 8192, v3
    v_lshl_add_u32 v6, v2, 2, v6
    v_lshl_add_u32 v6, v7, 8, v6
    v_add_u32 v126, s34, v6
    v_lshlrev_b32 v6, 4, v3
    v_lshl_add_u32 v6, v5, 1, v6
    v_and_b32 v7, 1, v2
    v_add_u32 v6, v6, v7
    v_lshlrev_b32 v6, 4, v6
    v_and_b32 v7, 2, v2
    v_lshl_add_u32 v6, v7, 2, v6
    s_lshr_b32 s33, s20, 2
    s_lshl_b32 s33, s33, 10
    s_and_b32 s34, s20, 3
    s_lshl_b32 s34, s34, 6
    s_add_u32 s33, s33, s34
    v_add_u32 v6, s33, v6
    v_mov_b32 v7, 0x80000000
    v_cmp_gt_u32 vcc, 8, v2
    s_nop 1
    v_cndmask_b32 v6, v7, v6, vcc
    v_cmp_gt_u32 vcc, 64, v0
    s_nop 1
    v_cndmask_b32 v127, v7, v6, vcc
    s_add_u32 s48, s4, 92536832
    s_addc_u32 s49, s5, 0
    s_mov_b32 s50, 1572864
    s_mov_b32 s51, 0x20000
    s_add_u32 s52, s4, 92540928
    s_addc_u32 s53, s5, 0
    s_mov_b32 s54, 1572864
    s_mov_b32 s55, 0x20000
    s_add_u32 s56, s4, 92274688
    s_addc_u32 s57, s5, 0
    s_mov_b32 s58, 1572864
    s_mov_b32 s59, 0x20000
    s_add_u32 s60, s4, 92405760
    s_addc_u32 s61, s5, 0
    s_mov_b32 s62, 1572864
    s_mov_b32 s63, 0x20000
    s_mul_i32 s33, s20, 8192
    s_add_u32 s35, s33, 92274688
    s_add_u32 s64, s4, s35
    s_addc_u32 s65, s5, 0
    s_mov_b32 s66, 1572864
    s_mov_b32 s67, 0x20000
    s_add_u32 s35, s33, 92278784
    s_add_u32 s68, s4, s35
    s_addc_u32 s69, s5, 0
    s_mov_b32 s70, 1572864
    s_mov_b32 s71, 0x20000
    s_mov_b32 s23, 0
    s_mov_b32 s24, 524288
    s_mov_b32 s25, 1048576
    v_and_b32 v1, 63, v0
    v_lshrrev_b32 v3, 4, v1
    v_bfe_u32 v5, v1, 2, 2
    v_and_b32 v4, 3, v1
    v_and_b32 v6, 1, v3
    v_and_b32 v7, 1, v5
    v_lshl_add_u32 v6, v6, 1, v7
    v_lshrrev_b32 v7, 1, v3
    v_lshlrev_b32 v7, 4, v7
    v_lshrrev_b32 v8, 1, v5
    v_lshl_add_u32 v7, v8, 3, v7
    v_add_u32 v7, v7, v6
    v_and_b32 v6, 3, v6
    v_xor_b32 v8, s21, v6
    v_lshlrev_b32 v8, 6, v8
    v_lshl_add_u32 v8, v7, 8, v8
    v_lshl_add_u32 v8, v4, 4, v8
    v_and_b32 v9, 2, v5
    v_lshl_add_u32 v8, v9, 2, v8
    s_lshl_b32 s32, s21, 13
    v_add_u32 v8, s32, v8
    v_mov_b32 v114, v8
    v_xor_b32 v115, 8192, v8
    v_xor_b32 v116, 16384, v8
    v_xor_b32 v117, 24576, v8
    s_lshl_b32 s32, s21, 7
    v_lshlrev_b32 v8, 3, v4
    v_add_u32 v8, s32, v8
    v_lshrrev_b32 v9, 1, v5
    v_lshl_add_u32 v8, v9, 5, v8
    v_lshlrev_b32 v9, 6, v6
    v_xor_b32 v8, v8, v9
    v_and_b32 v9, 1, v5
    v_lshl_add_u32 v9, v3, 1, v9
    v_lshl_add_u32 v8, v9, 10, v8
    s_lshl_b32 s32, s21, 13
    v_add_u32 v118, s32, v8
    s_lshl_b32 s32, s20, 13
    s_lshl_b32 s33, s21, 11
    s_add_u32 s32, s32, s33
    s_add_u32 s26, s32, 2097152
    s_add_u32 s27, s32, 18874368
    s_add_u32 s36, s33, 0
    s_add_u32 s37, s33, 8192
    s_mov_b32 s28, 75497472
    s_lshl_b32 s29, s21, 10
    s_lshl_b32 s31, s20, 12
    s_add_u32 s31, s31, 94502912
    s_mov_b32 s22, 0
    s_mov_b32 s72, 0x3e0293ee
    s_mov_b32 s73, 0x3e0293ee
    s_mov_b32 s74, 0x3f803f80
    s_mov_b32 s75, 0x3f803f80
    s_mov_b32 s100, 0x3f803f80
    s_mov_b32 s101, 0
    s_lshr_b32 s42, s20, 0
    s_and_b32 s42, s42, 1
    s_lshl_b32 s42, s42, 7
    s_xor_b32 s43, s42, 128
    s_mov_b32 s46, 0x33333333
    s_mov_b32 s47, 0x33333333
    s_load_dwordx2 s[8:9], s[0:1], 8
    s_mov_b32 s10, 8192
    s_mov_b32 s11, 0x20000
    s_waitcnt lgkmcnt(0)
    v_and_b32 v96, 63, v0
    v_and_b32 v97, 1, v96
    v_lshlrev_b32 v97, 10, v97
    v_bfe_u32 v98, v96, 1, 2
    v_lshl_add_u32 v97, v98, 1, v97
    v_lshrrev_b32 v96, 4, v96
    v_lshl_add_u32 v97, v96, 5, v97
    s_and_b32 s32, s20, 3
    s_lshl_b32 s32, s32, 11
    s_lshr_b32 s33, s20, 2
    s_lshl_b32 s33, s33, 7
    s_add_u32 s32, s32, s33
    v_mov_b64 v[104:105], -1
    v_mov_b64 v[106:107], -1
    v_mov_b32 v110, 0
    buffer_load_ushort v100, v97, s[8:11], s32 offen offset:0
    buffer_load_ushort v102, v97, s[8:11], s32 offen offset:8
    buffer_load_ushort v101, v97, s[8:11], s32 offen offset:16
    buffer_load_ushort v103, v97, s[8:11], s32 offen offset:24
    buffer_load_dwordx2 v[108:109], v110, s[16:19], 0 offen sc1
    s_waitcnt vmcnt(21)
    s_barrier
    s_add_u32 m0, s95, 98304
    s_add_u32 s35, s93, 18432
    buffer_load_dwordx4 v113, s[84:87], s35 offen nt lds
    s_add_u32 m0, s95, 102400
    s_add_u32 s35, s93, 26624
    buffer_load_dwordx4 v113, s[84:87], s35 offen nt lds
    s_add_u32 m0, s95, 106496
    s_add_u32 s35, s93, 51200
    buffer_load_dwordx4 v113, s[84:87], s35 offen nt lds
    s_add_u32 m0, s95, 110592
    s_add_u32 s35, s93, 59392
    buffer_load_dwordx4 v113, s[84:87], s35 offen nt lds
    s_add_u32 m0, s95, 114688
    s_add_u32 s35, s93, 83968
    buffer_load_dwordx4 v113, s[84:87], s35 offen nt lds
    s_add_u32 m0, s95, 118784
    s_add_u32 s35, s93, 92160
    buffer_load_dwordx4 v113, s[84:87], s35 offen nt lds
    s_add_u32 m0, s95, 122880
    s_add_u32 s35, s93, 116736
    buffer_load_dwordx4 v113, s[84:87], s35 offen nt lds
    s_add_u32 m0, s95, 126976
    s_add_u32 s35, s93, 124928
    buffer_load_dwordx4 v113, s[84:87], s35 offen nt lds
    v_xor_b32 v119, 131072, v118
    ds_read_b64_tr_b16 v[0:1], v119 offset:0
    ds_read_b64_tr_b16 v[16:17], v119 offset:512
    v_xor_b32 v119, 131136, v118
    ds_read_b64_tr_b16 v[8:9], v119 offset:0
    ds_read_b64_tr_b16 v[24:25], v119 offset:512
    v_xor_b32 v119, 139264, v118
    ds_read_b64_tr_b16 a[192:193], v119 offset:0
    ds_read_b64_tr_b16 a[240:241], v119 offset:512
    v_xor_b32 v119, 139328, v118
    ds_read_b64_tr_b16 a[216:217], v119 offset:0
    ds_read_b64_tr_b16 v[40:41], v119 offset:512
    v_xor_b32 v119, 147456, v118
    ds_read_b64_tr_b16 a[200:201], v119 offset:0
    ds_read_b64_tr_b16 a[248:249], v119 offset:512
    v_xor_b32 v119, 147520, v118
    ds_read_b64_tr_b16 a[224:225], v119 offset:0
    ds_read_b64_tr_b16 v[48:49], v119 offset:512
    v_xor_b32 v119, 155648, v118
    ds_read_b64_tr_b16 a[208:209], v119 offset:0
    ds_read_b64_tr_b16 v[32:33], v119 offset:512
    v_xor_b32 v119, 155712, v118
    ds_read_b64_tr_b16 a[232:233], v119 offset:0
    ds_read_b64_tr_b16 v[56:57], v119 offset:512
    s_waitcnt lgkmcnt(0)
    s_waitcnt vmcnt(21)
    s_barrier
    s_add_u32 m0, s94, 65536
    s_add_u32 s35, s92, 0
    buffer_load_dwordx4 v112, s[80:83], s35 offen  lds
    s_add_u32 m0, s94, 66560
    s_add_u32 s35, s92, 65536
    buffer_load_dwordx4 v112, s[80:83], s35 offen  lds
    s_add_u32 m0, s94, 67584
    s_add_u32 s35, s92, 16384
    buffer_load_dwordx4 v112, s[80:83], s35 offen  lds
    s_add_u32 m0, s94, 68608
    s_add_u32 s35, s92, 81920
    buffer_load_dwordx4 v112, s[80:83], s35 offen  lds
    s_add_u32 m0, s94, 69632
    s_add_u32 s35, s92, 131072
    buffer_load_dwordx4 v112, s[80:83], s35 offen  lds
    s_add_u32 m0, s94, 70656
    s_add_u32 s35, s92, 196608
    buffer_load_dwordx4 v112, s[80:83], s35 offen  lds
    s_add_u32 m0, s94, 71680
    s_add_u32 s35, s92, 147456
    buffer_load_dwordx4 v112, s[80:83], s35 offen  lds
    s_add_u32 m0, s94, 72704
    s_add_u32 s35, s92, 212992
    buffer_load_dwordx4 v112, s[80:83], s35 offen  lds
    v_xor_b32 v119, 0, v118
    ds_read_b64_tr_b16 v[2:3], v119 offset:0
    ds_read_b64_tr_b16 v[18:19], v119 offset:512
    v_xor_b32 v119, 64, v118
    ds_read_b64_tr_b16 v[10:11], v119 offset:0
    ds_read_b64_tr_b16 v[26:27], v119 offset:512
    v_xor_b32 v119, 8192, v118
    ds_read_b64_tr_b16 a[194:195], v119 offset:0
    ds_read_b64_tr_b16 a[242:243], v119 offset:512
    v_xor_b32 v119, 8256, v118
    ds_read_b64_tr_b16 a[218:219], v119 offset:0
    ds_read_b64_tr_b16 v[42:43], v119 offset:512
    v_xor_b32 v119, 16384, v118
    ds_read_b64_tr_b16 a[202:203], v119 offset:0
    ds_read_b64_tr_b16 a[250:251], v119 offset:512
    v_xor_b32 v119, 16448, v118
    ds_read_b64_tr_b16 a[226:227], v119 offset:0
    ds_read_b64_tr_b16 v[50:51], v119 offset:512
    v_xor_b32 v119, 24576, v118
    ds_read_b64_tr_b16 a[210:211], v119 offset:0
    ds_read_b64_tr_b16 v[34:35], v119 offset:512
    v_xor_b32 v119, 24640, v118
    ds_read_b64_tr_b16 a[234:235], v119 offset:0
    ds_read_b64_tr_b16 v[58:59], v119 offset:512
    s_waitcnt lgkmcnt(0)
    s_waitcnt vmcnt(21)
    s_barrier
    s_add_u32 m0, s94, 131072
    s_add_u32 s35, s92, 262144
    buffer_load_dwordx4 v112, s[80:83], s35 offen  lds
    s_add_u32 m0, s94, 132096
    s_add_u32 s35, s92, 327680
    buffer_load_dwordx4 v112, s[80:83], s35 offen  lds
    s_add_u32 m0, s94, 133120
    s_add_u32 s35, s92, 278528
    buffer_load_dwordx4 v112, s[80:83], s35 offen  lds
    s_add_u32 m0, s94, 134144
    s_add_u32 s35, s92, 344064
    buffer_load_dwordx4 v112, s[80:83], s35 offen  lds
    s_add_u32 m0, s94, 135168
    s_add_u32 s35, s92, 393216
    buffer_load_dwordx4 v112, s[80:83], s35 offen  lds
    s_add_u32 m0, s94, 136192
    s_add_u32 s35, s92, 458752
    buffer_load_dwordx4 v112, s[80:83], s35 offen  lds
    s_add_u32 m0, s94, 137216
    s_add_u32 s35, s92, 409600
    buffer_load_dwordx4 v112, s[80:83], s35 offen  lds
    s_add_u32 m0, s94, 138240
    s_add_u32 s35, s92, 475136
    buffer_load_dwordx4 v112, s[80:83], s35 offen  lds
    v_xor_b32 v119, 32768, v118
    ds_read_b64_tr_b16 v[4:5], v119 offset:0
    ds_read_b64_tr_b16 v[20:21], v119 offset:512
    v_xor_b32 v119, 32832, v118
    ds_read_b64_tr_b16 v[12:13], v119 offset:0
    ds_read_b64_tr_b16 v[28:29], v119 offset:512
    v_xor_b32 v119, 40960, v118
    ds_read_b64_tr_b16 a[196:197], v119 offset:0
    ds_read_b64_tr_b16 a[244:245], v119 offset:512
    v_xor_b32 v119, 41024, v118
    ds_read_b64_tr_b16 a[220:221], v119 offset:0
    ds_read_b64_tr_b16 v[44:45], v119 offset:512
    v_xor_b32 v119, 49152, v118
    ds_read_b64_tr_b16 a[204:205], v119 offset:0
    ds_read_b64_tr_b16 a[252:253], v119 offset:512
    v_xor_b32 v119, 49216, v118
    ds_read_b64_tr_b16 a[228:229], v119 offset:0
    ds_read_b64_tr_b16 v[52:53], v119 offset:512
    v_xor_b32 v119, 57344, v118
    ds_read_b64_tr_b16 a[212:213], v119 offset:0
    ds_read_b64_tr_b16 v[36:37], v119 offset:512
    v_xor_b32 v119, 57408, v118
    ds_read_b64_tr_b16 a[236:237], v119 offset:0
    ds_read_b64_tr_b16 v[60:61], v119 offset:512
    s_waitcnt lgkmcnt(0)
    s_waitcnt vmcnt(16)
    s_barrier
    v_lshl_or_b32 v100, v102, 16, v100
    v_lshl_or_b32 v101, v103, 16, v101
    v_min_u32 v100, -2, v100
    v_min_u32 v101, -2, v101
    v_readfirstlane_b32 s38, v108
    v_readfirstlane_b32 s39, v109
    s_nop 1
    s_cmp_lg_u32 s39, 0
    s_cbranch_scc1 TK_84
    s_mov_b32 s30, 1000000
TP_85:
    buffer_load_dwordx2 v[108:109], v110, s[16:19], 0 offen sc1
    s_sub_u32 s30, s30, 1
    s_cbranch_scc1 L_FAIL2
    s_waitcnt vmcnt(0)
    v_readfirstlane_b32 s38, v108
    v_readfirstlane_b32 s39, v109
    s_nop 3
    s_cmp_eq_u32 s39, 0
    s_cbranch_scc1 TP_85
TK_84:
    s_bfe_u32 s32, s39, 0x30018
    s_cmp_lg_u32 s32, s3
    s_cbranch_scc1 L_RESTART
    buffer_store_dwordx2 v[100:101], v127, s[48:51], s23 offen sc1
    buffer_store_dword v104, v126, s[56:59], 0 offen offset:0 sc1
    buffer_store_dword v104, v126, s[56:59], 0 offen offset:64 sc1
    buffer_store_dword v104, v126, s[56:59], 0 offen offset:128 sc1
    buffer_store_dword v104, v126, s[56:59], 0 offen offset:192 sc1
    buffer_store_dword v104, v126, s[60:63], 0 offen offset:0 sc1
    buffer_store_dword v104, v126, s[60:63], 0 offen offset:64 sc1
    buffer_store_dword v104, v126, s[60:63], 0 offen offset:128 sc1
    buffer_store_dword v104, v126, s[60:63], 0 offen offset:192 sc1
    buffer_store_dwordx2 v[104:105], v127, s[48:51], s24 offen sc1
    s_lshl_b32 s32, s20, 14
    s_lshl_b32 s33, s21, 12
    s_add_u32 s32, s32, s33
    s_add_u32 s32, s32, 75497472
    s_add_u32 m0, s94, 0
    s_add_u32 s35, s92, 2097152
    buffer_load_dwordx4 v112, s[80:83], s35 offen  lds
    s_add_u32 m0, s94, 1024
    s_add_u32 s35, s92, 2162688
    buffer_load_dwordx4 v112, s[80:83], s35 offen  lds
    s_add_u32 m0, s94, 2048
    s_add_u32 s35, s92, 2113536
    buffer_load_dwordx4 v112, s[80:83], s35 offen  lds
    s_add_u32 m0, s94, 3072
    s_add_u32 s35, s92, 2179072
    buffer_load_dwordx4 v112, s[80:83], s35 offen  lds
    s_add_u32 m0, s94, 4096
    s_add_u32 s35, s92, 2228224
    buffer_load_dwordx4 v112, s[80:83], s35 offen  lds
    s_add_u32 m0, s94, 5120
    s_add_u32 s35, s92, 2293760
    buffer_load_dwordx4 v112, s[80:83], s35 offen  lds
    s_add_u32 m0, s94, 6144
    s_add_u32 s35, s92, 2244608
    buffer_load_dwordx4 v112, s[80:83], s35 offen  lds
    s_add_u32 m0, s94, 7168
    s_add_u32 s35, s92, 2310144
    buffer_load_dwordx4 v112, s[80:83], s35 offen  lds
    v_xor_b32 v119, 98304, v118
    ds_read_b64_tr_b16 v[6:7], v119 offset:0
    ds_read_b64_tr_b16 v[22:23], v119 offset:512
    v_xor_b32 v119, 98368, v118
    ds_read_b64_tr_b16 v[14:15], v119 offset:0
    ds_read_b64_tr_b16 v[30:31], v119 offset:512
    v_xor_b32 v119, 106496, v118
    ds_read_b64_tr_b16 a[198:199], v119 offset:0
    ds_read_b64_tr_b16 a[246:247], v119 offset:512
    v_xor_b32 v119, 106560, v118
    ds_read_b64_tr_b16 a[222:223], v119 offset:0
    ds_read_b64_tr_b16 v[46:47], v119 offset:512
    v_xor_b32 v119, 114688, v118
    ds_read_b64_tr_b16 a[206:207], v119 offset:0
    ds_read_b64_tr_b16 a[254:255], v119 offset:512
    v_xor_b32 v119, 114752, v118
    ds_read_b64_tr_b16 a[230:231], v119 offset:0
    ds_read_b64_tr_b16 v[54:55], v119 offset:512
    v_xor_b32 v119, 122880, v118
    ds_read_b64_tr_b16 a[214:215], v119 offset:0
    ds_read_b64_tr_b16 v[38:39], v119 offset:512
    v_xor_b32 v119, 122944, v118
    ds_read_b64_tr_b16 a[238:239], v119 offset:0
    ds_read_b64_tr_b16 v[62:63], v119 offset:512
    s_waitcnt lgkmcnt(0)
    s_waitcnt vmcnt(26)
    s_barrier
    s_add_u32 m0, s94, 32768
    s_add_u32 s35, s92, 2359296
    buffer_load_dwordx4 v112, s[80:83], s35 offen  lds
    s_add_u32 m0, s94, 33792
    s_add_u32 s35, s92, 2424832
    buffer_load_dwordx4 v112, s[80:83], s35 offen  lds
    s_add_u32 m0, s94, 34816
    s_add_u32 s35, s92, 2375680
    buffer_load_dwordx4 v112, s[80:83], s35 offen  lds
    s_add_u32 m0, s94, 35840
    s_add_u32 s35, s92, 2441216
    buffer_load_dwordx4 v112, s[80:83], s35 offen  lds
    s_add_u32 m0, s94, 36864
    s_add_u32 s35, s92, 2490368
    buffer_load_dwordx4 v112, s[80:83], s35 offen  lds
    s_add_u32 m0, s94, 37888
    s_add_u32 s35, s92, 2555904
    buffer_load_dwordx4 v112, s[80:83], s35 offen  lds
    s_add_u32 m0, s94, 38912
    s_add_u32 s35, s92, 2506752
    buffer_load_dwordx4 v112, s[80:83], s35 offen  lds
    s_add_u32 m0, s94, 39936
    s_add_u32 s35, s92, 2572288
    buffer_load_dwordx4 v112, s[80:83], s35 offen  lds
    v_add_u32 v114, 65536, v114
    v_add_u32 v115, 65536, v115
    v_add_u32 v116, 65536, v116
    v_add_u32 v117, 65536, v117
    ds_read_b64_tr_b16 a[0:1], v114 offset:0
    ds_read_b64_tr_b16 a[2:3], v114 offset:1024
    v_xor_b32 v119, 8, v114
    ds_read_b64_tr_b16 a[8:9], v119 offset:0
    ds_read_b64_tr_b16 a[10:11], v119 offset:1024
    ds_read_b64_tr_b16 a[32:33], v115 offset:0
    ds_read_b64_tr_b16 a[34:35], v115 offset:1024
    v_xor_b32 v119, 8, v115
    ds_read_b64_tr_b16 a[40:41], v119 offset:0
    ds_read_b64_tr_b16 a[42:43], v119 offset:1024
    ds_read_b64_tr_b16 a[64:65], v116 offset:0
    ds_read_b64_tr_b16 a[66:67], v116 offset:1024
    v_xor_b32 v119, 8, v116
    ds_read_b64_tr_b16 a[72:73], v119 offset:0
    ds_read_b64_tr_b16 a[74:75], v119 offset:1024
    ds_read_b64_tr_b16 a[96:97], v117 offset:0
    ds_read_b64_tr_b16 a[98:99], v117 offset:1024
    v_xor_b32 v119, 8, v117
    ds_read_b64_tr_b16 a[104:105], v119 offset:0
    ds_read_b64_tr_b16 a[106:107], v119 offset:1024
    v_subrev_u32 v114, 65536, v114
    v_subrev_u32 v115, 65536, v115
    v_subrev_u32 v116, 65536, v116
    v_subrev_u32 v117, 65536, v117
    s_waitcnt lgkmcnt(0)
    s_waitcnt vmcnt(26)
    s_barrier
    s_add_u32 m0, s94, 98304
    s_add_u32 s35, s92, 0
    buffer_load_dwordx4 v112, s[76:79], s35 offen  lds
    s_add_u32 m0, s94, 99328
    s_add_u32 s35, s92, 65536
    buffer_load_dwordx4 v112, s[76:79], s35 offen  lds
    s_add_u32 m0, s94, 100352
    s_add_u32 s35, s92, 16384
    buffer_load_dwordx4 v112, s[76:79], s35 offen  lds
    s_add_u32 m0, s94, 101376
    s_add_u32 s35, s92, 81920
    buffer_load_dwordx4 v112, s[76:79], s35 offen  lds
    s_add_u32 m0, s94, 102400
    s_add_u32 s35, s92, 131072
    buffer_load_dwordx4 v112, s[76:79], s35 offen  lds
    s_add_u32 m0, s94, 103424
    s_add_u32 s35, s92, 196608
    buffer_load_dwordx4 v112, s[76:79], s35 offen  lds
    s_add_u32 m0, s94, 104448
    s_add_u32 s35, s92, 147456
    buffer_load_dwordx4 v112, s[76:79], s35 offen  lds
    s_add_u32 m0, s94, 105472
    s_add_u32 s35, s92, 212992
    buffer_load_dwordx4 v112, s[76:79], s35 offen  lds
    v_add_u32 v114, 131072, v114
    v_add_u32 v115, 131072, v115
    v_add_u32 v116, 131072, v116
    v_add_u32 v117, 131072, v117
    ds_read_b64_tr_b16 a[4:5], v114 offset:0
    ds_read_b64_tr_b16 a[6:7], v114 offset:1024
    v_xor_b32 v119, 8, v114
    ds_read_b64_tr_b16 a[12:13], v119 offset:0
    ds_read_b64_tr_b16 a[14:15], v119 offset:1024
    ds_read_b64_tr_b16 a[36:37], v115 offset:0
    ds_read_b64_tr_b16 a[38:39], v115 offset:1024
    v_xor_b32 v119, 8, v115
    ds_read_b64_tr_b16 a[44:45], v119 offset:0
    ds_read_b64_tr_b16 a[46:47], v119 offset:1024
    ds_read_b64_tr_b16 a[68:69], v116 offset:0
    ds_read_b64_tr_b16 a[70:71], v116 offset:1024
    v_xor_b32 v119, 8, v116
    ds_read_b64_tr_b16 a[76:77], v119 offset:0
    ds_read_b64_tr_b16 a[78:79], v119 offset:1024
    ds_read_b64_tr_b16 a[100:101], v117 offset:0
    ds_read_b64_tr_b16 a[102:103], v117 offset:1024
    v_xor_b32 v119, 8, v117
    ds_read_b64_tr_b16 a[108:109], v119 offset:0
    ds_read_b64_tr_b16 a[110:111], v119 offset:1024
    v_subrev_u32 v114, 131072, v114
    v_subrev_u32 v115, 131072, v115
    v_subrev_u32 v116, 131072, v116
    v_subrev_u32 v117, 131072, v117
    s_waitcnt lgkmcnt(0)
    s_waitcnt vmcnt(16)
    s_barrier
    s_getreg_b32 s32, hwreg(HW_REG_XCC_ID, 0, 4)
    s_lshl_b32 s32, s32, 28
    s_or_b32 s32, s32, s39
    v_mov_b32 v108, s38
    v_mov_b32 v109, s32
    s_lshl_b32 s33, s20, 7
    s_add_u32 s33, s33, 94371840
    buffer_store_dwordx2 v[108:109], v110, s[4:7], s33 offen sc1
    s_add_u32 m0, s94, 65536
    s_add_u32 s35, s92, 262144
    buffer_load_dwordx4 v112, s[76:79], s35 offen  lds
    s_add_u32 m0, s94, 66560
    s_add_u32 s35, s92, 327680
    buffer_load_dwordx4 v112, s[76:79], s35 offen  lds
    s_add_u32 m0, s94, 67584
    s_add_u32 s35, s92, 278528
    buffer_load_dwordx4 v112, s[76:79], s35 offen  lds
    s_add_u32 m0, s94, 68608
    s_add_u32 s35, s92, 344064
    buffer_load_dwordx4 v112, s[76:79], s35 offen  lds
    s_add_u32 m0, s94, 69632
    s_add_u32 s35, s92, 393216
    buffer_load_dwordx4 v112, s[76:79], s35 offen  lds
    s_add_u32 m0, s94, 70656
    s_add_u32 s35, s92, 458752
    buffer_load_dwordx4 v112, s[76:79], s35 offen  lds
    s_add_u32 m0, s94, 71680
    s_add_u32 s35, s92, 409600
    buffer_load_dwordx4 v112, s[76:79], s35 offen  lds
    s_add_u32 m0, s94, 72704
    s_add_u32 s35, s92, 475136
    buffer_load_dwordx4 v112, s[76:79], s35 offen  lds
    ds_read_b64_tr_b16 a[16:17], v114 offset:0
    ds_read_b64_tr_b16 a[18:19], v114 offset:1024
    v_xor_b32 v119, 8, v114
    ds_read_b64_tr_b16 a[24:25], v119 offset:0
    ds_read_b64_tr_b16 a[26:27], v119 offset:1024
    ds_read_b64_tr_b16 a[48:49], v115 offset:0
    ds_read_b64_tr_b16 a[50:51], v115 offset:1024
    v_xor_b32 v119, 8, v115
    ds_read_b64_tr_b16 a[56:57], v119 offset:0
    ds_read_b64_tr_b16 a[58:59], v119 offset:1024
    ds_read_b64_tr_b16 a[80:81], v116 offset:0
    ds_read_b64_tr_b16 a[82:83], v116 offset:1024
    v_xor_b32 v119, 8, v116
    ds_read_b64_tr_b16 a[88:89], v119 offset:0
    ds_read_b64_tr_b16 a[90:91], v119 offset:1024
    ds_read_b64_tr_b16 a[112:113], v117 offset:0
    ds_read_b64_tr_b16 a[114:115], v117 offset:1024
    v_xor_b32 v119, 8, v117
    ds_read_b64_tr_b16 a[120:121], v119 offset:0
    ds_read_b64_tr_b16 a[122:123], v119 offset:1024
    s_waitcnt lgkmcnt(0)
    s_waitcnt vmcnt(17)
    s_barrier
    s_add_u32 m0, s94, 131072
    s_add_u32 s35, s92, 2097152
    buffer_load_dwordx4 v112, s[76:79], s35 offen  lds
    s_add_u32 m0, s94, 132096
    s_add_u32 s35, s92, 2162688
    buffer_load_dwordx4 v112, s[76:79], s35 offen  lds
    s_add_u32 m0, s94, 133120
    s_add_u32 s35, s92, 2113536
    buffer_load_dwordx4 v112, s[76:79], s35 offen  lds
    s_add_u32 m0, s94, 134144
    s_add_u32 s35, s92, 2179072
    buffer_load_dwordx4 v112, s[76:79], s35 offen  lds
    s_add_u32 m0, s94, 135168
    s_add_u32 s35, s92, 2228224
    buffer_load_dwordx4 v112, s[76:79], s35 offen  lds
    s_add_u32 m0, s94, 136192
    s_add_u32 s35, s92, 2293760
    buffer_load_dwordx4 v112, s[76:79], s35 offen  lds
    s_add_u32 m0, s94, 137216
    s_add_u32 s35, s92, 2244608
    buffer_load_dwordx4 v112, s[76:79], s35 offen  lds
    s_add_u32 m0, s94, 138240
    s_add_u32 s35, s92, 2310144
    buffer_load_dwordx4 v112, s[76:79], s35 offen  lds
    ds_read_b64_tr_b16 a[20:21], v114 offset:32768
    ds_read_b64_tr_b16 a[22:23], v114 offset:33792
    v_xor_b32 v119, 8, v114
    ds_read_b64_tr_b16 a[28:29], v119 offset:32768
    ds_read_b64_tr_b16 a[30:31], v119 offset:33792
    ds_read_b64_tr_b16 a[52:53], v115 offset:32768
    ds_read_b64_tr_b16 a[54:55], v115 offset:33792
    v_xor_b32 v119, 8, v115
    ds_read_b64_tr_b16 a[60:61], v119 offset:32768
    ds_read_b64_tr_b16 a[62:63], v119 offset:33792
    ds_read_b64_tr_b16 a[84:85], v116 offset:32768
    ds_read_b64_tr_b16 a[86:87], v116 offset:33792
    v_xor_b32 v119, 8, v116
    ds_read_b64_tr_b16 a[92:93], v119 offset:32768
    ds_read_b64_tr_b16 a[94:95], v119 offset:33792
    ds_read_b64_tr_b16 a[116:117], v117 offset:32768
    ds_read_b64_tr_b16 a[118:119], v117 offset:33792
    v_xor_b32 v119, 8, v117
    ds_read_b64_tr_b16 a[124:125], v119 offset:32768
    ds_read_b64_tr_b16 a[126:127], v119 offset:33792
    s_waitcnt lgkmcnt(0)
    s_waitcnt vmcnt(17)
    s_barrier
    s_add_u32 m0, s94, 0
    s_add_u32 s35, s92, 2359296
    buffer_load_dwordx4 v112, s[76:79], s35 offen  lds
    s_add_u32 m0, s94, 1024
    s_add_u32 s35, s92, 2424832
    buffer_load_dwordx4 v112, s[76:79], s35 offen  lds
    s_add_u32 m0, s94, 2048
    s_add_u32 s35, s92, 2375680
    buffer_load_dwordx4 v112, s[76:79], s35 offen  lds
    s_add_u32 m0, s94, 3072
    s_add_u32 s35, s92, 2441216
    buffer_load_dwordx4 v112, s[76:79], s35 offen  lds
    s_add_u32 m0, s94, 4096
    s_add_u32 s35, s92, 2490368
    buffer_load_dwordx4 v112, s[76:79], s35 offen  lds
    s_add_u32 m0, s94, 5120
    s_add_u32 s35, s92, 2555904
    buffer_load_dwordx4 v112, s[76:79], s35 offen  lds
    s_add_u32 m0, s94, 6144
    s_add_u32 s35, s92, 2506752
    buffer_load_dwordx4 v112, s[76:79], s35 offen  lds
    s_add_u32 m0, s94, 7168
    s_add_u32 s35, s92, 2572288
    buffer_load_dwordx4 v112, s[76:79], s35 offen  lds
    v_add_u32 v114, 65536, v114
    v_add_u32 v115, 65536, v115
    v_add_u32 v116, 65536, v116
    v_add_u32 v117, 65536, v117
    ds_read_b64_tr_b16 v[128:129], v114 offset:32768
    ds_read_b64_tr_b16 v[130:131], v114 offset:33792
    v_xor_b32 v119, 8, v114
    ds_read_b64_tr_b16 v[136:137], v119 offset:32768
    ds_read_b64_tr_b16 v[138:139], v119 offset:33792
    ds_read_b64_tr_b16 v[160:161], v115 offset:32768
    ds_read_b64_tr_b16 v[162:163], v115 offset:33792
    v_xor_b32 v119, 8, v115
    ds_read_b64_tr_b16 v[168:169], v119 offset:32768
    ds_read_b64_tr_b16 v[170:171], v119 offset:33792
    ds_read_b64_tr_b16 v[192:193], v116 offset:32768
    ds_read_b64_tr_b16 v[194:195], v116 offset:33792
    v_xor_b32 v119, 8, v116
    ds_read_b64_tr_b16 v[200:201], v119 offset:32768
    ds_read_b64_tr_b16 v[202:203], v119 offset:33792
    ds_read_b64_tr_b16 v[224:225], v117 offset:32768
    ds_read_b64_tr_b16 v[226:227], v117 offset:33792
    v_xor_b32 v119, 8, v117
    ds_read_b64_tr_b16 v[232:233], v119 offset:32768
    ds_read_b64_tr_b16 v[234:235], v119 offset:33792
    v_subrev_u32 v114, 65536, v114
    v_subrev_u32 v115, 65536, v115
    v_subrev_u32 v116, 65536, v116
    v_subrev_u32 v117, 65536, v117
    s_waitcnt lgkmcnt(0)
    s_waitcnt vmcnt(16)
    s_barrier
    s_add_u32 m0, s94, 32768
    s_add_u32 s35, s92, 0
    buffer_load_dwordx4 v112, s[88:91], s35 offen  lds
    s_add_u32 m0, s94, 33792
    s_add_u32 s35, s92, 65536
    buffer_load_dwordx4 v112, s[88:91], s35 offen  lds
    s_add_u32 m0, s94, 34816
    s_add_u32 s35, s92, 16384
    buffer_load_dwordx4 v112, s[88:91], s35 offen  lds
    s_add_u32 m0, s94, 35840
    s_add_u32 s35, s92, 81920
    buffer_load_dwordx4 v112, s[88:91], s35 offen  lds
    s_add_u32 m0, s94, 36864
    s_add_u32 s35, s92, 131072
    buffer_load_dwordx4 v112, s[88:91], s35 offen  lds
    s_add_u32 m0, s94, 37888
    s_add_u32 s35, s92, 196608
    buffer_load_dwordx4 v112, s[88:91], s35 offen  lds
    s_add_u32 m0, s94, 38912
    s_add_u32 s35, s92, 147456
    buffer_load_dwordx4 v112, s[88:91], s35 offen  lds
    s_add_u32 m0, s94, 39936
    s_add_u32 s35, s92, 212992
    buffer_load_dwordx4 v112, s[88:91], s35 offen  lds
    v_add_u32 v114, 65536, v114
    v_add_u32 v115, 65536, v115
    v_add_u32 v116, 65536, v116
    v_add_u32 v117, 65536, v117
    ds_read_b64_tr_b16 v[132:133], v114 offset:0
    ds_read_b64_tr_b16 v[134:135], v114 offset:1024
    v_xor_b32 v119, 8, v114
    ds_read_b64_tr_b16 v[140:141], v119 offset:0
    ds_read_b64_tr_b16 v[142:143], v119 offset:1024
    ds_read_b64_tr_b16 v[164:165], v115 offset:0
    ds_read_b64_tr_b16 v[166:167], v115 offset:1024
    v_xor_b32 v119, 8, v115
    ds_read_b64_tr_b16 v[172:173], v119 offset:0
    ds_read_b64_tr_b16 v[174:175], v119 offset:1024
    ds_read_b64_tr_b16 v[196:197], v116 offset:0
    ds_read_b64_tr_b16 v[198:199], v116 offset:1024
    v_xor_b32 v119, 8, v116
    ds_read_b64_tr_b16 v[204:205], v119 offset:0
    ds_read_b64_tr_b16 v[206:207], v119 offset:1024
    ds_read_b64_tr_b16 v[228:229], v117 offset:0
    ds_read_b64_tr_b16 v[230:231], v117 offset:1024
    v_xor_b32 v119, 8, v117
    ds_read_b64_tr_b16 v[236:237], v119 offset:0
    ds_read_b64_tr_b16 v[238:239], v119 offset:1024
    v_subrev_u32 v114, 65536, v114
    v_subrev_u32 v115, 65536, v115
    v_subrev_u32 v116, 65536, v116
    v_subrev_u32 v117, 65536, v117
    s_waitcnt lgkmcnt(0)
    s_waitcnt vmcnt(16)
    s_barrier
    v_lshlrev_b32 v98, 3, v121
    s_mul_i32 s32, s21, 524288
    s_add_u32 s32, s32, 262144
    s_mul_i32 s33, s20, 8192
    s_cmp_eq_u32 s21, 3
    s_cselect_b32 s32, s33, s32
    buffer_load_dword v99, v98, s[56:59], s32 offen sc1
    s_add_u32 m0, s94, 98304
    s_add_u32 s35, s92, 262144
    buffer_load_dwordx4 v112, s[88:91], s35 offen  lds
    s_add_u32 m0, s94, 99328
    s_add_u32 s35, s92, 327680
    buffer_load_dwordx4 v112, s[88:91], s35 offen  lds
    s_add_u32 m0, s94, 100352
    s_add_u32 s35, s92, 278528
    buffer_load_dwordx4 v112, s[88:91], s35 offen  lds
    s_add_u32 m0, s94, 101376
    s_add_u32 s35, s92, 344064
    buffer_load_dwordx4 v112, s[88:91], s35 offen  lds
    s_add_u32 m0, s94, 102400
    s_add_u32 s35, s92, 393216
    buffer_load_dwordx4 v112, s[88:91], s35 offen  lds
    s_add_u32 m0, s94, 103424
    s_add_u32 s35, s92, 458752
    buffer_load_dwordx4 v112, s[88:91], s35 offen  lds
    s_add_u32 m0, s94, 104448
    s_add_u32 s35, s92, 409600
    buffer_load_dwordx4 v112, s[88:91], s35 offen  lds
    s_add_u32 m0, s94, 105472
    s_add_u32 s35, s92, 475136
    buffer_load_dwordx4 v112, s[88:91], s35 offen  lds
    v_add_u32 v114, 131072, v114
    v_add_u32 v115, 131072, v115
    v_add_u32 v116, 131072, v116
    v_add_u32 v117, 131072, v117
    ds_read_b64_tr_b16 v[144:145], v114 offset:0
    ds_read_b64_tr_b16 v[146:147], v114 offset:1024
    v_xor_b32 v119, 8, v114
    ds_read_b64_tr_b16 v[152:153], v119 offset:0
    ds_read_b64_tr_b16 v[154:155], v119 offset:1024
    ds_read_b64_tr_b16 v[176:177], v115 offset:0
    ds_read_b64_tr_b16 v[178:179], v115 offset:1024
    v_xor_b32 v119, 8, v115
    ds_read_b64_tr_b16 v[184:185], v119 offset:0
    ds_read_b64_tr_b16 v[186:187], v119 offset:1024
    ds_read_b64_tr_b16 v[208:209], v116 offset:0
    ds_read_b64_tr_b16 v[210:211], v116 offset:1024
    v_xor_b32 v119, 8, v116
    ds_read_b64_tr_b16 v[216:217], v119 offset:0
    ds_read_b64_tr_b16 v[218:219], v119 offset:1024
    ds_read_b64_tr_b16 v[240:241], v117 offset:0
    ds_read_b64_tr_b16 v[242:243], v117 offset:1024
    v_xor_b32 v119, 8, v117
    ds_read_b64_tr_b16 v[248:249], v119 offset:0
    ds_read_b64_tr_b16 v[250:251], v119 offset:1024
    v_subrev_u32 v114, 131072, v114
    v_subrev_u32 v115, 131072, v115
    v_subrev_u32 v116, 131072, v116
    v_subrev_u32 v117, 131072, v117
    s_waitcnt lgkmcnt(0)
    s_waitcnt vmcnt(17)
    s_barrier
    s_getpc_b64 s[96:97]
L_PCREF:
    s_add_u32 s96, s96, L_LOOPCODE - L_PCREF
    s_addc_u32 s97, s97, 0
    s_lshl_b32 s32, s21, 12
    v_lshlrev_b32 v109, 2, v121
    v_add_u32 v109, s32, v109
    v_min_u32 v109, L_EXIT - L_LOOPCODE, v109
    global_load_dword v111, v109, s[96:97]
    s_add_u32 m0, s94, 65536
    s_add_u32 s35, s92, 2097152
    buffer_load_dwordx4 v112, s[88:91], s35 offen  lds
    s_add_u32 m0, s94, 66560
    s_add_u32 s35, s92, 2162688
    buffer_load_dwordx4 v112, s[88:91], s35 offen  lds
    s_add_u32 m0, s94, 67584
    s_add_u32 s35, s92, 2113536
    buffer_load_dwordx4 v112, s[88:91], s35 offen  lds
    s_add_u32 m0, s94, 68608
    s_add_u32 s35, s92, 2179072
    buffer_load_dwordx4 v112, s[88:91], s35 offen  lds
    s_add_u32 m0, s94, 69632
    s_add_u32 s35, s92, 2228224
    buffer_load_dwordx4 v112, s[88:91], s35 offen  lds
    s_add_u32 m0, s94, 70656
    s_add_u32 s35, s92, 2293760
    buffer_load_dwordx4 v112, s[88:91], s35 offen  lds
    s_add_u32 m0, s94, 71680
    s_add_u32 s35, s92, 2244608
    buffer_load_dwordx4 v112, s[88:91], s35 offen  lds
    s_add_u32 m0, s94, 72704
    s_add_u32 s35, s92, 2310144
    buffer_load_dwordx4 v112, s[88:91], s35 offen  lds
    ds_read_b64_tr_b16 v[148:149], v114 offset:0
    ds_read_b64_tr_b16 v[150:151], v114 offset:1024
    v_xor_b32 v119, 8, v114
    ds_read_b64_tr_b16 v[156:157], v119 offset:0
    ds_read_b64_tr_b16 v[158:159], v119 offset:1024
    ds_read_b64_tr_b16 v[180:181], v115 offset:0
    ds_read_b64_tr_b16 v[182:183], v115 offset:1024
    v_xor_b32 v119, 8, v115
    ds_read_b64_tr_b16 v[188:189], v119 offset:0
    ds_read_b64_tr_b16 v[190:191], v119 offset:1024
    ds_read_b64_tr_b16 v[212:213], v116 offset:0
    ds_read_b64_tr_b16 v[214:215], v116 offset:1024
    v_xor_b32 v119, 8, v116
    ds_read_b64_tr_b16 v[220:221], v119 offset:0
    ds_read_b64_tr_b16 v[222:223], v119 offset:1024
    ds_read_b64_tr_b16 v[244:245], v117 offset:0
    ds_read_b64_tr_b16 v[246:247], v117 offset:1024
    v_xor_b32 v119, 8, v117
    ds_read_b64_tr_b16 v[252:253], v119 offset:0
    ds_read_b64_tr_b16 v[254:255], v119 offset:1024
    s_waitcnt lgkmcnt(0)
    s_waitcnt vmcnt(18)
    s_barrier
    s_add_u32 m0, s94, 131072
    s_add_u32 s35, s92, 2359296
    buffer_load_dwordx4 v112, s[88:91], s35 offen  lds
    s_add_u32 m0, s94, 132096
    s_add_u32 s35, s92, 2424832
    buffer_load_dwordx4 v112, s[88:91], s35 offen  lds
    s_add_u32 m0, s94, 133120
    s_add_u32 s35, s92, 2375680
    buffer_load_dwordx4 v112, s[88:91], s35 offen  lds
    s_add_u32 m0, s94, 134144
    s_add_u32 s35, s92, 2441216
    buffer_load_dwordx4 v112, s[88:91], s35 offen  lds
    s_add_u32 m0, s94, 135168
    s_add_u32 s35, s92, 2490368
    buffer_load_dwordx4 v112, s[88:91], s35 offen  lds
    s_add_u32 m0, s94, 136192
    s_add_u32 s35, s92, 2555904
    buffer_load_dwordx4 v112, s[88:91], s35 offen  lds
    s_add_u32 m0, s94, 137216
    s_add_u32 s35, s92, 2506752
    buffer_load_dwordx4 v112, s[88:91], s35 offen  lds
    s_add_u32 m0, s94, 138240
    s_add_u32 s35, s92, 2572288
    buffer_load_dwordx4 v112, s[88:91], s35 offen  lds
    v_bfe_u32 v108, v121, 4, 1
    v_lshlrev_b32 v108, 4, v108
    v_mov_b32 v109, 0x3f80
    v_lshlrev_b32 v108, v108, v109
    v_bfe_u32 v109, v121, 5, 3
    v_cmp_eq_u32 vcc, 0, v109
    s_nop 1
    v_cndmask_b32 v104, 0, v108, vcc
    v_cmp_eq_u32 vcc, 1, v109
    s_nop 1
    v_cndmask_b32 v105, 0, v108, vcc
    v_cmp_eq_u32 vcc, 2, v109
    s_nop 1
    v_cndmask_b32 v106, 0, v108, vcc
    v_cmp_eq_u32 vcc, 3, v109
    s_nop 1
    v_cndmask_b32 v107, 0, v108, vcc
    ds_write_b128 v121, v[104:107] offset:30720
    ds_read_b64_tr_b16 v[64:65], v114 offset:32768
    ds_read_b64_tr_b16 v[66:67], v114 offset:33792
    v_xor_b32 v119, 8, v114
    ds_read_b64_tr_b16 v[72:73], v119 offset:32768
    ds_read_b64_tr_b16 v[74:75], v119 offset:33792
    ds_read_b64_tr_b16 a[128:129], v115 offset:32768
    ds_read_b64_tr_b16 a[130:131], v115 offset:33792
    v_xor_b32 v119, 8, v115
    ds_read_b64_tr_b16 a[136:137], v119 offset:32768
    ds_read_b64_tr_b16 a[138:139], v119 offset:33792
    ds_read_b64_tr_b16 v[80:81], v116 offset:32768
    ds_read_b64_tr_b16 v[82:83], v116 offset:33792
    v_xor_b32 v119, 8, v116
    ds_read_b64_tr_b16 v[88:89], v119 offset:32768
    ds_read_b64_tr_b16 v[90:91], v119 offset:33792
    ds_read_b64_tr_b16 a[160:161], v117 offset:32768
    ds_read_b64_tr_b16 a[162:163], v117 offset:33792
    v_xor_b32 v119, 8, v117
    ds_read_b64_tr_b16 a[168:169], v119 offset:32768
    ds_read_b64_tr_b16 a[170:171], v119 offset:33792
    s_waitcnt lgkmcnt(0)
    s_waitcnt vmcnt(17)
    s_barrier
    v_mov_b32 v98, 0
    buffer_load_dwordx2 v[96:97], v98, s[4:7], s31 offen sc1
    v_and_b32 v110, 1008, v121
    v_lshlrev_b32 v110, 3, v110
    s_mov_b32 s33, 94371840
    buffer_load_dwordx2 v[102:103], v110, s[4:7], s33 offen sc1
    v_add_u32 v114, 65536, v114
    v_add_u32 v115, 65536, v115
    v_add_u32 v116, 65536, v116
    v_add_u32 v117, 65536, v117
    ds_read_b64_tr_b16 v[68:69], v114 offset:32768
    ds_read_b64_tr_b16 v[70:71], v114 offset:33792
    v_xor_b32 v119, 8, v114
    ds_read_b64_tr_b16 v[76:77], v119 offset:32768
    ds_read_b64_tr_b16 v[78:79], v119 offset:33792
    ds_read_b64_tr_b16 a[132:133], v115 offset:32768
    ds_read_b64_tr_b16 a[134:135], v115 offset:33792
    v_xor_b32 v119, 8, v115
    ds_read_b64_tr_b16 a[140:141], v119 offset:32768
    ds_read_b64_tr_b16 a[142:143], v119 offset:33792
    ds_read_b64_tr_b16 v[84:85], v116 offset:32768
    ds_read_b64_tr_b16 v[86:87], v116 offset:33792
    v_xor_b32 v119, 8, v116
    ds_read_b64_tr_b16 v[92:93], v119 offset:32768
    ds_read_b64_tr_b16 v[94:95], v119 offset:33792
    ds_read_b64_tr_b16 a[164:165], v117 offset:32768
    ds_read_b64_tr_b16 a[166:167], v117 offset:33792
    v_xor_b32 v119, 8, v117
    ds_read_b64_tr_b16 a[172:173], v119 offset:32768
    ds_read_b64_tr_b16 a[174:175], v119 offset:33792
    v_subrev_u32 v114, 65536, v114
    v_subrev_u32 v115, 65536, v115
    v_subrev_u32 v116, 65536, v116
    v_subrev_u32 v117, 65536, v117
    s_waitcnt lgkmcnt(0)
    s_waitcnt vmcnt(10)
    s_barrier
    ds_write_b128 v122, v[0:3] offset:0
    ds_write_b128 v122, v[4:7] offset:1024
    ds_write_b128 v122, v[8:11] offset:2048
    ds_write_b128 v122, v[12:15] offset:3072
    ds_write_b128 v122, v[16:19] offset:4096
    ds_write_b128 v122, v[20:23] offset:5120
    ds_write_b128 v122, v[24:27] offset:6144
    ds_write_b128 v122, v[28:31] offset:7168
    ds_write_b128 v122, v[32:35] offset:8192
    ds_write_b128 v122, v[36:39] offset:9216
    ds_write_b128 v122, v[40:43] offset:10240
    ds_write_b128 v122, v[44:47] offset:11264
    ds_write_b128 v122, v[48:51] offset:12288
    ds_write_b128 v122, v[52:55] offset:13312
    ds_write_b128 v122, v[56:59] offset:14336
    ds_write_b128 v122, v[60:63] offset:15360
    s_waitcnt lgkmcnt(0)
    s_add_u32 s88, s48, s23
    s_addc_u32 s89, s49, 0
    s_mov_b32 s90, 8192
    s_mov_b32 s91, 0x20000
    s_add_u32 s92, s52, s23
    s_addc_u32 s93, s53, 0
    s_mov_b32 s94, 4096
    s_mov_b32 s95, 0x20000
    s_add_u32 s76, s4, s26
    s_addc_u32 s77, s5, 0
    s_mov_b32 s78, 2048
    s_mov_b32 s79, 0x20000
    s_add_u32 s80, s4, s27
    s_addc_u32 s81, s5, 0
    s_mov_b32 s82, 2048
    s_mov_b32 s83, 0x20000
    s_add_u32 s84, s4, s28
    s_addc_u32 s85, s5, 0
    s_mov_b32 s86, 8192
    s_mov_b32 s87, 0x20000
    v_add_u32 v114, 65536, v114
    v_add_u32 v115, 65536, v115
    v_add_u32 v116, 65536, v116
    v_add_u32 v117, 65536, v117
    ds_read_b64_tr_b16 v[0:1], v114 offset:0
    ds_read_b64_tr_b16 v[2:3], v114 offset:1024
    v_xor_b32 v119, 8, v114
    ds_read_b64_tr_b16 v[8:9], v119 offset:0
    ds_read_b64_tr_b16 v[10:11], v119 offset:1024
    ds_read_b64_tr_b16 a[144:145], v115 offset:0
    ds_read_b64_tr_b16 a[146:147], v115 offset:1024
    v_xor_b32 v119, 8, v115
    ds_read_b64_tr_b16 a[152:153], v119 offset:0
    ds_read_b64_tr_b16 a[154:155], v119 offset:1024
    ds_read_b64_tr_b16 v[16:17], v116 offset:0
    ds_read_b64_tr_b16 v[18:19], v116 offset:1024
    v_xor_b32 v119, 8, v116
    ds_read_b64_tr_b16 v[24:25], v119 offset:0
    ds_read_b64_tr_b16 v[26:27], v119 offset:1024
    ds_read_b64_tr_b16 a[176:177], v117 offset:0
    ds_read_b64_tr_b16 a[178:179], v117 offset:1024
    v_xor_b32 v119, 8, v117
    ds_read_b64_tr_b16 a[184:185], v119 offset:0
    ds_read_b64_tr_b16 a[186:187], v119 offset:1024
    v_subrev_u32 v114, 65536, v114
    v_subrev_u32 v115, 65536, v115
    v_subrev_u32 v116, 65536, v116
    v_subrev_u32 v117, 65536, v117
    s_waitcnt lgkmcnt(0)
    s_waitcnt vmcnt(2)
    s_barrier
    v_add_u32 v114, 131072, v114
    v_add_u32 v115, 131072, v115
    v_add_u32 v116, 131072, v116
    v_add_u32 v117, 131072, v117
    ds_read_b64_tr_b16 v[4:5], v114 offset:0
    ds_read_b64_tr_b16 v[6:7], v114 offset:1024
    v_xor_b32 v119, 8, v114
    ds_read_b64_tr_b16 v[12:13], v119 offset:0
    ds_read_b64_tr_b16 v[14:15], v119 offset:1024
    ds_read_b64_tr_b16 a[148:149], v115 offset:0
    ds_read_b64_tr_b16 a[150:151], v115 offset:1024
    v_xor_b32 v119, 8, v115
    ds_read_b64_tr_b16 a[156:157], v119 offset:0
    ds_read_b64_tr_b16 a[158:159], v119 offset:1024
    ds_read_b64_tr_b16 v[20:21], v116 offset:0
    ds_read_b64_tr_b16 v[22:23], v116 offset:1024
    v_xor_b32 v119, 8, v116
    ds_read_b64_tr_b16 v[28:29], v119 offset:0
    ds_read_b64_tr_b16 v[30:31], v119 offset:1024
    ds_read_b64_tr_b16 a[180:181], v117 offset:0
    ds_read_b64_tr_b16 a[182:183], v117 offset:1024
    v_xor_b32 v119, 8, v117
    ds_read_b64_tr_b16 a[188:189], v119 offset:0
    ds_read_b64_tr_b16 a[190:191], v119 offset:1024
    v_subrev_u32 v114, 131072, v114
    v_subrev_u32 v115, 131072, v115
    v_subrev_u32 v116, 131072, v116
    v_subrev_u32 v117, 131072, v117
    s_waitcnt lgkmcnt(0)
    s_waitcnt vmcnt(0)
    s_mov_b32 s34, 0
    v_cmp_ne_u64 vcc, s[38:39], v[96:97]
    s_cbranch_vccnz EP_86
    s_mov_b32 m0, s36
    buffer_load_dwordx4 v[104:107], v121, s[80:83], 0 offen sc1
    buffer_load_dwordx4 v121, s[76:79], 0 offen sc1 lds
    buffer_load_dwordx4 v[108:111], v121, s[80:83], 0 offen offset:1024 sc1
    buffer_load_dwordx4 v121, s[76:79], 0 offen offset:1024 sc1 lds
    s_add_u32 s26, s26, 262144
    s_add_u32 s27, s27, 262144
    s_mov_b32 s34, 1
EP_86:
    s_barrier
    ds_write_b128 v122, v[64:67] offset:32768
    ds_write_b128 v122, v[68:71] offset:33792
    ds_write_b128 v122, v[72:75] offset:34816
    ds_write_b128 v122, v[76:79] offset:35840
    ds_write_b128 v122, v[0:3] offset:36864
    ds_write_b128 v122, v[4:7] offset:37888
    ds_write_b128 v122, v[8:11] offset:38912
    ds_write_b128 v122, v[12:15] offset:39936
    ds_write_b128 v122, v[80:83] offset:40960
    ds_write_b128 v122, v[84:87] offset:41984
    ds_write_b128 v122, v[88:91] offset:43008
    ds_write_b128 v122, v[92:95] offset:44032
    ds_write_b128 v122, v[16:19] offset:45056
    ds_write_b128 v122, v[20:23] offset:46080
    ds_write_b128 v122, v[24:27] offset:47104
    ds_write_b128 v122, v[28:31] offset:48128
    s_mov_b32 s30, 0x3ffffff
    s_cmp_lg_u32 s34, 0
    s_cbranch_scc1 EQ_87
KP_88:
    v_mov_b32 v98, 0
    buffer_load_dwordx2 v[96:97], v98, s[4:7], s31 offen sc1
    s_sub_u32 s30, s30, 16
    s_cbranch_scc1 L_FAIL2
    s_waitcnt vmcnt(0)
    v_cmp_ne_u64 vcc, s[38:39], v[96:97]
    s_cbranch_vccnz KP_88
    s_mov_b32 m0, s36
    buffer_load_dwordx4 v[104:107], v121, s[80:83], 0 offen sc1
    buffer_load_dwordx4 v121, s[76:79], 0 offen sc1 lds
    buffer_load_dwordx4 v[108:111], v121, s[80:83], 0 offen offset:1024 sc1
    buffer_load_dwordx4 v121, s[76:79], 0 offen offset:1024 sc1 lds
    s_add_u32 s26, s26, 262144
    s_add_u32 s27, s27, 262144
EQ_87:
    v_and_b32 v98, 1008, v121
    v_lshlrev_b32 v98, 3, v98
    s_mov_b32 s33, 94371840
    s_getreg_b32 s32, hwreg(HW_REG_XCC_ID, 0, 4)
    s_branch SE_90
SP_89:
    buffer_load_dwordx2 v[102:103], v98, s[4:7], s33 offen sc1
    s_sub_u32 s30, s30, 16
    s_cbranch_scc1 L_FAIL2
    s_waitcnt vmcnt(0)
SE_90:
    v_lshrrev_b32 v97, 28, v103
    v_and_b32 v103, 0x0fffffff, v103
    v_cmp_ne_u64 vcc, s[38:39], v[102:103]
    s_cbranch_vccnz SP_89
    v_cmp_ne_u32 vcc, s32, v97
    s_waitcnt lgkmcnt(0)
    s_nop 2
    s_mov_b32 s14, vcc_lo
    s_mov_b32 s30, 0x3ffffff
    s_add_u32 s31, s31, 128
    s_buffer_load_dwordx2 s[12:13], s[4:7], s31
    s_add_u32 s88, s48, s23
    s_addc_u32 s89, s49, 0
    s_add_u32 s92, s52, s23
    s_addc_u32 s93, s53, 0
    s_add_u32 s76, s4, s26
    s_addc_u32 s77, s5, 0
    s_add_u32 s80, s4, s27
    s_addc_u32 s81, s5, 0
    s_add_u32 s84, s4, s28
    s_addc_u32 s85, s5, 0
    v_mov_b64 v[64:65], 0
    v_mov_b64 v[66:67], 0
    v_mov_b64 v[68:69], 0
    v_mov_b64 v[70:71], 0
    v_mov_b64 v[72:73], 0
    v_mov_b64 v[74:75], 0
    v_mov_b64 v[76:77], 0
    v_mov_b64 v[78:79], 0
    v_mov_b64 v[80:81], 0
    v_mov_b64 v[82:83], 0
    v_mov_b64 v[84:85], 0
    v_mov_b64 v[86:87], 0
    v_add_u32 v92, s29, v121
    v_xor_b32 v93, 1024, v92
    v_xor_b32 v94, 2048, v92
    v_xor_b32 v95, 3072, v92
    s_cmp_lg_u32 s14, 0
    s_cbranch_scc1 L_SLOW
L_LOOPCODE:
    s_branch STEP_91
.p2align 6
    s_nop 0
    s_nop 0
STEP_91:
    buffer_load_dwordx4 v[0:3], v92, s[88:91], 0 offen sc1
    v_mov_b32 v88, 0
    s_nop 1
    v_mov_b32 v88, 0
    s_nop 1
    v_mov_b32 v88, 0
    s_nop 1
    v_mov_b32 v88, 0
    s_nop 1
    v_mov_b32 v88, 0
    s_nop 1
    v_mov_b32 v88, 0
    s_nop 1
    v_mov_b32 v88, 0
    s_nop 0
    buffer_load_dwordx4 v[4:7], v92, s[92:95], 0 offen sc1
    s_waitcnt vmcnt(3)
    ds_read_b128 v[32:35], v122 offset:32768
    ds_read_b128 v[36:39], v122 offset:33792
    v_mov_b32 v88, 0
    ds_read_b128 v[40:43], v122 offset:34816
    ds_read_b128 v[44:47], v122 offset:35840
    v_mov_b32_e64 v88, 0
    ds_read_b128 v[48:51], v122 offset:36864
    ds_read_b128 v[52:55], v122 offset:37888
    v_mov_b32_e64 v88, 0
    buffer_load_dwordx4 v[0:3], v92, s[88:91], 0 offen sc1
    ds_read_b128 v[56:59], v122 offset:38912
    ds_read_b128 v[60:63], v122 offset:39936
    v_mov_b32 v88, 0
    v_mov_b32 v88, 0
    s_nop 1
    v_mov_b32 v88, 0
    buffer_load_dwordx4 v[4:7], v92, s[92:95], 0 offen sc1
    v_mov_b32 v88, 0
    s_nop 1
    v_mov_b32 v88, 0
    s_nop 1
    v_mov_b32 v88, 0
    s_nop 1
    v_mov_b32_e64 v88, 0
    s_nop 1
    s_waitcnt vmcnt(3) lgkmcnt(0)
    v_max3_u32 v88, v0, v1, v2
    v_max_u32 v88, v88, v3
    v_cmp_eq_u32 vcc, -1, v88
H2_92:
    v_smfmac_f32_16x16x64_bf16 v[72:75], v[0:3], v[32:39], v120
    ds_write_b128 v92, v[0:3] offset:20480
    s_cbranch_vccnz HF_93
    v_smfmac_f32_16x16x64_bf16 v[76:79], v[0:3], v[40:47], v120
    v_smfmac_f32_16x16x64_bf16 v[64:67], v[0:3], v[128:135], v120
    s_waitcnt vmcnt(2)
    v_max3_u32 v88, v4, v5, v6
    v_smfmac_f32_16x16x64_bf16 v[68:71], v[0:3], v[136:143], v120
    v_max_u32 v88, v88, v7
    v_cmp_eq_u32 vcc, -1, v88
    v_smfmac_f32_16x16x64_bf16 v[80:83], v[0:3], a[0:7], v120
    s_cbranch_vccnz HG_95
H3_94:
    ds_write_b128 v92, v[4:7] offset:24576
    s_mov_b32 m0, s37
    v_smfmac_f32_16x16x64_bf16 v[84:87], v[0:3], a[8:15], v120
    buffer_load_dwordx4 v[112:115], v121, s[80:83], 0 offen sc1
    v_smfmac_f32_16x16x64_bf16 v[72:75], v[4:7], v[48:55], v120
    buffer_load_dwordx4 v121, s[76:79], 0 offen sc1 lds
    v_smfmac_f32_16x16x64_bf16 v[76:79], v[4:7], v[56:63], v120
    buffer_load_dwordx4 v[116:119], v121, s[80:83], 0 offen offset:1024 sc1
    v_smfmac_f32_16x16x64_bf16 v[64:67], v[4:7], v[144:151], v120
    s_waitcnt lgkmcnt(0)
    s_barrier
    ds_read_b128 v[8:11], v93 offset:20480
    v_smfmac_f32_16x16x64_bf16 v[68:71], v[4:7], v[152:159], v120
    ds_read_b128 v[12:15], v93 offset:24576
    v_smfmac_f32_16x16x64_bf16 v[80:83], v[4:7], a[16:23], v120
    ds_read_b128 v[16:19], v94 offset:20480
    v_smfmac_f32_16x16x64_bf16 v[84:87], v[4:7], a[24:31], v120
    ds_read_b128 v[20:23], v94 offset:24576
    s_waitcnt lgkmcnt(3)
    v_smfmac_f32_16x16x64_bf16 v[72:75], v[8:11], a[128:135], v120
    ds_read_b128 v[24:27], v95 offset:20480
    v_smfmac_f32_16x16x64_bf16 v[76:79], v[8:11], a[136:143], v120
    ds_read_b128 v[28:31], v95 offset:24576
    v_smfmac_f32_16x16x64_bf16 v[64:67], v[8:11], v[160:167], v120
    ds_read_b128 v[32:35], v122 offset:40960
    v_smfmac_f32_16x16x64_bf16 v[68:71], v[8:11], v[168:175], v120
    ds_read_b128 v[36:39], v122 offset:41984
    s_waitcnt lgkmcnt(6)
    v_smfmac_f32_16x16x64_bf16 v[72:75], v[12:15], a[144:151], v120
    ds_read_b128 v[40:43], v122 offset:43008
    v_smfmac_f32_16x16x64_bf16 v[76:79], v[12:15], a[152:159], v120
    ds_read_b128 v[44:47], v122 offset:44032
    v_smfmac_f32_16x16x64_bf16 v[64:67], v[12:15], v[176:183], v120
    ds_read_b128 v[48:51], v122 offset:45056
    v_smfmac_f32_16x16x64_bf16 v[68:71], v[12:15], v[184:191], v120
    ds_read_b128 v[52:55], v122 offset:46080
    s_waitcnt lgkmcnt(4)
    v_smfmac_f32_16x16x64_bf16 v[72:75], v[16:19], v[32:39], v120
    ds_read_b128 v[56:59], v122 offset:47104
    s_waitcnt lgkmcnt(3)
    v_smfmac_f32_16x16x64_bf16 v[76:79], v[16:19], v[40:47], v120
    ds_read_b128 v[60:63], v122 offset:48128
    v_smfmac_f32_16x16x64_bf16 v[64:67], v[16:19], v[192:199], v120
    ds_read_b128 v[32:35], v121 offset:0
    v_smfmac_f32_16x16x64_bf16 v[68:71], v[16:19], v[200:207], v120
    ds_read_b128 v[36:39], v121 offset:1024
    s_waitcnt lgkmcnt(4)
    v_smfmac_f32_16x16x64_bf16 v[72:75], v[20:23], v[48:55], v120
    ds_read_b128 v[40:43], v121 offset:2048
    s_waitcnt lgkmcnt(3)
    v_smfmac_f32_16x16x64_bf16 v[76:79], v[20:23], v[56:63], v120
    buffer_load_dwordx4 v121, s[76:79], 0 offen offset:1024 sc1 lds
    ds_read_b128 v[44:47], v121 offset:3072
    v_smfmac_f32_16x16x64_bf16 v[64:67], v[20:23], v[208:215], v120
    ds_read_b128 v[48:51], v121 offset:4096
    v_smfmac_f32_16x16x64_bf16 v[68:71], v[20:23], v[216:223], v120
    ds_read_b128 v[52:55], v121 offset:5120
    v_smfmac_f32_16x16x64_bf16 v[72:75], v[24:27], a[160:167], v120
    ds_read_b128 v[56:59], v121 offset:6144
    v_smfmac_f32_16x16x64_bf16 v[76:79], v[24:27], a[168:175], v120
    buffer_store_dwordx2 v[100:101], v127, s[84:87], 0 offen sc1
    ds_read_b128 v[60:63], v121 offset:7168
    v_smfmac_f32_16x16x64_bf16 v[64:67], v[24:27], v[224:231], v120
    s_add_u32 s26, s26, 262144
    v_smfmac_f32_16x16x64_bf16 v[68:71], v[24:27], v[232:239], v120
    s_add_u32 s27, s27, 262144
    v_smfmac_f32_16x16x64_bf16 v[72:75], v[28:31], a[176:183], v120
    s_add_u32 s28, s28, 8192
    s_nop 0
    v_smfmac_f32_16x16x64_bf16 v[76:79], v[28:31], a[184:191], v120
    s_nop 1
    v_smfmac_f32_16x16x64_bf16 v[64:67], v[28:31], v[240:247], v120
    s_nop 1
    v_smfmac_f32_16x16x64_bf16 v[68:71], v[28:31], v[248:255], v120
    s_nop 1
    v_add_f32 v72, v72, v78
    v_add_f32 v73, v73, v79
    v_cvt_pk_bf16_f32 v89, v72, v73
    v_add_f32 v76, v76, v74
    v_add_f32 v77, v77, v75
    v_cvt_pk_bf16_f32 v91, v76, v77
    v_pk_add_f32 v[64:65], v[64:65], v[70:71]
    v_cvt_pk_bf16_f32 v88, v64, v65
    v_pk_add_f32 v[68:69], v[68:69], v[66:67]
    v_cvt_pk_bf16_f32 v90, v68, v69
    v_smfmac_f32_16x16x64_bf16 v[80:83], v[8:11], a[32:39], v120
    ds_write2_b64 v124, v[88:89], v[90:91] offset1:64
    v_smfmac_f32_16x16x64_bf16 v[84:87], v[8:11], a[40:47], v120
    v_smfmac_f32_16x16x64_bf16 v[80:83], v[12:15], a[48:55], v120
    v_smfmac_f32_16x16x64_bf16 v[84:87], v[12:15], a[56:63], v120
    v_smfmac_f32_16x16x64_bf16 v[80:83], v[16:19], a[64:71], v120
    s_waitcnt lgkmcnt(0)
    s_barrier
    ds_read_b64_tr_b16 v[88:89], v125 offset:0
    ds_read_b64_tr_b16 v[90:91], v125 offset:512
    v_smfmac_f32_16x16x64_bf16 v[84:87], v[16:19], a[72:79], v120
    ds_read_b64_tr_b16 v[92:93], v125 offset:1024
    ds_read_b64_tr_b16 v[94:95], v125 offset:1536
    v_smfmac_f32_16x16x64_bf16 v[80:83], v[20:23], a[80:87], v120
    ds_read_b64_tr_b16 v[96:97], v125 offset:2048
    ds_read_b64_tr_b16 v[98:99], v125 offset:2560
    v_smfmac_f32_16x16x64_bf16 v[84:87], v[20:23], a[88:95], v120
    ds_read_b64_tr_b16 v[100:101], v125 offset:3072
    ds_read_b64_tr_b16 v[102:103], v125 offset:3584
    v_smfmac_f32_16x16x64_bf16 v[80:83], v[24:27], a[96:103], v120
    s_mov_b64 vcc, s[46:47]
    s_waitcnt lgkmcnt(6)
    v_mfma_f32_16x16x32_bf16 v[64:67], v[32:35], v[88:91], 0
    v_mfma_f32_16x16x32_bf16 v[68:71], v[48:51], v[88:91], 0
    s_waitcnt lgkmcnt(4)
    v_mfma_f32_16x16x32_bf16 v[64:67], v[36:39], v[92:95], v[64:67]
    v_mov_b64 v[48:49], 0
    v_mov_b64_e64 v[50:51], 0
    v_mfma_f32_16x16x32_bf16 v[68:71], v[52:55], v[92:95], v[68:71]
    s_waitcnt lgkmcnt(2)
    v_mfma_f32_16x16x32_bf16 v[64:67], v[40:43], v[96:99], v[64:67]
    v_mov_b64 v[52:53], 0
    v_mov_b64_e64 v[54:55], 0
    v_mfma_f32_16x16x32_bf16 v[68:71], v[56:59], v[96:99], v[68:71]
    s_waitcnt lgkmcnt(0) vmcnt(5)
    v_mfma_f32_16x16x32_bf16 v[64:67], v[44:47], v[100:103], v[64:67]
    v_mov_b64 v[56:57], 0
    v_mov_b64_e64 v[58:59], 0
    v_mfma_f32_16x16x32_bf16 v[68:71], v[60:63], v[100:103], v[68:71]
    v_mfma_f32_16x16x32_bf16 v[72:75], v[88:91], v[88:91], 0
    ds_read_b128 v[0:3], v122 offset:0
    v_mov_b64 v[44:45], s[74:75]
    v_mov_b64 v[46:47], s[74:75]
    v_mfma_f32_16x16x32_bf16 v[72:75], v[92:95], v[92:95], v[72:75]
    ds_read_b128 v[4:7], v122 offset:1024
    v_mov_b64 v[60:61], 0
    v_mov_b64 v[62:63], 0
    v_mfma_f32_16x16x32_bf16 v[72:75], v[96:99], v[96:99], v[72:75]
    ds_read_b128 v[8:11], v122 offset:2048
    v_cndmask_b32_dpp v64, v68, v64, vcc quad_perm:[0,1,0,1] row_mask:0xf bank_mask:0xf
    v_cndmask_b32_dpp v65, v69, v65, vcc quad_perm:[0,1,0,1] row_mask:0xf bank_mask:0xf
    v_mfma_f32_16x16x32_bf16 v[72:75], v[100:103], v[100:103], v[72:75]
    ds_read_b128 v[12:15], v122 offset:3072
    v_cndmask_b32_dpp v66, v70, v66, vcc quad_perm:[0,1,0,1] row_mask:0xf bank_mask:0xf
    v_cndmask_b32_dpp v67, v71, v67, vcc quad_perm:[0,1,0,1] row_mask:0xf bank_mask:0xf
    v_max3_f32 v78, v64, v65, v66
    v_max_f32_e64 v78, v78, v67
    v_smfmac_f32_16x16x64_bf16 v[84:87], v[24:27], a[104:111], v120
    s_nop 0
    v_max_f32_dpp v78, v78, v78 quad_perm:[2,3,0,1] row_mask:0xf bank_mask:0xf
    v_mov_b32_dpp v68, v74 quad_perm:[0,1,0,1] row_mask:0xf bank_mask:0xf
    v_mov_b32_dpp v69, v75 quad_perm:[0,1,0,1] row_mask:0xf bank_mask:0xf
    v_max3_f32 v76, v78, v68, v69
    v_max3_f32 v77, v78, v68, v69
    v_smfmac_f32_16x16x64_bf16 v[80:83], v[28:31], a[112:119], v120
    s_nop 0
    v_permlane16_swap_b32 v76, v77
    v_max_f32 v78, v76, v77
    v_max_f32_e64 v79, v76, v77
    v_smfmac_f32_16x16x64_bf16 v[84:87], v[28:31], a[120:127], v120
    s_nop 0
    v_permlane32_swap_b32 v78, v79
    v_max_f32_e64 v76, v78, v79
    v_pk_add_f32 v[64:65], v[64:65], v[76:77] op_sel_hi:[1,0] neg_lo:[0,1] neg_hi:[0,1]
    v_pk_mul_f32 v[64:65], v[64:65], s[72:73]
    v_pk_add_f32 v[66:67], v[66:67], v[76:77] op_sel_hi:[1,0] neg_lo:[0,1] neg_hi:[0,1]
    v_pk_mul_f32 v[66:67], v[66:67], s[72:73]
    v_pk_add_f32 v[74:75], v[74:75], v[76:77] op_sel_hi:[1,0] neg_lo:[0,1] neg_hi:[0,1]
    v_pk_mul_f32 v[74:75], v[74:75], s[72:73]
    v_exp_f32 v64, v64
    v_exp_f32 v65, v65
    v_exp_f32 v66, v66
    v_exp_f32 v67, v67
    v_cvt_pk_bf16_f32 v88, v64, v65
    v_cvt_pk_bf16_f32 v89, v66, v67
    v_exp_f32_e64 v74, v74
    v_mov_b32_dpp v90, v88 quad_perm:[2,3,2,3] row_mask:0xf bank_mask:0xf
    v_mov_b32_dpp v91, v89 quad_perm:[2,3,2,3] row_mask:0xf bank_mask:0xf
    ds_read_b128 v[16:19], v122 offset:4096
    s_nop 0
    v_mfma_f32_16x16x32_bf16 v[40:43], v[44:47], v[88:91], 0
    ds_read_b128 v[20:23], v122 offset:5120
    v_exp_f32 v75, v75
    v_mov_b64_e64 v[72:73], s[100:101]
    v_mfma_f32_16x16x32_bf16 v[32:35], v[104:107], v[88:91], 0
    ds_read_b128 v[24:27], v122 offset:6144
    v_cvt_pk_bf16_f32 v92, v74, v75
    v_cvt_pk_bf16_f32 v93, v74, v75
    v_mfma_f32_16x16x32_bf16 v[36:39], v[108:111], v[88:91], 0
    ds_read_b128 v[28:31], v122 offset:7168
    v_cvt_pk_bf16_f32 v80, v80, v81
    v_cvt_pk_bf16_f32 v81, v86, v87
    v_mfma_f32_16x16x16_bf16 v[40:43], v[72:73], v[92:93], v[40:43]
    s_add_u32 s22, s22, 1
    v_cvt_pk_bf16_f32 v83, v82, v83
    v_cvt_pk_bf16_f32 v82, v84, v85
    v_mfma_f32_16x16x16_bf16 v[32:35], v[80:81], v[92:93], v[32:35]
    s_nop 0
    v_mov_b32_dpp v64, v123 quad_perm:[0,1,0,1] row_mask:0xf bank_mask:0xf
    v_xor_b32 v65, 512, v64
    v_mfma_f32_16x16x16_bf16 v[36:39], v[82:83], v[92:93], v[36:39]
    s_nop 0
    v_rcp_f32 v76, v40
    v_xor_b32 v66, 1024, v64
    v_xor_b32 v67, 1536, v64
    v_pk_mul_f32 v[32:33], v[32:33], v[76:77] op_sel_hi:[1,0]
    v_pk_mul_f32 v[34:35], v[34:35], v[76:77] op_sel_hi:[1,0]
    v_cvt_pk_bf16_f32 v88, v32, v33
    v_cvt_pk_bf16_f32 v89, v34, v35
    v_pk_mul_f32 v[36:37], v[36:37], v[76:77] op_sel_hi:[1,0]
    v_pk_mul_f32 v[38:39], v[38:39], v[76:77] op_sel_hi:[1,0]
    v_cvt_pk_bf16_f32 v90, v36, v37
    v_cvt_pk_bf16_f32 v91, v38, v39
    v_mfma_f32_16x16x16_bf16 v[40:43], v[44:45], v[44:45], 0
    ds_write_b128 v123, v[88:91]
    v_mov_b32_dpp v88, v88 quad_perm:[0,1,0,1] row_mask:0xf bank_mask:0xf
    v_mov_b32_dpp v89, v89 quad_perm:[0,1,0,1] row_mask:0xf bank_mask:0xf
    v_mov_b32_dpp v90, v90 quad_perm:[0,1,0,1] row_mask:0xf bank_mask:0xf
    v_mov_b32_dpp v91, v91 quad_perm:[0,1,0,1] row_mask:0xf bank_mask:0xf
    s_waitcnt lgkmcnt(1)
    s_cmp_lg_u32 s21, 0
    v_smfmac_f32_16x16x64_bf16 v[48:51], v[88:91], v[0:7], v120
    v_and_b32_e64 v68, 0x30, v121
    v_smfmac_f32_16x16x64_bf16 v[52:55], v[88:91], v[8:15], v120
    v_min_u32_e64 v68, 1, v68
    s_waitcnt lgkmcnt(0)
    s_barrier
    ds_read_b128 v[92:95], v65
    ds_read_b128 v[96:99], v66
    ds_read_b128 v[100:103], v67
    v_smfmac_f32_16x16x64_bf16 v[56:59], v[88:91], v[16:23], v120
    v_or_b32_e64 v68, -2, v68
    v_smfmac_f32_16x16x64_bf16 v[60:63], v[88:91], v[24:31], v120
    s_cbranch_scc1 NR_96
    s_waitcnt lgkmcnt(2)
    v_smfmac_f32_16x16x64_bf16 v[48:51], v[92:95], a[192:199], v120
    ds_read_b128 v[0:3], v122 offset:8192
    ds_read_b128 v[4:7], v122 offset:9216
    s_waitcnt lgkmcnt(3)
    v_smfmac_f32_16x16x64_bf16 v[48:51], v[96:99], a[200:207], v120
    ds_read_b128 v[8:11], v122 offset:10240
    ds_read_b128 v[12:15], v122 offset:11264
    s_waitcnt lgkmcnt(4)
    v_smfmac_f32_16x16x64_bf16 v[48:51], v[100:103], a[208:215], v120
    ds_read_b128 v[16:19], v122 offset:12288
    ds_read_b128 v[20:23], v122 offset:13312
    v_smfmac_f32_16x16x64_bf16 v[52:55], v[92:95], a[216:223], v120
    ds_read_b128 v[24:27], v122 offset:14336
    ds_read_b128 v[28:31], v122 offset:15360
    v_smfmac_f32_16x16x64_bf16 v[52:55], v[96:99], a[224:231], v120
    s_nop 1
    v_cvt_pk_bf16_f32 v48, v48, v49
    v_and_b32 v48, v68, v48
    v_smfmac_f32_16x16x64_bf16 v[52:55], v[100:103], a[232:239], v120
    buffer_store_dword v48, v126, s[56:59], 0 offen offset:0
    s_nop 0
    v_cvt_pk_bf16_f32 v49, v50, v51
    v_and_b32 v49, v68, v49
    v_smfmac_f32_16x16x64_bf16 v[56:59], v[92:95], a[240:247], v120
    buffer_store_dword v49, v126, s[56:59], 0 offen offset:64
    s_nop 0
    v_smfmac_f32_16x16x64_bf16 v[56:59], v[96:99], a[248:255], v120
    s_nop 1
    v_cvt_pk_bf16_f32 v52, v52, v53
    v_and_b32 v52, v68, v52
    s_waitcnt lgkmcnt(6)
    v_smfmac_f32_16x16x64_bf16 v[56:59], v[100:103], v[0:7], v120
    buffer_store_dword v52, v126, s[56:59], 0 offen offset:128
    s_nop 0
    v_cvt_pk_bf16_f32 v53, v54, v55
    v_and_b32_e64 v53, v68, v53
    s_waitcnt lgkmcnt(0)
    v_smfmac_f32_16x16x64_bf16 v[60:63], v[92:95], v[8:15], v120
    buffer_store_dword v53, v126, s[56:59], 0 offen offset:192
    s_nop 0
    v_cvt_pk_bf16_f32 v56, v56, v57
    v_and_b32 v56, v68, v56
    v_smfmac_f32_16x16x64_bf16 v[60:63], v[96:99], v[16:23], v120
    buffer_store_dword v56, v126, s[60:63], 0 offen offset:0
    s_nop 0
    v_cvt_pk_bf16_f32 v57, v58, v59
    v_and_b32 v57, v68, v57
    v_smfmac_f32_16x16x64_bf16 v[60:63], v[100:103], v[24:31], v120
    buffer_store_dword v57, v126, s[60:63], 0 offen offset:64
    s_nop 0
    s_nop 5
    v_cvt_pk_bf16_f32 v60, v60, v61
    v_and_b32_e64 v60, v68, v60
    buffer_store_dword v60, v126, s[60:63], 0 offen offset:128
    v_cvt_pk_bf16_f32 v61, v62, v63
    v_and_b32_e64 v61, v68, v61
    buffer_store_dword v61, v126, s[60:63], 0 offen offset:192
    v_mov_b64_e64 v[100:101], -1
    ds_read_b128 v[88:91], v121 offset:30720
    buffer_store_dwordx2 v[100:101], v127, s[48:51], s25 offen
    v_mov_b64 v[64:65], 0
    v_mov_b64 v[66:67], 0
    v_mov_b64 v[68:69], 0
    v_mov_b64 v[70:71], 0
    v_mov_b64 v[72:73], 0
    v_mov_b64 v[74:75], 0
    v_mov_b64 v[76:77], 0
    v_mov_b64 v[78:79], 0
    v_mov_b64 v[80:81], 0
    v_mov_b64 v[82:83], 0
    v_mov_b64 v[84:85], 0
    v_mov_b64 v[86:87], 0
    v_add_u32_e64 v92, s29, v121
    v_xor_b32 v93, 1024, v92
    v_xor_b32 v94, 2048, v92
    v_xor_b32 v95, 3072, v92
    s_mov_b32 s32, s25
    s_mov_b32 s25, s23
    s_mov_b32 s23, s24
    s_mov_b32 s24, s32
    s_waitcnt vmcnt(7)
    s_cmp_lt_u32 s20, 16
    s_cbranch_scc1 RE_97
    s_waitcnt vmcnt(2)
RE_97:
    buffer_load_dwordx4 v[0:3], v121, s[64:67], 0 offen offset:0 sc1
    buffer_load_dwordx4 v[4:7], v121, s[64:67], 0 offen offset:1024 sc1
    buffer_load_dwordx4 v[8:11], v121, s[64:67], 0 offen offset:2048 sc1
    buffer_load_dwordx4 v[12:15], v121, s[64:67], 0 offen offset:3072 sc1
    buffer_load_dwordx4 v[16:19], v121, s[68:71], 0 offen offset:0 sc1
    buffer_load_dwordx4 v[20:23], v121, s[68:71], 0 offen offset:1024 sc1
    buffer_load_dwordx4 v[24:27], v121, s[68:71], 0 offen offset:2048 sc1
    buffer_load_dwordx4 v[28:31], v121, s[68:71], 0 offen offset:3072 sc1
    v_mov_b32 v102, 0
    s_nop 1
    v_mov_b32 v102, 0
    s_nop 1
    v_mov_b32 v102, 0
    s_nop 0
    buffer_load_dwordx4 v[32:35], v121, s[64:67], 0 offen offset:0 sc1
    buffer_load_dwordx4 v[36:39], v121, s[64:67], 0 offen offset:1024 sc1
    buffer_load_dwordx4 v[40:43], v121, s[64:67], 0 offen offset:2048 sc1
    buffer_load_dwordx4 v[44:47], v121, s[64:67], 0 offen offset:3072 sc1
    buffer_load_dwordx4 v[48:51], v121, s[68:71], 0 offen offset:0 sc1
    buffer_load_dwordx4 v[52:55], v121, s[68:71], 0 offen offset:1024 sc1
    buffer_load_dwordx4 v[56:59], v121, s[68:71], 0 offen offset:2048 sc1
    buffer_load_dwordx4 v[60:63], v121, s[68:71], 0 offen offset:3072 sc1
    s_add_u32 s88, s48, s23
    s_addc_u32 s89, s49, 0
    s_add_u32 s92, s52, s23
    s_addc_u32 s93, s53, 0
    s_add_u32 s76, s4, s26
    s_addc_u32 s77, s5, 0
    s_add_u32 s80, s4, s27
    s_addc_u32 s81, s5, 0
    s_add_u32 s84, s4, s28
    s_addc_u32 s85, s5, 0
    s_waitcnt lgkmcnt(0)
    s_waitcnt vmcnt(15)
    v_mfma_f32_16x16x32_bf16 v[96:99], v[0:3], v[88:91], 0
    s_waitcnt vmcnt(14)
    v_mfma_f32_16x16x32_bf16 v[96:99], v[4:7], v[88:91], v[96:99]
    v_or_b32_e64 v102, v0, v4
    s_waitcnt vmcnt(13)
    v_mfma_f32_16x16x32_bf16 v[96:99], v[8:11], v[88:91], v[96:99]
    s_waitcnt vmcnt(12)
    v_mfma_f32_16x16x32_bf16 v[96:99], v[12:15], v[88:91], v[96:99]
    v_bitop3_b32 v102, v102, v8, v12 bitop3:0xfe
    s_waitcnt vmcnt(11)
    v_mfma_f32_16x16x32_bf16 v[96:99], v[16:19], v[88:91], v[96:99]
    s_waitcnt vmcnt(10)
    v_mfma_f32_16x16x32_bf16 v[96:99], v[20:23], v[88:91], v[96:99]
    v_bitop3_b32 v102, v102, v16, v20 bitop3:0xfe
    s_waitcnt vmcnt(9)
    v_mfma_f32_16x16x32_bf16 v[96:99], v[24:27], v[88:91], v[96:99]
    v_or_b32 v102, v102, v24
    s_waitcnt vmcnt(8)
    v_mfma_f32_16x16x32_bf16 v[96:99], v[28:31], v[88:91], v[96:99]
    v_bitop3_b32 v102, v102, v28, 1 bitop3:0xa8
    v_cmp_ne_u32 vcc, 0, v102
    s_nop 5
    v_cvt_pk_bf16_f32 v100, v96, v97
    v_cvt_pk_bf16_f32 v101, v98, v99
    s_cbranch_vccnz RL_98
RK_99:
    buffer_store_dwordx2 v[100:101], v127, s[88:91], 0 offen
JN_100:
    s_cmp_eq_u32 s22, 63
    s_cbranch_scc0 GO_101
    buffer_store_dwordx2 v[100:101], v127, s[4:7], s28 offen sc1
    s_or_b32 s32, s20, s21
    s_cmp_lg_u32 s32, 0
    s_cbranch_scc1 WB_102
    s_waitcnt vmcnt(0)
    buffer_wbl2 sc1
WB_102:
    s_branch L_EXIT
GO_101:
    s_barrier
    v_mov_b32 v102, 0
    s_nop 1
    v_mov_b32 v102, 0
    s_nop 0
    s_cmp_ge_u32 s20, 16
    s_cbranch_scc1 DE_103
    v_mov_b32 v102, 0
    s_nop 1
    v_mov_b32 v102, 0
    s_nop 1
    v_mov_b32 v102, 0
    s_nop 1
    v_mov_b32 v102, 0
    s_nop 1
    v_mov_b32 v102, 0
    s_nop 1
    v_mov_b32 v102, 0
    s_nop 1
    v_mov_b32 v102, 0
    s_nop 1
    v_mov_b32 v102, 0
    s_nop 1
    v_mov_b32 v102, 0
    s_nop 1
    v_mov_b32 v102, 0
    s_nop 1
    v_mov_b32 v102, 0
    s_nop 1
    v_mov_b32_e64 v102, 0
    s_nop 0
DE_103:
    buffer_load_dwordx4 v[0:3], v92, s[88:91], 0 offen sc1
    v_mov_b32 v88, 0
    s_nop 1
    v_mov_b32 v88, 0
    s_nop 1
    v_mov_b32 v88, 0
    s_nop 1
    v_mov_b32 v88, 0
    s_nop 1
    v_mov_b32 v88, 0
    s_nop 1
    v_mov_b32 v88, 0
    s_nop 1
    v_mov_b32 v88, 0
    s_nop 0
    buffer_load_dwordx4 v[4:7], v92, s[92:95], 0 offen sc1
    s_waitcnt vmcnt(3)
    ds_read_b128 v[32:35], v122 offset:32768
    ds_read_b128 v[36:39], v122 offset:33792
    v_mov_b32 v88, 0
    ds_read_b128 v[40:43], v122 offset:34816
    ds_read_b128 v[44:47], v122 offset:35840
    v_mov_b32_e64 v88, 0
    ds_read_b128 v[48:51], v122 offset:36864
    ds_read_b128 v[52:55], v122 offset:37888
    v_mov_b32_e64 v88, 0
    buffer_load_dwordx4 v[0:3], v92, s[88:91], 0 offen sc1
    ds_read_b128 v[56:59], v122 offset:38912
    ds_read_b128 v[60:63], v122 offset:39936
    v_mov_b32 v88, 0
    v_mov_b32 v88, 0
    s_nop 1
    v_mov_b32 v88, 0
    buffer_load_dwordx4 v[4:7], v92, s[92:95], 0 offen sc1
    v_mov_b32 v88, 0
    s_nop 1
    v_mov_b32 v88, 0
    s_nop 1
    v_mov_b32 v88, 0
    s_nop 1
    v_mov_b32_e64 v88, 0
    s_nop 1
    s_waitcnt vmcnt(3) lgkmcnt(0)
    v_max3_u32 v88, v0, v1, v2
    v_max_u32 v88, v88, v3
    v_cmp_eq_u32 vcc, -1, v88
H2_104:
    v_smfmac_f32_16x16x64_bf16 v[72:75], v[0:3], v[32:39], v120
    ds_write_b128 v92, v[0:3] offset:20480
    s_cbranch_vccnz HF_105
    v_smfmac_f32_16x16x64_bf16 v[76:79], v[0:3], v[40:47], v120
    v_smfmac_f32_16x16x64_bf16 v[64:67], v[0:3], v[128:135], v120
    s_waitcnt vmcnt(2)
    v_max3_u32 v88, v4, v5, v6
    v_smfmac_f32_16x16x64_bf16 v[68:71], v[0:3], v[136:143], v120
    v_max_u32 v88, v88, v7
    v_cmp_eq_u32 vcc, -1, v88
    v_smfmac_f32_16x16x64_bf16 v[80:83], v[0:3], a[0:7], v120
    s_cbranch_vccnz HG_107
H3_106:
    ds_write_b128 v92, v[4:7] offset:24576
    s_mov_b32 m0, s36
    v_smfmac_f32_16x16x64_bf16 v[84:87], v[0:3], a[8:15], v120
    buffer_load_dwordx4 v[104:107], v121, s[80:83], 0 offen sc1
    v_smfmac_f32_16x16x64_bf16 v[72:75], v[4:7], v[48:55], v120
    buffer_load_dwordx4 v121, s[76:79], 0 offen sc1 lds
    v_smfmac_f32_16x16x64_bf16 v[76:79], v[4:7], v[56:63], v120
    buffer_load_dwordx4 v[108:111], v121, s[80:83], 0 offen offset:1024 sc1
    v_smfmac_f32_16x16x64_bf16 v[64:67], v[4:7], v[144:151], v120
    s_waitcnt lgkmcnt(0)
    s_barrier
    ds_read_b128 v[8:11], v93 offset:20480
    v_smfmac_f32_16x16x64_bf16 v[68:71], v[4:7], v[152:159], v120
    ds_read_b128 v[12:15], v93 offset:24576
    v_smfmac_f32_16x16x64_bf16 v[80:83], v[4:7], a[16:23], v120
    ds_read_b128 v[16:19], v94 offset:20480
    v_smfmac_f32_16x16x64_bf16 v[84:87], v[4:7], a[24:31], v120
    ds_read_b128 v[20:23], v94 offset:24576
    s_waitcnt lgkmcnt(3)
    v_smfmac_f32_16x16x64_bf16 v[72:75], v[8:11], a[128:135], v120
    ds_read_b128 v[24:27], v95 offset:20480
    v_smfmac_f32_16x16x64_bf16 v[76:79], v[8:11], a[136:143], v120
    ds_read_b128 v[28:31], v95 offset:24576
    v_smfmac_f32_16x16x64_bf16 v[64:67], v[8:11], v[160:167], v120
    ds_read_b128 v[32:35], v122 offset:40960
    v_smfmac_f32_16x16x64_bf16 v[68:71], v[8:11], v[168:175], v120
    ds_read_b128 v[36:39], v122 offset:41984
    s_waitcnt lgkmcnt(6)
    v_smfmac_f32_16x16x64_bf16 v[72:75], v[12:15], a[144:151], v120
    ds_read_b128 v[40:43], v122 offset:43008
    v_smfmac_f32_16x16x64_bf16 v[76:79], v[12:15], a[152:159], v120
    ds_read_b128 v[44:47], v122 offset:44032
    v_smfmac_f32_16x16x64_bf16 v[64:67], v[12:15], v[176:183], v120
    ds_read_b128 v[48:51], v122 offset:45056
    v_smfmac_f32_16x16x64_bf16 v[68:71], v[12:15], v[184:191], v120
    ds_read_b128 v[52:55], v122 offset:46080
    s_waitcnt lgkmcnt(4)
    v_smfmac_f32_16x16x64_bf16 v[72:75], v[16:19], v[32:39], v120
    ds_read_b128 v[56:59], v122 offset:47104
    s_waitcnt lgkmcnt(3)
    v_smfmac_f32_16x16x64_bf16 v[76:79], v[16:19], v[40:47], v120
    ds_read_b128 v[60:63], v122 offset:48128
    v_smfmac_f32_16x16x64_bf16 v[64:67], v[16:19], v[192:199], v120
    ds_read_b128 v[32:35], v121 offset:8192
    v_smfmac_f32_16x16x64_bf16 v[68:71], v[16:19], v[200:207], v120
    ds_read_b128 v[36:39], v121 offset:9216
    s_waitcnt lgkmcnt(4)
    v_smfmac_f32_16x16x64_bf16 v[72:75], v[20:23], v[48:55], v120
    ds_read_b128 v[40:43], v121 offset:10240
    s_waitcnt lgkmcnt(3)
    v_smfmac_f32_16x16x64_bf16 v[76:79], v[20:23], v[56:63], v120
    buffer_load_dwordx4 v121, s[76:79], 0 offen offset:1024 sc1 lds
    ds_read_b128 v[44:47], v121 offset:11264
    v_smfmac_f32_16x16x64_bf16 v[64:67], v[20:23], v[208:215], v120
    ds_read_b128 v[48:51], v121 offset:12288
    v_smfmac_f32_16x16x64_bf16 v[68:71], v[20:23], v[216:223], v120
    ds_read_b128 v[52:55], v121 offset:13312
    v_smfmac_f32_16x16x64_bf16 v[72:75], v[24:27], a[160:167], v120
    ds_read_b128 v[56:59], v121 offset:14336
    v_smfmac_f32_16x16x64_bf16 v[76:79], v[24:27], a[168:175], v120
    buffer_store_dwordx2 v[100:101], v127, s[84:87], 0 offen sc1
    ds_read_b128 v[60:63], v121 offset:15360
    v_smfmac_f32_16x16x64_bf16 v[64:67], v[24:27], v[224:231], v120
    s_add_u32 s26, s26, 262144
    v_smfmac_f32_16x16x64_bf16 v[68:71], v[24:27], v[232:239], v120
    s_add_u32 s27, s27, 262144
    v_smfmac_f32_16x16x64_bf16 v[72:75], v[28:31], a[176:183], v120
    s_add_u32 s28, s28, 8192
    s_nop 0
    v_smfmac_f32_16x16x64_bf16 v[76:79], v[28:31], a[184:191], v120
    s_nop 1
    v_smfmac_f32_16x16x64_bf16 v[64:67], v[28:31], v[240:247], v120
    s_nop 1
    v_smfmac_f32_16x16x64_bf16 v[68:71], v[28:31], v[248:255], v120
    s_nop 1
    v_add_f32 v72, v72, v78
    v_add_f32 v73, v73, v79
    v_cvt_pk_bf16_f32 v89, v72, v73
    v_add_f32 v76, v76, v74
    v_add_f32 v77, v77, v75
    v_cvt_pk_bf16_f32 v91, v76, v77
    v_pk_add_f32 v[64:65], v[64:65], v[70:71]
    v_cvt_pk_bf16_f32 v88, v64, v65
    v_pk_add_f32 v[68:69], v[68:69], v[66:67]
    v_cvt_pk_bf16_f32 v90, v68, v69
    v_smfmac_f32_16x16x64_bf16 v[80:83], v[8:11], a[32:39], v120
    ds_write2_b64 v124, v[88:89], v[90:91] offset1:64
    v_smfmac_f32_16x16x64_bf16 v[84:87], v[8:11], a[40:47], v120
    v_smfmac_f32_16x16x64_bf16 v[80:83], v[12:15], a[48:55], v120
    v_smfmac_f32_16x16x64_bf16 v[84:87], v[12:15], a[56:63], v120
    v_smfmac_f32_16x16x64_bf16 v[80:83], v[16:19], a[64:71], v120
    s_waitcnt lgkmcnt(0)
    s_barrier
    ds_read_b64_tr_b16 v[88:89], v125 offset:0
    ds_read_b64_tr_b16 v[90:91], v125 offset:512
    v_smfmac_f32_16x16x64_bf16 v[84:87], v[16:19], a[72:79], v120
    ds_read_b64_tr_b16 v[92:93], v125 offset:1024
    ds_read_b64_tr_b16 v[94:95], v125 offset:1536
    v_smfmac_f32_16x16x64_bf16 v[80:83], v[20:23], a[80:87], v120
    ds_read_b64_tr_b16 v[96:97], v125 offset:2048
    ds_read_b64_tr_b16 v[98:99], v125 offset:2560
    v_smfmac_f32_16x16x64_bf16 v[84:87], v[20:23], a[88:95], v120
    ds_read_b64_tr_b16 v[100:101], v125 offset:3072
    ds_read_b64_tr_b16 v[102:103], v125 offset:3584
    v_smfmac_f32_16x16x64_bf16 v[80:83], v[24:27], a[96:103], v120
    s_mov_b64 vcc, s[46:47]
    s_waitcnt lgkmcnt(6)
    v_mfma_f32_16x16x32_bf16 v[64:67], v[32:35], v[88:91], 0
    v_mfma_f32_16x16x32_bf16 v[68:71], v[48:51], v[88:91], 0
    s_waitcnt lgkmcnt(4)
    v_mfma_f32_16x16x32_bf16 v[64:67], v[36:39], v[92:95], v[64:67]
    v_mov_b64 v[48:49], 0
    v_mov_b64_e64 v[50:51], 0
    v_mfma_f32_16x16x32_bf16 v[68:71], v[52:55], v[92:95], v[68:71]
    s_waitcnt lgkmcnt(2)
    v_mfma_f32_16x16x32_bf16 v[64:67], v[40:43], v[96:99], v[64:67]
    v_mov_b64 v[52:53], 0
    v_mov_b64_e64 v[54:55], 0
    v_mfma_f32_16x16x32_bf16 v[68:71], v[56:59], v[96:99], v[68:71]
    s_waitcnt lgkmcnt(0) vmcnt(5)
    v_mfma_f32_16x16x32_bf16 v[64:67], v[44:47], v[100:103], v[64:67]
    v_mov_b64 v[56:57], 0
    v_mov_b64_e64 v[58:59], 0
    v_mfma_f32_16x16x32_bf16 v[68:71], v[60:63], v[100:103], v[68:71]
    v_mfma_f32_16x16x32_bf16 v[72:75], v[88:91], v[88:91], 0
    ds_read_b128 v[0:3], v122 offset:0
    v_mov_b64 v[44:45], s[74:75]
    v_mov_b64 v[46:47], s[74:75]
    v_mfma_f32_16x16x32_bf16 v[72:75], v[92:95], v[92:95], v[72:75]
    ds_read_b128 v[4:7], v122 offset:1024
    v_mov_b64 v[60:61], 0
    v_mov_b64 v[62:63], 0
    v_mfma_f32_16x16x32_bf16 v[72:75], v[96:99], v[96:99], v[72:75]
    ds_read_b128 v[8:11], v122 offset:2048
    v_cndmask_b32_dpp v64, v68, v64, vcc quad_perm:[0,1,0,1] row_mask:0xf bank_mask:0xf
    v_cndmask_b32_dpp v65, v69, v65, vcc quad_perm:[0,1,0,1] row_mask:0xf bank_mask:0xf
    v_mfma_f32_16x16x32_bf16 v[72:75], v[100:103], v[100:103], v[72:75]
    ds_read_b128 v[12:15], v122 offset:3072
    v_cndmask_b32_dpp v66, v70, v66, vcc quad_perm:[0,1,0,1] row_mask:0xf bank_mask:0xf
    v_cndmask_b32_dpp v67, v71, v67, vcc quad_perm:[0,1,0,1] row_mask:0xf bank_mask:0xf
    v_max3_f32 v78, v64, v65, v66
    v_max_f32_e64 v78, v78, v67
    v_smfmac_f32_16x16x64_bf16 v[84:87], v[24:27], a[104:111], v120
    s_nop 0
    v_max_f32_dpp v78, v78, v78 quad_perm:[2,3,0,1] row_mask:0xf bank_mask:0xf
    v_mov_b32_dpp v68, v74 quad_perm:[0,1,0,1] row_mask:0xf bank_mask:0xf
    v_mov_b32_dpp v69, v75 quad_perm:[0,1,0,1] row_mask:0xf bank_mask:0xf
    v_max3_f32 v76, v78, v68, v69
    v_max3_f32 v77, v78, v68, v69
    v_smfmac_f32_16x16x64_bf16 v[80:83], v[28:31], a[112:119], v120
    s_nop 0
    v_permlane16_swap_b32 v76, v77
    v_max_f32 v78, v76, v77
    v_max_f32_e64 v79, v76, v77
    v_smfmac_f32_16x16x64_bf16 v[84:87], v[28:31], a[120:127], v120
    s_nop 0
    v_permlane32_swap_b32 v78, v79
    v_max_f32_e64 v76, v78, v79
    v_pk_add_f32 v[64:65], v[64:65], v[76:77] op_sel_hi:[1,0] neg_lo:[0,1] neg_hi:[0,1]
    v_pk_mul_f32 v[64:65], v[64:65], s[72:73]
    v_pk_add_f32 v[66:67], v[66:67], v[76:77] op_sel_hi:[1,0] neg_lo:[0,1] neg_hi:[0,1]
    v_pk_mul_f32 v[66:67], v[66:67], s[72:73]
    v_pk_add_f32 v[74:75], v[74:75], v[76:77] op_sel_hi:[1,0] neg_lo:[0,1] neg_hi:[0,1]
    v_pk_mul_f32 v[74:75], v[74:75], s[72:73]
    v_exp_f32 v64, v64
    v_exp_f32 v65, v65
    v_exp_f32 v66, v66
    v_exp_f32 v67, v67
    v_cvt_pk_bf16_f32 v88, v64, v65
    v_cvt_pk_bf16_f32 v89, v66, v67
    v_exp_f32_e64 v74, v74
    v_mov_b32_dpp v90, v88 quad_perm:[2,3,2,3] row_mask:0xf bank_mask:0xf
    v_mov_b32_dpp v91, v89 quad_perm:[2,3,2,3] row_mask:0xf bank_mask:0xf
    ds_read_b128 v[16:19], v122 offset:4096
    s_nop 0
    v_mfma_f32_16x16x32_bf16 v[40:43], v[44:47], v[88:91], 0
    ds_read_b128 v[20:23], v122 offset:5120
    v_exp_f32 v75, v75
    v_mov_b64_e64 v[72:73], s[100:101]
    v_mfma_f32_16x16x32_bf16 v[32:35], v[112:115], v[88:91], 0
    ds_read_b128 v[24:27], v122 offset:6144
    v_cvt_pk_bf16_f32 v92, v74, v75
    v_cvt_pk_bf16_f32 v93, v74, v75
    v_mfma_f32_16x16x32_bf16 v[36:39], v[116:119], v[88:91], 0
    ds_read_b128 v[28:31], v122 offset:7168
    v_cvt_pk_bf16_f32 v80, v80, v81
    v_cvt_pk_bf16_f32 v81, v86, v87
    v_mfma_f32_16x16x16_bf16 v[40:43], v[72:73], v[92:93], v[40:43]
    s_add_u32 s22, s22, 1
    v_cvt_pk_bf16_f32 v83, v82, v83
    v_cvt_pk_bf16_f32 v82, v84, v85
    v_mfma_f32_16x16x16_bf16 v[32:35], v[80:81], v[92:93], v[32:35]
    s_nop 0
    v_mov_b32_dpp v64, v123 quad_perm:[0,1,0,1] row_mask:0xf bank_mask:0xf
    v_xor_b32 v65, 512, v64
    v_mfma_f32_16x16x16_bf16 v[36:39], v[82:83], v[92:93], v[36:39]
    s_nop 0
    v_rcp_f32 v76, v40
    v_xor_b32 v66, 1024, v64
    v_xor_b32 v67, 1536, v64
    v_pk_mul_f32 v[32:33], v[32:33], v[76:77] op_sel_hi:[1,0]
    v_pk_mul_f32 v[34:35], v[34:35], v[76:77] op_sel_hi:[1,0]
    v_cvt_pk_bf16_f32 v88, v32, v33
    v_cvt_pk_bf16_f32 v89, v34, v35
    v_pk_mul_f32 v[36:37], v[36:37], v[76:77] op_sel_hi:[1,0]
    v_pk_mul_f32 v[38:39], v[38:39], v[76:77] op_sel_hi:[1,0]
    v_cvt_pk_bf16_f32 v90, v36, v37
    v_cvt_pk_bf16_f32 v91, v38, v39
    v_mfma_f32_16x16x16_bf16 v[40:43], v[44:45], v[44:45], 0
    ds_write_b128 v123, v[88:91]
    v_mov_b32_dpp v88, v88 quad_perm:[0,1,0,1] row_mask:0xf bank_mask:0xf
    v_mov_b32_dpp v89, v89 quad_perm:[0,1,0,1] row_mask:0xf bank_mask:0xf
    v_mov_b32_dpp v90, v90 quad_perm:[0,1,0,1] row_mask:0xf bank_mask:0xf
    v_mov_b32_dpp v91, v91 quad_perm:[0,1,0,1] row_mask:0xf bank_mask:0xf
    s_waitcnt lgkmcnt(1)
    s_cmp_lg_u32 s21, 0
    v_smfmac_f32_16x16x64_bf16 v[48:51], v[88:91], v[0:7], v120
    v_and_b32_e64 v68, 0x30, v121
    v_smfmac_f32_16x16x64_bf16 v[52:55], v[88:91], v[8:15], v120
    v_min_u32_e64 v68, 1, v68
    s_waitcnt lgkmcnt(0)
    s_barrier
    ds_read_b128 v[92:95], v65
    ds_read_b128 v[96:99], v66
    ds_read_b128 v[100:103], v67
    v_smfmac_f32_16x16x64_bf16 v[56:59], v[88:91], v[16:23], v120
    v_xor_b32_e64 v68, 1, v68
    v_smfmac_f32_16x16x64_bf16 v[60:63], v[88:91], v[24:31], v120
    s_cbranch_scc1 NR_108
    s_waitcnt lgkmcnt(2)
    v_smfmac_f32_16x16x64_bf16 v[48:51], v[92:95], a[192:199], v120
    ds_read_b128 v[0:3], v122 offset:8192
    ds_read_b128 v[4:7], v122 offset:9216
    s_waitcnt lgkmcnt(3)
    v_smfmac_f32_16x16x64_bf16 v[48:51], v[96:99], a[200:207], v120
    ds_read_b128 v[8:11], v122 offset:10240
    ds_read_b128 v[12:15], v122 offset:11264
    s_waitcnt lgkmcnt(4)
    v_smfmac_f32_16x16x64_bf16 v[48:51], v[100:103], a[208:215], v120
    ds_read_b128 v[16:19], v122 offset:12288
    ds_read_b128 v[20:23], v122 offset:13312
    v_smfmac_f32_16x16x64_bf16 v[52:55], v[92:95], a[216:223], v120
    ds_read_b128 v[24:27], v122 offset:14336
    ds_read_b128 v[28:31], v122 offset:15360
    v_smfmac_f32_16x16x64_bf16 v[52:55], v[96:99], a[224:231], v120
    s_nop 1
    v_cvt_pk_bf16_f32 v48, v48, v49
    v_or_b32 v48, v68, v48
    v_smfmac_f32_16x16x64_bf16 v[52:55], v[100:103], a[232:239], v120
    buffer_store_dword v48, v126, s[56:59], 0 offen offset:0
    s_nop 0
    v_cvt_pk_bf16_f32 v49, v50, v51
    v_or_b32 v49, v68, v49
    v_smfmac_f32_16x16x64_bf16 v[56:59], v[92:95], a[240:247], v120
    buffer_store_dword v49, v126, s[56:59], 0 offen offset:64
    s_nop 0
    v_smfmac_f32_16x16x64_bf16 v[56:59], v[96:99], a[248:255], v120
    s_nop 1
    v_cvt_pk_bf16_f32 v52, v52, v53
    v_or_b32 v52, v68, v52
    s_waitcnt lgkmcnt(6)
    v_smfmac_f32_16x16x64_bf16 v[56:59], v[100:103], v[0:7], v120
    buffer_store_dword v52, v126, s[56:59], 0 offen offset:128
    s_nop 0
    v_cvt_pk_bf16_f32 v53, v54, v55
    v_or_b32_e64 v53, v68, v53
    s_waitcnt lgkmcnt(0)
    v_smfmac_f32_16x16x64_bf16 v[60:63], v[92:95], v[8:15], v120
    buffer_store_dword v53, v126, s[56:59], 0 offen offset:192
    s_nop 0
    v_cvt_pk_bf16_f32 v56, v56, v57
    v_or_b32 v56, v68, v56
    v_smfmac_f32_16x16x64_bf16 v[60:63], v[96:99], v[16:23], v120
    buffer_store_dword v56, v126, s[60:63], 0 offen offset:0
    s_nop 0
    v_cvt_pk_bf16_f32 v57, v58, v59
    v_or_b32 v57, v68, v57
    v_smfmac_f32_16x16x64_bf16 v[60:63], v[100:103], v[24:31], v120
    buffer_store_dword v57, v126, s[60:63], 0 offen offset:64
    s_nop 0
    s_nop 5
    v_cvt_pk_bf16_f32 v60, v60, v61
    v_or_b32_e64 v60, v68, v60
    buffer_store_dword v60, v126, s[60:63], 0 offen offset:128
    v_cvt_pk_bf16_f32 v61, v62, v63
    v_or_b32_e64 v61, v68, v61
    buffer_store_dword v61, v126, s[60:63], 0 offen offset:192
    v_mov_b64_e64 v[100:101], -1
    ds_read_b128 v[88:91], v121 offset:30720
    buffer_store_dwordx2 v[100:101], v127, s[48:51], s25 offen
    v_mov_b64 v[64:65], 0
    v_mov_b64 v[66:67], 0
    v_mov_b64 v[68:69], 0
    v_mov_b64 v[70:71], 0
    v_mov_b64 v[72:73], 0
    v_mov_b64 v[74:75], 0
    v_mov_b64 v[76:77], 0
    v_mov_b64 v[78:79], 0
    v_mov_b64 v[80:81], 0
    v_mov_b64 v[82:83], 0
    v_mov_b64 v[84:85], 0
    v_mov_b64 v[86:87], 0
    v_add_u32_e64 v92, s29, v121
    v_xor_b32 v93, 1024, v92
    v_xor_b32 v94, 2048, v92
    v_xor_b32 v95, 3072, v92
    s_mov_b32 s32, s25
    s_mov_b32 s25, s23
    s_mov_b32 s23, s24
    s_mov_b32 s24, s32
    s_waitcnt vmcnt(7)
    s_cmp_lt_u32 s20, 16
    s_cbranch_scc1 RE_109
    s_waitcnt vmcnt(2)
RE_109:
    buffer_load_dwordx4 v[0:3], v121, s[64:67], 0 offen offset:0 sc1
    buffer_load_dwordx4 v[4:7], v121, s[64:67], 0 offen offset:1024 sc1
    buffer_load_dwordx4 v[8:11], v121, s[64:67], 0 offen offset:2048 sc1
    buffer_load_dwordx4 v[12:15], v121, s[64:67], 0 offen offset:3072 sc1
    buffer_load_dwordx4 v[16:19], v121, s[68:71], 0 offen offset:0 sc1
    buffer_load_dwordx4 v[20:23], v121, s[68:71], 0 offen offset:1024 sc1
    buffer_load_dwordx4 v[24:27], v121, s[68:71], 0 offen offset:2048 sc1
    buffer_load_dwordx4 v[28:31], v121, s[68:71], 0 offen offset:3072 sc1
    v_mov_b32 v102, 0
    s_nop 1
    v_mov_b32 v102, 0
    s_nop 1
    v_mov_b32 v102, 0
    s_nop 0
    buffer_load_dwordx4 v[32:35], v121, s[64:67], 0 offen offset:0 sc1
    buffer_load_dwordx4 v[36:39], v121, s[64:67], 0 offen offset:1024 sc1
    buffer_load_dwordx4 v[40:43], v121, s[64:67], 0 offen offset:2048 sc1
    buffer_load_dwordx4 v[44:47], v121, s[64:67], 0 offen offset:3072 sc1
    buffer_load_dwordx4 v[48:51], v121, s[68:71], 0 offen offset:0 sc1
    buffer_load_dwordx4 v[52:55], v121, s[68:71], 0 offen offset:1024 sc1
    buffer_load_dwordx4 v[56:59], v121, s[68:71], 0 offen offset:2048 sc1
    buffer_load_dwordx4 v[60:63], v121, s[68:71], 0 offen offset:3072 sc1
    s_add_u32 s88, s48, s23
    s_addc_u32 s89, s49, 0
    s_add_u32 s92, s52, s23
    s_addc_u32 s93, s53, 0
    s_add_u32 s76, s4, s26
    s_addc_u32 s77, s5, 0
    s_add_u32 s80, s4, s27
    s_addc_u32 s81, s5, 0
    s_add_u32 s84, s4, s28
    s_addc_u32 s85, s5, 0
    s_waitcnt lgkmcnt(0)
    s_waitcnt vmcnt(15)
    v_mfma_f32_16x16x32_bf16 v[96:99], v[0:3], v[88:91], 0
    s_waitcnt vmcnt(14)
    v_mfma_f32_16x16x32_bf16 v[96:99], v[4:7], v[88:91], v[96:99]
    v_and_b32_e64 v102, v0, v4
    s_waitcnt vmcnt(13)
    v_mfma_f32_16x16x32_bf16 v[96:99], v[8:11], v[88:91], v[96:99]
    s_waitcnt vmcnt(12)
    v_mfma_f32_16x16x32_bf16 v[96:99], v[12:15], v[88:91], v[96:99]
    v_bitop3_b32 v102, v102, v8, v12 bitop3:0x80
    s_waitcnt vmcnt(11)
    v_mfma_f32_16x16x32_bf16 v[96:99], v[16:19], v[88:91], v[96:99]
    s_waitcnt vmcnt(10)
    v_mfma_f32_16x16x32_bf16 v[96:99], v[20:23], v[88:91], v[96:99]
    v_bitop3_b32 v102, v102, v16, v20 bitop3:0x80
    s_waitcnt vmcnt(9)
    v_mfma_f32_16x16x32_bf16 v[96:99], v[24:27], v[88:91], v[96:99]
    v_and_b32 v102, v102, v24
    s_waitcnt vmcnt(8)
    v_mfma_f32_16x16x32_bf16 v[96:99], v[28:31], v[88:91], v[96:99]
    v_bitop3_b32 v102, v102, v28, 1 bitop3:0x80
    v_cmp_ne_u32 vcc, 1, v102
    s_nop 5
    v_cvt_pk_bf16_f32 v100, v96, v97
    v_cvt_pk_bf16_f32 v101, v98, v99
    s_cbranch_vccnz RL_110
RK_111:
    buffer_store_dwordx2 v[100:101], v127, s[88:91], 0 offen
JN_112:
    s_barrier
    v_mov_b32 v102, 0
    s_nop 1
    v_mov_b32 v102, 0
    s_nop 0
    s_cmp_ge_u32 s20, 16
    s_cbranch_scc1 DE_113
    v_mov_b32 v102, 0
    s_nop 1
    v_mov_b32 v102, 0
    s_nop 1
    v_mov_b32 v102, 0
    s_nop 1
    v_mov_b32 v102, 0
    s_nop 1
    v_mov_b32 v102, 0
    s_nop 1
    v_mov_b32 v102, 0
    s_nop 1
    v_mov_b32 v102, 0
    s_nop 1
    v_mov_b32 v102, 0
    s_nop 1
    v_mov_b32 v102, 0
    s_nop 1
    v_mov_b32 v102, 0
    s_nop 1
    v_mov_b32 v102, 0
    s_nop 1
    v_mov_b32 v102, 0
    s_nop 0
DE_113:
    s_branch STEP_91
.p2align 3
HF_93:
    buffer_load_dwordx4 v[0:3], v92, s[88:91], 0 offen sc1
    s_nop 5
    v_mov_b64 v[72:73], 0
    v_mov_b64 v[74:75], 0
    s_waitcnt vmcnt(2)
    v_max3_u32 v88, v0, v1, v2
    v_max_u32 v88, v88, v3
    v_cmp_eq_u32 vcc, -1, v88
    s_sub_u32 s30, s30, 8
    s_cbranch_vccz H2_92
HB_114:
    buffer_load_dwordx4 v[0:3], v92, s[88:91], 0 offen sc1
    s_sub_u32 s30, s30, 8
    s_cbranch_scc1 L_FAIL2
    s_waitcnt vmcnt(1)
    v_max3_u32 v88, v0, v1, v2
    v_max_u32 v88, v88, v3
    v_cmp_eq_u32 vcc, -1, v88
    s_cbranch_vccnz HB_114
    s_branch H2_92
.p2align 3
HG_95:
    buffer_load_dwordx4 v[4:7], v92, s[92:95], 0 offen sc1
    s_waitcnt vmcnt(1)
    v_max3_u32 v88, v4, v5, v6
    v_max_u32 v88, v88, v7
    v_cmp_eq_u32_e64 vcc, -1, v88
    s_sub_u32 s30, s30, 8
    s_cbranch_vccz H3_94
HB_115:
    buffer_load_dwordx4 v[4:7], v92, s[92:95], 0 offen sc1
    s_sub_u32 s30, s30, 8
    s_cbranch_scc1 L_FAIL2
    s_waitcnt vmcnt(1)
    v_max3_u32 v88, v4, v5, v6
    v_max_u32 v88, v88, v7
    v_cmp_eq_u32 vcc, -1, v88
    s_cbranch_vccnz HB_115
    s_branch H3_94
.p2align 3
RL_98:
    s_sub_u32 s30, s30, 8
    s_cbranch_scc1 L_FAIL2
    s_waitcnt vmcnt(7)
    v_mfma_f32_16x16x32_bf16 v[96:99], v[32:35], v[88:91], 0
    buffer_load_dwordx4 v[0:3], v121, s[64:67], 0 offen offset:0 sc1
    s_waitcnt vmcnt(7)
    v_mfma_f32_16x16x32_bf16 v[96:99], v[36:39], v[88:91], v[96:99]
    buffer_load_dwordx4 v[4:7], v121, s[64:67], 0 offen offset:1024 sc1
    v_or_b32 v102, v32, v36
    s_waitcnt vmcnt(7)
    v_mfma_f32_16x16x32_bf16 v[96:99], v[40:43], v[88:91], v[96:99]
    buffer_load_dwordx4 v[8:11], v121, s[64:67], 0 offen offset:2048 sc1
    s_waitcnt vmcnt(7)
    v_mfma_f32_16x16x32_bf16 v[96:99], v[44:47], v[88:91], v[96:99]
    buffer_load_dwordx4 v[12:15], v121, s[64:67], 0 offen offset:3072 sc1
    v_bitop3_b32 v102, v102, v40, v44 bitop3:0xfe
    s_waitcnt vmcnt(7)
    v_mfma_f32_16x16x32_bf16 v[96:99], v[48:51], v[88:91], v[96:99]
    buffer_load_dwordx4 v[16:19], v121, s[68:71], 0 offen offset:0 sc1
    s_waitcnt vmcnt(7)
    v_mfma_f32_16x16x32_bf16 v[96:99], v[52:55], v[88:91], v[96:99]
    buffer_load_dwordx4 v[20:23], v121, s[68:71], 0 offen offset:1024 sc1
    v_bitop3_b32 v102, v102, v48, v52 bitop3:0xfe
    s_waitcnt vmcnt(7)
    v_mfma_f32_16x16x32_bf16 v[96:99], v[56:59], v[88:91], v[96:99]
    buffer_load_dwordx4 v[24:27], v121, s[68:71], 0 offen offset:2048 sc1
    v_or_b32 v102, v102, v56
    s_waitcnt vmcnt(7)
    v_mfma_f32_16x16x32_bf16 v[96:99], v[60:63], v[88:91], v[96:99]
    buffer_load_dwordx4 v[28:31], v121, s[68:71], 0 offen offset:3072 sc1
    v_bitop3_b32 v102, v102, v60, 1 bitop3:0xa8
    v_cmp_ne_u32 vcc, 0, v102
    s_nop 4
    v_cvt_pk_bf16_f32 v100, v96, v97
    v_cvt_pk_bf16_f32 v101, v98, v99
    s_cbranch_vccz RK_99
    s_sub_u32 s30, s30, 8
    s_cbranch_scc1 L_FAIL2
    s_waitcnt vmcnt(7)
    v_mfma_f32_16x16x32_bf16 v[96:99], v[0:3], v[88:91], 0
    buffer_load_dwordx4 v[32:35], v121, s[64:67], 0 offen offset:0 sc1
    s_waitcnt vmcnt(7)
    v_mfma_f32_16x16x32_bf16 v[96:99], v[4:7], v[88:91], v[96:99]
    buffer_load_dwordx4 v[36:39], v121, s[64:67], 0 offen offset:1024 sc1
    v_or_b32_e64 v102, v0, v4
    s_waitcnt vmcnt(7)
    v_mfma_f32_16x16x32_bf16 v[96:99], v[8:11], v[88:91], v[96:99]
    buffer_load_dwordx4 v[40:43], v121, s[64:67], 0 offen offset:2048 sc1
    s_waitcnt vmcnt(7)
    v_mfma_f32_16x16x32_bf16 v[96:99], v[12:15], v[88:91], v[96:99]
    buffer_load_dwordx4 v[44:47], v121, s[64:67], 0 offen offset:3072 sc1
    v_bitop3_b32 v102, v102, v8, v12 bitop3:0xfe
    s_waitcnt vmcnt(7)
    v_mfma_f32_16x16x32_bf16 v[96:99], v[16:19], v[88:91], v[96:99]
    buffer_load_dwordx4 v[48:51], v121, s[68:71], 0 offen offset:0 sc1
    s_waitcnt vmcnt(7)
    v_mfma_f32_16x16x32_bf16 v[96:99], v[20:23], v[88:91], v[96:99]
    buffer_load_dwordx4 v[52:55], v121, s[68:71], 0 offen offset:1024 sc1
    v_bitop3_b32 v102, v102, v16, v20 bitop3:0xfe
    s_waitcnt vmcnt(7)
    v_mfma_f32_16x16x32_bf16 v[96:99], v[24:27], v[88:91], v[96:99]
    buffer_load_dwordx4 v[56:59], v121, s[68:71], 0 offen offset:2048 sc1
    v_or_b32 v102, v102, v24
    s_waitcnt vmcnt(7)
    v_mfma_f32_16x16x32_bf16 v[96:99], v[28:31], v[88:91], v[96:99]
    buffer_load_dwordx4 v[60:63], v121, s[68:71], 0 offen offset:3072 sc1
    v_bitop3_b32 v102, v102, v28, 1 bitop3:0xa8
    v_cmp_ne_u32 vcc, 0, v102
    s_nop 4
    v_cvt_pk_bf16_f32 v100, v96, v97
    v_cvt_pk_bf16_f32 v101, v98, v99
    s_cbranch_vccnz RL_98
    s_branch RK_99
.p2align 3
NR_96:
    s_waitcnt lgkmcnt(2)
    v_smfmac_f32_16x16x64_bf16 v[48:51], v[92:95], a[192:199], v120
    ds_read_b128 v[0:3], v122 offset:8192
    ds_read_b128 v[4:7], v122 offset:9216
    s_waitcnt lgkmcnt(3)
    v_smfmac_f32_16x16x64_bf16 v[48:51], v[96:99], a[200:207], v120
    ds_read_b128 v[8:11], v122 offset:10240
    ds_read_b128 v[12:15], v122 offset:11264
    s_waitcnt lgkmcnt(4)
    v_smfmac_f32_16x16x64_bf16 v[48:51], v[100:103], a[208:215], v120
    ds_read_b128 v[16:19], v122 offset:12288
    ds_read_b128 v[20:23], v122 offset:13312
    v_smfmac_f32_16x16x64_bf16 v[52:55], v[92:95], a[216:223], v120
    ds_read_b128 v[24:27], v122 offset:14336
    ds_read_b128 v[28:31], v122 offset:15360
    v_smfmac_f32_16x16x64_bf16 v[52:55], v[96:99], a[224:231], v120
    s_nop 1
    v_cvt_pk_bf16_f32 v48, v48, v49
    v_and_b32_e64 v48, v68, v48
    v_smfmac_f32_16x16x64_bf16 v[52:55], v[100:103], a[232:239], v120
    buffer_store_dword v48, v126, s[56:59], 0 offen offset:0
    s_nop 0
    v_cvt_pk_bf16_f32 v49, v50, v51
    v_and_b32 v49, v68, v49
    v_smfmac_f32_16x16x64_bf16 v[56:59], v[92:95], a[240:247], v120
    buffer_store_dword v49, v126, s[56:59], 0 offen offset:64
    s_nop 0
    v_smfmac_f32_16x16x64_bf16 v[56:59], v[96:99], a[248:255], v120
    s_nop 1
    v_cvt_pk_bf16_f32 v52, v52, v53
    v_and_b32 v52, v68, v52
    s_waitcnt lgkmcnt(6)
    v_smfmac_f32_16x16x64_bf16 v[56:59], v[100:103], v[0:7], v120
    buffer_store_dword v52, v126, s[56:59], 0 offen offset:128
    s_nop 0
    v_cvt_pk_bf16_f32 v53, v54, v55
    v_and_b32_e64 v53, v68, v53
    s_waitcnt lgkmcnt(0)
    v_smfmac_f32_16x16x64_bf16 v[60:63], v[92:95], v[8:15], v120
    buffer_store_dword v53, v126, s[56:59], 0 offen offset:192
    s_nop 0
    v_cvt_pk_bf16_f32 v56, v56, v57
    v_and_b32 v56, v68, v56
    v_smfmac_f32_16x16x64_bf16 v[60:63], v[96:99], v[16:23], v120
    buffer_store_dword v56, v126, s[60:63], 0 offen offset:0
    s_nop 0
    v_cvt_pk_bf16_f32 v57, v58, v59
    v_and_b32 v57, v68, v57
    v_smfmac_f32_16x16x64_bf16 v[60:63], v[100:103], v[24:31], v120
    buffer_store_dword v57, v126, s[60:63], 0 offen offset:64
    s_nop 0
    s_nop 5
    v_cvt_pk_bf16_f32 v60, v60, v61
    v_and_b32_e64 v60, v68, v60
    buffer_store_dword v60, v126, s[60:63], 0 offen offset:128
    v_cvt_pk_bf16_f32 v61, v62, v63
    v_and_b32_e64 v61, v68, v61
    buffer_store_dword v61, v126, s[60:63], 0 offen offset:192
    v_mov_b64 v[64:65], 0
    v_mov_b64 v[66:67], 0
    v_mov_b64 v[68:69], 0
    v_mov_b64 v[70:71], 0
    v_mov_b64 v[72:73], 0
    v_mov_b64 v[74:75], 0
    v_mov_b64 v[76:77], 0
    v_mov_b64 v[78:79], 0
    v_mov_b64 v[80:81], 0
    v_mov_b64 v[82:83], 0
    v_mov_b64 v[84:85], 0
    v_mov_b64 v[86:87], 0
    v_add_u32_e64 v92, s29, v121
    v_xor_b32 v93, 1024, v92
    v_xor_b32 v94, 2048, v92
    v_xor_b32 v95, 3072, v92
    s_mov_b32 s32, s25
    s_mov_b32 s25, s23
    s_mov_b32 s23, s24
    s_mov_b32 s24, s32
    s_add_u32 s88, s48, s23
    s_addc_u32 s89, s49, 0
    s_add_u32 s92, s52, s23
    s_addc_u32 s93, s53, 0
    s_add_u32 s76, s4, s26
    s_addc_u32 s77, s5, 0
    s_add_u32 s80, s4, s27
    s_addc_u32 s81, s5, 0
    s_add_u32 s84, s4, s28
    s_addc_u32 s85, s5, 0
    s_waitcnt lgkmcnt(0)
    s_cmp_eq_u64 s[12:13], s[38:39]
    s_cbranch_scc0 KE_116
KF_117:
    s_waitcnt vmcnt(0)
    s_branch JN_100
.p2align 3
HF_105:
    buffer_load_dwordx4 v[0:3], v92, s[88:91], 0 offen sc1
    s_nop 5
    v_mov_b64 v[72:73], 0
    v_mov_b64 v[74:75], 0
    s_waitcnt vmcnt(2)
    v_max3_u32 v88, v0, v1, v2
    v_max_u32 v88, v88, v3
    v_cmp_eq_u32 vcc, -1, v88
    s_sub_u32 s30, s30, 8
    s_cbranch_vccz H2_104
HB_118:
    buffer_load_dwordx4 v[0:3], v92, s[88:91], 0 offen sc1
    s_sub_u32 s30, s30, 8
    s_cbranch_scc1 L_FAIL2
    s_waitcnt vmcnt(1)
    v_max3_u32 v88, v0, v1, v2
    v_max_u32 v88, v88, v3
    v_cmp_eq_u32 vcc, -1, v88
    s_cbranch_vccnz HB_118
    s_branch H2_104
.p2align 3
HG_107:
    buffer_load_dwordx4 v[4:7], v92, s[92:95], 0 offen sc1
    s_waitcnt vmcnt(1)
    v_max3_u32 v88, v4, v5, v6
    v_max_u32 v88, v88, v7
    v_cmp_eq_u32_e64 vcc, -1, v88
    s_sub_u32 s30, s30, 8
    s_cbranch_vccz H3_106
HB_119:
    buffer_load_dwordx4 v[4:7], v92, s[92:95], 0 offen sc1
    s_sub_u32 s30, s30, 8
    s_cbranch_scc1 L_FAIL2
    s_waitcnt vmcnt(1)
    v_max3_u32 v88, v4, v5, v6
    v_max_u32 v88, v88, v7
    v_cmp_eq_u32 vcc, -1, v88
    s_cbranch_vccnz HB_119
    s_branch H3_106
.p2align 3
RL_110:
    s_sub_u32 s30, s30, 8
    s_cbranch_scc1 L_FAIL2
    s_waitcnt vmcnt(7)
    v_mfma_f32_16x16x32_bf16 v[96:99], v[32:35], v[88:91], 0
    buffer_load_dwordx4 v[0:3], v121, s[64:67], 0 offen offset:0 sc1
    s_waitcnt vmcnt(7)
    v_mfma_f32_16x16x32_bf16 v[96:99], v[36:39], v[88:91], v[96:99]
    buffer_load_dwordx4 v[4:7], v121, s[64:67], 0 offen offset:1024 sc1
    v_and_b32 v102, v32, v36
    s_waitcnt vmcnt(7)
    v_mfma_f32_16x16x32_bf16 v[96:99], v[40:43], v[88:91], v[96:99]
    buffer_load_dwordx4 v[8:11], v121, s[64:67], 0 offen offset:2048 sc1
    s_waitcnt vmcnt(7)
    v_mfma_f32_16x16x32_bf16 v[96:99], v[44:47], v[88:91], v[96:99]
    buffer_load_dwordx4 v[12:15], v121, s[64:67], 0 offen offset:3072 sc1
    v_bitop3_b32 v102, v102, v40, v44 bitop3:0x80
    s_waitcnt vmcnt(7)
    v_mfma_f32_16x16x32_bf16 v[96:99], v[48:51], v[88:91], v[96:99]
    buffer_load_dwordx4 v[16:19], v121, s[68:71], 0 offen offset:0 sc1
    s_waitcnt vmcnt(7)
    v_mfma_f32_16x16x32_bf16 v[96:99], v[52:55], v[88:91], v[96:99]
    buffer_load_dwordx4 v[20:23], v121, s[68:71], 0 offen offset:1024 sc1
    v_bitop3_b32 v102, v102, v48, v52 bitop3:0x80
    s_waitcnt vmcnt(7)
    v_mfma_f32_16x16x32_bf16 v[96:99], v[56:59], v[88:91], v[96:99]
    buffer_load_dwordx4 v[24:27], v121, s[68:71], 0 offen offset:2048 sc1
    v_and_b32 v102, v102, v56
    s_waitcnt vmcnt(7)
    v_mfma_f32_16x16x32_bf16 v[96:99], v[60:63], v[88:91], v[96:99]
    buffer_load_dwordx4 v[28:31], v121, s[68:71], 0 offen offset:3072 sc1
    v_bitop3_b32 v102, v102, v60, 1 bitop3:0x80
    v_cmp_ne_u32 vcc, 1, v102
    s_nop 4
    v_cvt_pk_bf16_f32 v100, v96, v97
    v_cvt_pk_bf16_f32 v101, v98, v99
    s_cbranch_vccz RK_111
    s_sub_u32 s30, s30, 8
    s_cbranch_scc1 L_FAIL2
    s_waitcnt vmcnt(7)
    v_mfma_f32_16x16x32_bf16 v[96:99], v[0:3], v[88:91], 0
    buffer_load_dwordx4 v[32:35], v121, s[64:67], 0 offen offset:0 sc1
    s_waitcnt vmcnt(7)
    v_mfma_f32_16x16x32_bf16 v[96:99], v[4:7], v[88:91], v[96:99]
    buffer_load_dwordx4 v[36:39], v121, s[64:67], 0 offen offset:1024 sc1
    v_and_b32_e64 v102, v0, v4
    s_waitcnt vmcnt(7)
    v_mfma_f32_16x16x32_bf16 v[96:99], v[8:11], v[88:91], v[96:99]
    buffer_load_dwordx4 v[40:43], v121, s[64:67], 0 offen offset:2048 sc1
    s_waitcnt vmcnt(7)
    v_mfma_f32_16x16x32_bf16 v[96:99], v[12:15], v[88:91], v[96:99]
    buffer_load_dwordx4 v[44:47], v121, s[64:67], 0 offen offset:3072 sc1
    v_bitop3_b32 v102, v102, v8, v12 bitop3:0x80
    s_waitcnt vmcnt(7)
    v_mfma_f32_16x16x32_bf16 v[96:99], v[16:19], v[88:91], v[96:99]
    buffer_load_dwordx4 v[48:51], v121, s[68:71], 0 offen offset:0 sc1
    s_waitcnt vmcnt(7)
    v_mfma_f32_16x16x32_bf16 v[96:99], v[20:23], v[88:91], v[96:99]
    buffer_load_dwordx4 v[52:55], v121, s[68:71], 0 offen offset:1024 sc1
    v_bitop3_b32 v102, v102, v16, v20 bitop3:0x80
    s_waitcnt vmcnt(7)
    v_mfma_f32_16x16x32_bf16 v[96:99], v[24:27], v[88:91], v[96:99]
    buffer_load_dwordx4 v[56:59], v121, s[68:71], 0 offen offset:2048 sc1
    v_and_b32 v102, v102, v24
    s_waitcnt vmcnt(7)
    v_mfma_f32_16x16x32_bf16 v[96:99], v[28:31], v[88:91], v[96:99]
    buffer_load_dwordx4 v[60:63], v121, s[68:71], 0 offen offset:3072 sc1
    v_bitop3_b32 v102, v102, v28, 1 bitop3:0x80
    v_cmp_ne_u32 vcc, 1, v102
    s_nop 4
    v_cvt_pk_bf16_f32 v100, v96, v97
    v_cvt_pk_bf16_f32 v101, v98, v99
    s_cbranch_vccnz RL_110
    s_branch RK_111
.p2align 3
NR_108:
    s_waitcnt lgkmcnt(2)
    v_smfmac_f32_16x16x64_bf16 v[48:51], v[92:95], a[192:199], v120
    ds_read_b128 v[0:3], v122 offset:8192
    ds_read_b128 v[4:7], v122 offset:9216
    s_waitcnt lgkmcnt(3)
    v_smfmac_f32_16x16x64_bf16 v[48:51], v[96:99], a[200:207], v120
    ds_read_b128 v[8:11], v122 offset:10240
    ds_read_b128 v[12:15], v122 offset:11264
    s_waitcnt lgkmcnt(4)
    v_smfmac_f32_16x16x64_bf16 v[48:51], v[100:103], a[208:215], v120
    ds_read_b128 v[16:19], v122 offset:12288
    ds_read_b128 v[20:23], v122 offset:13312
    v_smfmac_f32_16x16x64_bf16 v[52:55], v[92:95], a[216:223], v120
    ds_read_b128 v[24:27], v122 offset:14336
    ds_read_b128 v[28:31], v122 offset:15360
    v_smfmac_f32_16x16x64_bf16 v[52:55], v[96:99], a[224:231], v120
    s_nop 1
    v_cvt_pk_bf16_f32 v48, v48, v49
    v_or_b32_e64 v48, v68, v48
    v_smfmac_f32_16x16x64_bf16 v[52:55], v[100:103], a[232:239], v120
    buffer_store_dword v48, v126, s[56:59], 0 offen offset:0
    s_nop 0
    v_cvt_pk_bf16_f32 v49, v50, v51
    v_or_b32 v49, v68, v49
    v_smfmac_f32_16x16x64_bf16 v[56:59], v[92:95], a[240:247], v120
    buffer_store_dword v49, v126, s[56:59], 0 offen offset:64
    s_nop 0
    v_smfmac_f32_16x16x64_bf16 v[56:59], v[96:99], a[248:255], v120
    s_nop 1
    v_cvt_pk_bf16_f32 v52, v52, v53
    v_or_b32 v52, v68, v52
    s_waitcnt lgkmcnt(6)
    v_smfmac_f32_16x16x64_bf16 v[56:59], v[100:103], v[0:7], v120
    buffer_store_dword v52, v126, s[56:59], 0 offen offset:128
    s_nop 0
    v_cvt_pk_bf16_f32 v53, v54, v55
    v_or_b32_e64 v53, v68, v53
    s_waitcnt lgkmcnt(0)
    v_smfmac_f32_16x16x64_bf16 v[60:63], v[92:95], v[8:15], v120
    buffer_store_dword v53, v126, s[56:59], 0 offen offset:192
    s_nop 0
    v_cvt_pk_bf16_f32 v56, v56, v57
    v_or_b32 v56, v68, v56
    v_smfmac_f32_16x16x64_bf16 v[60:63], v[96:99], v[16:23], v120
    buffer_store_dword v56, v126, s[60:63], 0 offen offset:0
    s_nop 0
    v_cvt_pk_bf16_f32 v57, v58, v59
    v_or_b32 v57, v68, v57
    v_smfmac_f32_16x16x64_bf16 v[60:63], v[100:103], v[24:31], v120
    buffer_store_dword v57, v126, s[60:63], 0 offen offset:64
    s_nop 0
    s_nop 5
    v_cvt_pk_bf16_f32 v60, v60, v61
    v_or_b32_e64 v60, v68, v60
    buffer_store_dword v60, v126, s[60:63], 0 offen offset:128
    v_cvt_pk_bf16_f32 v61, v62, v63
    v_or_b32_e64 v61, v68, v61
    buffer_store_dword v61, v126, s[60:63], 0 offen offset:192
    v_mov_b64 v[64:65], 0
    v_mov_b64 v[66:67], 0
    v_mov_b64 v[68:69], 0
    v_mov_b64 v[70:71], 0
    v_mov_b64 v[72:73], 0
    v_mov_b64 v[74:75], 0
    v_mov_b64 v[76:77], 0
    v_mov_b64 v[78:79], 0
    v_mov_b64 v[80:81], 0
    v_mov_b64 v[82:83], 0
    v_mov_b64 v[84:85], 0
    v_mov_b64 v[86:87], 0
    v_add_u32_e64 v92, s29, v121
    v_xor_b32 v93, 1024, v92
    v_xor_b32 v94, 2048, v92
    v_xor_b32 v95, 3072, v92
    s_mov_b32 s32, s25
    s_mov_b32 s25, s23
    s_mov_b32 s23, s24
    s_mov_b32 s24, s32
    s_add_u32 s88, s48, s23
    s_addc_u32 s89, s49, 0
    s_add_u32 s92, s52, s23
    s_addc_u32 s93, s53, 0
    s_add_u32 s76, s4, s26
    s_addc_u32 s77, s5, 0
    s_add_u32 s80, s4, s27
    s_addc_u32 s81, s5, 0
    s_add_u32 s84, s4, s28
    s_addc_u32 s85, s5, 0
    s_add_u32 s31, s31, 128
    s_buffer_load_dwordx2 s[12:13], s[4:7], s31
    s_waitcnt vmcnt(0)
    s_branch JN_112
.p2align 3
KE_116:
    s_cmp_eq_u32 s22, 63
    s_cbranch_scc1 KF_117
KP_120:
    v_mov_b32_e64 v98, 0
    buffer_load_dwordx2 v[96:97], v98, s[4:7], s31 offen sc1
    s_sub_u32 s30, s30, 16
    s_cbranch_scc1 L_FAIL2
    s_waitcnt vmcnt(0)
    v_cmp_ne_u64 vcc, s[38:39], v[96:97]
    s_cbranch_vccnz KP_120
    s_branch KF_117
L_SLOW:
    s_branch STEP_121
.p2align 6
    s_nop 0
    s_nop 0
STEP_121:
    buffer_load_dwordx4 v[0:3], v92, s[88:91], 0 offen sc1
    v_mov_b32 v88, 0
    s_nop 1
    v_mov_b32 v88, 0
    s_nop 1
    v_mov_b32 v88, 0
    s_nop 1
    v_mov_b32 v88, 0
    s_nop 1
    v_mov_b32 v88, 0
    s_nop 1
    v_mov_b32 v88, 0
    s_nop 1
    v_mov_b32 v88, 0
    s_nop 0
    buffer_load_dwordx4 v[4:7], v92, s[92:95], 0 offen sc1
    s_waitcnt vmcnt(3)
    ds_read_b128 v[32:35], v122 offset:32768
    ds_read_b128 v[36:39], v122 offset:33792
    v_mov_b32 v88, 0
    ds_read_b128 v[40:43], v122 offset:34816
    ds_read_b128 v[44:47], v122 offset:35840
    v_mov_b32_e64 v88, 0
    ds_read_b128 v[48:51], v122 offset:36864
    ds_read_b128 v[52:55], v122 offset:37888
    v_mov_b32_e64 v88, 0
    buffer_load_dwordx4 v[0:3], v92, s[88:91], 0 offen sc1
    ds_read_b128 v[56:59], v122 offset:38912
    ds_read_b128 v[60:63], v122 offset:39936
    v_mov_b32 v88, 0
    v_mov_b32 v88, 0
    s_nop 1
    v_mov_b32 v88, 0
    buffer_load_dwordx4 v[4:7], v92, s[92:95], 0 offen sc1
    v_mov_b32 v88, 0
    s_nop 1
    v_mov_b32 v88, 0
    s_nop 1
    v_mov_b32 v88, 0
    s_nop 1
    v_mov_b32_e64 v88, 0
    s_nop 1
    s_waitcnt vmcnt(3) lgkmcnt(0)
    v_max3_u32 v88, v0, v1, v2
    v_max_u32 v88, v88, v3
    v_cmp_eq_u32 vcc, -1, v88
H2_122:
    v_smfmac_f32_16x16x64_bf16 v[72:75], v[0:3], v[32:39], v120
    ds_write_b128 v92, v[0:3] offset:20480
    s_cbranch_vccnz HF_123
    v_smfmac_f32_16x16x64_bf16 v[76:79], v[0:3], v[40:47], v120
    v_smfmac_f32_16x16x64_bf16 v[64:67], v[0:3], v[128:135], v120
    s_waitcnt vmcnt(2)
    v_max3_u32 v88, v4, v5, v6
    v_smfmac_f32_16x16x64_bf16 v[68:71], v[0:3], v[136:143], v120
    v_max_u32 v88, v88, v7
    v_cmp_eq_u32 vcc, -1, v88
    v_smfmac_f32_16x16x64_bf16 v[80:83], v[0:3], a[0:7], v120
    s_cbranch_vccnz HG_125
H3_124:
    ds_write_b128 v92, v[4:7] offset:24576
    s_mov_b32 m0, s37
    v_smfmac_f32_16x16x64_bf16 v[84:87], v[0:3], a[8:15], v120
    buffer_load_dwordx4 v[112:115], v121, s[80:83], 0 offen sc1
    v_smfmac_f32_16x16x64_bf16 v[72:75], v[4:7], v[48:55], v120
    buffer_load_dwordx4 v121, s[76:79], 0 offen sc1 lds
    v_smfmac_f32_16x16x64_bf16 v[76:79], v[4:7], v[56:63], v120
    buffer_load_dwordx4 v[116:119], v121, s[80:83], 0 offen offset:1024 sc1
    v_smfmac_f32_16x16x64_bf16 v[64:67], v[4:7], v[144:151], v120
    s_waitcnt lgkmcnt(0)
    s_barrier
    ds_read_b128 v[8:11], v93 offset:20480
    v_smfmac_f32_16x16x64_bf16 v[68:71], v[4:7], v[152:159], v120
    ds_read_b128 v[12:15], v93 offset:24576
    v_smfmac_f32_16x16x64_bf16 v[80:83], v[4:7], a[16:23], v120
    ds_read_b128 v[16:19], v94 offset:20480
    v_smfmac_f32_16x16x64_bf16 v[84:87], v[4:7], a[24:31], v120
    ds_read_b128 v[20:23], v94 offset:24576
    s_waitcnt lgkmcnt(3)
    v_smfmac_f32_16x16x64_bf16 v[72:75], v[8:11], a[128:135], v120
    ds_read_b128 v[24:27], v95 offset:20480
    v_smfmac_f32_16x16x64_bf16 v[76:79], v[8:11], a[136:143], v120
    ds_read_b128 v[28:31], v95 offset:24576
    v_smfmac_f32_16x16x64_bf16 v[64:67], v[8:11], v[160:167], v120
    ds_read_b128 v[32:35], v122 offset:40960
    v_smfmac_f32_16x16x64_bf16 v[68:71], v[8:11], v[168:175], v120
    ds_read_b128 v[36:39], v122 offset:41984
    s_waitcnt lgkmcnt(6)
    v_smfmac_f32_16x16x64_bf16 v[72:75], v[12:15], a[144:151], v120
    ds_read_b128 v[40:43], v122 offset:43008
    v_smfmac_f32_16x16x64_bf16 v[76:79], v[12:15], a[152:159], v120
    ds_read_b128 v[44:47], v122 offset:44032
    v_smfmac_f32_16x16x64_bf16 v[64:67], v[12:15], v[176:183], v120
    ds_read_b128 v[48:51], v122 offset:45056
    v_smfmac_f32_16x16x64_bf16 v[68:71], v[12:15], v[184:191], v120
    ds_read_b128 v[52:55], v122 offset:46080
    s_waitcnt lgkmcnt(4)
    v_smfmac_f32_16x16x64_bf16 v[72:75], v[16:19], v[32:39], v120
    ds_read_b128 v[56:59], v122 offset:47104
    s_waitcnt lgkmcnt(3)
    v_smfmac_f32_16x16x64_bf16 v[76:79], v[16:19], v[40:47], v120
    ds_read_b128 v[60:63], v122 offset:48128
    v_smfmac_f32_16x16x64_bf16 v[64:67], v[16:19], v[192:199], v120
    ds_read_b128 v[32:35], v121 offset:0
    v_smfmac_f32_16x16x64_bf16 v[68:71], v[16:19], v[200:207], v120
    ds_read_b128 v[36:39], v121 offset:1024
    s_waitcnt lgkmcnt(4)
    v_smfmac_f32_16x16x64_bf16 v[72:75], v[20:23], v[48:55], v120
    ds_read_b128 v[40:43], v121 offset:2048
    s_waitcnt lgkmcnt(3)
    v_smfmac_f32_16x16x64_bf16 v[76:79], v[20:23], v[56:63], v120
    buffer_load_dwordx4 v121, s[76:79], 0 offen offset:1024 sc1 lds
    ds_read_b128 v[44:47], v121 offset:3072
    v_smfmac_f32_16x16x64_bf16 v[64:67], v[20:23], v[208:215], v120
    ds_read_b128 v[48:51], v121 offset:4096
    v_smfmac_f32_16x16x64_bf16 v[68:71], v[20:23], v[216:223], v120
    ds_read_b128 v[52:55], v121 offset:5120
    v_smfmac_f32_16x16x64_bf16 v[72:75], v[24:27], a[160:167], v120
    ds_read_b128 v[56:59], v121 offset:6144
    v_smfmac_f32_16x16x64_bf16 v[76:79], v[24:27], a[168:175], v120
    buffer_store_dwordx2 v[100:101], v127, s[84:87], 0 offen sc1
    ds_read_b128 v[60:63], v121 offset:7168
    v_smfmac_f32_16x16x64_bf16 v[64:67], v[24:27], v[224:231], v120
    s_add_u32 s26, s26, 262144
    v_smfmac_f32_16x16x64_bf16 v[68:71], v[24:27], v[232:239], v120
    s_add_u32 s27, s27, 262144
    v_smfmac_f32_16x16x64_bf16 v[72:75], v[28:31], a[176:183], v120
    s_add_u32 s28, s28, 8192
    s_nop 0
    v_smfmac_f32_16x16x64_bf16 v[76:79], v[28:31], a[184:191], v120
    s_nop 1
    v_smfmac_f32_16x16x64_bf16 v[64:67], v[28:31], v[240:247], v120
    s_nop 1
    v_smfmac_f32_16x16x64_bf16 v[68:71], v[28:31], v[248:255], v120
    s_nop 1
    v_add_f32 v72, v72, v78
    v_add_f32 v73, v73, v79
    v_cvt_pk_bf16_f32 v89, v72, v73
    v_add_f32 v76, v76, v74
    v_add_f32 v77, v77, v75
    v_cvt_pk_bf16_f32 v91, v76, v77
    v_pk_add_f32 v[64:65], v[64:65], v[70:71]
    v_cvt_pk_bf16_f32 v88, v64, v65
    v_pk_add_f32 v[68:69], v[68:69], v[66:67]
    v_cvt_pk_bf16_f32 v90, v68, v69
    v_smfmac_f32_16x16x64_bf16 v[80:83], v[8:11], a[32:39], v120
    ds_write2_b64 v124, v[88:89], v[90:91] offset1:64
    v_smfmac_f32_16x16x64_bf16 v[84:87], v[8:11], a[40:47], v120
    v_smfmac_f32_16x16x64_bf16 v[80:83], v[12:15], a[48:55], v120
    v_smfmac_f32_16x16x64_bf16 v[84:87], v[12:15], a[56:63], v120
    v_smfmac_f32_16x16x64_bf16 v[80:83], v[16:19], a[64:71], v120
    s_waitcnt lgkmcnt(0)
    s_barrier
    ds_read_b64_tr_b16 v[88:89], v125 offset:0
    ds_read_b64_tr_b16 v[90:91], v125 offset:512
    v_smfmac_f32_16x16x64_bf16 v[84:87], v[16:19], a[72:79], v120
    ds_read_b64_tr_b16 v[92:93], v125 offset:1024
    ds_read_b64_tr_b16 v[94:95], v125 offset:1536
    v_smfmac_f32_16x16x64_bf16 v[80:83], v[20:23], a[80:87], v120
    ds_read_b64_tr_b16 v[96:97], v125 offset:2048
    ds_read_b64_tr_b16 v[98:99], v125 offset:2560
    v_smfmac_f32_16x16x64_bf16 v[84:87], v[20:23], a[88:95], v120
    ds_read_b64_tr_b16 v[100:101], v125 offset:3072
    ds_read_b64_tr_b16 v[102:103], v125 offset:3584
    v_smfmac_f32_16x16x64_bf16 v[80:83], v[24:27], a[96:103], v120
    s_mov_b64 vcc, s[46:47]
    s_waitcnt lgkmcnt(6)
    v_mfma_f32_16x16x32_bf16 v[64:67], v[32:35], v[88:91], 0
    v_mfma_f32_16x16x32_bf16 v[68:71], v[48:51], v[88:91], 0
    s_waitcnt lgkmcnt(4)
    v_mfma_f32_16x16x32_bf16 v[64:67], v[36:39], v[92:95], v[64:67]
    v_mov_b64 v[48:49], 0
    v_mov_b64_e64 v[50:51], 0
    v_mfma_f32_16x16x32_bf16 v[68:71], v[52:55], v[92:95], v[68:71]
    s_waitcnt lgkmcnt(2)
    v_mfma_f32_16x16x32_bf16 v[64:67], v[40:43], v[96:99], v[64:67]
    v_mov_b64 v[52:53], 0
    v_mov_b64_e64 v[54:55], 0
    v_mfma_f32_16x16x32_bf16 v[68:71], v[56:59], v[96:99], v[68:71]
    s_waitcnt lgkmcnt(0) vmcnt(5)
    v_mfma_f32_16x16x32_bf16 v[64:67], v[44:47], v[100:103], v[64:67]
    v_mov_b64 v[56:57], 0
    v_mov_b64_e64 v[58:59], 0
    v_mfma_f32_16x16x32_bf16 v[68:71], v[60:63], v[100:103], v[68:71]
    v_mfma_f32_16x16x32_bf16 v[72:75], v[88:91], v[88:91], 0
    ds_read_b128 v[0:3], v122 offset:0
    v_mov_b64 v[44:45], s[74:75]
    v_mov_b64 v[46:47], s[74:75]
    v_mfma_f32_16x16x32_bf16 v[72:75], v[92:95], v[92:95], v[72:75]
    ds_read_b128 v[4:7], v122 offset:1024
    v_mov_b64 v[60:61], 0
    v_mov_b64 v[62:63], 0
    v_mfma_f32_16x16x32_bf16 v[72:75], v[96:99], v[96:99], v[72:75]
    ds_read_b128 v[8:11], v122 offset:2048
    v_cndmask_b32_dpp v64, v68, v64, vcc quad_perm:[0,1,0,1] row_mask:0xf bank_mask:0xf
    v_cndmask_b32_dpp v65, v69, v65, vcc quad_perm:[0,1,0,1] row_mask:0xf bank_mask:0xf
    v_mfma_f32_16x16x32_bf16 v[72:75], v[100:103], v[100:103], v[72:75]
    ds_read_b128 v[12:15], v122 offset:3072
    v_cndmask_b32_dpp v66, v70, v66, vcc quad_perm:[0,1,0,1] row_mask:0xf bank_mask:0xf
    v_cndmask_b32_dpp v67, v71, v67, vcc quad_perm:[0,1,0,1] row_mask:0xf bank_mask:0xf
    v_max3_f32 v78, v64, v65, v66
    v_max_f32_e64 v78, v78, v67
    v_smfmac_f32_16x16x64_bf16 v[84:87], v[24:27], a[104:111], v120
    s_nop 0
    v_max_f32_dpp v78, v78, v78 quad_perm:[2,3,0,1] row_mask:0xf bank_mask:0xf
    v_mov_b32_dpp v68, v74 quad_perm:[0,1,0,1] row_mask:0xf bank_mask:0xf
    v_mov_b32_dpp v69, v75 quad_perm:[0,1,0,1] row_mask:0xf bank_mask:0xf
    v_max3_f32 v76, v78, v68, v69
    v_max3_f32 v77, v78, v68, v69
    v_smfmac_f32_16x16x64_bf16 v[80:83], v[28:31], a[112:119], v120
    s_nop 0
    v_permlane16_swap_b32 v76, v77
    v_max_f32 v78, v76, v77
    v_max_f32_e64 v79, v76, v77
    v_smfmac_f32_16x16x64_bf16 v[84:87], v[28:31], a[120:127], v120
    s_nop 0
    v_permlane32_swap_b32 v78, v79
    v_max_f32_e64 v76, v78, v79
    v_pk_add_f32 v[64:65], v[64:65], v[76:77] op_sel_hi:[1,0] neg_lo:[0,1] neg_hi:[0,1]
    v_pk_mul_f32 v[64:65], v[64:65], s[72:73]
    v_pk_add_f32 v[66:67], v[66:67], v[76:77] op_sel_hi:[1,0] neg_lo:[0,1] neg_hi:[0,1]
    v_pk_mul_f32 v[66:67], v[66:67], s[72:73]
    v_pk_add_f32 v[74:75], v[74:75], v[76:77] op_sel_hi:[1,0] neg_lo:[0,1] neg_hi:[0,1]
    v_pk_mul_f32 v[74:75], v[74:75], s[72:73]
    v_exp_f32 v64, v64
    v_exp_f32 v65, v65
    v_exp_f32 v66, v66
    v_exp_f32 v67, v67
    v_cvt_pk_bf16_f32 v88, v64, v65
    v_cvt_pk_bf16_f32 v89, v66, v67
    v_exp_f32_e64 v74, v74
    v_mov_b32_dpp v90, v88 quad_perm:[2,3,2,3] row_mask:0xf bank_mask:0xf
    v_mov_b32_dpp v91, v89 quad_perm:[2,3,2,3] row_mask:0xf bank_mask:0xf
    ds_read_b128 v[16:19], v122 offset:4096
    s_nop 0
    v_mfma_f32_16x16x32_bf16 v[40:43], v[44:47], v[88:91], 0
    ds_read_b128 v[20:23], v122 offset:5120
    v_exp_f32 v75, v75
    v_mov_b64_e64 v[72:73], s[100:101]
    v_mfma_f32_16x16x32_bf16 v[32:35], v[104:107], v[88:91], 0
    ds_read_b128 v[24:27], v122 offset:6144
    v_cvt_pk_bf16_f32 v92, v74, v75
    v_cvt_pk_bf16_f32 v93, v74, v75
    v_mfma_f32_16x16x32_bf16 v[36:39], v[108:111], v[88:91], 0
    ds_read_b128 v[28:31], v122 offset:7168
    v_cvt_pk_bf16_f32 v80, v80, v81
    v_cvt_pk_bf16_f32 v81, v86, v87
    v_mfma_f32_16x16x16_bf16 v[40:43], v[72:73], v[92:93], v[40:43]
    s_add_u32 s22, s22, 1
    v_cvt_pk_bf16_f32 v83, v82, v83
    v_cvt_pk_bf16_f32 v82, v84, v85
    v_mfma_f32_16x16x16_bf16 v[32:35], v[80:81], v[92:93], v[32:35]
    s_nop 0
    v_mov_b32_dpp v64, v123 quad_perm:[0,1,0,1] row_mask:0xf bank_mask:0xf
    v_xor_b32 v65, 512, v64
    v_mfma_f32_16x16x16_bf16 v[36:39], v[82:83], v[92:93], v[36:39]
    s_nop 0
    v_rcp_f32 v76, v40
    v_xor_b32 v66, 1024, v64
    v_xor_b32 v67, 1536, v64
    v_pk_mul_f32 v[32:33], v[32:33], v[76:77] op_sel_hi:[1,0]
    v_pk_mul_f32 v[34:35], v[34:35], v[76:77] op_sel_hi:[1,0]
    v_cvt_pk_bf16_f32 v88, v32, v33
    v_cvt_pk_bf16_f32 v89, v34, v35
    v_pk_mul_f32 v[36:37], v[36:37], v[76:77] op_sel_hi:[1,0]
    v_pk_mul_f32 v[38:39], v[38:39], v[76:77] op_sel_hi:[1,0]
    v_cvt_pk_bf16_f32 v90, v36, v37
    v_cvt_pk_bf16_f32 v91, v38, v39
    v_mfma_f32_16x16x16_bf16 v[40:43], v[44:45], v[44:45], 0
    ds_write_b128 v123, v[88:91]
    v_mov_b32_dpp v88, v88 quad_perm:[0,1,0,1] row_mask:0xf bank_mask:0xf
    v_mov_b32_dpp v89, v89 quad_perm:[0,1,0,1] row_mask:0xf bank_mask:0xf
    v_mov_b32_dpp v90, v90 quad_perm:[0,1,0,1] row_mask:0xf bank_mask:0xf
    v_mov_b32_dpp v91, v91 quad_perm:[0,1,0,1] row_mask:0xf bank_mask:0xf
    s_waitcnt lgkmcnt(1)
    s_cmp_lg_u32 s21, 0
    v_smfmac_f32_16x16x64_bf16 v[48:51], v[88:91], v[0:7], v120
    v_and_b32_e64 v68, 0x30, v121
    v_smfmac_f32_16x16x64_bf16 v[52:55], v[88:91], v[8:15], v120
    v_min_u32_e64 v68, 1, v68
    s_waitcnt lgkmcnt(0)
    s_barrier
    ds_read_b128 v[92:95], v65
    ds_read_b128 v[96:99], v66
    ds_read_b128 v[100:103], v67
    v_smfmac_f32_16x16x64_bf16 v[56:59], v[88:91], v[16:23], v120
    v_or_b32_e64 v68, -2, v68
    v_smfmac_f32_16x16x64_bf16 v[60:63], v[88:91], v[24:31], v120
    s_cbranch_scc1 NR_126
    s_waitcnt lgkmcnt(2)
    v_smfmac_f32_16x16x64_bf16 v[48:51], v[92:95], a[192:199], v120
    ds_read_b128 v[0:3], v122 offset:8192
    ds_read_b128 v[4:7], v122 offset:9216
    s_waitcnt lgkmcnt(3)
    v_smfmac_f32_16x16x64_bf16 v[48:51], v[96:99], a[200:207], v120
    ds_read_b128 v[8:11], v122 offset:10240
    ds_read_b128 v[12:15], v122 offset:11264
    s_waitcnt lgkmcnt(4)
    v_smfmac_f32_16x16x64_bf16 v[48:51], v[100:103], a[208:215], v120
    ds_read_b128 v[16:19], v122 offset:12288
    ds_read_b128 v[20:23], v122 offset:13312
    v_smfmac_f32_16x16x64_bf16 v[52:55], v[92:95], a[216:223], v120
    ds_read_b128 v[24:27], v122 offset:14336
    ds_read_b128 v[28:31], v122 offset:15360
    v_smfmac_f32_16x16x64_bf16 v[52:55], v[96:99], a[224:231], v120
    s_nop 1
    v_cvt_pk_bf16_f32 v48, v48, v49
    v_and_b32 v48, v68, v48
    v_smfmac_f32_16x16x64_bf16 v[52:55], v[100:103], a[232:239], v120
    buffer_store_dword v48, v126, s[56:59], 0 offen offset:0 sc1
    s_nop 0
    v_cvt_pk_bf16_f32 v49, v50, v51
    v_and_b32 v49, v68, v49
    v_smfmac_f32_16x16x64_bf16 v[56:59], v[92:95], a[240:247], v120
    buffer_store_dword v49, v126, s[56:59], 0 offen offset:64 sc1
    s_nop 0
    v_smfmac_f32_16x16x64_bf16 v[56:59], v[96:99], a[248:255], v120
    s_nop 1
    v_cvt_pk_bf16_f32 v52, v52, v53
    v_and_b32 v52, v68, v52
    s_waitcnt lgkmcnt(6)
    v_smfmac_f32_16x16x64_bf16 v[56:59], v[100:103], v[0:7], v120
    buffer_store_dword v52, v126, s[56:59], 0 offen offset:128 sc1
    s_nop 0
    v_cvt_pk_bf16_f32 v53, v54, v55
    v_and_b32_e64 v53, v68, v53
    s_waitcnt lgkmcnt(0)
    v_smfmac_f32_16x16x64_bf16 v[60:63], v[92:95], v[8:15], v120
    buffer_store_dword v53, v126, s[56:59], 0 offen offset:192 sc1
    s_nop 0
    v_cvt_pk_bf16_f32 v56, v56, v57
    v_and_b32 v56, v68, v56
    v_smfmac_f32_16x16x64_bf16 v[60:63], v[96:99], v[16:23], v120
    buffer_store_dword v56, v126, s[60:63], 0 offen offset:0 sc1
    s_nop 0
    v_cvt_pk_bf16_f32 v57, v58, v59
    v_and_b32 v57, v68, v57
    v_smfmac_f32_16x16x64_bf16 v[60:63], v[100:103], v[24:31], v120
    buffer_store_dword v57, v126, s[60:63], 0 offen offset:64 sc1
    s_nop 0
    s_nop 5
    v_cvt_pk_bf16_f32 v60, v60, v61
    v_and_b32_e64 v60, v68, v60
    buffer_store_dword v60, v126, s[60:63], 0 offen offset:128 sc1
    v_cvt_pk_bf16_f32 v61, v62, v63
    v_and_b32_e64 v61, v68, v61
    buffer_store_dword v61, v126, s[60:63], 0 offen offset:192 sc1
    v_mov_b64_e64 v[100:101], -1
    ds_read_b128 v[88:91], v121 offset:30720
    buffer_store_dwordx2 v[100:101], v127, s[48:51], s25 offen sc1
    v_mov_b64 v[64:65], 0
    v_mov_b64 v[66:67], 0
    v_mov_b64 v[68:69], 0
    v_mov_b64 v[70:71], 0
    v_mov_b64 v[72:73], 0
    v_mov_b64 v[74:75], 0
    v_mov_b64 v[76:77], 0
    v_mov_b64 v[78:79], 0
    v_mov_b64 v[80:81], 0
    v_mov_b64 v[82:83], 0
    v_mov_b64 v[84:85], 0
    v_mov_b64 v[86:87], 0
    v_add_u32_e64 v92, s29, v121
    v_xor_b32 v93, 1024, v92
    v_xor_b32 v94, 2048, v92
    v_xor_b32 v95, 3072, v92
    s_mov_b32 s32, s25
    s_mov_b32 s25, s23
    s_mov_b32 s23, s24
    s_mov_b32 s24, s32
    s_waitcnt vmcnt(7)
    s_cmp_lt_u32 s20, 16
    s_cbranch_scc1 RE_127
    s_waitcnt vmcnt(2)
RE_127:
    buffer_load_dwordx4 v[0:3], v121, s[64:67], 0 offen offset:0 sc1
    buffer_load_dwordx4 v[4:7], v121, s[64:67], 0 offen offset:1024 sc1
    buffer_load_dwordx4 v[8:11], v121, s[64:67], 0 offen offset:2048 sc1
    buffer_load_dwordx4 v[12:15], v121, s[64:67], 0 offen offset:3072 sc1
    buffer_load_dwordx4 v[16:19], v121, s[68:71], 0 offen offset:0 sc1
    buffer_load_dwordx4 v[20:23], v121, s[68:71], 0 offen offset:1024 sc1
    buffer_load_dwordx4 v[24:27], v121, s[68:71], 0 offen offset:2048 sc1
    buffer_load_dwordx4 v[28:31], v121, s[68:71], 0 offen offset:3072 sc1
    v_mov_b32 v102, 0
    s_nop 1
    v_mov_b32 v102, 0
    s_nop 1
    v_mov_b32 v102, 0
    s_nop 0
    buffer_load_dwordx4 v[32:35], v121, s[64:67], 0 offen offset:0 sc1
    buffer_load_dwordx4 v[36:39], v121, s[64:67], 0 offen offset:1024 sc1
    buffer_load_dwordx4 v[40:43], v121, s[64:67], 0 offen offset:2048 sc1
    buffer_load_dwordx4 v[44:47], v121, s[64:67], 0 offen offset:3072 sc1
    buffer_load_dwordx4 v[48:51], v121, s[68:71], 0 offen offset:0 sc1
    buffer_load_dwordx4 v[52:55], v121, s[68:71], 0 offen offset:1024 sc1
    buffer_load_dwordx4 v[56:59], v121, s[68:71], 0 offen offset:2048 sc1
    buffer_load_dwordx4 v[60:63], v121, s[68:71], 0 offen offset:3072 sc1
    s_add_u32 s88, s48, s23
    s_addc_u32 s89, s49, 0
    s_add_u32 s92, s52, s23
    s_addc_u32 s93, s53, 0
    s_add_u32 s76, s4, s26
    s_addc_u32 s77, s5, 0
    s_add_u32 s80, s4, s27
    s_addc_u32 s81, s5, 0
    s_add_u32 s84, s4, s28
    s_addc_u32 s85, s5, 0
    s_waitcnt lgkmcnt(0)
    s_waitcnt vmcnt(15)
    v_mfma_f32_16x16x32_bf16 v[96:99], v[0:3], v[88:91], 0
    s_waitcnt vmcnt(14)
    v_mfma_f32_16x16x32_bf16 v[96:99], v[4:7], v[88:91], v[96:99]
    v_or_b32_e64 v102, v0, v4
    s_waitcnt vmcnt(13)
    v_mfma_f32_16x16x32_bf16 v[96:99], v[8:11], v[88:91], v[96:99]
    s_waitcnt vmcnt(12)
    v_mfma_f32_16x16x32_bf16 v[96:99], v[12:15], v[88:91], v[96:99]
    v_bitop3_b32 v102, v102, v8, v12 bitop3:0xfe
    s_waitcnt vmcnt(11)
    v_mfma_f32_16x16x32_bf16 v[96:99], v[16:19], v[88:91], v[96:99]
    s_waitcnt vmcnt(10)
    v_mfma_f32_16x16x32_bf16 v[96:99], v[20:23], v[88:91], v[96:99]
    v_bitop3_b32 v102, v102, v16, v20 bitop3:0xfe
    s_waitcnt vmcnt(9)
    v_mfma_f32_16x16x32_bf16 v[96:99], v[24:27], v[88:91], v[96:99]
    v_or_b32 v102, v102, v24
    s_waitcnt vmcnt(8)
    v_mfma_f32_16x16x32_bf16 v[96:99], v[28:31], v[88:91], v[96:99]
    v_bitop3_b32 v102, v102, v28, 1 bitop3:0xa8
    v_cmp_ne_u32 vcc, 0, v102
    s_nop 5
    v_cvt_pk_bf16_f32 v100, v96, v97
    v_cvt_pk_bf16_f32 v101, v98, v99
    s_cbranch_vccnz RL_128
RK_129:
    buffer_store_dwordx2 v[100:101], v127, s[88:91], 0 offen sc1
JN_130:
    s_cmp_eq_u32 s22, 63
    s_cbranch_scc0 GO_131
    buffer_store_dwordx2 v[100:101], v127, s[4:7], s28 offen sc1
    s_or_b32 s32, s20, s21
    s_cmp_lg_u32 s32, 0
    s_cbranch_scc1 WB_132
    s_waitcnt vmcnt(0)
    buffer_wbl2 sc1
WB_132:
    s_branch L_EXIT
GO_131:
    s_barrier
    v_mov_b32 v102, 0
    s_nop 1
    v_mov_b32 v102, 0
    s_nop 0
    s_cmp_ge_u32 s20, 16
    s_cbranch_scc1 DE_133
    v_mov_b32 v102, 0
    s_nop 1
    v_mov_b32 v102, 0
    s_nop 1
    v_mov_b32 v102, 0
    s_nop 1
    v_mov_b32 v102, 0
    s_nop 1
    v_mov_b32 v102, 0
    s_nop 1
    v_mov_b32 v102, 0
    s_nop 1
    v_mov_b32 v102, 0
    s_nop 1
    v_mov_b32 v102, 0
    s_nop 1
    v_mov_b32 v102, 0
    s_nop 1
    v_mov_b32 v102, 0
    s_nop 1
    v_mov_b32 v102, 0
    s_nop 1
    v_mov_b32_e64 v102, 0
    s_nop 0
DE_133:
    buffer_load_dwordx4 v[0:3], v92, s[88:91], 0 offen sc1
    v_mov_b32 v88, 0
    s_nop 1
    v_mov_b32 v88, 0
    s_nop 1
    v_mov_b32 v88, 0
    s_nop 1
    v_mov_b32 v88, 0
    s_nop 1
    v_mov_b32 v88, 0
    s_nop 1
    v_mov_b32 v88, 0
    s_nop 1
    v_mov_b32 v88, 0
    s_nop 0
    buffer_load_dwordx4 v[4:7], v92, s[92:95], 0 offen sc1
    s_waitcnt vmcnt(3)
    ds_read_b128 v[32:35], v122 offset:32768
    ds_read_b128 v[36:39], v122 offset:33792
    v_mov_b32 v88, 0
    ds_read_b128 v[40:43], v122 offset:34816
    ds_read_b128 v[44:47], v122 offset:35840
    v_mov_b32_e64 v88, 0
    ds_read_b128 v[48:51], v122 offset:36864
    ds_read_b128 v[52:55], v122 offset:37888
    v_mov_b32_e64 v88, 0
    buffer_load_dwordx4 v[0:3], v92, s[88:91], 0 offen sc1
    ds_read_b128 v[56:59], v122 offset:38912
    ds_read_b128 v[60:63], v122 offset:39936
    v_mov_b32 v88, 0
    v_mov_b32 v88, 0
    s_nop 1
    v_mov_b32 v88, 0
    buffer_load_dwordx4 v[4:7], v92, s[92:95], 0 offen sc1
    v_mov_b32 v88, 0
    s_nop 1
    v_mov_b32 v88, 0
    s_nop 1
    v_mov_b32 v88, 0
    s_nop 1
    v_mov_b32_e64 v88, 0
    s_nop 1
    s_waitcnt vmcnt(3) lgkmcnt(0)
    v_max3_u32 v88, v0, v1, v2
    v_max_u32 v88, v88, v3
    v_cmp_eq_u32 vcc, -1, v88
H2_134:
    v_smfmac_f32_16x16x64_bf16 v[72:75], v[0:3], v[32:39], v120
    ds_write_b128 v92, v[0:3] offset:20480
    s_cbranch_vccnz HF_135
    v_smfmac_f32_16x16x64_bf16 v[76:79], v[0:3], v[40:47], v120
    v_smfmac_f32_16x16x64_bf16 v[64:67], v[0:3], v[128:135], v120
    s_waitcnt vmcnt(2)
    v_max3_u32 v88, v4, v5, v6
    v_smfmac_f32_16x16x64_bf16 v[68:71], v[0:3], v[136:143], v120
    v_max_u32 v88, v88, v7
    v_cmp_eq_u32 vcc, -1, v88
    v_smfmac_f32_16x16x64_bf16 v[80:83], v[0:3], a[0:7], v120
    s_cbranch_vccnz HG_137
H3_136:
    ds_write_b128 v92, v[4:7] offset:24576
    s_mov_b32 m0, s36
    v_smfmac_f32_16x16x64_bf16 v[84:87], v[0:3], a[8:15], v120
    buffer_load_dwordx4 v[104:107], v121, s[80:83], 0 offen sc1
    v_smfmac_f32_16x16x64_bf16 v[72:75], v[4:7], v[48:55], v120
    buffer_load_dwordx4 v121, s[76:79], 0 offen sc1 lds
    v_smfmac_f32_16x16x64_bf16 v[76:79], v[4:7], v[56:63], v120
    buffer_load_dwordx4 v[108:111], v121, s[80:83], 0 offen offset:1024 sc1
    v_smfmac_f32_16x16x64_bf16 v[64:67], v[4:7], v[144:151], v120
    s_waitcnt lgkmcnt(0)
    s_barrier
    ds_read_b128 v[8:11], v93 offset:20480
    v_smfmac_f32_16x16x64_bf16 v[68:71], v[4:7], v[152:159], v120
    ds_read_b128 v[12:15], v93 offset:24576
    v_smfmac_f32_16x16x64_bf16 v[80:83], v[4:7], a[16:23], v120
    ds_read_b128 v[16:19], v94 offset:20480
    v_smfmac_f32_16x16x64_bf16 v[84:87], v[4:7], a[24:31], v120
    ds_read_b128 v[20:23], v94 offset:24576
    s_waitcnt lgkmcnt(3)
    v_smfmac_f32_16x16x64_bf16 v[72:75], v[8:11], a[128:135], v120
    ds_read_b128 v[24:27], v95 offset:20480
    v_smfmac_f32_16x16x64_bf16 v[76:79], v[8:11], a[136:143], v120
    ds_read_b128 v[28:31], v95 offset:24576
    v_smfmac_f32_16x16x64_bf16 v[64:67], v[8:11], v[160:167], v120
    ds_read_b128 v[32:35], v122 offset:40960
    v_smfmac_f32_16x16x64_bf16 v[68:71], v[8:11], v[168:175], v120
    ds_read_b128 v[36:39], v122 offset:41984
    s_waitcnt lgkmcnt(6)
    v_smfmac_f32_16x16x64_bf16 v[72:75], v[12:15], a[144:151], v120
    ds_read_b128 v[40:43], v122 offset:43008
    v_smfmac_f32_16x16x64_bf16 v[76:79], v[12:15], a[152:159], v120
    ds_read_b128 v[44:47], v122 offset:44032
    v_smfmac_f32_16x16x64_bf16 v[64:67], v[12:15], v[176:183], v120
    ds_read_b128 v[48:51], v122 offset:45056
    v_smfmac_f32_16x16x64_bf16 v[68:71], v[12:15], v[184:191], v120
    ds_read_b128 v[52:55], v122 offset:46080
    s_waitcnt lgkmcnt(4)
    v_smfmac_f32_16x16x64_bf16 v[72:75], v[16:19], v[32:39], v120
    ds_read_b128 v[56:59], v122 offset:47104
    s_waitcnt lgkmcnt(3)
    v_smfmac_f32_16x16x64_bf16 v[76:79], v[16:19], v[40:47], v120
    ds_read_b128 v[60:63], v122 offset:48128
    v_smfmac_f32_16x16x64_bf16 v[64:67], v[16:19], v[192:199], v120
    ds_read_b128 v[32:35], v121 offset:8192
    v_smfmac_f32_16x16x64_bf16 v[68:71], v[16:19], v[200:207], v120
    ds_read_b128 v[36:39], v121 offset:9216
    s_waitcnt lgkmcnt(4)
    v_smfmac_f32_16x16x64_bf16 v[72:75], v[20:23], v[48:55], v120
    ds_read_b128 v[40:43], v121 offset:10240
    s_waitcnt lgkmcnt(3)
    v_smfmac_f32_16x16x64_bf16 v[76:79], v[20:23], v[56:63], v120
    buffer_load_dwordx4 v121, s[76:79], 0 offen offset:1024 sc1 lds
    ds_read_b128 v[44:47], v121 offset:11264
    v_smfmac_f32_16x16x64_bf16 v[64:67], v[20:23], v[208:215], v120
    ds_read_b128 v[48:51], v121 offset:12288
    v_smfmac_f32_16x16x64_bf16 v[68:71], v[20:23], v[216:223], v120
    ds_read_b128 v[52:55], v121 offset:13312
    v_smfmac_f32_16x16x64_bf16 v[72:75], v[24:27], a[160:167], v120
    ds_read_b128 v[56:59], v121 offset:14336
    v_smfmac_f32_16x16x64_bf16 v[76:79], v[24:27], a[168:175], v120
    buffer_store_dwordx2 v[100:101], v127, s[84:87], 0 offen sc1
    ds_read_b128 v[60:63], v121 offset:15360
    v_smfmac_f32_16x16x64_bf16 v[64:67], v[24:27], v[224:231], v120
    s_add_u32 s26, s26, 262144
    v_smfmac_f32_16x16x64_bf16 v[68:71], v[24:27], v[232:239], v120
    s_add_u32 s27, s27, 262144
    v_smfmac_f32_16x16x64_bf16 v[72:75], v[28:31], a[176:183], v120
    s_add_u32 s28, s28, 8192
    s_nop 0
    v_smfmac_f32_16x16x64_bf16 v[76:79], v[28:31], a[184:191], v120
    s_nop 1
    v_smfmac_f32_16x16x64_bf16 v[64:67], v[28:31], v[240:247], v120
    s_nop 1
    v_smfmac_f32_16x16x64_bf16 v[68:71], v[28:31], v[248:255], v120
    s_nop 1
    v_add_f32 v72, v72, v78
    v_add_f32 v73, v73, v79
    v_cvt_pk_bf16_f32 v89, v72, v73
    v_add_f32 v76, v76, v74
    v_add_f32 v77, v77, v75
    v_cvt_pk_bf16_f32 v91, v76, v77
    v_pk_add_f32 v[64:65], v[64:65], v[70:71]
    v_cvt_pk_bf16_f32 v88, v64, v65
    v_pk_add_f32 v[68:69], v[68:69], v[66:67]
    v_cvt_pk_bf16_f32 v90, v68, v69
    v_smfmac_f32_16x16x64_bf16 v[80:83], v[8:11], a[32:39], v120
    ds_write2_b64 v124, v[88:89], v[90:91] offset1:64
    v_smfmac_f32_16x16x64_bf16 v[84:87], v[8:11], a[40:47], v120
    v_smfmac_f32_16x16x64_bf16 v[80:83], v[12:15], a[48:55], v120
    v_smfmac_f32_16x16x64_bf16 v[84:87], v[12:15], a[56:63], v120
    v_smfmac_f32_16x16x64_bf16 v[80:83], v[16:19], a[64:71], v120
    s_waitcnt lgkmcnt(0)
    s_barrier
    ds_read_b64_tr_b16 v[88:89], v125 offset:0
    ds_read_b64_tr_b16 v[90:91], v125 offset:512
    v_smfmac_f32_16x16x64_bf16 v[84:87], v[16:19], a[72:79], v120
    ds_read_b64_tr_b16 v[92:93], v125 offset:1024
    ds_read_b64_tr_b16 v[94:95], v125 offset:1536
    v_smfmac_f32_16x16x64_bf16 v[80:83], v[20:23], a[80:87], v120
    ds_read_b64_tr_b16 v[96:97], v125 offset:2048
    ds_read_b64_tr_b16 v[98:99], v125 offset:2560
    v_smfmac_f32_16x16x64_bf16 v[84:87], v[20:23], a[88:95], v120
    ds_read_b64_tr_b16 v[100:101], v125 offset:3072
    ds_read_b64_tr_b16 v[102:103], v125 offset:3584
    v_smfmac_f32_16x16x64_bf16 v[80:83], v[24:27], a[96:103], v120
    s_mov_b64 vcc, s[46:47]
    s_waitcnt lgkmcnt(6)
    v_mfma_f32_16x16x32_bf16 v[64:67], v[32:35], v[88:91], 0
    v_mfma_f32_16x16x32_bf16 v[68:71], v[48:51], v[88:91], 0
    s_waitcnt lgkmcnt(4)
    v_mfma_f32_16x16x32_bf16 v[64:67], v[36:39], v[92:95], v[64:67]
    v_mov_b64 v[48:49], 0
    v_mov_b64_e64 v[50:51], 0
    v_mfma_f32_16x16x32_bf16 v[68:71], v[52:55], v[92:95], v[68:71]
    s_waitcnt lgkmcnt(2)
    v_mfma_f32_16x16x32_bf16 v[64:67], v[40:43], v[96:99], v[64:67]
    v_mov_b64 v[52:53], 0
    v_mov_b64_e64 v[54:55], 0
    v_mfma_f32_16x16x32_bf16 v[68:71], v[56:59], v[96:99], v[68:71]
    s_waitcnt lgkmcnt(0) vmcnt(5)
    v_mfma_f32_16x16x32_bf16 v[64:67], v[44:47], v[100:103], v[64:67]
    v_mov_b64 v[56:57], 0
    v_mov_b64_e64 v[58:59], 0
    v_mfma_f32_16x16x32_bf16 v[68:71], v[60:63], v[100:103], v[68:71]
    v_mfma_f32_16x16x32_bf16 v[72:75], v[88:91], v[88:91], 0
    ds_read_b128 v[0:3], v122 offset:0
    v_mov_b64 v[44:45], s[74:75]
    v_mov_b64 v[46:47], s[74:75]
    v_mfma_f32_16x16x32_bf16 v[72:75], v[92:95], v[92:95], v[72:75]
    ds_read_b128 v[4:7], v122 offset:1024
    v_mov_b64 v[60:61], 0
    v_mov_b64 v[62:63], 0
    v_mfma_f32_16x16x32_bf16 v[72:75], v[96:99], v[96:99], v[72:75]
    ds_read_b128 v[8:11], v122 offset:2048
    v_cndmask_b32_dpp v64, v68, v64, vcc quad_perm:[0,1,0,1] row_mask:0xf bank_mask:0xf
    v_cndmask_b32_dpp v65, v69, v65, vcc quad_perm:[0,1,0,1] row_mask:0xf bank_mask:0xf
    v_mfma_f32_16x16x32_bf16 v[72:75], v[100:103], v[100:103], v[72:75]
    ds_read_b128 v[12:15], v122 offset:3072
    v_cndmask_b32_dpp v66, v70, v66, vcc quad_perm:[0,1,0,1] row_mask:0xf bank_mask:0xf
    v_cndmask_b32_dpp v67, v71, v67, vcc quad_perm:[0,1,0,1] row_mask:0xf bank_mask:0xf
    v_max3_f32 v78, v64, v65, v66
    v_max_f32_e64 v78, v78, v67
    v_smfmac_f32_16x16x64_bf16 v[84:87], v[24:27], a[104:111], v120
    s_nop 0
    v_max_f32_dpp v78, v78, v78 quad_perm:[2,3,0,1] row_mask:0xf bank_mask:0xf
    v_mov_b32_dpp v68, v74 quad_perm:[0,1,0,1] row_mask:0xf bank_mask:0xf
    v_mov_b32_dpp v69, v75 quad_perm:[0,1,0,1] row_mask:0xf bank_mask:0xf
    v_max3_f32 v76, v78, v68, v69
    v_max3_f32 v77, v78, v68, v69
    v_smfmac_f32_16x16x64_bf16 v[80:83], v[28:31], a[112:119], v120
    s_nop 0
    v_permlane16_swap_b32 v76, v77
    v_max_f32 v78, v76, v77
    v_max_f32_e64 v79, v76, v77
    v_smfmac_f32_16x16x64_bf16 v[84:87], v[28:31], a[120:127], v120
    s_nop 0
    v_permlane32_swap_b32 v78, v79
    v_max_f32_e64 v76, v78, v79
    v_pk_add_f32 v[64:65], v[64:65], v[76:77] op_sel_hi:[1,0] neg_lo:[0,1] neg_hi:[0,1]
    v_pk_mul_f32 v[64:65], v[64:65], s[72:73]
    v_pk_add_f32 v[66:67], v[66:67], v[76:77] op_sel_hi:[1,0] neg_lo:[0,1] neg_hi:[0,1]
    v_pk_mul_f32 v[66:67], v[66:67], s[72:73]
    v_pk_add_f32 v[74:75], v[74:75], v[76:77] op_sel_hi:[1,0] neg_lo:[0,1] neg_hi:[0,1]
    v_pk_mul_f32 v[74:75], v[74:75], s[72:73]
    v_exp_f32 v64, v64
    v_exp_f32 v65, v65
    v_exp_f32 v66, v66
    v_exp_f32 v67, v67
    v_cvt_pk_bf16_f32 v88, v64, v65
    v_cvt_pk_bf16_f32 v89, v66, v67
    v_exp_f32_e64 v74, v74
    v_mov_b32_dpp v90, v88 quad_perm:[2,3,2,3] row_mask:0xf bank_mask:0xf
    v_mov_b32_dpp v91, v89 quad_perm:[2,3,2,3] row_mask:0xf bank_mask:0xf
    ds_read_b128 v[16:19], v122 offset:4096
    s_nop 0
    v_mfma_f32_16x16x32_bf16 v[40:43], v[44:47], v[88:91], 0
    ds_read_b128 v[20:23], v122 offset:5120
    v_exp_f32 v75, v75
    v_mov_b64_e64 v[72:73], s[100:101]
    v_mfma_f32_16x16x32_bf16 v[32:35], v[112:115], v[88:91], 0
    ds_read_b128 v[24:27], v122 offset:6144
    v_cvt_pk_bf16_f32 v92, v74, v75
    v_cvt_pk_bf16_f32 v93, v74, v75
    v_mfma_f32_16x16x32_bf16 v[36:39], v[116:119], v[88:91], 0
    ds_read_b128 v[28:31], v122 offset:7168
    v_cvt_pk_bf16_f32 v80, v80, v81
    v_cvt_pk_bf16_f32 v81, v86, v87
    v_mfma_f32_16x16x16_bf16 v[40:43], v[72:73], v[92:93], v[40:43]
    s_add_u32 s22, s22, 1
    v_cvt_pk_bf16_f32 v83, v82, v83
    v_cvt_pk_bf16_f32 v82, v84, v85
    v_mfma_f32_16x16x16_bf16 v[32:35], v[80:81], v[92:93], v[32:35]
    s_nop 0
    v_mov_b32_dpp v64, v123 quad_perm:[0,1,0,1] row_mask:0xf bank_mask:0xf
    v_xor_b32 v65, 512, v64
    v_mfma_f32_16x16x16_bf16 v[36:39], v[82:83], v[92:93], v[36:39]
    s_nop 0
    v_rcp_f32 v76, v40
    v_xor_b32 v66, 1024, v64
    v_xor_b32 v67, 1536, v64
    v_pk_mul_f32 v[32:33], v[32:33], v[76:77] op_sel_hi:[1,0]
    v_pk_mul_f32 v[34:35], v[34:35], v[76:77] op_sel_hi:[1,0]
    v_cvt_pk_bf16_f32 v88, v32, v33
    v_cvt_pk_bf16_f32 v89, v34, v35
    v_pk_mul_f32 v[36:37], v[36:37], v[76:77] op_sel_hi:[1,0]
    v_pk_mul_f32 v[38:39], v[38:39], v[76:77] op_sel_hi:[1,0]
    v_cvt_pk_bf16_f32 v90, v36, v37
    v_cvt_pk_bf16_f32 v91, v38, v39
    v_mfma_f32_16x16x16_bf16 v[40:43], v[44:45], v[44:45], 0
    ds_write_b128 v123, v[88:91]
    v_mov_b32_dpp v88, v88 quad_perm:[0,1,0,1] row_mask:0xf bank_mask:0xf
    v_mov_b32_dpp v89, v89 quad_perm:[0,1,0,1] row_mask:0xf bank_mask:0xf
    v_mov_b32_dpp v90, v90 quad_perm:[0,1,0,1] row_mask:0xf bank_mask:0xf
    v_mov_b32_dpp v91, v91 quad_perm:[0,1,0,1] row_mask:0xf bank_mask:0xf
    s_waitcnt lgkmcnt(1)
    s_cmp_lg_u32 s21, 0
    v_smfmac_f32_16x16x64_bf16 v[48:51], v[88:91], v[0:7], v120
    v_and_b32_e64 v68, 0x30, v121
    v_smfmac_f32_16x16x64_bf16 v[52:55], v[88:91], v[8:15], v120
    v_min_u32_e64 v68, 1, v68
    s_waitcnt lgkmcnt(0)
    s_barrier
    ds_read_b128 v[92:95], v65
    ds_read_b128 v[96:99], v66
    ds_read_b128 v[100:103], v67
    v_smfmac_f32_16x16x64_bf16 v[56:59], v[88:91], v[16:23], v120
    v_xor_b32_e64 v68, 1, v68
    v_smfmac_f32_16x16x64_bf16 v[60:63], v[88:91], v[24:31], v120
    s_cbranch_scc1 NR_138
    s_waitcnt lgkmcnt(2)
    v_smfmac_f32_16x16x64_bf16 v[48:51], v[92:95], a[192:199], v120
    ds_read_b128 v[0:3], v122 offset:8192
    ds_read_b128 v[4:7], v122 offset:9216
    s_waitcnt lgkmcnt(3)
    v_smfmac_f32_16x16x64_bf16 v[48:51], v[96:99], a[200:207], v120
    ds_read_b128 v[8:11], v122 offset:10240
    ds_read_b128 v[12:15], v122 offset:11264
    s_waitcnt lgkmcnt(4)
    v_smfmac_f32_16x16x64_bf16 v[48:51], v[100:103], a[208:215], v120
    ds_read_b128 v[16:19], v122 offset:12288
    ds_read_b128 v[20:23], v122 offset:13312
    v_smfmac_f32_16x16x64_bf16 v[52:55], v[92:95], a[216:223], v120
    ds_read_b128 v[24:27], v122 offset:14336
    ds_read_b128 v[28:31], v122 offset:15360
    v_smfmac_f32_16x16x64_bf16 v[52:55], v[96:99], a[224:231], v120
    s_nop 1
    v_cvt_pk_bf16_f32 v48, v48, v49
    v_or_b32 v48, v68, v48
    v_smfmac_f32_16x16x64_bf16 v[52:55], v[100:103], a[232:239], v120
    buffer_store_dword v48, v126, s[56:59], 0 offen offset:0 sc1
    s_nop 0
    v_cvt_pk_bf16_f32 v49, v50, v51
    v_or_b32 v49, v68, v49
    v_smfmac_f32_16x16x64_bf16 v[56:59], v[92:95], a[240:247], v120
    buffer_store_dword v49, v126, s[56:59], 0 offen offset:64 sc1
    s_nop 0
    v_smfmac_f32_16x16x64_bf16 v[56:59], v[96:99], a[248:255], v120
    s_nop 1
    v_cvt_pk_bf16_f32 v52, v52, v53
    v_or_b32 v52, v68, v52
    s_waitcnt lgkmcnt(6)
    v_smfmac_f32_16x16x64_bf16 v[56:59], v[100:103], v[0:7], v120
    buffer_store_dword v52, v126, s[56:59], 0 offen offset:128 sc1
    s_nop 0
    v_cvt_pk_bf16_f32 v53, v54, v55
    v_or_b32_e64 v53, v68, v53
    s_waitcnt lgkmcnt(0)
    v_smfmac_f32_16x16x64_bf16 v[60:63], v[92:95], v[8:15], v120
    buffer_store_dword v53, v126, s[56:59], 0 offen offset:192 sc1
    s_nop 0
    v_cvt_pk_bf16_f32 v56, v56, v57
    v_or_b32 v56, v68, v56
    v_smfmac_f32_16x16x64_bf16 v[60:63], v[96:99], v[16:23], v120
    buffer_store_dword v56, v126, s[60:63], 0 offen offset:0 sc1
    s_nop 0
    v_cvt_pk_bf16_f32 v57, v58, v59
    v_or_b32 v57, v68, v57
    v_smfmac_f32_16x16x64_bf16 v[60:63], v[100:103], v[24:31], v120
    buffer_store_dword v57, v126, s[60:63], 0 offen offset:64 sc1
    s_nop 0
    s_nop 5
    v_cvt_pk_bf16_f32 v60, v60, v61
    v_or_b32_e64 v60, v68, v60
    buffer_store_dword v60, v126, s[60:63], 0 offen offset:128 sc1
    v_cvt_pk_bf16_f32 v61, v62, v63
    v_or_b32_e64 v61, v68, v61
    buffer_store_dword v61, v126, s[60:63], 0 offen offset:192 sc1
    v_mov_b64_e64 v[100:101], -1
    ds_read_b128 v[88:91], v121 offset:30720
    buffer_store_dwordx2 v[100:101], v127, s[48:51], s25 offen sc1
    v_mov_b64 v[64:65], 0
    v_mov_b64 v[66:67], 0
    v_mov_b64 v[68:69], 0
    v_mov_b64 v[70:71], 0
    v_mov_b64 v[72:73], 0
    v_mov_b64 v[74:75], 0
    v_mov_b64 v[76:77], 0
    v_mov_b64 v[78:79], 0
    v_mov_b64 v[80:81], 0
    v_mov_b64 v[82:83], 0
    v_mov_b64 v[84:85], 0
    v_mov_b64 v[86:87], 0
    v_add_u32_e64 v92, s29, v121
    v_xor_b32 v93, 1024, v92
    v_xor_b32 v94, 2048, v92
    v_xor_b32 v95, 3072, v92
    s_mov_b32 s32, s25
    s_mov_b32 s25, s23
    s_mov_b32 s23, s24
    s_mov_b32 s24, s32
    s_waitcnt vmcnt(7)
    s_cmp_lt_u32 s20, 16
    s_cbranch_scc1 RE_139
    s_waitcnt vmcnt(2)
RE_139:
    buffer_load_dwordx4 v[0:3], v121, s[64:67], 0 offen offset:0 sc1
    buffer_load_dwordx4 v[4:7], v121, s[64:67], 0 offen offset:1024 sc1
    buffer_load_dwordx4 v[8:11], v121, s[64:67], 0 offen offset:2048 sc1
    buffer_load_dwordx4 v[12:15], v121, s[64:67], 0 offen offset:3072 sc1
    buffer_load_dwordx4 v[16:19], v121, s[68:71], 0 offen offset:0 sc1
    buffer_load_dwordx4 v[20:23], v121, s[68:71], 0 offen offset:1024 sc1
    buffer_load_dwordx4 v[24:27], v121, s[68:71], 0 offen offset:2048 sc1
    buffer_load_dwordx4 v[28:31], v121, s[68:71], 0 offen offset:3072 sc1
    v_mov_b32 v102, 0
    s_nop 1
    v_mov_b32 v102, 0
    s_nop 1
    v_mov_b32 v102, 0
    s_nop 0
    buffer_load_dwordx4 v[32:35], v121, s[64:67], 0 offen offset:0 sc1
    buffer_load_dwordx4 v[36:39], v121, s[64:67], 0 offen offset:1024 sc1
    buffer_load_dwordx4 v[40:43], v121, s[64:67], 0 offen offset:2048 sc1
    buffer_load_dwordx4 v[44:47], v121, s[64:67], 0 offen offset:3072 sc1
    buffer_load_dwordx4 v[48:51], v121, s[68:71], 0 offen offset:0 sc1
    buffer_load_dwordx4 v[52:55], v121, s[68:71], 0 offen offset:1024 sc1
    buffer_load_dwordx4 v[56:59], v121, s[68:71], 0 offen offset:2048 sc1
    buffer_load_dwordx4 v[60:63], v121, s[68:71], 0 offen offset:3072 sc1
    s_add_u32 s88, s48, s23
    s_addc_u32 s89, s49, 0
    s_add_u32 s92, s52, s23
    s_addc_u32 s93, s53, 0
    s_add_u32 s76, s4, s26
    s_addc_u32 s77, s5, 0
    s_add_u32 s80, s4, s27
    s_addc_u32 s81, s5, 0
    s_add_u32 s84, s4, s28
    s_addc_u32 s85, s5, 0
    s_waitcnt lgkmcnt(0)
    s_waitcnt vmcnt(15)
    v_mfma_f32_16x16x32_bf16 v[96:99], v[0:3], v[88:91], 0
    s_waitcnt vmcnt(14)
    v_mfma_f32_16x16x32_bf16 v[96:99], v[4:7], v[88:91], v[96:99]
    v_and_b32_e64 v102, v0, v4
    s_waitcnt vmcnt(13)
    v_mfma_f32_16x16x32_bf16 v[96:99], v[8:11], v[88:91], v[96:99]
    s_waitcnt vmcnt(12)
    v_mfma_f32_16x16x32_bf16 v[96:99], v[12:15], v[88:91], v[96:99]
    v_bitop3_b32 v102, v102, v8, v12 bitop3:0x80
    s_waitcnt vmcnt(11)
    v_mfma_f32_16x16x32_bf16 v[96:99], v[16:19], v[88:91], v[96:99]
    s_waitcnt vmcnt(10)
    v_mfma_f32_16x16x32_bf16 v[96:99], v[20:23], v[88:91], v[96:99]
    v_bitop3_b32 v102, v102, v16, v20 bitop3:0x80
    s_waitcnt vmcnt(9)
    v_mfma_f32_16x16x32_bf16 v[96:99], v[24:27], v[88:91], v[96:99]
    v_and_b32 v102, v102, v24
    s_waitcnt vmcnt(8)
    v_mfma_f32_16x16x32_bf16 v[96:99], v[28:31], v[88:91], v[96:99]
    v_bitop3_b32 v102, v102, v28, 1 bitop3:0x80
    v_cmp_ne_u32 vcc, 1, v102
    s_nop 5
    v_cvt_pk_bf16_f32 v100, v96, v97
    v_cvt_pk_bf16_f32 v101, v98, v99
    s_cbranch_vccnz RL_140
RK_141:
    buffer_store_dwordx2 v[100:101], v127, s[88:91], 0 offen sc1
JN_142:
    s_barrier
    v_mov_b32 v102, 0
    s_nop 1
    v_mov_b32 v102, 0
    s_nop 0
    s_cmp_ge_u32 s20, 16
    s_cbranch_scc1 DE_143
    v_mov_b32 v102, 0
    s_nop 1
    v_mov_b32 v102, 0
    s_nop 1
    v_mov_b32 v102, 0
    s_nop 1
    v_mov_b32 v102, 0
    s_nop 1
    v_mov_b32 v102, 0
    s_nop 1
    v_mov_b32 v102, 0
    s_nop 1
    v_mov_b32 v102, 0
    s_nop 1
    v_mov_b32 v102, 0
    s_nop 1
    v_mov_b32 v102, 0
    s_nop 1
    v_mov_b32 v102, 0
    s_nop 1
    v_mov_b32 v102, 0
    s_nop 1
    v_mov_b32 v102, 0
    s_nop 0
DE_143:
    s_branch STEP_121
.p2align 3
HF_123:
    buffer_load_dwordx4 v[0:3], v92, s[88:91], 0 offen sc1
    s_nop 5
    v_mov_b64 v[72:73], 0
    v_mov_b64 v[74:75], 0
    s_waitcnt vmcnt(2)
    v_max3_u32 v88, v0, v1, v2
    v_max_u32 v88, v88, v3
    v_cmp_eq_u32 vcc, -1, v88
    s_sub_u32 s30, s30, 8
    s_cbranch_vccz H2_122
HB_144:
    buffer_load_dwordx4 v[0:3], v92, s[88:91], 0 offen sc1
    s_sub_u32 s30, s30, 8
    s_cbranch_scc1 L_FAIL2
    s_waitcnt vmcnt(1)
    v_max3_u32 v88, v0, v1, v2
    v_max_u32 v88, v88, v3
    v_cmp_eq_u32 vcc, -1, v88
    s_cbranch_vccnz HB_144
    s_branch H2_122
.p2align 3
HG_125:
    buffer_load_dwordx4 v[4:7], v92, s[92:95], 0 offen sc1
    s_waitcnt vmcnt(1)
    v_max3_u32 v88, v4, v5, v6
    v_max_u32 v88, v88, v7
    v_cmp_eq_u32_e64 vcc, -1, v88
    s_sub_u32 s30, s30, 8
    s_cbranch_vccz H3_124
HB_145:
    buffer_load_dwordx4 v[4:7], v92, s[92:95], 0 offen sc1
    s_sub_u32 s30, s30, 8
    s_cbranch_scc1 L_FAIL2
    s_waitcnt vmcnt(1)
    v_max3_u32 v88, v4, v5, v6
    v_max_u32 v88, v88, v7
    v_cmp_eq_u32 vcc, -1, v88
    s_cbranch_vccnz HB_145
    s_branch H3_124
.p2align 3
RL_128:
    s_sub_u32 s30, s30, 8
    s_cbranch_scc1 L_FAIL2
    s_waitcnt vmcnt(7)
    v_mfma_f32_16x16x32_bf16 v[96:99], v[32:35], v[88:91], 0
    buffer_load_dwordx4 v[0:3], v121, s[64:67], 0 offen offset:0 sc1
    s_waitcnt vmcnt(7)
    v_mfma_f32_16x16x32_bf16 v[96:99], v[36:39], v[88:91], v[96:99]
    buffer_load_dwordx4 v[4:7], v121, s[64:67], 0 offen offset:1024 sc1
    v_or_b32 v102, v32, v36
    s_waitcnt vmcnt(7)
    v_mfma_f32_16x16x32_bf16 v[96:99], v[40:43], v[88:91], v[96:99]
    buffer_load_dwordx4 v[8:11], v121, s[64:67], 0 offen offset:2048 sc1
    s_waitcnt vmcnt(7)
    v_mfma_f32_16x16x32_bf16 v[96:99], v[44:47], v[88:91], v[96:99]
    buffer_load_dwordx4 v[12:15], v121, s[64:67], 0 offen offset:3072 sc1
    v_bitop3_b32 v102, v102, v40, v44 bitop3:0xfe
    s_waitcnt vmcnt(7)
    v_mfma_f32_16x16x32_bf16 v[96:99], v[48:51], v[88:91], v[96:99]
    buffer_load_dwordx4 v[16:19], v121, s[68:71], 0 offen offset:0 sc1
    s_waitcnt vmcnt(7)
    v_mfma_f32_16x16x32_bf16 v[96:99], v[52:55], v[88:91], v[96:99]
    buffer_load_dwordx4 v[20:23], v121, s[68:71], 0 offen offset:1024 sc1
    v_bitop3_b32 v102, v102, v48, v52 bitop3:0xfe
    s_waitcnt vmcnt(7)
    v_mfma_f32_16x16x32_bf16 v[96:99], v[56:59], v[88:91], v[96:99]
    buffer_load_dwordx4 v[24:27], v121, s[68:71], 0 offen offset:2048 sc1
    v_or_b32 v102, v102, v56
    s_waitcnt vmcnt(7)
    v_mfma_f32_16x16x32_bf16 v[96:99], v[60:63], v[88:91], v[96:99]
    buffer_load_dwordx4 v[28:31], v121, s[68:71], 0 offen offset:3072 sc1
    v_bitop3_b32 v102, v102, v60, 1 bitop3:0xa8
    v_cmp_ne_u32 vcc, 0, v102
    s_nop 4
    v_cvt_pk_bf16_f32 v100, v96, v97
    v_cvt_pk_bf16_f32 v101, v98, v99
    s_cbranch_vccz RK_129
    s_sub_u32 s30, s30, 8
    s_cbranch_scc1 L_FAIL2
    s_waitcnt vmcnt(7)
    v_mfma_f32_16x16x32_bf16 v[96:99], v[0:3], v[88:91], 0
    buffer_load_dwordx4 v[32:35], v121, s[64:67], 0 offen offset:0 sc1
    s_waitcnt vmcnt(7)
    v_mfma_f32_16x16x32_bf16 v[96:99], v[4:7], v[88:91], v[96:99]
    buffer_load_dwordx4 v[36:39], v121, s[64:67], 0 offen offset:1024 sc1
    v_or_b32_e64 v102, v0, v4
    s_waitcnt vmcnt(7)
    v_mfma_f32_16x16x32_bf16 v[96:99], v[8:11], v[88:91], v[96:99]
    buffer_load_dwordx4 v[40:43], v121, s[64:67], 0 offen offset:2048 sc1
    s_waitcnt vmcnt(7)
    v_mfma_f32_16x16x32_bf16 v[96:99], v[12:15], v[88:91], v[96:99]
    buffer_load_dwordx4 v[44:47], v121, s[64:67], 0 offen offset:3072 sc1
    v_bitop3_b32 v102, v102, v8, v12 bitop3:0xfe
    s_waitcnt vmcnt(7)
    v_mfma_f32_16x16x32_bf16 v[96:99], v[16:19], v[88:91], v[96:99]
    buffer_load_dwordx4 v[48:51], v121, s[68:71], 0 offen offset:0 sc1
    s_waitcnt vmcnt(7)
    v_mfma_f32_16x16x32_bf16 v[96:99], v[20:23], v[88:91], v[96:99]
    buffer_load_dwordx4 v[52:55], v121, s[68:71], 0 offen offset:1024 sc1
    v_bitop3_b32 v102, v102, v16, v20 bitop3:0xfe
    s_waitcnt vmcnt(7)
    v_mfma_f32_16x16x32_bf16 v[96:99], v[24:27], v[88:91], v[96:99]
    buffer_load_dwordx4 v[56:59], v121, s[68:71], 0 offen offset:2048 sc1
    v_or_b32 v102, v102, v24
    s_waitcnt vmcnt(7)
    v_mfma_f32_16x16x32_bf16 v[96:99], v[28:31], v[88:91], v[96:99]
    buffer_load_dwordx4 v[60:63], v121, s[68:71], 0 offen offset:3072 sc1
    v_bitop3_b32 v102, v102, v28, 1 bitop3:0xa8
    v_cmp_ne_u32 vcc, 0, v102
    s_nop 4
    v_cvt_pk_bf16_f32 v100, v96, v97
    v_cvt_pk_bf16_f32 v101, v98, v99
    s_cbranch_vccnz RL_128
    s_branch RK_129
.p2align 3
NR_126:
    s_waitcnt lgkmcnt(2)
    v_smfmac_f32_16x16x64_bf16 v[48:51], v[92:95], a[192:199], v120
    ds_read_b128 v[0:3], v122 offset:8192
    ds_read_b128 v[4:7], v122 offset:9216
    s_waitcnt lgkmcnt(3)
    v_smfmac_f32_16x16x64_bf16 v[48:51], v[96:99], a[200:207], v120
    ds_read_b128 v[8:11], v122 offset:10240
    ds_read_b128 v[12:15], v122 offset:11264
    s_waitcnt lgkmcnt(4)
    v_smfmac_f32_16x16x64_bf16 v[48:51], v[100:103], a[208:215], v120
    ds_read_b128 v[16:19], v122 offset:12288
    ds_read_b128 v[20:23], v122 offset:13312
    v_smfmac_f32_16x16x64_bf16 v[52:55], v[92:95], a[216:223], v120
    ds_read_b128 v[24:27], v122 offset:14336
    ds_read_b128 v[28:31], v122 offset:15360
    v_smfmac_f32_16x16x64_bf16 v[52:55], v[96:99], a[224:231], v120
    s_nop 1
    v_cvt_pk_bf16_f32 v48, v48, v49
    v_and_b32_e64 v48, v68, v48
    v_smfmac_f32_16x16x64_bf16 v[52:55], v[100:103], a[232:239], v120
    buffer_store_dword v48, v126, s[56:59], 0 offen offset:0 sc1
    s_nop 0
    v_cvt_pk_bf16_f32 v49, v50, v51
    v_and_b32 v49, v68, v49
    v_smfmac_f32_16x16x64_bf16 v[56:59], v[92:95], a[240:247], v120
    buffer_store_dword v49, v126, s[56:59], 0 offen offset:64 sc1
    s_nop 0
    v_smfmac_f32_16x16x64_bf16 v[56:59], v[96:99], a[248:255], v120
    s_nop 1
    v_cvt_pk_bf16_f32 v52, v52, v53
    v_and_b32 v52, v68, v52
    s_waitcnt lgkmcnt(6)
    v_smfmac_f32_16x16x64_bf16 v[56:59], v[100:103], v[0:7], v120
    buffer_store_dword v52, v126, s[56:59], 0 offen offset:128 sc1
    s_nop 0
    v_cvt_pk_bf16_f32 v53, v54, v55
    v_and_b32_e64 v53, v68, v53
    s_waitcnt lgkmcnt(0)
    v_smfmac_f32_16x16x64_bf16 v[60:63], v[92:95], v[8:15], v120
    buffer_store_dword v53, v126, s[56:59], 0 offen offset:192 sc1
    s_nop 0
    v_cvt_pk_bf16_f32 v56, v56, v57
    v_and_b32 v56, v68, v56
    v_smfmac_f32_16x16x64_bf16 v[60:63], v[96:99], v[16:23], v120
    buffer_store_dword v56, v126, s[60:63], 0 offen offset:0 sc1
    s_nop 0
    v_cvt_pk_bf16_f32 v57, v58, v59
    v_and_b32 v57, v68, v57
    v_smfmac_f32_16x16x64_bf16 v[60:63], v[100:103], v[24:31], v120
    buffer_store_dword v57, v126, s[60:63], 0 offen offset:64 sc1
    s_nop 0
    s_nop 5
    v_cvt_pk_bf16_f32 v60, v60, v61
    v_and_b32_e64 v60, v68, v60
    buffer_store_dword v60, v126, s[60:63], 0 offen offset:128 sc1
    v_cvt_pk_bf16_f32 v61, v62, v63
    v_and_b32_e64 v61, v68, v61
    buffer_store_dword v61, v126, s[60:63], 0 offen offset:192 sc1
    v_mov_b64 v[64:65], 0
    v_mov_b64 v[66:67], 0
    v_mov_b64 v[68:69], 0
    v_mov_b64 v[70:71], 0
    v_mov_b64 v[72:73], 0
    v_mov_b64 v[74:75], 0
    v_mov_b64 v[76:77], 0
    v_mov_b64 v[78:79], 0
    v_mov_b64 v[80:81], 0
    v_mov_b64 v[82:83], 0
    v_mov_b64 v[84:85], 0
    v_mov_b64 v[86:87], 0
    v_add_u32_e64 v92, s29, v121
    v_xor_b32 v93, 1024, v92
    v_xor_b32 v94, 2048, v92
    v_xor_b32 v95, 3072, v92
    s_mov_b32 s32, s25
    s_mov_b32 s25, s23
    s_mov_b32 s23, s24
    s_mov_b32 s24, s32
    s_add_u32 s88, s48, s23
    s_addc_u32 s89, s49, 0
    s_add_u32 s92, s52, s23
    s_addc_u32 s93, s53, 0
    s_add_u32 s76, s4, s26
    s_addc_u32 s77, s5, 0
    s_add_u32 s80, s4, s27
    s_addc_u32 s81, s5, 0
    s_add_u32 s84, s4, s28
    s_addc_u32 s85, s5, 0
    s_waitcnt lgkmcnt(0)
    s_cmp_eq_u64 s[12:13], s[38:39]
    s_cbranch_scc0 KE_146
KF_147:
    s_waitcnt vmcnt(0)
    s_branch JN_130
.p2align 3
HF_135:
    buffer_load_dwordx4 v[0:3], v92, s[88:91], 0 offen sc1
    s_nop 5
    v_mov_b64 v[72:73], 0
    v_mov_b64 v[74:75], 0
    s_waitcnt vmcnt(2)
    v_max3_u32 v88, v0, v1, v2
    v_max_u32 v88, v88, v3
    v_cmp_eq_u32 vcc, -1, v88
    s_sub_u32 s30, s30, 8
    s_cbranch_vccz H2_134
HB_148:
    buffer_load_dwordx4 v[0:3], v92, s[88:91], 0 offen sc1
    s_sub_u32 s30, s30, 8
    s_cbranch_scc1 L_FAIL2
    s_waitcnt vmcnt(1)
    v_max3_u32 v88, v0, v1, v2
    v_max_u32 v88, v88, v3
    v_cmp_eq_u32 vcc, -1, v88
    s_cbranch_vccnz HB_148
    s_branch H2_134
.p2align 3
HG_137:
    buffer_load_dwordx4 v[4:7], v92, s[92:95], 0 offen sc1
    s_waitcnt vmcnt(1)
    v_max3_u32 v88, v4, v5, v6
    v_max_u32 v88, v88, v7
    v_cmp_eq_u32_e64 vcc, -1, v88
    s_sub_u32 s30, s30, 8
    s_cbranch_vccz H3_136
HB_149:
    buffer_load_dwordx4 v[4:7], v92, s[92:95], 0 offen sc1
    s_sub_u32 s30, s30, 8
    s_cbranch_scc1 L_FAIL2
    s_waitcnt vmcnt(1)
    v_max3_u32 v88, v4, v5, v6
    v_max_u32 v88, v88, v7
    v_cmp_eq_u32 vcc, -1, v88
    s_cbranch_vccnz HB_149
    s_branch H3_136
.p2align 3
RL_140:
    s_sub_u32 s30, s30, 8
    s_cbranch_scc1 L_FAIL2
    s_waitcnt vmcnt(7)
    v_mfma_f32_16x16x32_bf16 v[96:99], v[32:35], v[88:91], 0
    buffer_load_dwordx4 v[0:3], v121, s[64:67], 0 offen offset:0 sc1
    s_waitcnt vmcnt(7)
    v_mfma_f32_16x16x32_bf16 v[96:99], v[36:39], v[88:91], v[96:99]
    buffer_load_dwordx4 v[4:7], v121, s[64:67], 0 offen offset:1024 sc1
    v_and_b32 v102, v32, v36
    s_waitcnt vmcnt(7)
    v_mfma_f32_16x16x32_bf16 v[96:99], v[40:43], v[88:91], v[96:99]
    buffer_load_dwordx4 v[8:11], v121, s[64:67], 0 offen offset:2048 sc1
    s_waitcnt vmcnt(7)
    v_mfma_f32_16x16x32_bf16 v[96:99], v[44:47], v[88:91], v[96:99]
    buffer_load_dwordx4 v[12:15], v121, s[64:67], 0 offen offset:3072 sc1
    v_bitop3_b32 v102, v102, v40, v44 bitop3:0x80
    s_waitcnt vmcnt(7)
    v_mfma_f32_16x16x32_bf16 v[96:99], v[48:51], v[88:91], v[96:99]
    buffer_load_dwordx4 v[16:19], v121, s[68:71], 0 offen offset:0 sc1
    s_waitcnt vmcnt(7)
    v_mfma_f32_16x16x32_bf16 v[96:99], v[52:55], v[88:91], v[96:99]
    buffer_load_dwordx4 v[20:23], v121, s[68:71], 0 offen offset:1024 sc1
    v_bitop3_b32 v102, v102, v48, v52 bitop3:0x80
    s_waitcnt vmcnt(7)
    v_mfma_f32_16x16x32_bf16 v[96:99], v[56:59], v[88:91], v[96:99]
    buffer_load_dwordx4 v[24:27], v121, s[68:71], 0 offen offset:2048 sc1
    v_and_b32 v102, v102, v56
    s_waitcnt vmcnt(7)
    v_mfma_f32_16x16x32_bf16 v[96:99], v[60:63], v[88:91], v[96:99]
    buffer_load_dwordx4 v[28:31], v121, s[68:71], 0 offen offset:3072 sc1
    v_bitop3_b32 v102, v102, v60, 1 bitop3:0x80
    v_cmp_ne_u32 vcc, 1, v102
    s_nop 4
    v_cvt_pk_bf16_f32 v100, v96, v97
    v_cvt_pk_bf16_f32 v101, v98, v99
    s_cbranch_vccz RK_141
    s_sub_u32 s30, s30, 8
    s_cbranch_scc1 L_FAIL2
    s_waitcnt vmcnt(7)
    v_mfma_f32_16x16x32_bf16 v[96:99], v[0:3], v[88:91], 0
    buffer_load_dwordx4 v[32:35], v121, s[64:67], 0 offen offset:0 sc1
    s_waitcnt vmcnt(7)
    v_mfma_f32_16x16x32_bf16 v[96:99], v[4:7], v[88:91], v[96:99]
    buffer_load_dwordx4 v[36:39], v121, s[64:67], 0 offen offset:1024 sc1
    v_and_b32_e64 v102, v0, v4
    s_waitcnt vmcnt(7)
    v_mfma_f32_16x16x32_bf16 v[96:99], v[8:11], v[88:91], v[96:99]
    buffer_load_dwordx4 v[40:43], v121, s[64:67], 0 offen offset:2048 sc1
    s_waitcnt vmcnt(7)
    v_mfma_f32_16x16x32_bf16 v[96:99], v[12:15], v[88:91], v[96:99]
    buffer_load_dwordx4 v[44:47], v121, s[64:67], 0 offen offset:3072 sc1
    v_bitop3_b32 v102, v102, v8, v12 bitop3:0x80
    s_waitcnt vmcnt(7)
    v_mfma_f32_16x16x32_bf16 v[96:99], v[16:19], v[88:91], v[96:99]
    buffer_load_dwordx4 v[48:51], v121, s[68:71], 0 offen offset:0 sc1
    s_waitcnt vmcnt(7)
    v_mfma_f32_16x16x32_bf16 v[96:99], v[20:23], v[88:91], v[96:99]
    buffer_load_dwordx4 v[52:55], v121, s[68:71], 0 offen offset:1024 sc1
    v_bitop3_b32 v102, v102, v16, v20 bitop3:0x80
    s_waitcnt vmcnt(7)
    v_mfma_f32_16x16x32_bf16 v[96:99], v[24:27], v[88:91], v[96:99]
    buffer_load_dwordx4 v[56:59], v121, s[68:71], 0 offen offset:2048 sc1
    v_and_b32 v102, v102, v24
    s_waitcnt vmcnt(7)
    v_mfma_f32_16x16x32_bf16 v[96:99], v[28:31], v[88:91], v[96:99]
    buffer_load_dwordx4 v[60:63], v121, s[68:71], 0 offen offset:3072 sc1
    v_bitop3_b32 v102, v102, v28, 1 bitop3:0x80
    v_cmp_ne_u32 vcc, 1, v102
    s_nop 4
    v_cvt_pk_bf16_f32 v100, v96, v97
    v_cvt_pk_bf16_f32 v101, v98, v99
    s_cbranch_vccnz RL_140
    s_branch RK_141
.p2align 3
NR_138:
    s_waitcnt lgkmcnt(2)
    v_smfmac_f32_16x16x64_bf16 v[48:51], v[92:95], a[192:199], v120
    ds_read_b128 v[0:3], v122 offset:8192
    ds_read_b128 v[4:7], v122 offset:9216
    s_waitcnt lgkmcnt(3)
    v_smfmac_f32_16x16x64_bf16 v[48:51], v[96:99], a[200:207], v120
    ds_read_b128 v[8:11], v122 offset:10240
    ds_read_b128 v[12:15], v122 offset:11264
    s_waitcnt lgkmcnt(4)
    v_smfmac_f32_16x16x64_bf16 v[48:51], v[100:103], a[208:215], v120
    ds_read_b128 v[16:19], v122 offset:12288
    ds_read_b128 v[20:23], v122 offset:13312
    v_smfmac_f32_16x16x64_bf16 v[52:55], v[92:95], a[216:223], v120
    ds_read_b128 v[24:27], v122 offset:14336
    ds_read_b128 v[28:31], v122 offset:15360
    v_smfmac_f32_16x16x64_bf16 v[52:55], v[96:99], a[224:231], v120
    s_nop 1
    v_cvt_pk_bf16_f32 v48, v48, v49
    v_or_b32_e64 v48, v68, v48
    v_smfmac_f32_16x16x64_bf16 v[52:55], v[100:103], a[232:239], v120
    buffer_store_dword v48, v126, s[56:59], 0 offen offset:0 sc1
    s_nop 0
    v_cvt_pk_bf16_f32 v49, v50, v51
    v_or_b32 v49, v68, v49
    v_smfmac_f32_16x16x64_bf16 v[56:59], v[92:95], a[240:247], v120
    buffer_store_dword v49, v126, s[56:59], 0 offen offset:64 sc1
    s_nop 0
    v_smfmac_f32_16x16x64_bf16 v[56:59], v[96:99], a[248:255], v120
    s_nop 1
    v_cvt_pk_bf16_f32 v52, v52, v53
    v_or_b32 v52, v68, v52
    s_waitcnt lgkmcnt(6)
    v_smfmac_f32_16x16x64_bf16 v[56:59], v[100:103], v[0:7], v120
    buffer_store_dword v52, v126, s[56:59], 0 offen offset:128 sc1
    s_nop 0
    v_cvt_pk_bf16_f32 v53, v54, v55
    v_or_b32_e64 v53, v68, v53
    s_waitcnt lgkmcnt(0)
    v_smfmac_f32_16x16x64_bf16 v[60:63], v[92:95], v[8:15], v120
    buffer_store_dword v53, v126, s[56:59], 0 offen offset:192 sc1
    s_nop 0
    v_cvt_pk_bf16_f32 v56, v56, v57
    v_or_b32 v56, v68, v56
    v_smfmac_f32_16x16x64_bf16 v[60:63], v[96:99], v[16:23], v120
    buffer_store_dword v56, v126, s[60:63], 0 offen offset:0 sc1
    s_nop 0
    v_cvt_pk_bf16_f32 v57, v58, v59
    v_or_b32 v57, v68, v57
    v_smfmac_f32_16x16x64_bf16 v[60:63], v[100:103], v[24:31], v120
    buffer_store_dword v57, v126, s[60:63], 0 offen offset:64 sc1
    s_nop 0
    s_nop 5
    v_cvt_pk_bf16_f32 v60, v60, v61
    v_or_b32_e64 v60, v68, v60
    buffer_store_dword v60, v126, s[60:63], 0 offen offset:128 sc1
    v_cvt_pk_bf16_f32 v61, v62, v63
    v_or_b32_e64 v61, v68, v61
    buffer_store_dword v61, v126, s[60:63], 0 offen offset:192 sc1
    v_mov_b64 v[64:65], 0
    v_mov_b64 v[66:67], 0
    v_mov_b64 v[68:69], 0
    v_mov_b64 v[70:71], 0
    v_mov_b64 v[72:73], 0
    v_mov_b64 v[74:75], 0
    v_mov_b64 v[76:77], 0
    v_mov_b64 v[78:79], 0
    v_mov_b64 v[80:81], 0
    v_mov_b64 v[82:83], 0
    v_mov_b64 v[84:85], 0
    v_mov_b64 v[86:87], 0
    v_add_u32_e64 v92, s29, v121
    v_xor_b32 v93, 1024, v92
    v_xor_b32 v94, 2048, v92
    v_xor_b32 v95, 3072, v92
    s_mov_b32 s32, s25
    s_mov_b32 s25, s23
    s_mov_b32 s23, s24
    s_mov_b32 s24, s32
    s_add_u32 s88, s48, s23
    s_addc_u32 s89, s49, 0
    s_add_u32 s92, s52, s23
    s_addc_u32 s93, s53, 0
    s_add_u32 s76, s4, s26
    s_addc_u32 s77, s5, 0
    s_add_u32 s80, s4, s27
    s_addc_u32 s81, s5, 0
    s_add_u32 s84, s4, s28
    s_addc_u32 s85, s5, 0
    s_add_u32 s31, s31, 128
    s_buffer_load_dwordx2 s[12:13], s[4:7], s31
    s_waitcnt vmcnt(0)
    s_branch JN_142
.p2align 3
KE_146:
    s_cmp_eq_u32 s22, 63
    s_cbranch_scc1 KF_147
KP_150:
    v_mov_b32_e64 v98, 0
    buffer_load_dwordx2 v[96:97], v98, s[4:7], s31 offen sc1
    s_sub_u32 s30, s30, 16
    s_cbranch_scc1 L_FAIL2
    s_waitcnt vmcnt(0)
    v_cmp_ne_u64 vcc, s[38:39], v[96:97]
    s_cbranch_vccnz KP_150
    s_branch KF_147
L_EXIT:
    s_waitcnt vmcnt(0)
    s_endpgm
L_LAST:
L_FAIL2:
    v_mov_b32 v20, 0xdeae
    v_mov_b32 v21, 20
    buffer_store_dword v20, v21, s[16:19], 0 offen
    s_waitcnt vmcnt(0)
    s_endpgm
.section .rodata,"a"
.p2align 6
.amdhsa_kernel recurrent_scan__memory_aug_recurrent_mem_tr__glu_gated_reglu__prompt_kernel
  .amdhsa_next_free_vgpr 512
  .amdhsa_next_free_sgpr 102
  .amdhsa_accum_offset 256
  .amdhsa_group_segment_fixed_size 0
  .amdhsa_kernarg_size 112
  .amdhsa_user_sgpr_count 2
  .amdhsa_user_sgpr_kernarg_segment_ptr 1
  .amdhsa_system_sgpr_workgroup_id_x 1
.end_amdhsa_kernel
```
